```python
import torch

def _softmax(x, axis=-1):
    return torch.softmax(x, dim=axis)
def _gelu(x):
    return torch.nn.functional.gelu(x, approximate="tanh")
def _silu(x):
    return torch.nn.functional.silu(x)
def _sigmoid(x):
    return torch.sigmoid(x)
def _layernorm(x, axis=-1, eps=1e-5):
    m = x.mean(dim=axis, keepdim=True)
    v = x.var(dim=axis, keepdim=True, unbiased=False)
    return (x - m) / torch.sqrt(v + eps)
def _scatter_add(tgt, idx, src, axis=0):
    return tgt.clone().index_add_(axis, idx, src)
def _segment_sum(src, seg, n):
    out = torch.zeros((n,) + src.shape[1:], dtype=src.dtype)
    return out.index_add_(0, seg, src)
def _pad(x, pw):
    flat = tuple(v for pair in reversed(pw) for v in pair)
    return torch.nn.functional.pad(x, flat)

kernel_name = 'standalone__gqa_softmax__near_ridge'

def setup_inputs():

    _w = (lambda a: (lambda t: t.to(torch.bfloat16) if t.is_floating_point() else t)(torch.as_tensor(a)))
    B, Hq, Hkv, Sq, Sk, D = 16, 32, 32, 736, 512, 128
    return {
        "q": _w((lambda *s: torch.randn(*s, dtype=torch.bfloat16) * 0.8)(B, Hq, Sq, D)),
        "k": _w((lambda *s: torch.randn(*s, dtype=torch.bfloat16) * 0.8)(B, Hkv, Sk, D)),
        "v": _w((lambda *s: torch.randn(*s, dtype=torch.bfloat16) * 0.05)(B, Hkv, Sk, D)),
    }

def reference(q, k, v):
    B, Hq, Sq, D = q.shape
    Hkv = k.shape[1]
    rep = Hq // Hkv
    k = (lambda x, n, axis: torch.repeat_interleave(x, n, dim=axis))(k, rep, axis=1)
    v = (lambda x, n, axis: torch.repeat_interleave(x, n, dim=axis))(v, rep, axis=1)
    scale = D ** -0.5
    scores = torch.einsum("bhqd,bhkd->bhqk", q, k) * scale
    p = _softmax(scores, axis=-1)
    return torch.einsum("bhqk,bhkd->bhqd", p, v)
```

```asm
; @launch grid=(256,1,1) block=(256,1,1) lds=163840
.amdgcn_target "amdgcn-amd-amdhsa--gfx950"
.text
.globl standalone__gqa_softmax__near_ridge_kernel
.p2align 12
.p2align 8
.type standalone__gqa_softmax__near_ridge_kernel,@function
standalone__gqa_softmax__near_ridge_kernel:
    s_cmp_ge_u32 s2, 256
    s_cbranch_scc1 L_end
    s_load_dwordx4 s[48:51], s[0:1], 0
    s_load_dwordx4 s[52:55], s[0:1], 16
    v_lshrrev_b32 v1, 6, v0
    v_and_b32 v0, 63, v0
    s_and_b32 s38, s2, 7
    v_readfirstlane_b32 s40, v1
    s_lshr_b32 s37, s2, 3
    s_mov_b32 s33, 0
    s_mov_b32 s34, 0
    s_mov_b32 s20, 1040356334
    s_mov_b32 s21, 1602224128
    s_lshl_b32 s35, s40, 11
    s_mul_i32 s36, s40, 6
    s_lshl_b32 s30, s36, 12
    s_add_u32 s30, s30, 65536
    s_lshr_b32 s41, s40, 1
    s_sub_u32 s58, 24, s41
    s_lshl_b32 s41, s33, 5
    s_add_u32 s41, s41, s37
    s_lshr_b32 s42, s41, 1
    s_xor_b32 s43, s33, s37
    s_and_b32 s43, s43, 1
    s_mul_i32 s44, s43, s58
    s_mul_i32 s43, s43, 22
    s_add_u32 s43, s43, 24
    s_lshl_b32 s42, s42, 3
    s_add_u32 s42, s42, s38
    s_lshl_b32 s23, s42, 17
    s_mul_i32 s42, s42, 46
    s_add_u32 s44, s44, s36
    s_add_u32 s44, s44, s42
    s_lshl_b32 s24, s44, 12
    s_add_u32 s43, s43, s42
    s_lshl_b32 s43, s43, 12
    s_min_u32 s25, s43, 96468992
    v_and_b32 v28, 15, v0
    v_lshrrev_b32 v29, 4, v0
    v_xor_b32 v30, v28, v29
    v_lshlrev_b32 v30, 4, v30
    v_lshl_add_u32 v14, v29, 8, v30
    v_xor_b32 v15, 64, v14
    v_xor_b32 v16, 0x80, v14
    v_xor_b32 v17, 0xc0, v14
    s_lshl_b32 s41, s40, 6
    v_xor_b32 v18, s41, v14
    v_add_u32 v18, s35, v18
    v_lshlrev_b32 v31, 2, v29
    v_xor_b32 v31, v31, v28
    v_lshlrev_b32 v31, 4, v31
    v_lshl_add_u32 v19, v29, 8, v31
    v_add_u32 v19, s35, v19
    s_waitcnt lgkmcnt(0)
    s_mov_b32 s4, s48
    s_mov_b32 s5, s49
    s_mov_b32 s6, s25
    s_mov_b32 s7, 0x20000
    s_mov_b32 s8, s50
    s_mov_b32 s9, s51
    s_mov_b32 s10, 67108864
    s_mov_b32 s11, 0x20000
    s_mov_b32 s12, s52
    s_mov_b32 s13, s53
    s_mov_b32 s14, 67108864
    s_mov_b32 s15, 0x20000
    s_mov_b32 s16, s54
    s_mov_b32 s17, s55
    s_mov_b32 s18, 0
    s_mov_b32 s19, 0x20000
    s_mov_b32 s31, 0
    s_mov_b32 s32, 0
    s_mov_b32 s22, s23
    s_add_u32 m0, s35, 0
    s_nop 0
    buffer_load_dwordx4 v18, s[8:11], s22 offen lds
    buffer_load_dwordx4 v18, s[8:11], s22 offen offset:1024 lds
    s_add_u32 m0, s30, 0
    s_add_u32 s28, s24, 0
    buffer_load_dwordx4 v14, s[4:7], s28 offen nt lds
    buffer_load_dwordx4 v15, s[4:7], s28 offen offset:1024 nt lds
    buffer_load_dwordx4 v16, s[4:7], s28 offen offset:2048 nt lds
    buffer_load_dwordx4 v17, s[4:7], s28 offen offset:3072 nt lds
    s_add_u32 m0, s35, 32768
    s_nop 0
    buffer_load_dwordx4 v19, s[12:15], s22 offen lds
    buffer_load_dwordx4 v19, s[12:15], s22 offen offset:1024 lds
    s_xor_b32 s22, s22, 8192
    s_add_u32 m0, s30, 4096
    s_add_u32 s28, s24, 4096
    buffer_load_dwordx4 v14, s[4:7], s28 offen nt lds
    buffer_load_dwordx4 v15, s[4:7], s28 offen offset:1024 nt lds
    buffer_load_dwordx4 v16, s[4:7], s28 offen offset:2048 nt lds
    buffer_load_dwordx4 v17, s[4:7], s28 offen offset:3072 nt lds
    s_add_u32 m0, s30, 8192
    s_add_u32 s28, s24, 8192
    buffer_load_dwordx4 v14, s[4:7], s28 offen nt lds
    buffer_load_dwordx4 v15, s[4:7], s28 offen offset:1024 nt lds
    buffer_load_dwordx4 v16, s[4:7], s28 offen offset:2048 nt lds
    buffer_load_dwordx4 v17, s[4:7], s28 offen offset:3072 nt lds
    s_and_b32 s41, s40, 1
    s_mul_i32 s51, s41, 0x480
    s_mul_i32 s42, s41, 24576
    s_sub_u32 s48, 20480, s42
    s_lshl_b32 s42, s42, 1
    s_sub_u32 s50, 24576, s42
    s_lshl_b32 s41, s41, 7
    s_add_u32 s49, s48, s41
    v_lshl_add_u32 v31, v28, 8, v30
    v_add_u32 v10, s30, v31
    v_xor_b32 v10, s41, v10
    v_xor_b32 v11, 64, v10
    v_xor_b32 v12, 0x80, v10
    v_xor_b32 v13, 0xc0, v10
    v_and_b32 v32, 12, v28
    v_lshl_add_u32 v2, v32, 8, v31
    v_xor_b32 v2, s51, v2
    v_xor_b32 v3, 64, v2
    v_xor_b32 v4, 0x80, v2
    v_xor_b32 v5, 0xc0, v2
    v_lshlrev_b32 v31, 4, v28
    v_lshl_add_u32 v31, v32, 6, v31
    v_lshl_add_u32 v31, v29, 11, v31
    v_add_u32 v6, 32768, v31
    v_xor_b32 v6, s51, v6
    v_xor_b32 v7, 64, v6
    v_xor_b32 v8, 0x80, v6
    v_xor_b32 v9, 0xc0, v6
    v_lshlrev_b32 v31, 4, v29
    v_lshl_add_u32 v20, v28, 8, v31
    v_lshlrev_b32 v24, 4, v0
    v_add_u32 v24, s30, v24
    v_and_b32 v31, 3, v28
    v_cmp_eq_u32 vcc, 0, v31
    v_mov_b32 v31, 0x3f803f80
    v_mov_b32 v21, 0
    v_cndmask_b32 v31, 0, v31, vcc
    v_accvgpr_write_b32 a248, v31
    v_accvgpr_write_b32 a249, v31
    v_accvgpr_write_b32 a250, v31
    v_accvgpr_write_b32 a251, v31
    v_and_b32 v31, 1, v0
    v_mov_b32 v26, 0xeeeeeeee
    v_cmp_eq_u32 vcc, 1, v31
    v_mov_b32 v30, 0x44444444
    v_lshrrev_b32 v31, 4, v0
    v_cndmask_b32 v26, v30, v26, vcc
    v_xor_b32 v31, v31, v0
    v_and_b32 v31, 2, v31
    v_cmp_eq_u32 vcc, 0, v31
    v_mov_b32 v31, 0x3f803f80
    s_nop 0
    v_cndmask_b32 v30, 0, v31, vcc
    v_xor_b32 v31, v31, v30
    v_accvgpr_write_b32 a238, v30
    v_accvgpr_write_b32 a239, v30
    v_accvgpr_write_b32 a240, v30
    v_accvgpr_write_b32 a241, v30
    v_accvgpr_write_b32 a242, v31
    v_accvgpr_write_b32 a243, v31
    v_accvgpr_write_b32 a244, v31
    v_accvgpr_write_b32 a245, v31
    v_accvgpr_write_b32 a236, 0
    v_accvgpr_write_b32 a237, 0
    s_getpc_b64 s[46:47]
    s_and_b32 s46, s46, 0xfffff000
    v_lshlrev_b32 v31, 6, v0
    s_lshl2_add_u32 s41, s37, s40
    s_mul_i32 s41, s41, 17
    s_lshr_b32 s41, s41, 7
    s_add_u32 s41, s41, 1
    s_lshl_b32 s41, s41, 12
    s_add_u32 s46, s46, s41
    s_addc_u32 s47, s47, 0
    v_or_b32 v22, s46, v31
    v_mov_b32 v23, s47
    v_accvgpr_write_b32 a255, v22
    global_load_dword v22, v[22:23], off
    v_xor_b32 v0, 0x400, v2
    v_xor_b32 v1, 0x400, v3
    v_xor_b32 v25, 0x400, v4
    v_xor_b32 v27, 0x400, v5
    v_xor_b32 v36, 0x400, v6
    v_xor_b32 v37, 0x400, v7
    v_xor_b32 v38, 0x400, v8
    v_xor_b32 v39, 0x400, v9
    s_add_u32 m0, s30, 12288
    s_add_u32 s28, s24, 12288
    buffer_load_dwordx4 v14, s[4:7], s28 offen nt lds
    buffer_load_dwordx4 v15, s[4:7], s28 offen offset:1024 nt lds
    buffer_load_dwordx4 v16, s[4:7], s28 offen offset:2048 nt lds
    buffer_load_dwordx4 v17, s[4:7], s28 offen offset:3072 nt lds
    s_add_u32 m0, s30, 16384
    s_add_u32 s28, s24, 16384
    buffer_load_dwordx4 v14, s[4:7], s28 offen nt lds
    buffer_load_dwordx4 v15, s[4:7], s28 offen offset:1024 nt lds
    buffer_load_dwordx4 v16, s[4:7], s28 offen offset:2048 nt lds
    buffer_load_dwordx4 v17, s[4:7], s28 offen offset:3072 nt lds
    s_branch L_over
L_lateA:
    s_mov_b32 m0, s30
    s_nop 0
    buffer_load_dwordx4 v14, s[4:7], s24 offen nt lds
    buffer_load_dwordx4 v15, s[4:7], s24 offen offset:1024 nt lds
    buffer_load_dwordx4 v16, s[4:7], s24 offen offset:2048 nt lds
    s_branch L_A9
L_lateB:
    s_mov_b32 m0, s30
    s_nop 0
    buffer_load_dwordx4 v14, s[4:7], s24 offen nt lds
    buffer_load_dwordx4 v15, s[4:7], s24 offen offset:1024 nt lds
    buffer_load_dwordx4 v16, s[4:7], s24 offen offset:2048 nt lds
    s_branch L_B9
L_over:
    s_waitcnt vmcnt(17)
    s_barrier
    ds_read_b128 a[96:99], v2 offset:0
    ds_read_b128 a[100:103], v3 offset:0
    ds_read_b128 a[104:107], v4 offset:0
    ds_read_b128 a[108:111], v5 offset:0
    ds_read_b128 a[112:115], v0 offset:0
    ds_read_b128 a[116:119], v1 offset:0
    ds_read_b128 a[120:123], v25 offset:0
    ds_read_b128 a[124:127], v27 offset:0
    ds_read_b128 a[0:3], v10 offset:0
    ds_read_b128 a[4:7], v11 offset:0
    ds_read_b128 a[8:11], v12 offset:0
    ds_read_b128 a[12:15], v13 offset:0
    ds_read_b64_tr_b16 a[160:161], v6 offset:0
    ds_read_b64_tr_b16 a[162:163], v36 offset:0
    ds_read_b64_tr_b16 a[168:169], v6 offset:8
    ds_read_b64_tr_b16 a[170:171], v36 offset:8
    ds_read_b64_tr_b16 a[176:177], v7 offset:0
    ds_read_b64_tr_b16 a[178:179], v37 offset:0
    ds_read_b64_tr_b16 a[184:185], v7 offset:8
    ds_read_b64_tr_b16 a[186:187], v37 offset:8
    ds_read_b64_tr_b16 a[192:193], v8 offset:0
    ds_read_b64_tr_b16 a[194:195], v38 offset:0
    ds_read_b64_tr_b16 a[200:201], v8 offset:8
    ds_read_b64_tr_b16 a[202:203], v38 offset:8
    ds_read_b64_tr_b16 a[208:209], v9 offset:0
    ds_read_b64_tr_b16 a[210:211], v39 offset:0
    ds_read_b64_tr_b16 a[216:217], v9 offset:8
    ds_read_b64_tr_b16 a[218:219], v39 offset:8
    s_bitcmp1_b32 s37, 0
    s_waitcnt lgkmcnt(15)
    s_cbranch_scc1 L_proB
    v_mfma_f32_16x16x32_bf16 v[40:43], a[96:99], a[0:3], 0
    s_nop 0
    v_mfma_f32_16x16x32_bf16 v[40:43], a[100:103], a[4:7], v[40:43]
    s_nop 0
    v_mfma_f32_16x16x32_bf16 v[40:43], a[104:107], a[8:11], v[40:43]
    s_nop 0
    v_mfma_f32_16x16x32_bf16 v[40:43], a[108:111], a[12:15], v[40:43]
    s_nop 0
    v_mfma_f32_16x16x32_bf16 v[44:47], a[112:115], a[0:3], 0
    s_nop 0
    v_mfma_f32_16x16x32_bf16 v[44:47], a[116:119], a[4:7], v[44:47]
    s_nop 0
    v_mfma_f32_16x16x32_bf16 v[44:47], a[120:123], a[8:11], v[44:47]
    s_nop 0
    v_mfma_f32_16x16x32_bf16 v[44:47], a[124:127], a[12:15], v[44:47]
    s_add_u32 m0, s35, 8192
    s_nop 0
    buffer_load_dwordx4 v18, s[8:11], s22 offen lds
    buffer_load_dwordx4 v18, s[8:11], s22 offen offset:1024 lds
    s_add_u32 m0, s35, 40960
    s_nop 0
    buffer_load_dwordx4 v19, s[12:15], s22 offen lds
    buffer_load_dwordx4 v19, s[12:15], s22 offen offset:1024 lds
    s_xor_b32 s22, s22, 24576
    s_waitcnt vmcnt(17)
    v_mul_f32 v40, s20, v40
    s_nop 1
    ds_read_b128 a[16:19], v10 offset:4096
    v_exp_f32 v40, v40
    s_nop 1
    ds_read_b128 a[20:23], v11 offset:4096
    v_mul_f32 v41, s20, v41
    v_mul_f32 v42, s20, v42
    s_nop 1
    ds_read_b128 a[24:27], v12 offset:4096
    v_mul_f32 v43, s20, v43
    s_nop 1
    ds_read_b128 a[28:31], v13 offset:4096
    v_exp_f32 v41, v41
    s_nop 1
    v_exp_f32 v42, v42
    s_nop 1
    v_mul_f32 v44, s20, v44
    s_nop 1
    v_exp_f32 v43, v43
    s_nop 1
    v_exp_f32 v44, v44
    s_nop 1
    s_waitcnt lgkmcnt(0)
    v_mul_f32 v45, s20, v45
    v_mfma_f32_16x16x32_bf16 v[48:51], a[96:99], a[16:19], 0
    v_mul_f32 v46, s20, v46
    v_mul_f32 v47, s20, v47
    v_mfma_f32_16x16x32_bf16 v[48:51], a[100:103], a[20:23], v[48:51]
    v_exp_f32 v45, v45
    v_mfma_f32_16x16x32_bf16 v[48:51], a[104:107], a[24:27], v[48:51]
    v_cvt_pk_bf16_f32 v56, v40, v41
    v_cvt_pk_bf16_f32 v57, v42, v43
    v_mfma_f32_16x16x32_bf16 v[48:51], a[108:111], a[28:31], v[48:51]
    v_exp_f32 v46, v46
    v_mfma_f32_16x16x32_bf16 v[52:55], a[112:115], a[16:19], 0
    v_exp_f32 v47, v47
    v_mfma_f32_16x16x32_bf16 v[52:55], a[116:119], a[20:23], v[52:55]
    v_cvt_pk_bf16_f32 v58, v44, v45
    v_cvt_pk_bf16_f32 v59, v46, v47
    v_mfma_f32_16x16x32_bf16 v[52:55], a[120:123], a[24:27], v[52:55]
    s_nop 0
    v_mfma_f32_16x16x32_bf16 v[52:55], a[124:127], a[28:31], v[52:55]
    s_add_u32 m0, s30, 20480
    s_add_u32 s28, s24, 20480
    buffer_load_dwordx4 v14, s[4:7], s28 offen nt lds
    buffer_load_dwordx4 v15, s[4:7], s28 offen offset:1024 nt lds
    buffer_load_dwordx4 v16, s[4:7], s28 offen offset:2048 nt lds
    buffer_load_dwordx4 v17, s[4:7], s28 offen offset:3072 nt lds
    s_mov_b32 s26, s24
    s_mov_b32 s27, s25
    s_add_u32 s33, s33, 1
    s_lshl_b32 s41, s33, 5
    s_add_u32 s41, s41, s37
    s_lshr_b32 s42, s41, 1
    s_xor_b32 s43, s33, s37
    s_and_b32 s43, s43, 1
    s_mul_i32 s44, s43, s58
    s_mul_i32 s43, s43, 22
    s_add_u32 s43, s43, 24
    s_lshl_b32 s42, s42, 3
    s_add_u32 s42, s42, s38
    s_lshl_b32 s23, s42, 17
    s_mul_i32 s42, s42, 46
    s_add_u32 s44, s44, s36
    s_add_u32 s44, s44, s42
    s_lshl_b32 s24, s44, 12
    s_add_u32 s43, s43, s42
    s_lshl_b32 s43, s43, 12
    s_min_u32 s25, s43, 96468992
    s_mov_b32 s6, s25
    s_waitcnt vmcnt(17)
    v_mul_f32 v48, s20, v48

    ds_read_b128 a[32:35], v10 offset:8192
    v_exp_f32 v48, v48
    v_accvgpr_write_b32 a224, 0
    v_accvgpr_write_b32 a225, 0
    v_accvgpr_write_b32 a226, 0
    v_accvgpr_write_b32 a227, 0
    v_mfma_f32_16x16x32_bf16 v[64:67], a[160:163], v[56:59], 0
    ds_read_b128 a[36:39], v11 offset:8192
    v_mul_f32 v49, s20, v49
    v_mul_f32 v50, s20, v50
    v_mfma_f32_16x16x32_bf16 v[68:71], a[168:171], v[56:59], 0
    ds_read_b128 a[40:43], v12 offset:8192
    v_mul_f32 v51, s20, v51
    v_mfma_f32_16x16x32_bf16 v[72:75], a[176:179], v[56:59], 0
    ds_read_b128 a[44:47], v13 offset:8192
    v_exp_f32 v49, v49
    v_mfma_f32_16x16x32_bf16 v[76:79], a[184:187], v[56:59], 0
    v_exp_f32 v50, v50
    v_mfma_f32_16x16x32_bf16 v[80:83], a[192:195], v[56:59], 0
    v_mul_f32 v52, s20, v52
    v_mfma_f32_16x16x32_bf16 v[84:87], a[200:203], v[56:59], 0
    v_exp_f32 v51, v51
    v_mfma_f32_16x16x32_bf16 v[88:91], a[208:211], v[56:59], 0
    v_exp_f32 v52, v52
    v_mfma_f32_16x16x32_bf16 v[92:95], a[216:219], v[56:59], 0
    s_waitcnt lgkmcnt(0)
    v_mul_f32 v53, s20, v53
    v_mfma_f32_16x16x32_bf16 v[40:43], a[96:99], a[32:35], 0
    v_mul_f32 v54, s20, v54
    v_mul_f32 v55, s20, v55
    v_mfma_f32_16x16x32_bf16 v[40:43], a[100:103], a[36:39], v[40:43]
    v_exp_f32 v53, v53
    v_mfma_f32_16x16x32_bf16 v[40:43], a[104:107], a[40:43], v[40:43]
    v_cvt_pk_bf16_f32 v60, v48, v49
    v_cvt_pk_bf16_f32 v61, v50, v51
    v_mfma_f32_16x16x32_bf16 v[40:43], a[108:111], a[44:47], v[40:43]
    v_exp_f32 v54, v54
    v_mfma_f32_16x16x32_bf16 v[44:47], a[112:115], a[32:35], 0
    v_exp_f32 v55, v55
    v_mfma_f32_16x16x32_bf16 v[44:47], a[116:119], a[36:39], v[44:47]
    v_cvt_pk_bf16_f32 v62, v52, v53
    v_cvt_pk_bf16_f32 v63, v54, v55
    v_mfma_f32_16x16x32_bf16 v[44:47], a[120:123], a[40:43], v[44:47]
    s_nop 0
    v_mfma_f32_16x16x32_bf16 v[44:47], a[124:127], a[44:47], v[44:47]
    s_add_u32 m0, s35, 16384
    s_nop 0
    buffer_load_dwordx4 v18, s[8:11], s22 offen lds
    buffer_load_dwordx4 v18, s[8:11], s22 offen offset:1024 lds
    s_add_u32 m0, s35, 49152
    s_nop 0
    buffer_load_dwordx4 v19, s[12:15], s22 offen lds
    buffer_load_dwordx4 v19, s[12:15], s22 offen offset:1024 lds
    s_xor_b32 s22, s22, 8192
    s_waitcnt vmcnt(16)
    v_mul_f32 v40, s20, v40
    v_smfmac_f32_16x16x64_bf16 a[224:227], a[238:241], v[56:63], v26
    ds_read_b128 a[48:51], v10 offset:12288
    v_exp_f32 v40, v40
    v_mfma_f32_16x16x32_bf16 v[96:99], a[160:163], v[60:63], 0
    ds_read_b128 a[52:55], v11 offset:12288
    v_mul_f32 v41, s20, v41
    v_mul_f32 v42, s20, v42
    v_mfma_f32_16x16x32_bf16 v[100:103], a[168:171], v[60:63], 0
    ds_read_b128 a[56:59], v12 offset:12288
    v_mul_f32 v43, s20, v43
    v_mfma_f32_16x16x32_bf16 v[104:107], a[176:179], v[60:63], 0
    ds_read_b128 a[60:63], v13 offset:12288
    v_exp_f32 v41, v41
    v_mfma_f32_16x16x32_bf16 v[108:111], a[184:187], v[60:63], 0
    v_exp_f32 v42, v42
    v_mfma_f32_16x16x32_bf16 v[112:115], a[192:195], v[60:63], 0
    v_mul_f32 v44, s20, v44
    v_mfma_f32_16x16x32_bf16 v[116:119], a[200:203], v[60:63], 0
    v_exp_f32 v43, v43
    v_mfma_f32_16x16x32_bf16 v[120:123], a[208:211], v[60:63], 0
    v_exp_f32 v44, v44
    v_mfma_f32_16x16x32_bf16 v[124:127], a[216:219], v[60:63], 0
    s_waitcnt lgkmcnt(0)
    v_mul_f32 v45, s20, v45
    v_mfma_f32_16x16x32_bf16 v[48:51], a[96:99], a[48:51], 0
    v_mul_f32 v46, s20, v46
    v_mul_f32 v47, s20, v47
    v_mfma_f32_16x16x32_bf16 v[48:51], a[100:103], a[52:55], v[48:51]
    v_exp_f32 v45, v45
    v_mfma_f32_16x16x32_bf16 v[48:51], a[104:107], a[56:59], v[48:51]
    v_cvt_pk_bf16_f32 v56, v40, v41
    v_cvt_pk_bf16_f32 v57, v42, v43
    v_mfma_f32_16x16x32_bf16 v[48:51], a[108:111], a[60:63], v[48:51]
    v_exp_f32 v46, v46
    v_mfma_f32_16x16x32_bf16 v[52:55], a[112:115], a[48:51], 0
    v_exp_f32 v47, v47
    v_mfma_f32_16x16x32_bf16 v[52:55], a[116:119], a[52:55], v[52:55]
    v_cvt_pk_bf16_f32 v58, v44, v45
    v_cvt_pk_bf16_f32 v59, v46, v47
    v_mfma_f32_16x16x32_bf16 v[52:55], a[120:123], a[56:59], v[52:55]
    s_nop 0
    v_mfma_f32_16x16x32_bf16 v[52:55], a[124:127], a[60:63], v[52:55]
    s_add_u32 m0, s35, 24576
    s_nop 0
    buffer_load_dwordx4 v18, s[8:11], s22 offen lds
    buffer_load_dwordx4 v18, s[8:11], s22 offen offset:1024 lds
    s_add_u32 m0, s35, 57344
    s_nop 0
    buffer_load_dwordx4 v19, s[12:15], s22 offen lds
    buffer_load_dwordx4 v19, s[12:15], s22 offen offset:1024 lds
    s_xor_b32 s22, s22, 57344
    s_waitcnt vmcnt(16)
    v_mul_f32 v48, s20, v48

    ds_read_b128 a[64:67], v10 offset:16384
    v_exp_f32 v48, v48
    v_accvgpr_write_b32 a228, 0
    v_accvgpr_write_b32 a229, 0
    v_accvgpr_write_b32 a230, 0
    v_accvgpr_write_b32 a231, 0
    v_mfma_f32_16x16x32_bf16 v[128:131], a[160:163], v[56:59], 0
    ds_read_b128 a[68:71], v11 offset:16384
    v_mul_f32 v49, s20, v49
    v_mul_f32 v50, s20, v50
    v_mfma_f32_16x16x32_bf16 v[132:135], a[168:171], v[56:59], 0
    ds_read_b128 a[72:75], v12 offset:16384
    v_mul_f32 v51, s20, v51
    v_mfma_f32_16x16x32_bf16 v[136:139], a[176:179], v[56:59], 0
    ds_read_b128 a[76:79], v13 offset:16384
    v_exp_f32 v49, v49
    v_mfma_f32_16x16x32_bf16 v[140:143], a[184:187], v[56:59], 0
    v_exp_f32 v50, v50
    v_mfma_f32_16x16x32_bf16 v[144:147], a[192:195], v[56:59], 0
    v_mul_f32 v52, s20, v52
    v_mfma_f32_16x16x32_bf16 v[148:151], a[200:203], v[56:59], 0
    v_exp_f32 v51, v51
    v_mfma_f32_16x16x32_bf16 v[152:155], a[208:211], v[56:59], 0
    v_exp_f32 v52, v52
    v_mfma_f32_16x16x32_bf16 v[156:159], a[216:219], v[56:59], 0
    s_waitcnt lgkmcnt(0)
    v_mul_f32 v53, s20, v53
    v_mfma_f32_16x16x32_bf16 v[40:43], a[96:99], a[64:67], 0
    v_mul_f32 v54, s20, v54
    v_mul_f32 v55, s20, v55
    v_mfma_f32_16x16x32_bf16 v[40:43], a[100:103], a[68:71], v[40:43]
    v_exp_f32 v53, v53
    v_mfma_f32_16x16x32_bf16 v[40:43], a[104:107], a[72:75], v[40:43]
    v_cvt_pk_bf16_f32 v60, v48, v49
    v_cvt_pk_bf16_f32 v61, v50, v51
    v_mfma_f32_16x16x32_bf16 v[40:43], a[108:111], a[76:79], v[40:43]
    v_exp_f32 v54, v54
    v_mfma_f32_16x16x32_bf16 v[44:47], a[112:115], a[64:67], 0
    v_exp_f32 v55, v55
    v_mfma_f32_16x16x32_bf16 v[44:47], a[116:119], a[68:71], v[44:47]
    s_waitcnt vmcnt(12) lgkmcnt(0)
    v_cvt_pk_bf16_f32 v62, v52, v53
    v_cvt_pk_bf16_f32 v63, v54, v55
    v_mfma_f32_16x16x32_bf16 v[44:47], a[120:123], a[72:75], v[44:47]
    s_barrier
    v_mfma_f32_16x16x32_bf16 v[44:47], a[124:127], a[76:79], v[44:47]
    s_waitcnt vmcnt(8)
    v_mul_f32 v40, s20, v40
    v_smfmac_f32_16x16x64_bf16 a[228:231], a[238:241], v[56:63], v26
    ds_read_b128 a[80:83], v10 offset:20480
    v_exp_f32 v40, v40
    v_mfma_f32_16x16x32_bf16 v[160:163], a[160:163], v[60:63], 0
    ds_read_b128 a[84:87], v11 offset:20480
    v_mul_f32 v41, s20, v41
    v_mul_f32 v42, s20, v42
    v_mfma_f32_16x16x32_bf16 v[164:167], a[168:171], v[60:63], 0
    ds_read_b128 a[88:91], v12 offset:20480
    v_mul_f32 v43, s20, v43
    v_mfma_f32_16x16x32_bf16 v[168:171], a[176:179], v[60:63], 0
    ds_read_b128 a[92:95], v13 offset:20480
    v_exp_f32 v41, v41
    v_mfma_f32_16x16x32_bf16 v[172:175], a[184:187], v[60:63], 0
    ds_read_b128 a[128:131], v2 offset:8192
    v_exp_f32 v42, v42
    v_mfma_f32_16x16x32_bf16 v[176:179], a[192:195], v[60:63], 0
    ds_read_b128 a[132:135], v3 offset:8192
    v_mul_f32 v44, s20, v44
    v_mfma_f32_16x16x32_bf16 v[180:183], a[200:203], v[60:63], 0
    ds_read_b128 a[136:139], v4 offset:8192
    v_exp_f32 v43, v43
    v_mfma_f32_16x16x32_bf16 v[184:187], a[208:211], v[60:63], 0
    ds_read_b128 a[140:143], v5 offset:8192
    v_exp_f32 v44, v44
    v_mfma_f32_16x16x32_bf16 v[188:191], a[216:219], v[60:63], 0
    s_waitcnt lgkmcnt(4)
    ds_read_b128 a[144:147], v0 offset:8192
    v_mul_f32 v45, s20, v45
    v_mfma_f32_16x16x32_bf16 v[48:51], a[96:99], a[80:83], 0
    ds_read_b128 a[148:151], v1 offset:8192
    v_mul_f32 v46, s20, v46
    v_mul_f32 v47, s20, v47
    s_add_u32 m0, s35, 0
    s_nop 0
    buffer_load_dwordx4 v18, s[8:11], s22 offen lds
    v_mfma_f32_16x16x32_bf16 v[48:51], a[100:103], a[84:87], v[48:51]
    ds_read_b128 a[152:155], v25 offset:8192
    v_exp_f32 v45, v45
    v_mfma_f32_16x16x32_bf16 v[48:51], a[104:107], a[88:91], v[48:51]
    ds_read_b128 a[156:159], v27 offset:8192
    v_cvt_pk_bf16_f32 v56, v40, v41
    v_cvt_pk_bf16_f32 v57, v42, v43
    s_nop 0
    buffer_load_dwordx4 v18, s[8:11], s22 offen offset:1024 lds
    v_mfma_f32_16x16x32_bf16 v[48:51], a[108:111], a[92:95], v[48:51]
    ds_read_b64_tr_b16 a[164:165], v6 offset:8192
    v_exp_f32 v46, v46
    v_mfma_f32_16x16x32_bf16 v[52:55], a[112:115], a[80:83], 0
    ds_read_b64_tr_b16 a[166:167], v36 offset:8192
    v_exp_f32 v47, v47
    s_add_u32 m0, s35, 32768
    s_nop 0
    buffer_load_dwordx4 v19, s[12:15], s22 offen lds
    v_mfma_f32_16x16x32_bf16 v[52:55], a[116:119], a[84:87], v[52:55]
    ds_read_b64_tr_b16 a[172:173], v6 offset:8200
    v_cvt_pk_bf16_f32 v58, v44, v45
    v_cvt_pk_bf16_f32 v59, v46, v47
    v_mfma_f32_16x16x32_bf16 v[52:55], a[120:123], a[88:91], v[52:55]
    ds_read_b64_tr_b16 a[174:175], v36 offset:8200
    s_nop 0
    buffer_load_dwordx4 v19, s[12:15], s22 offen offset:1024 lds
    v_mfma_f32_16x16x32_bf16 v[52:55], a[124:127], a[92:95], v[52:55]
    ds_read_b64_tr_b16 a[180:181], v7 offset:8192
    v_mul_f32 v48, s20, v48

    ds_read_b64_tr_b16 a[182:183], v37 offset:8192
    v_exp_f32 v48, v48
    v_accvgpr_write_b32 a232, 0
    v_accvgpr_write_b32 a233, 0
    v_accvgpr_write_b32 a234, 0
    v_accvgpr_write_b32 a235, 0
    s_add_u32 s32, s31, 0
    s_nop 0
    buffer_store_dwordx4 v[28:31], v14, s[16:19], s32 offen nt
    v_mfma_f32_16x16x32_bf16 v[192:195], a[160:163], v[56:59], 0
    ds_read_b64_tr_b16 a[188:189], v7 offset:8200
    v_mul_f32 v49, s20, v49
    v_mul_f32 v50, s20, v50
    v_mfma_f32_16x16x32_bf16 v[196:199], a[168:171], v[56:59], 0
    ds_read_b64_tr_b16 a[190:191], v37 offset:8200
    v_mul_f32 v51, s20, v51
    s_nop 0
    buffer_store_dwordx4 v[32:35], v14, s[16:19], s32 offen nt
    v_mfma_f32_16x16x32_bf16 v[200:203], a[176:179], v[56:59], 0
    ds_read_b64_tr_b16 a[196:197], v8 offset:8192
    v_exp_f32 v49, v49
    v_mfma_f32_16x16x32_bf16 v[204:207], a[184:187], v[56:59], 0
    ds_read_b64_tr_b16 a[198:199], v38 offset:8192
    v_exp_f32 v50, v50
    s_nop 0
    buffer_store_dwordx4 v[28:31], v14, s[16:19], s32 offen nt
    v_mfma_f32_16x16x32_bf16 v[208:211], a[192:195], v[56:59], 0
    ds_read_b64_tr_b16 a[204:205], v8 offset:8200
    v_mul_f32 v52, s20, v52
    v_mfma_f32_16x16x32_bf16 v[212:215], a[200:203], v[56:59], 0
    ds_read_b64_tr_b16 a[206:207], v38 offset:8200
    v_exp_f32 v51, v51
    s_nop 0
    buffer_store_dwordx4 v[32:35], v14, s[16:19], s32 offen nt
    v_mfma_f32_16x16x32_bf16 v[216:219], a[208:211], v[56:59], 0
    ds_read_b64_tr_b16 a[212:213], v9 offset:8192
    v_exp_f32 v52, v52
    v_mfma_f32_16x16x32_bf16 v[220:223], a[216:219], v[56:59], 0
    s_waitcnt lgkmcnt(13)
    ds_read_b64_tr_b16 a[214:215], v39 offset:8192
    ds_read_b64_tr_b16 a[220:221], v9 offset:8200
    ds_read_b64_tr_b16 a[222:223], v39 offset:8200
    v_mul_f32 v53, s20, v53
    s_xor_b32 s22, s22, 8192
L_A1:
    v_mfma_f32_16x16x32_bf16 v[40:43], a[128:131], a[0:3], 0
    v_mul_f32 v54, s20, v54
    v_mul_f32 v55, s20, v55
    v_mfma_f32_16x16x32_bf16 v[40:43], a[132:135], a[4:7], v[40:43]
    v_exp_f32 v53, v53
    v_mfma_f32_16x16x32_bf16 v[40:43], a[136:139], a[8:11], v[40:43]
    v_cvt_pk_bf16_f32 v60, v48, v49
    v_cvt_pk_bf16_f32 v61, v50, v51
    v_mfma_f32_16x16x32_bf16 v[40:43], a[140:143], a[12:15], v[40:43]
    v_exp_f32 v54, v54
    v_mfma_f32_16x16x32_bf16 v[44:47], a[144:147], a[0:3], 0
    v_exp_f32 v55, v55
    v_mfma_f32_16x16x32_bf16 v[44:47], a[148:151], a[4:7], v[44:47]
    s_waitcnt vmcnt(12) lgkmcnt(0)
    v_cvt_pk_bf16_f32 v62, v52, v53
    v_cvt_pk_bf16_f32 v63, v54, v55
    v_mfma_f32_16x16x32_bf16 v[44:47], a[152:155], a[8:11], v[44:47]
    s_barrier
    v_mfma_f32_16x16x32_bf16 v[44:47], a[156:159], a[12:15], v[44:47]
    ds_read_b128 a[96:99], v2 offset:16384
    v_mul_f32 v40, s20, v40
    v_smfmac_f32_16x16x64_bf16 a[232:235], a[238:241], v[56:63], v26
    v_exp_f32 v40, v40
    v_mul_f32 v41, s20, v41
    v_mul_f32 v42, s20, v42
    v_mfma_f32_16x16x32_bf16 v[224:227], a[160:163], v[60:63], 0
    ds_read_b128 a[100:103], v3 offset:16384
    v_mul_f32 v43, s20, v43
    v_mfma_f32_16x16x32_bf16 v[228:231], a[168:171], v[60:63], 0
    v_exp_f32 v41, v41
    v_mfma_f32_16x16x32_bf16 v[232:235], a[176:179], v[60:63], 0
    v_exp_f32 v42, v42
    v_mfma_f32_16x16x32_bf16 v[236:239], a[184:187], v[60:63], 0
    ds_read_b128 a[104:107], v4 offset:16384
    v_mul_f32 v44, s20, v44
    v_mfma_f32_16x16x32_bf16 v[240:243], a[192:195], v[60:63], 0
    v_exp_f32 v43, v43
    v_mfma_f32_16x16x32_bf16 v[244:247], a[200:203], v[60:63], 0
    v_exp_f32 v44, v44
    v_mfma_f32_16x16x32_bf16 v[248:251], a[208:211], v[60:63], 0
    ds_read_b128 a[108:111], v5 offset:16384
    v_mul_f32 v45, s20, v45
    v_mfma_f32_16x16x32_bf16 v[252:255], a[216:219], v[60:63], 0
    v_mul_f32 v46, s20, v46
    v_mul_f32 v47, s20, v47
    v_mfma_f32_16x16x32_bf16 v[48:51], a[128:131], a[16:19], 0
    v_exp_f32 v45, v45
    v_mfma_f32_16x16x32_bf16 v[48:51], a[132:135], a[20:23], v[48:51]
    v_cvt_pk_bf16_f32 v56, v40, v41
    v_cvt_pk_bf16_f32 v57, v42, v43
    v_mfma_f32_16x16x32_bf16 v[48:51], a[136:139], a[24:27], v[48:51]
    v_exp_f32 v46, v46
    v_mfma_f32_16x16x32_bf16 v[48:51], a[140:143], a[28:31], v[48:51]
    v_exp_f32 v47, v47
    v_mfma_f32_16x16x32_bf16 v[52:55], a[144:147], a[16:19], 0
    s_add_u32 m0, s35, 8192
    v_cvt_pk_bf16_f32 v58, v44, v45
    v_cvt_pk_bf16_f32 v59, v46, v47
    v_mfma_f32_16x16x32_bf16 v[52:55], a[148:151], a[20:23], v[52:55]
    buffer_load_dwordx4 v18, s[8:11], s22 offen lds
    v_mfma_f32_16x16x32_bf16 v[52:55], a[152:155], a[24:27], v[52:55]
    ds_read_b128 a[112:115], v0 offset:16384
    v_mul_f32 v48, s20, v48
    v_mfma_f32_16x16x32_bf16 v[52:55], a[156:159], a[28:31], v[52:55]
    v_exp_f32 v48, v48

    v_mfma_f32_16x16x32_bf16 v[64:67], a[164:167], v[56:59], v[64:67]
    v_mul_f32 v49, s20, v49
    v_mul_f32 v50, s20, v50
    v_mfma_f32_16x16x32_bf16 v[68:71], a[172:175], v[56:59], v[68:71]
    ds_read_b128 a[116:119], v1 offset:16384
    v_mul_f32 v51, s20, v51
    v_mfma_f32_16x16x32_bf16 v[72:75], a[180:183], v[56:59], v[72:75]
    v_exp_f32 v49, v49
    v_mfma_f32_16x16x32_bf16 v[76:79], a[188:191], v[56:59], v[76:79]
    v_exp_f32 v50, v50
    v_mfma_f32_16x16x32_bf16 v[80:83], a[196:199], v[56:59], v[80:83]
    ds_read_b128 a[120:123], v25 offset:16384
    v_mul_f32 v52, s20, v52
    v_mfma_f32_16x16x32_bf16 v[84:87], a[204:207], v[56:59], v[84:87]
    v_exp_f32 v51, v51
    v_mfma_f32_16x16x32_bf16 v[88:91], a[212:215], v[56:59], v[88:91]
    v_exp_f32 v52, v52
    v_mfma_f32_16x16x32_bf16 v[92:95], a[220:223], v[56:59], v[92:95]
    ds_read_b128 a[124:127], v27 offset:16384
    v_mul_f32 v53, s20, v53
    v_mfma_f32_16x16x32_bf16 v[40:43], a[128:131], a[32:35], 0
    v_mul_f32 v54, s20, v54
    v_mul_f32 v55, s20, v55
    v_mfma_f32_16x16x32_bf16 v[40:43], a[132:135], a[36:39], v[40:43]
    v_exp_f32 v53, v53
    v_mfma_f32_16x16x32_bf16 v[40:43], a[136:139], a[40:43], v[40:43]
    v_cvt_pk_bf16_f32 v60, v48, v49
    v_cvt_pk_bf16_f32 v61, v50, v51
    v_mfma_f32_16x16x32_bf16 v[40:43], a[140:143], a[44:47], v[40:43]
    v_exp_f32 v54, v54
    v_mfma_f32_16x16x32_bf16 v[44:47], a[144:147], a[32:35], 0
    v_exp_f32 v55, v55
    v_mfma_f32_16x16x32_bf16 v[44:47], a[148:151], a[36:39], v[44:47]
    v_cvt_pk_bf16_f32 v62, v52, v53
    v_cvt_pk_bf16_f32 v63, v54, v55
    v_mfma_f32_16x16x32_bf16 v[44:47], a[152:155], a[40:43], v[44:47]
    buffer_load_dwordx4 v18, s[8:11], s22 offen offset:1024 lds
    v_mfma_f32_16x16x32_bf16 v[44:47], a[156:159], a[44:47], v[44:47]
    ds_read_b64_tr_b16 a[160:161], v6 offset:16384
    v_mul_f32 v40, s20, v40
    v_smfmac_f32_16x16x64_bf16 a[224:227], a[238:241], v[56:63], v26
    v_exp_f32 v40, v40
    v_mul_f32 v41, s20, v41
    v_mul_f32 v42, s20, v42
    v_mfma_f32_16x16x32_bf16 v[96:99], a[164:167], v[60:63], v[96:99]
    ds_read_b64_tr_b16 a[162:163], v36 offset:16384
    v_mul_f32 v43, s20, v43
    v_mfma_f32_16x16x32_bf16 v[100:103], a[172:175], v[60:63], v[100:103]
    v_exp_f32 v41, v41
    v_mfma_f32_16x16x32_bf16 v[104:107], a[180:183], v[60:63], v[104:107]
    v_exp_f32 v42, v42
    v_mfma_f32_16x16x32_bf16 v[108:111], a[188:191], v[60:63], v[108:111]
    ds_read_b64_tr_b16 a[168:169], v6 offset:16392
    v_mul_f32 v44, s20, v44
    v_mfma_f32_16x16x32_bf16 v[112:115], a[196:199], v[60:63], v[112:115]
    v_exp_f32 v43, v43
    v_mfma_f32_16x16x32_bf16 v[116:119], a[204:207], v[60:63], v[116:119]
    v_exp_f32 v44, v44
    v_mfma_f32_16x16x32_bf16 v[120:123], a[212:215], v[60:63], v[120:123]
    ds_read_b64_tr_b16 a[170:171], v36 offset:16392
    v_mul_f32 v45, s20, v45
    v_mfma_f32_16x16x32_bf16 v[124:127], a[220:223], v[60:63], v[124:127]
    v_mul_f32 v46, s20, v46
    v_mul_f32 v47, s20, v47
    v_mfma_f32_16x16x32_bf16 v[48:51], a[128:131], a[48:51], 0
    v_exp_f32 v45, v45
    v_mfma_f32_16x16x32_bf16 v[48:51], a[132:135], a[52:55], v[48:51]
    v_cvt_pk_bf16_f32 v56, v40, v41
    v_cvt_pk_bf16_f32 v57, v42, v43
    v_mfma_f32_16x16x32_bf16 v[48:51], a[136:139], a[56:59], v[48:51]
    v_exp_f32 v46, v46
    v_mfma_f32_16x16x32_bf16 v[48:51], a[140:143], a[60:63], v[48:51]
    v_exp_f32 v47, v47
    v_mfma_f32_16x16x32_bf16 v[52:55], a[144:147], a[48:51], 0
    s_add_u32 m0, s35, 40960
    v_cvt_pk_bf16_f32 v58, v44, v45
    v_cvt_pk_bf16_f32 v59, v46, v47
    v_mfma_f32_16x16x32_bf16 v[52:55], a[148:151], a[52:55], v[52:55]
    buffer_load_dwordx4 v19, s[12:15], s22 offen lds
    v_mfma_f32_16x16x32_bf16 v[52:55], a[152:155], a[56:59], v[52:55]
    ds_read_b64_tr_b16 a[176:177], v7 offset:16384
    v_mul_f32 v48, s20, v48
    v_mfma_f32_16x16x32_bf16 v[52:55], a[156:159], a[60:63], v[52:55]
    v_exp_f32 v48, v48

    v_mfma_f32_16x16x32_bf16 v[128:131], a[164:167], v[56:59], v[128:131]
    v_mul_f32 v49, s20, v49
    v_mul_f32 v50, s20, v50
    v_mfma_f32_16x16x32_bf16 v[132:135], a[172:175], v[56:59], v[132:135]
    ds_read_b64_tr_b16 a[178:179], v37 offset:16384
    v_mul_f32 v51, s20, v51
    v_mfma_f32_16x16x32_bf16 v[136:139], a[180:183], v[56:59], v[136:139]
    v_exp_f32 v49, v49
    v_mfma_f32_16x16x32_bf16 v[140:143], a[188:191], v[56:59], v[140:143]
    v_exp_f32 v50, v50
    v_mfma_f32_16x16x32_bf16 v[144:147], a[196:199], v[56:59], v[144:147]
    ds_read_b64_tr_b16 a[184:185], v7 offset:16392
    v_mul_f32 v52, s20, v52
    v_mfma_f32_16x16x32_bf16 v[148:151], a[204:207], v[56:59], v[148:151]
    v_exp_f32 v51, v51
    v_mfma_f32_16x16x32_bf16 v[152:155], a[212:215], v[56:59], v[152:155]
    v_exp_f32 v52, v52
    v_mfma_f32_16x16x32_bf16 v[156:159], a[220:223], v[56:59], v[156:159]
    ds_read_b64_tr_b16 a[186:187], v37 offset:16392
    v_mul_f32 v53, s20, v53
    v_mfma_f32_16x16x32_bf16 v[40:43], a[128:131], a[64:67], 0
    v_mul_f32 v54, s20, v54
    v_mul_f32 v55, s20, v55
    v_mfma_f32_16x16x32_bf16 v[40:43], a[132:135], a[68:71], v[40:43]
    v_exp_f32 v53, v53
    v_mfma_f32_16x16x32_bf16 v[40:43], a[136:139], a[72:75], v[40:43]
    v_cvt_pk_bf16_f32 v60, v48, v49
    v_cvt_pk_bf16_f32 v61, v50, v51
    v_mfma_f32_16x16x32_bf16 v[40:43], a[140:143], a[76:79], v[40:43]
    v_exp_f32 v54, v54
    v_mfma_f32_16x16x32_bf16 v[44:47], a[144:147], a[64:67], 0
    s_add_u32 s28, s24, 0
    v_exp_f32 v55, v55
    v_mfma_f32_16x16x32_bf16 v[44:47], a[148:151], a[68:71], v[44:47]
    s_add_u32 s32, s31, 0
    v_cvt_pk_bf16_f32 v62, v52, v53
    v_cvt_pk_bf16_f32 v63, v54, v55
    v_mfma_f32_16x16x32_bf16 v[44:47], a[152:155], a[72:75], v[44:47]
    buffer_load_dwordx4 v19, s[12:15], s22 offen offset:1024 lds
    v_mfma_f32_16x16x32_bf16 v[44:47], a[156:159], a[76:79], v[44:47]
    s_add_u32 m0, s30, 0
    ds_read_b64_tr_b16 a[192:193], v8 offset:16384
    v_mul_f32 v40, s20, v40
    v_smfmac_f32_16x16x64_bf16 a[228:231], a[238:241], v[56:63], v26
    buffer_store_dwordx4 v[28:31], v17, s[16:19], s32 offen offset:3072 nt
    buffer_load_dwordx4 v17, s[4:7], s28 offen offset:3072 nt lds
    v_exp_f32 v40, v40
    v_mul_f32 v41, s20, v41
    v_mul_f32 v42, s20, v42
    v_mfma_f32_16x16x32_bf16 v[160:163], a[164:167], v[60:63], v[160:163]
    s_xor_b32 s22, s22, 24576
    ds_read_b64_tr_b16 a[194:195], v38 offset:16384
    v_mul_f32 v43, s20, v43
    v_mfma_f32_16x16x32_bf16 v[164:167], a[172:175], v[60:63], v[164:167]
    v_exp_f32 v41, v41
    v_mfma_f32_16x16x32_bf16 v[168:171], a[180:183], v[60:63], v[168:171]
    v_exp_f32 v42, v42
    v_mfma_f32_16x16x32_bf16 v[172:175], a[188:191], v[60:63], v[172:175]
    ds_read_b64_tr_b16 a[200:201], v8 offset:16392
    v_mul_f32 v44, s20, v44
    v_mfma_f32_16x16x32_bf16 v[176:179], a[196:199], v[60:63], v[176:179]
    v_exp_f32 v43, v43
    v_mfma_f32_16x16x32_bf16 v[180:183], a[204:207], v[60:63], v[180:183]
    v_exp_f32 v44, v44
    v_mfma_f32_16x16x32_bf16 v[184:187], a[212:215], v[60:63], v[184:187]
    ds_read_b64_tr_b16 a[202:203], v38 offset:16392
    v_mul_f32 v45, s20, v45
    v_mfma_f32_16x16x32_bf16 v[188:191], a[220:223], v[60:63], v[188:191]
    v_mul_f32 v46, s20, v46
    v_mul_f32 v47, s20, v47
    v_mfma_f32_16x16x32_bf16 v[48:51], a[128:131], a[80:83], 0
    v_exp_f32 v45, v45
    v_mfma_f32_16x16x32_bf16 v[48:51], a[132:135], a[84:87], v[48:51]
    v_cvt_pk_bf16_f32 v56, v40, v41
    v_cvt_pk_bf16_f32 v57, v42, v43
    v_mfma_f32_16x16x32_bf16 v[48:51], a[136:139], a[88:91], v[48:51]
    v_exp_f32 v46, v46
    v_mfma_f32_16x16x32_bf16 v[48:51], a[140:143], a[92:95], v[48:51]
    v_exp_f32 v47, v47
    v_mfma_f32_16x16x32_bf16 v[52:55], a[144:147], a[80:83], 0
    v_cvt_pk_bf16_f32 v58, v44, v45
    v_cvt_pk_bf16_f32 v59, v46, v47
    v_mfma_f32_16x16x32_bf16 v[52:55], a[148:151], a[84:87], v[52:55]
    ds_read_b128 v[28:31], v24 offset:4096
    v_mfma_f32_16x16x32_bf16 v[52:55], a[152:155], a[88:91], v[52:55]
    ds_read_b64_tr_b16 a[208:209], v9 offset:16384
    v_mul_f32 v48, s20, v48
    v_mfma_f32_16x16x32_bf16 v[52:55], a[156:159], a[92:95], v[52:55]
    v_exp_f32 v48, v48

    v_mfma_f32_16x16x32_bf16 v[192:195], a[164:167], v[56:59], v[192:195]
    v_mul_f32 v49, s20, v49
    v_mul_f32 v50, s20, v50
    v_mfma_f32_16x16x32_bf16 v[196:199], a[172:175], v[56:59], v[196:199]
    ds_read_b64_tr_b16 a[210:211], v39 offset:16384
    v_mul_f32 v51, s20, v51
    v_mfma_f32_16x16x32_bf16 v[200:203], a[180:183], v[56:59], v[200:203]
    v_exp_f32 v49, v49
    v_mfma_f32_16x16x32_bf16 v[204:207], a[188:191], v[56:59], v[204:207]
    v_exp_f32 v50, v50
    v_mfma_f32_16x16x32_bf16 v[208:211], a[196:199], v[56:59], v[208:211]
    ds_read_b64_tr_b16 a[216:217], v9 offset:16392
    v_mul_f32 v52, s20, v52
    v_mfma_f32_16x16x32_bf16 v[212:215], a[204:207], v[56:59], v[212:215]
    v_exp_f32 v51, v51
    v_mfma_f32_16x16x32_bf16 v[216:219], a[212:215], v[56:59], v[216:219]
    v_exp_f32 v52, v52
    v_mfma_f32_16x16x32_bf16 v[220:223], a[220:223], v[56:59], v[220:223]
    s_waitcnt lgkmcnt(15)
    ds_read_b64_tr_b16 a[218:219], v39 offset:16392
    v_mul_f32 v53, s20, v53
L_A2:
    v_mfma_f32_16x16x32_bf16 v[40:43], a[96:99], a[0:3], 0
    v_mul_f32 v54, s20, v54
    v_mul_f32 v55, s20, v55
    v_mfma_f32_16x16x32_bf16 v[40:43], a[100:103], a[4:7], v[40:43]
    v_exp_f32 v53, v53
    v_mfma_f32_16x16x32_bf16 v[40:43], a[104:107], a[8:11], v[40:43]
    v_cvt_pk_bf16_f32 v60, v48, v49
    v_cvt_pk_bf16_f32 v61, v50, v51
    v_mfma_f32_16x16x32_bf16 v[40:43], a[108:111], a[12:15], v[40:43]
    v_exp_f32 v54, v54
    v_mfma_f32_16x16x32_bf16 v[44:47], a[112:115], a[0:3], 0
    v_exp_f32 v55, v55
    v_mfma_f32_16x16x32_bf16 v[44:47], a[116:119], a[4:7], v[44:47]
    s_waitcnt vmcnt(14) lgkmcnt(0)
    v_cvt_pk_bf16_f32 v62, v52, v53
    v_cvt_pk_bf16_f32 v63, v54, v55
    v_mfma_f32_16x16x32_bf16 v[44:47], a[120:123], a[8:11], v[44:47]
    s_barrier
    v_mfma_f32_16x16x32_bf16 v[44:47], a[124:127], a[12:15], v[44:47]
    ds_read_b128 a[128:131], v2 offset:24576
    v_mul_f32 v40, s20, v40
    v_smfmac_f32_16x16x64_bf16 a[232:235], a[238:241], v[56:63], v26
    v_exp_f32 v40, v40
    v_mul_f32 v41, s20, v41
    v_mul_f32 v42, s20, v42
    v_mfma_f32_16x16x32_bf16 v[224:227], a[164:167], v[60:63], v[224:227]
    ds_read_b128 a[132:135], v3 offset:24576
    v_mul_f32 v43, s20, v43
    v_mfma_f32_16x16x32_bf16 v[228:231], a[172:175], v[60:63], v[228:231]
    v_exp_f32 v41, v41
    v_mfma_f32_16x16x32_bf16 v[232:235], a[180:183], v[60:63], v[232:235]
    v_exp_f32 v42, v42
    v_mfma_f32_16x16x32_bf16 v[236:239], a[188:191], v[60:63], v[236:239]
    ds_read_b128 a[136:139], v4 offset:24576
    v_mul_f32 v44, s20, v44
    v_mfma_f32_16x16x32_bf16 v[240:243], a[196:199], v[60:63], v[240:243]
    v_exp_f32 v43, v43
    v_mfma_f32_16x16x32_bf16 v[244:247], a[204:207], v[60:63], v[244:247]
    v_exp_f32 v44, v44
    v_mfma_f32_16x16x32_bf16 v[248:251], a[212:215], v[60:63], v[248:251]
    ds_read_b128 a[140:143], v5 offset:24576
    v_mul_f32 v45, s20, v45
    v_mfma_f32_16x16x32_bf16 v[252:255], a[220:223], v[60:63], v[252:255]
    v_mul_f32 v46, s20, v46
    v_mul_f32 v47, s20, v47
    v_mfma_f32_16x16x32_bf16 v[48:51], a[96:99], a[16:19], 0
    v_exp_f32 v45, v45
    v_mfma_f32_16x16x32_bf16 v[48:51], a[100:103], a[20:23], v[48:51]
    v_cvt_pk_bf16_f32 v56, v40, v41
    v_cvt_pk_bf16_f32 v57, v42, v43
    v_mfma_f32_16x16x32_bf16 v[48:51], a[104:107], a[24:27], v[48:51]
    v_exp_f32 v46, v46
    v_mfma_f32_16x16x32_bf16 v[48:51], a[108:111], a[28:31], v[48:51]
    v_exp_f32 v47, v47
    v_mfma_f32_16x16x32_bf16 v[52:55], a[112:115], a[16:19], 0
    s_add_u32 m0, s35, 16384
    v_cvt_pk_bf16_f32 v58, v44, v45
    v_cvt_pk_bf16_f32 v59, v46, v47
    v_mfma_f32_16x16x32_bf16 v[52:55], a[116:119], a[20:23], v[52:55]
    buffer_load_dwordx4 v18, s[8:11], s22 offen lds
    v_mfma_f32_16x16x32_bf16 v[52:55], a[120:123], a[24:27], v[52:55]
    ds_read_b128 a[144:147], v0 offset:24576
    v_mul_f32 v48, s20, v48
    v_mfma_f32_16x16x32_bf16 v[52:55], a[124:127], a[28:31], v[52:55]
    v_exp_f32 v48, v48

    v_mfma_f32_16x16x32_bf16 v[64:67], a[160:163], v[56:59], v[64:67]
    v_mul_f32 v49, s20, v49
    v_mul_f32 v50, s20, v50
    v_mfma_f32_16x16x32_bf16 v[68:71], a[168:171], v[56:59], v[68:71]
    ds_read_b128 a[148:151], v1 offset:24576
    v_mul_f32 v51, s20, v51
    v_mfma_f32_16x16x32_bf16 v[72:75], a[176:179], v[56:59], v[72:75]
    v_exp_f32 v49, v49
    v_mfma_f32_16x16x32_bf16 v[76:79], a[184:187], v[56:59], v[76:79]
    v_exp_f32 v50, v50
    v_mfma_f32_16x16x32_bf16 v[80:83], a[192:195], v[56:59], v[80:83]
    ds_read_b128 a[152:155], v25 offset:24576
    v_mul_f32 v52, s20, v52
    v_mfma_f32_16x16x32_bf16 v[84:87], a[200:203], v[56:59], v[84:87]
    v_exp_f32 v51, v51
    v_mfma_f32_16x16x32_bf16 v[88:91], a[208:211], v[56:59], v[88:91]
    v_exp_f32 v52, v52
    v_mfma_f32_16x16x32_bf16 v[92:95], a[216:219], v[56:59], v[92:95]
    ds_read_b128 a[156:159], v27 offset:24576
    v_mul_f32 v53, s20, v53
    v_mfma_f32_16x16x32_bf16 v[40:43], a[96:99], a[32:35], 0
    v_mul_f32 v54, s20, v54
    v_mul_f32 v55, s20, v55
    v_mfma_f32_16x16x32_bf16 v[40:43], a[100:103], a[36:39], v[40:43]
    v_exp_f32 v53, v53
    v_mfma_f32_16x16x32_bf16 v[40:43], a[104:107], a[40:43], v[40:43]
    v_cvt_pk_bf16_f32 v60, v48, v49
    v_cvt_pk_bf16_f32 v61, v50, v51
    v_mfma_f32_16x16x32_bf16 v[40:43], a[108:111], a[44:47], v[40:43]
    v_exp_f32 v54, v54
    v_mfma_f32_16x16x32_bf16 v[44:47], a[112:115], a[32:35], 0
    v_exp_f32 v55, v55
    v_mfma_f32_16x16x32_bf16 v[44:47], a[116:119], a[36:39], v[44:47]
    v_cvt_pk_bf16_f32 v62, v52, v53
    v_cvt_pk_bf16_f32 v63, v54, v55
    v_mfma_f32_16x16x32_bf16 v[44:47], a[120:123], a[40:43], v[44:47]
    buffer_load_dwordx4 v18, s[8:11], s22 offen offset:1024 lds
    v_mfma_f32_16x16x32_bf16 v[44:47], a[124:127], a[44:47], v[44:47]
    ds_read_b64_tr_b16 a[164:165], v6 offset:24576
    v_mul_f32 v40, s20, v40
    v_smfmac_f32_16x16x64_bf16 a[224:227], a[238:241], v[56:63], v26
    v_exp_f32 v40, v40
    v_mul_f32 v41, s20, v41
    v_mul_f32 v42, s20, v42
    v_mfma_f32_16x16x32_bf16 v[96:99], a[160:163], v[60:63], v[96:99]
    ds_read_b64_tr_b16 a[166:167], v36 offset:24576
    v_mul_f32 v43, s20, v43
    v_mfma_f32_16x16x32_bf16 v[100:103], a[168:171], v[60:63], v[100:103]
    v_exp_f32 v41, v41
    v_mfma_f32_16x16x32_bf16 v[104:107], a[176:179], v[60:63], v[104:107]
    v_exp_f32 v42, v42
    v_mfma_f32_16x16x32_bf16 v[108:111], a[184:187], v[60:63], v[108:111]
    ds_read_b64_tr_b16 a[172:173], v6 offset:24584
    v_mul_f32 v44, s20, v44
    v_mfma_f32_16x16x32_bf16 v[112:115], a[192:195], v[60:63], v[112:115]
    v_exp_f32 v43, v43
    v_mfma_f32_16x16x32_bf16 v[116:119], a[200:203], v[60:63], v[116:119]
    v_exp_f32 v44, v44
    v_mfma_f32_16x16x32_bf16 v[120:123], a[208:211], v[60:63], v[120:123]
    ds_read_b64_tr_b16 a[174:175], v36 offset:24584
    v_mul_f32 v45, s20, v45
    v_mfma_f32_16x16x32_bf16 v[124:127], a[216:219], v[60:63], v[124:127]
    v_mul_f32 v46, s20, v46
    v_mul_f32 v47, s20, v47
    v_mfma_f32_16x16x32_bf16 v[48:51], a[96:99], a[48:51], 0
    v_exp_f32 v45, v45
    v_mfma_f32_16x16x32_bf16 v[48:51], a[100:103], a[52:55], v[48:51]
    v_cvt_pk_bf16_f32 v56, v40, v41
    v_cvt_pk_bf16_f32 v57, v42, v43
    v_mfma_f32_16x16x32_bf16 v[48:51], a[104:107], a[56:59], v[48:51]
    v_exp_f32 v46, v46
    v_mfma_f32_16x16x32_bf16 v[48:51], a[108:111], a[60:63], v[48:51]
    v_exp_f32 v47, v47
    v_mfma_f32_16x16x32_bf16 v[52:55], a[112:115], a[48:51], 0
    s_add_u32 m0, s35, 49152
    v_cvt_pk_bf16_f32 v58, v44, v45
    v_cvt_pk_bf16_f32 v59, v46, v47
    v_mfma_f32_16x16x32_bf16 v[52:55], a[116:119], a[52:55], v[52:55]
    buffer_load_dwordx4 v19, s[12:15], s22 offen lds
    v_mfma_f32_16x16x32_bf16 v[52:55], a[120:123], a[56:59], v[52:55]
    ds_read_b64_tr_b16 a[180:181], v7 offset:24576
    v_mul_f32 v48, s20, v48
    v_mfma_f32_16x16x32_bf16 v[52:55], a[124:127], a[60:63], v[52:55]
    v_exp_f32 v48, v48

    v_mfma_f32_16x16x32_bf16 v[128:131], a[160:163], v[56:59], v[128:131]
    v_mul_f32 v49, s20, v49
    v_mul_f32 v50, s20, v50
    v_mfma_f32_16x16x32_bf16 v[132:135], a[168:171], v[56:59], v[132:135]
    ds_read_b64_tr_b16 a[182:183], v37 offset:24576
    v_mul_f32 v51, s20, v51
    v_mfma_f32_16x16x32_bf16 v[136:139], a[176:179], v[56:59], v[136:139]
    v_exp_f32 v49, v49
    v_mfma_f32_16x16x32_bf16 v[140:143], a[184:187], v[56:59], v[140:143]
    v_exp_f32 v50, v50
    v_mfma_f32_16x16x32_bf16 v[144:147], a[192:195], v[56:59], v[144:147]
    ds_read_b64_tr_b16 a[188:189], v7 offset:24584
    v_mul_f32 v52, s20, v52
    v_mfma_f32_16x16x32_bf16 v[148:151], a[200:203], v[56:59], v[148:151]
    v_exp_f32 v51, v51
    v_mfma_f32_16x16x32_bf16 v[152:155], a[208:211], v[56:59], v[152:155]
    v_exp_f32 v52, v52
    v_mfma_f32_16x16x32_bf16 v[156:159], a[216:219], v[56:59], v[156:159]
    ds_read_b64_tr_b16 a[190:191], v37 offset:24584
    v_mul_f32 v53, s20, v53
    v_mfma_f32_16x16x32_bf16 v[40:43], a[96:99], a[64:67], 0
    v_mul_f32 v54, s20, v54
    v_mul_f32 v55, s20, v55
    v_mfma_f32_16x16x32_bf16 v[40:43], a[100:103], a[68:71], v[40:43]
    v_exp_f32 v53, v53
    v_mfma_f32_16x16x32_bf16 v[40:43], a[104:107], a[72:75], v[40:43]
    v_cvt_pk_bf16_f32 v60, v48, v49
    v_cvt_pk_bf16_f32 v61, v50, v51
    v_mfma_f32_16x16x32_bf16 v[40:43], a[108:111], a[76:79], v[40:43]
    v_exp_f32 v54, v54
    v_mfma_f32_16x16x32_bf16 v[44:47], a[112:115], a[64:67], 0
    s_add_u32 s28, s24, 4096
    v_exp_f32 v55, v55
    v_mfma_f32_16x16x32_bf16 v[44:47], a[116:119], a[68:71], v[44:47]
    s_add_u32 s32, s31, 4096
    v_cvt_pk_bf16_f32 v62, v52, v53
    v_cvt_pk_bf16_f32 v63, v54, v55
    v_mfma_f32_16x16x32_bf16 v[44:47], a[120:123], a[72:75], v[44:47]
    buffer_load_dwordx4 v19, s[12:15], s22 offen offset:1024 lds
    v_mfma_f32_16x16x32_bf16 v[44:47], a[124:127], a[76:79], v[44:47]
    s_add_u32 m0, s30, 4096
    ds_read_b64_tr_b16 a[196:197], v8 offset:24576
    v_mul_f32 v40, s20, v40
    v_smfmac_f32_16x16x64_bf16 a[228:231], a[238:241], v[56:63], v26
    buffer_store_dwordx4 v[28:31], v14, s[16:19], s32 offen nt
    buffer_load_dwordx4 v14, s[4:7], s28 offen nt lds
    v_exp_f32 v40, v40
    v_mul_f32 v41, s20, v41
    v_mul_f32 v42, s20, v42
    v_mfma_f32_16x16x32_bf16 v[160:163], a[160:163], v[60:63], v[160:163]
    s_xor_b32 s22, s22, 8192
    ds_read_b64_tr_b16 a[198:199], v38 offset:24576
    v_mul_f32 v43, s20, v43
    v_mfma_f32_16x16x32_bf16 v[164:167], a[168:171], v[60:63], v[164:167]
    v_exp_f32 v41, v41
    v_mfma_f32_16x16x32_bf16 v[168:171], a[176:179], v[60:63], v[168:171]
    v_exp_f32 v42, v42
    v_mfma_f32_16x16x32_bf16 v[172:175], a[184:187], v[60:63], v[172:175]
    ds_read_b64_tr_b16 a[204:205], v8 offset:24584
    v_mul_f32 v44, s20, v44
    v_mfma_f32_16x16x32_bf16 v[176:179], a[192:195], v[60:63], v[176:179]
    v_exp_f32 v43, v43
    v_mfma_f32_16x16x32_bf16 v[180:183], a[200:203], v[60:63], v[180:183]
    v_exp_f32 v44, v44
    v_mfma_f32_16x16x32_bf16 v[184:187], a[208:211], v[60:63], v[184:187]
    ds_read_b64_tr_b16 a[206:207], v38 offset:24584
    v_mul_f32 v45, s20, v45
    v_mfma_f32_16x16x32_bf16 v[188:191], a[216:219], v[60:63], v[188:191]
    v_mul_f32 v46, s20, v46
    v_mul_f32 v47, s20, v47
    v_mfma_f32_16x16x32_bf16 v[48:51], a[96:99], a[80:83], 0
    v_exp_f32 v45, v45
    v_mfma_f32_16x16x32_bf16 v[48:51], a[100:103], a[84:87], v[48:51]
    v_cvt_pk_bf16_f32 v56, v40, v41
    v_cvt_pk_bf16_f32 v57, v42, v43
    v_mfma_f32_16x16x32_bf16 v[48:51], a[104:107], a[88:91], v[48:51]
    v_exp_f32 v46, v46
    v_mfma_f32_16x16x32_bf16 v[48:51], a[108:111], a[92:95], v[48:51]
    v_exp_f32 v47, v47
    v_mfma_f32_16x16x32_bf16 v[52:55], a[112:115], a[80:83], 0
    v_cvt_pk_bf16_f32 v58, v44, v45
    v_cvt_pk_bf16_f32 v59, v46, v47
    v_mfma_f32_16x16x32_bf16 v[52:55], a[116:119], a[84:87], v[52:55]
    ds_read_b128 v[28:31], v24 offset:5120
    v_mfma_f32_16x16x32_bf16 v[52:55], a[120:123], a[88:91], v[52:55]
    ds_read_b64_tr_b16 a[212:213], v9 offset:24576
    v_mul_f32 v48, s20, v48
    v_mfma_f32_16x16x32_bf16 v[52:55], a[124:127], a[92:95], v[52:55]
    v_exp_f32 v48, v48

    v_mfma_f32_16x16x32_bf16 v[192:195], a[160:163], v[56:59], v[192:195]
    v_mul_f32 v49, s20, v49
    v_mul_f32 v50, s20, v50
    v_mfma_f32_16x16x32_bf16 v[196:199], a[168:171], v[56:59], v[196:199]
    ds_read_b64_tr_b16 a[214:215], v39 offset:24576
    v_mul_f32 v51, s20, v51
    v_mfma_f32_16x16x32_bf16 v[200:203], a[176:179], v[56:59], v[200:203]
    v_exp_f32 v49, v49
    v_mfma_f32_16x16x32_bf16 v[204:207], a[184:187], v[56:59], v[204:207]
    v_exp_f32 v50, v50
    v_mfma_f32_16x16x32_bf16 v[208:211], a[192:195], v[56:59], v[208:211]
    ds_read_b64_tr_b16 a[220:221], v9 offset:24584
    v_mul_f32 v52, s20, v52
    v_mfma_f32_16x16x32_bf16 v[212:215], a[200:203], v[56:59], v[212:215]
    v_exp_f32 v51, v51
    v_mfma_f32_16x16x32_bf16 v[216:219], a[208:211], v[56:59], v[216:219]
    v_exp_f32 v52, v52
    v_mfma_f32_16x16x32_bf16 v[220:223], a[216:219], v[56:59], v[220:223]
    s_waitcnt lgkmcnt(15)
    ds_read_b64_tr_b16 a[222:223], v39 offset:24584
    v_mul_f32 v53, s20, v53
L_A3:
    v_mfma_f32_16x16x32_bf16 v[40:43], a[128:131], a[0:3], 0
    v_mul_f32 v54, s20, v54
    v_mul_f32 v55, s20, v55
    v_mfma_f32_16x16x32_bf16 v[40:43], a[132:135], a[4:7], v[40:43]
    v_exp_f32 v53, v53
    v_mfma_f32_16x16x32_bf16 v[40:43], a[136:139], a[8:11], v[40:43]
    v_cvt_pk_bf16_f32 v60, v48, v49
    v_cvt_pk_bf16_f32 v61, v50, v51
    v_mfma_f32_16x16x32_bf16 v[40:43], a[140:143], a[12:15], v[40:43]
    v_exp_f32 v54, v54
    v_mfma_f32_16x16x32_bf16 v[44:47], a[144:147], a[0:3], 0
    v_exp_f32 v55, v55
    v_mfma_f32_16x16x32_bf16 v[44:47], a[148:151], a[4:7], v[44:47]
    s_waitcnt vmcnt(16) lgkmcnt(0)
    v_cvt_pk_bf16_f32 v62, v52, v53
    v_cvt_pk_bf16_f32 v63, v54, v55
    v_mfma_f32_16x16x32_bf16 v[44:47], a[152:155], a[8:11], v[44:47]
    s_barrier
    v_mfma_f32_16x16x32_bf16 v[44:47], a[156:159], a[12:15], v[44:47]
    ds_read_b128 a[96:99], v2 offset:0
    v_mul_f32 v40, s20, v40
    v_smfmac_f32_16x16x64_bf16 a[232:235], a[238:241], v[56:63], v26
    v_exp_f32 v40, v40
    v_mul_f32 v41, s20, v41
    v_mul_f32 v42, s20, v42
    v_mfma_f32_16x16x32_bf16 v[224:227], a[160:163], v[60:63], v[224:227]
    ds_read_b128 a[100:103], v3 offset:0
    v_mul_f32 v43, s20, v43
    v_mfma_f32_16x16x32_bf16 v[228:231], a[168:171], v[60:63], v[228:231]
    v_exp_f32 v41, v41
    v_mfma_f32_16x16x32_bf16 v[232:235], a[176:179], v[60:63], v[232:235]
    v_exp_f32 v42, v42
    v_mfma_f32_16x16x32_bf16 v[236:239], a[184:187], v[60:63], v[236:239]
    ds_read_b128 a[104:107], v4 offset:0
    v_mul_f32 v44, s20, v44
    v_mfma_f32_16x16x32_bf16 v[240:243], a[192:195], v[60:63], v[240:243]
    v_exp_f32 v43, v43
    v_mfma_f32_16x16x32_bf16 v[244:247], a[200:203], v[60:63], v[244:247]
    v_exp_f32 v44, v44
    v_mfma_f32_16x16x32_bf16 v[248:251], a[208:211], v[60:63], v[248:251]
    ds_read_b128 a[108:111], v5 offset:0
    v_mul_f32 v45, s20, v45
    v_mfma_f32_16x16x32_bf16 v[252:255], a[216:219], v[60:63], v[252:255]
    v_mul_f32 v46, s20, v46
    v_mul_f32 v47, s20, v47
    v_mfma_f32_16x16x32_bf16 v[48:51], a[128:131], a[16:19], 0
    v_exp_f32 v45, v45
    v_mfma_f32_16x16x32_bf16 v[48:51], a[132:135], a[20:23], v[48:51]
    v_cvt_pk_bf16_f32 v56, v40, v41
    v_cvt_pk_bf16_f32 v57, v42, v43
    v_mfma_f32_16x16x32_bf16 v[48:51], a[136:139], a[24:27], v[48:51]
    v_exp_f32 v46, v46
    v_mfma_f32_16x16x32_bf16 v[48:51], a[140:143], a[28:31], v[48:51]
    v_exp_f32 v47, v47
    v_mfma_f32_16x16x32_bf16 v[52:55], a[144:147], a[16:19], 0
    s_add_u32 m0, s35, 24576
    v_cvt_pk_bf16_f32 v58, v44, v45
    v_cvt_pk_bf16_f32 v59, v46, v47
    v_mfma_f32_16x16x32_bf16 v[52:55], a[148:151], a[20:23], v[52:55]
    buffer_load_dwordx4 v18, s[8:11], s22 offen lds
    v_mfma_f32_16x16x32_bf16 v[52:55], a[152:155], a[24:27], v[52:55]
    ds_read_b128 a[112:115], v0 offset:0
    v_mul_f32 v48, s20, v48
    v_mfma_f32_16x16x32_bf16 v[52:55], a[156:159], a[28:31], v[52:55]
    v_exp_f32 v48, v48

    v_mfma_f32_16x16x32_bf16 v[64:67], a[164:167], v[56:59], v[64:67]
    v_mul_f32 v49, s20, v49
    v_mul_f32 v50, s20, v50
    v_mfma_f32_16x16x32_bf16 v[68:71], a[172:175], v[56:59], v[68:71]
    ds_read_b128 a[116:119], v1 offset:0
    v_mul_f32 v51, s20, v51
    v_mfma_f32_16x16x32_bf16 v[72:75], a[180:183], v[56:59], v[72:75]
    v_exp_f32 v49, v49
    v_mfma_f32_16x16x32_bf16 v[76:79], a[188:191], v[56:59], v[76:79]
    v_exp_f32 v50, v50
    v_mfma_f32_16x16x32_bf16 v[80:83], a[196:199], v[56:59], v[80:83]
    ds_read_b128 a[120:123], v25 offset:0
    v_mul_f32 v52, s20, v52
    v_mfma_f32_16x16x32_bf16 v[84:87], a[204:207], v[56:59], v[84:87]
    v_exp_f32 v51, v51
    v_mfma_f32_16x16x32_bf16 v[88:91], a[212:215], v[56:59], v[88:91]
    v_exp_f32 v52, v52
    v_mfma_f32_16x16x32_bf16 v[92:95], a[220:223], v[56:59], v[92:95]
    ds_read_b128 a[124:127], v27 offset:0
    v_mul_f32 v53, s20, v53
    v_mfma_f32_16x16x32_bf16 v[40:43], a[128:131], a[32:35], 0
    v_mul_f32 v54, s20, v54
    v_mul_f32 v55, s20, v55
    v_mfma_f32_16x16x32_bf16 v[40:43], a[132:135], a[36:39], v[40:43]
    v_exp_f32 v53, v53
    v_mfma_f32_16x16x32_bf16 v[40:43], a[136:139], a[40:43], v[40:43]
    v_cvt_pk_bf16_f32 v60, v48, v49
    v_cvt_pk_bf16_f32 v61, v50, v51
    v_mfma_f32_16x16x32_bf16 v[40:43], a[140:143], a[44:47], v[40:43]
    v_exp_f32 v54, v54
    v_mfma_f32_16x16x32_bf16 v[44:47], a[144:147], a[32:35], 0
    v_exp_f32 v55, v55
    v_mfma_f32_16x16x32_bf16 v[44:47], a[148:151], a[36:39], v[44:47]
    v_cvt_pk_bf16_f32 v62, v52, v53
    v_cvt_pk_bf16_f32 v63, v54, v55
    v_mfma_f32_16x16x32_bf16 v[44:47], a[152:155], a[40:43], v[44:47]
    buffer_load_dwordx4 v18, s[8:11], s22 offen offset:1024 lds
    v_mfma_f32_16x16x32_bf16 v[44:47], a[156:159], a[44:47], v[44:47]
    ds_read_b64_tr_b16 a[160:161], v6 offset:0
    v_mul_f32 v40, s20, v40
    v_smfmac_f32_16x16x64_bf16 a[224:227], a[238:241], v[56:63], v26
    v_exp_f32 v40, v40
    v_mul_f32 v41, s20, v41
    v_mul_f32 v42, s20, v42
    v_mfma_f32_16x16x32_bf16 v[96:99], a[164:167], v[60:63], v[96:99]
    ds_read_b64_tr_b16 a[162:163], v36 offset:0
    v_mul_f32 v43, s20, v43
    v_mfma_f32_16x16x32_bf16 v[100:103], a[172:175], v[60:63], v[100:103]
    v_exp_f32 v41, v41
    v_mfma_f32_16x16x32_bf16 v[104:107], a[180:183], v[60:63], v[104:107]
    v_exp_f32 v42, v42
    v_mfma_f32_16x16x32_bf16 v[108:111], a[188:191], v[60:63], v[108:111]
    ds_read_b64_tr_b16 a[168:169], v6 offset:8
    v_mul_f32 v44, s20, v44
    v_mfma_f32_16x16x32_bf16 v[112:115], a[196:199], v[60:63], v[112:115]
    v_exp_f32 v43, v43
    v_mfma_f32_16x16x32_bf16 v[116:119], a[204:207], v[60:63], v[116:119]
    v_exp_f32 v44, v44
    v_mfma_f32_16x16x32_bf16 v[120:123], a[212:215], v[60:63], v[120:123]
    ds_read_b64_tr_b16 a[170:171], v36 offset:8
    v_mul_f32 v45, s20, v45
    v_mfma_f32_16x16x32_bf16 v[124:127], a[220:223], v[60:63], v[124:127]
    v_mul_f32 v46, s20, v46
    v_mul_f32 v47, s20, v47
    v_mfma_f32_16x16x32_bf16 v[48:51], a[128:131], a[48:51], 0
    v_exp_f32 v45, v45
    v_mfma_f32_16x16x32_bf16 v[48:51], a[132:135], a[52:55], v[48:51]
    v_cvt_pk_bf16_f32 v56, v40, v41
    v_cvt_pk_bf16_f32 v57, v42, v43
    v_mfma_f32_16x16x32_bf16 v[48:51], a[136:139], a[56:59], v[48:51]
    v_exp_f32 v46, v46
    v_mfma_f32_16x16x32_bf16 v[48:51], a[140:143], a[60:63], v[48:51]
    v_exp_f32 v47, v47
    v_mfma_f32_16x16x32_bf16 v[52:55], a[144:147], a[48:51], 0
    s_add_u32 m0, s35, 57344
    v_cvt_pk_bf16_f32 v58, v44, v45
    v_cvt_pk_bf16_f32 v59, v46, v47
    v_mfma_f32_16x16x32_bf16 v[52:55], a[148:151], a[52:55], v[52:55]
    buffer_load_dwordx4 v19, s[12:15], s22 offen lds
    v_mfma_f32_16x16x32_bf16 v[52:55], a[152:155], a[56:59], v[52:55]
    ds_read_b64_tr_b16 a[176:177], v7 offset:0
    v_mul_f32 v48, s20, v48
    v_mfma_f32_16x16x32_bf16 v[52:55], a[156:159], a[60:63], v[52:55]
    v_exp_f32 v48, v48

    v_mfma_f32_16x16x32_bf16 v[128:131], a[164:167], v[56:59], v[128:131]
    v_mul_f32 v49, s20, v49
    v_mul_f32 v50, s20, v50
    v_mfma_f32_16x16x32_bf16 v[132:135], a[172:175], v[56:59], v[132:135]
    ds_read_b64_tr_b16 a[178:179], v37 offset:0
    v_mul_f32 v51, s20, v51
    v_mfma_f32_16x16x32_bf16 v[136:139], a[180:183], v[56:59], v[136:139]
    v_exp_f32 v49, v49
    v_mfma_f32_16x16x32_bf16 v[140:143], a[188:191], v[56:59], v[140:143]
    v_exp_f32 v50, v50
    v_mfma_f32_16x16x32_bf16 v[144:147], a[196:199], v[56:59], v[144:147]
    ds_read_b64_tr_b16 a[184:185], v7 offset:8
    v_mul_f32 v52, s20, v52
    v_mfma_f32_16x16x32_bf16 v[148:151], a[204:207], v[56:59], v[148:151]
    v_exp_f32 v51, v51
    v_mfma_f32_16x16x32_bf16 v[152:155], a[212:215], v[56:59], v[152:155]
    v_exp_f32 v52, v52
    v_mfma_f32_16x16x32_bf16 v[156:159], a[220:223], v[56:59], v[156:159]
    ds_read_b64_tr_b16 a[186:187], v37 offset:8
    v_mul_f32 v53, s20, v53
    v_mfma_f32_16x16x32_bf16 v[40:43], a[128:131], a[64:67], 0
    v_mul_f32 v54, s20, v54
    v_mul_f32 v55, s20, v55
    v_mfma_f32_16x16x32_bf16 v[40:43], a[132:135], a[68:71], v[40:43]
    v_exp_f32 v53, v53
    v_mfma_f32_16x16x32_bf16 v[40:43], a[136:139], a[72:75], v[40:43]
    v_cvt_pk_bf16_f32 v60, v48, v49
    v_cvt_pk_bf16_f32 v61, v50, v51
    v_mfma_f32_16x16x32_bf16 v[40:43], a[140:143], a[76:79], v[40:43]
    v_exp_f32 v54, v54
    v_mfma_f32_16x16x32_bf16 v[44:47], a[144:147], a[64:67], 0
    v_exp_f32 v55, v55
    v_mfma_f32_16x16x32_bf16 v[44:47], a[148:151], a[68:71], v[44:47]
    v_cvt_pk_bf16_f32 v62, v52, v53
    v_cvt_pk_bf16_f32 v63, v54, v55
    v_mfma_f32_16x16x32_bf16 v[44:47], a[152:155], a[72:75], v[44:47]
    buffer_load_dwordx4 v19, s[12:15], s22 offen offset:1024 lds
    v_mfma_f32_16x16x32_bf16 v[44:47], a[156:159], a[76:79], v[44:47]
    s_add_u32 m0, s30, 4096
    ds_read_b64_tr_b16 a[192:193], v8 offset:0
    v_mul_f32 v40, s20, v40
    v_smfmac_f32_16x16x64_bf16 a[228:231], a[238:241], v[56:63], v26
    buffer_store_dwordx4 v[28:31], v15, s[16:19], s32 offen offset:1024 nt
    buffer_load_dwordx4 v15, s[4:7], s28 offen offset:1024 nt lds
    v_exp_f32 v40, v40
    v_mul_f32 v41, s20, v41
    v_mul_f32 v42, s20, v42
    v_mfma_f32_16x16x32_bf16 v[160:163], a[164:167], v[60:63], v[160:163]
    s_xor_b32 s22, s22, 122880
    ds_read_b64_tr_b16 a[194:195], v38 offset:0
    v_mul_f32 v43, s20, v43
    v_mfma_f32_16x16x32_bf16 v[164:167], a[172:175], v[60:63], v[164:167]
    v_exp_f32 v41, v41
    v_mfma_f32_16x16x32_bf16 v[168:171], a[180:183], v[60:63], v[168:171]
    v_exp_f32 v42, v42
    v_mfma_f32_16x16x32_bf16 v[172:175], a[188:191], v[60:63], v[172:175]
    ds_read_b64_tr_b16 a[200:201], v8 offset:8
    v_mul_f32 v44, s20, v44
    v_mfma_f32_16x16x32_bf16 v[176:179], a[196:199], v[60:63], v[176:179]
    v_exp_f32 v43, v43
    v_mfma_f32_16x16x32_bf16 v[180:183], a[204:207], v[60:63], v[180:183]
    v_exp_f32 v44, v44
    v_mfma_f32_16x16x32_bf16 v[184:187], a[212:215], v[60:63], v[184:187]
    ds_read_b64_tr_b16 a[202:203], v38 offset:8
    v_mul_f32 v45, s20, v45
    v_mfma_f32_16x16x32_bf16 v[188:191], a[220:223], v[60:63], v[188:191]
    v_mul_f32 v46, s20, v46
    v_mul_f32 v47, s20, v47
    v_mfma_f32_16x16x32_bf16 v[48:51], a[128:131], a[80:83], 0
    v_exp_f32 v45, v45
    v_mfma_f32_16x16x32_bf16 v[48:51], a[132:135], a[84:87], v[48:51]
    v_cvt_pk_bf16_f32 v56, v40, v41
    v_cvt_pk_bf16_f32 v57, v42, v43
    v_mfma_f32_16x16x32_bf16 v[48:51], a[136:139], a[88:91], v[48:51]
    v_exp_f32 v46, v46
    v_mfma_f32_16x16x32_bf16 v[48:51], a[140:143], a[92:95], v[48:51]
    v_exp_f32 v47, v47
    v_mfma_f32_16x16x32_bf16 v[52:55], a[144:147], a[80:83], 0
    v_cvt_pk_bf16_f32 v58, v44, v45
    v_cvt_pk_bf16_f32 v59, v46, v47
    v_mfma_f32_16x16x32_bf16 v[52:55], a[148:151], a[84:87], v[52:55]
    ds_read_b128 v[28:31], v24 offset:6144
    v_mfma_f32_16x16x32_bf16 v[52:55], a[152:155], a[88:91], v[52:55]
    ds_read_b64_tr_b16 a[208:209], v9 offset:0
    v_mul_f32 v48, s20, v48
    v_mfma_f32_16x16x32_bf16 v[52:55], a[156:159], a[92:95], v[52:55]
    v_exp_f32 v48, v48

    v_mfma_f32_16x16x32_bf16 v[192:195], a[164:167], v[56:59], v[192:195]
    v_mul_f32 v49, s20, v49
    v_mul_f32 v50, s20, v50
    v_mfma_f32_16x16x32_bf16 v[196:199], a[172:175], v[56:59], v[196:199]
    ds_read_b64_tr_b16 a[210:211], v39 offset:0
    v_mul_f32 v51, s20, v51
    v_mfma_f32_16x16x32_bf16 v[200:203], a[180:183], v[56:59], v[200:203]
    v_exp_f32 v49, v49
    v_mfma_f32_16x16x32_bf16 v[204:207], a[188:191], v[56:59], v[204:207]
    v_exp_f32 v50, v50
    v_mfma_f32_16x16x32_bf16 v[208:211], a[196:199], v[56:59], v[208:211]
    ds_read_b64_tr_b16 a[216:217], v9 offset:8
    v_mul_f32 v52, s20, v52
    v_mfma_f32_16x16x32_bf16 v[212:215], a[204:207], v[56:59], v[212:215]
    v_exp_f32 v51, v51
    v_mfma_f32_16x16x32_bf16 v[216:219], a[212:215], v[56:59], v[216:219]
    v_exp_f32 v52, v52
    v_mfma_f32_16x16x32_bf16 v[220:223], a[220:223], v[56:59], v[220:223]
    s_waitcnt lgkmcnt(15)
    ds_read_b64_tr_b16 a[218:219], v39 offset:8
    v_mul_f32 v53, s20, v53
L_A4:
    v_mfma_f32_16x16x32_bf16 v[40:43], a[96:99], a[0:3], 0
    v_mul_f32 v54, s20, v54
    v_mul_f32 v55, s20, v55
    v_mfma_f32_16x16x32_bf16 v[40:43], a[100:103], a[4:7], v[40:43]
    v_exp_f32 v53, v53
    v_mfma_f32_16x16x32_bf16 v[40:43], a[104:107], a[8:11], v[40:43]
    v_cvt_pk_bf16_f32 v60, v48, v49
    v_cvt_pk_bf16_f32 v61, v50, v51
    v_mfma_f32_16x16x32_bf16 v[40:43], a[108:111], a[12:15], v[40:43]
    v_exp_f32 v54, v54
    v_mfma_f32_16x16x32_bf16 v[44:47], a[112:115], a[0:3], 0
    v_exp_f32 v55, v55
    v_mfma_f32_16x16x32_bf16 v[44:47], a[116:119], a[4:7], v[44:47]
    s_waitcnt vmcnt(14) lgkmcnt(0)
    v_cvt_pk_bf16_f32 v62, v52, v53
    v_cvt_pk_bf16_f32 v63, v54, v55
    v_mfma_f32_16x16x32_bf16 v[44:47], a[120:123], a[8:11], v[44:47]
    s_barrier
    v_mfma_f32_16x16x32_bf16 v[44:47], a[124:127], a[12:15], v[44:47]
    ds_read_b128 a[128:131], v2 offset:8192
    v_mul_f32 v40, s20, v40
    v_smfmac_f32_16x16x64_bf16 a[232:235], a[238:241], v[56:63], v26
    v_exp_f32 v40, v40
    v_mul_f32 v41, s20, v41
    v_mul_f32 v42, s20, v42
    v_mfma_f32_16x16x32_bf16 v[224:227], a[164:167], v[60:63], v[224:227]
    ds_read_b128 a[132:135], v3 offset:8192
    v_mul_f32 v43, s20, v43
    v_mfma_f32_16x16x32_bf16 v[228:231], a[172:175], v[60:63], v[228:231]
    v_exp_f32 v41, v41
    v_mfma_f32_16x16x32_bf16 v[232:235], a[180:183], v[60:63], v[232:235]
    v_exp_f32 v42, v42
    v_mfma_f32_16x16x32_bf16 v[236:239], a[188:191], v[60:63], v[236:239]
    ds_read_b128 a[136:139], v4 offset:8192
    v_mul_f32 v44, s20, v44
    v_mfma_f32_16x16x32_bf16 v[240:243], a[196:199], v[60:63], v[240:243]
    v_exp_f32 v43, v43
    v_mfma_f32_16x16x32_bf16 v[244:247], a[204:207], v[60:63], v[244:247]
    v_exp_f32 v44, v44
    v_mfma_f32_16x16x32_bf16 v[248:251], a[212:215], v[60:63], v[248:251]
    ds_read_b128 a[140:143], v5 offset:8192
    v_mul_f32 v45, s20, v45
    v_mfma_f32_16x16x32_bf16 v[252:255], a[220:223], v[60:63], v[252:255]
    v_mul_f32 v46, s20, v46
    v_mul_f32 v47, s20, v47
    v_mfma_f32_16x16x32_bf16 v[48:51], a[96:99], a[16:19], 0
    v_exp_f32 v45, v45
    v_mfma_f32_16x16x32_bf16 v[48:51], a[100:103], a[20:23], v[48:51]
    v_cvt_pk_bf16_f32 v56, v40, v41
    v_cvt_pk_bf16_f32 v57, v42, v43
    v_mfma_f32_16x16x32_bf16 v[48:51], a[104:107], a[24:27], v[48:51]
    v_exp_f32 v46, v46
    v_mfma_f32_16x16x32_bf16 v[48:51], a[108:111], a[28:31], v[48:51]
    v_exp_f32 v47, v47
    v_mfma_f32_16x16x32_bf16 v[52:55], a[112:115], a[16:19], 0
    s_add_u32 m0, s35, 0
    v_cvt_pk_bf16_f32 v58, v44, v45
    v_cvt_pk_bf16_f32 v59, v46, v47
    v_mfma_f32_16x16x32_bf16 v[52:55], a[116:119], a[20:23], v[52:55]
    buffer_load_dwordx4 v18, s[8:11], s22 offen lds
    v_mfma_f32_16x16x32_bf16 v[52:55], a[120:123], a[24:27], v[52:55]
    ds_read_b128 a[144:147], v0 offset:8192
    v_mul_f32 v48, s20, v48
    v_mfma_f32_16x16x32_bf16 v[52:55], a[124:127], a[28:31], v[52:55]
    v_exp_f32 v48, v48

    v_mfma_f32_16x16x32_bf16 v[64:67], a[160:163], v[56:59], v[64:67]
    v_mul_f32 v49, s20, v49
    v_mul_f32 v50, s20, v50
    v_mfma_f32_16x16x32_bf16 v[68:71], a[168:171], v[56:59], v[68:71]
    ds_read_b128 a[148:151], v1 offset:8192
    v_mul_f32 v51, s20, v51
    v_mfma_f32_16x16x32_bf16 v[72:75], a[176:179], v[56:59], v[72:75]
    v_exp_f32 v49, v49
    v_mfma_f32_16x16x32_bf16 v[76:79], a[184:187], v[56:59], v[76:79]
    v_exp_f32 v50, v50
    v_mfma_f32_16x16x32_bf16 v[80:83], a[192:195], v[56:59], v[80:83]
    ds_read_b128 a[152:155], v25 offset:8192
    v_mul_f32 v52, s20, v52
    v_mfma_f32_16x16x32_bf16 v[84:87], a[200:203], v[56:59], v[84:87]
    v_exp_f32 v51, v51
    v_mfma_f32_16x16x32_bf16 v[88:91], a[208:211], v[56:59], v[88:91]
    v_exp_f32 v52, v52
    v_mfma_f32_16x16x32_bf16 v[92:95], a[216:219], v[56:59], v[92:95]
    ds_read_b128 a[156:159], v27 offset:8192
    v_mul_f32 v53, s20, v53
    v_mfma_f32_16x16x32_bf16 v[40:43], a[96:99], a[32:35], 0
    v_mul_f32 v54, s20, v54
    v_mul_f32 v55, s20, v55
    v_mfma_f32_16x16x32_bf16 v[40:43], a[100:103], a[36:39], v[40:43]
    v_exp_f32 v53, v53
    v_mfma_f32_16x16x32_bf16 v[40:43], a[104:107], a[40:43], v[40:43]
    v_cvt_pk_bf16_f32 v60, v48, v49
    v_cvt_pk_bf16_f32 v61, v50, v51
    v_mfma_f32_16x16x32_bf16 v[40:43], a[108:111], a[44:47], v[40:43]
    v_exp_f32 v54, v54
    v_mfma_f32_16x16x32_bf16 v[44:47], a[112:115], a[32:35], 0
    v_exp_f32 v55, v55
    v_mfma_f32_16x16x32_bf16 v[44:47], a[116:119], a[36:39], v[44:47]
    v_cvt_pk_bf16_f32 v62, v52, v53
    v_cvt_pk_bf16_f32 v63, v54, v55
    v_mfma_f32_16x16x32_bf16 v[44:47], a[120:123], a[40:43], v[44:47]
    buffer_load_dwordx4 v18, s[8:11], s22 offen offset:1024 lds
    v_mfma_f32_16x16x32_bf16 v[44:47], a[124:127], a[44:47], v[44:47]
    ds_read_b64_tr_b16 a[164:165], v6 offset:8192
    v_mul_f32 v40, s20, v40
    v_smfmac_f32_16x16x64_bf16 a[224:227], a[238:241], v[56:63], v26
    v_exp_f32 v40, v40
    v_mul_f32 v41, s20, v41
    v_mul_f32 v42, s20, v42
    v_mfma_f32_16x16x32_bf16 v[96:99], a[160:163], v[60:63], v[96:99]
    ds_read_b64_tr_b16 a[166:167], v36 offset:8192
    v_mul_f32 v43, s20, v43
    v_mfma_f32_16x16x32_bf16 v[100:103], a[168:171], v[60:63], v[100:103]
    v_exp_f32 v41, v41
    v_mfma_f32_16x16x32_bf16 v[104:107], a[176:179], v[60:63], v[104:107]
    v_exp_f32 v42, v42
    v_mfma_f32_16x16x32_bf16 v[108:111], a[184:187], v[60:63], v[108:111]
    ds_read_b64_tr_b16 a[172:173], v6 offset:8200
    v_mul_f32 v44, s20, v44
    v_mfma_f32_16x16x32_bf16 v[112:115], a[192:195], v[60:63], v[112:115]
    v_exp_f32 v43, v43
    v_mfma_f32_16x16x32_bf16 v[116:119], a[200:203], v[60:63], v[116:119]
    v_exp_f32 v44, v44
    v_mfma_f32_16x16x32_bf16 v[120:123], a[208:211], v[60:63], v[120:123]
    ds_read_b64_tr_b16 a[174:175], v36 offset:8200
    v_mul_f32 v45, s20, v45
    v_mfma_f32_16x16x32_bf16 v[124:127], a[216:219], v[60:63], v[124:127]
    v_mul_f32 v46, s20, v46
    v_mul_f32 v47, s20, v47
    v_mfma_f32_16x16x32_bf16 v[48:51], a[96:99], a[48:51], 0
    v_exp_f32 v45, v45
    v_mfma_f32_16x16x32_bf16 v[48:51], a[100:103], a[52:55], v[48:51]
    v_cvt_pk_bf16_f32 v56, v40, v41
    v_cvt_pk_bf16_f32 v57, v42, v43
    v_mfma_f32_16x16x32_bf16 v[48:51], a[104:107], a[56:59], v[48:51]
    v_exp_f32 v46, v46
    v_mfma_f32_16x16x32_bf16 v[48:51], a[108:111], a[60:63], v[48:51]
    v_exp_f32 v47, v47
    v_mfma_f32_16x16x32_bf16 v[52:55], a[112:115], a[48:51], 0
    s_add_u32 m0, s35, 32768
    v_cvt_pk_bf16_f32 v58, v44, v45
    v_cvt_pk_bf16_f32 v59, v46, v47
    v_mfma_f32_16x16x32_bf16 v[52:55], a[116:119], a[52:55], v[52:55]
    buffer_load_dwordx4 v19, s[12:15], s22 offen lds
    v_mfma_f32_16x16x32_bf16 v[52:55], a[120:123], a[56:59], v[52:55]
    ds_read_b64_tr_b16 a[180:181], v7 offset:8192
    v_mul_f32 v48, s20, v48
    v_mfma_f32_16x16x32_bf16 v[52:55], a[124:127], a[60:63], v[52:55]
    v_exp_f32 v48, v48

    v_mfma_f32_16x16x32_bf16 v[128:131], a[160:163], v[56:59], v[128:131]
    v_mul_f32 v49, s20, v49
    v_mul_f32 v50, s20, v50
    v_mfma_f32_16x16x32_bf16 v[132:135], a[168:171], v[56:59], v[132:135]
    ds_read_b64_tr_b16 a[182:183], v37 offset:8192
    v_mul_f32 v51, s20, v51
    v_mfma_f32_16x16x32_bf16 v[136:139], a[176:179], v[56:59], v[136:139]
    v_exp_f32 v49, v49
    v_mfma_f32_16x16x32_bf16 v[140:143], a[184:187], v[56:59], v[140:143]
    v_exp_f32 v50, v50
    v_mfma_f32_16x16x32_bf16 v[144:147], a[192:195], v[56:59], v[144:147]
    ds_read_b64_tr_b16 a[188:189], v7 offset:8200
    v_mul_f32 v52, s20, v52
    v_mfma_f32_16x16x32_bf16 v[148:151], a[200:203], v[56:59], v[148:151]
    v_exp_f32 v51, v51
    v_mfma_f32_16x16x32_bf16 v[152:155], a[208:211], v[56:59], v[152:155]
    v_exp_f32 v52, v52
    v_mfma_f32_16x16x32_bf16 v[156:159], a[216:219], v[56:59], v[156:159]
    ds_read_b64_tr_b16 a[190:191], v37 offset:8200
    v_mul_f32 v53, s20, v53
    v_mfma_f32_16x16x32_bf16 v[40:43], a[96:99], a[64:67], 0
    v_mul_f32 v54, s20, v54
    v_mul_f32 v55, s20, v55
    v_mfma_f32_16x16x32_bf16 v[40:43], a[100:103], a[68:71], v[40:43]
    v_exp_f32 v53, v53
    v_mfma_f32_16x16x32_bf16 v[40:43], a[104:107], a[72:75], v[40:43]
    v_cvt_pk_bf16_f32 v60, v48, v49
    v_cvt_pk_bf16_f32 v61, v50, v51
    v_mfma_f32_16x16x32_bf16 v[40:43], a[108:111], a[76:79], v[40:43]
    v_exp_f32 v54, v54
    v_mfma_f32_16x16x32_bf16 v[44:47], a[112:115], a[64:67], 0
    v_exp_f32 v55, v55
    v_mfma_f32_16x16x32_bf16 v[44:47], a[116:119], a[68:71], v[44:47]
    v_cvt_pk_bf16_f32 v62, v52, v53
    v_cvt_pk_bf16_f32 v63, v54, v55
    v_mfma_f32_16x16x32_bf16 v[44:47], a[120:123], a[72:75], v[44:47]
    buffer_load_dwordx4 v19, s[12:15], s22 offen offset:1024 lds
    v_mfma_f32_16x16x32_bf16 v[44:47], a[124:127], a[76:79], v[44:47]
    s_add_u32 m0, s30, 4096
    ds_read_b64_tr_b16 a[196:197], v8 offset:8192
    v_mul_f32 v40, s20, v40
    v_smfmac_f32_16x16x64_bf16 a[228:231], a[238:241], v[56:63], v26
    buffer_store_dwordx4 v[28:31], v16, s[16:19], s32 offen offset:2048 nt
    buffer_load_dwordx4 v16, s[4:7], s28 offen offset:2048 nt lds
    v_exp_f32 v40, v40
    v_mul_f32 v41, s20, v41
    v_mul_f32 v42, s20, v42
    v_mfma_f32_16x16x32_bf16 v[160:163], a[160:163], v[60:63], v[160:163]
    s_xor_b32 s22, s22, 8192
    ds_read_b64_tr_b16 a[198:199], v38 offset:8192
    v_mul_f32 v43, s20, v43
    v_mfma_f32_16x16x32_bf16 v[164:167], a[168:171], v[60:63], v[164:167]
    v_exp_f32 v41, v41
    v_mfma_f32_16x16x32_bf16 v[168:171], a[176:179], v[60:63], v[168:171]
    v_exp_f32 v42, v42
    v_mfma_f32_16x16x32_bf16 v[172:175], a[184:187], v[60:63], v[172:175]
    ds_read_b64_tr_b16 a[204:205], v8 offset:8200
    v_mul_f32 v44, s20, v44
    v_mfma_f32_16x16x32_bf16 v[176:179], a[192:195], v[60:63], v[176:179]
    v_exp_f32 v43, v43
    v_mfma_f32_16x16x32_bf16 v[180:183], a[200:203], v[60:63], v[180:183]
    v_exp_f32 v44, v44
    v_mfma_f32_16x16x32_bf16 v[184:187], a[208:211], v[60:63], v[184:187]
    ds_read_b64_tr_b16 a[206:207], v38 offset:8200
    v_mul_f32 v45, s20, v45
    v_mfma_f32_16x16x32_bf16 v[188:191], a[216:219], v[60:63], v[188:191]
    v_mul_f32 v46, s20, v46
    v_mul_f32 v47, s20, v47
    v_mfma_f32_16x16x32_bf16 v[48:51], a[96:99], a[80:83], 0
    v_exp_f32 v45, v45
    v_mfma_f32_16x16x32_bf16 v[48:51], a[100:103], a[84:87], v[48:51]
    v_cvt_pk_bf16_f32 v56, v40, v41
    v_cvt_pk_bf16_f32 v57, v42, v43
    v_mfma_f32_16x16x32_bf16 v[48:51], a[104:107], a[88:91], v[48:51]
    v_exp_f32 v46, v46
    v_mfma_f32_16x16x32_bf16 v[48:51], a[108:111], a[92:95], v[48:51]
    v_exp_f32 v47, v47
    v_mfma_f32_16x16x32_bf16 v[52:55], a[112:115], a[80:83], 0
    v_cvt_pk_bf16_f32 v58, v44, v45
    v_cvt_pk_bf16_f32 v59, v46, v47
    v_mfma_f32_16x16x32_bf16 v[52:55], a[116:119], a[84:87], v[52:55]
    ds_read_b128 v[28:31], v24 offset:7168
    ds_read_b128 v[32:35], v24 offset:8192
    v_mfma_f32_16x16x32_bf16 v[52:55], a[120:123], a[88:91], v[52:55]
    ds_read_b64_tr_b16 a[212:213], v9 offset:8192
    v_mul_f32 v48, s20, v48
    v_mfma_f32_16x16x32_bf16 v[52:55], a[124:127], a[92:95], v[52:55]
    v_exp_f32 v48, v48

    v_mfma_f32_16x16x32_bf16 v[192:195], a[160:163], v[56:59], v[192:195]
    v_mul_f32 v49, s20, v49
    v_mul_f32 v50, s20, v50
    v_mfma_f32_16x16x32_bf16 v[196:199], a[168:171], v[56:59], v[196:199]
    ds_read_b64_tr_b16 a[214:215], v39 offset:8192
    v_mul_f32 v51, s20, v51
    v_mfma_f32_16x16x32_bf16 v[200:203], a[176:179], v[56:59], v[200:203]
    v_exp_f32 v49, v49
    v_mfma_f32_16x16x32_bf16 v[204:207], a[184:187], v[56:59], v[204:207]
    v_exp_f32 v50, v50
    v_mfma_f32_16x16x32_bf16 v[208:211], a[192:195], v[56:59], v[208:211]
    ds_read_b64_tr_b16 a[220:221], v9 offset:8200
    v_mul_f32 v52, s20, v52
    v_mfma_f32_16x16x32_bf16 v[212:215], a[200:203], v[56:59], v[212:215]
    v_exp_f32 v51, v51
    v_mfma_f32_16x16x32_bf16 v[216:219], a[208:211], v[56:59], v[216:219]
    v_exp_f32 v52, v52
    v_mfma_f32_16x16x32_bf16 v[220:223], a[216:219], v[56:59], v[220:223]
    s_waitcnt lgkmcnt(15)
    ds_read_b64_tr_b16 a[222:223], v39 offset:8200
    v_mul_f32 v53, s20, v53
L_A5:
    v_mfma_f32_16x16x32_bf16 v[40:43], a[128:131], a[0:3], 0
    v_mul_f32 v54, s20, v54
    v_mul_f32 v55, s20, v55
    v_mfma_f32_16x16x32_bf16 v[40:43], a[132:135], a[4:7], v[40:43]
    v_exp_f32 v53, v53
    v_mfma_f32_16x16x32_bf16 v[40:43], a[136:139], a[8:11], v[40:43]
    v_cvt_pk_bf16_f32 v60, v48, v49
    v_cvt_pk_bf16_f32 v61, v50, v51
    v_mfma_f32_16x16x32_bf16 v[40:43], a[140:143], a[12:15], v[40:43]
    v_exp_f32 v54, v54
    v_mfma_f32_16x16x32_bf16 v[44:47], a[144:147], a[0:3], 0
    v_exp_f32 v55, v55
    v_mfma_f32_16x16x32_bf16 v[44:47], a[148:151], a[4:7], v[44:47]
    s_waitcnt vmcnt(14) lgkmcnt(0)
    v_cvt_pk_bf16_f32 v62, v52, v53
    v_cvt_pk_bf16_f32 v63, v54, v55
    v_mfma_f32_16x16x32_bf16 v[44:47], a[152:155], a[8:11], v[44:47]
    s_barrier
    v_mfma_f32_16x16x32_bf16 v[44:47], a[156:159], a[12:15], v[44:47]
    ds_read_b128 a[96:99], v2 offset:16384
    v_mul_f32 v40, s20, v40
    v_smfmac_f32_16x16x64_bf16 a[232:235], a[238:241], v[56:63], v26
    v_exp_f32 v40, v40
    v_mul_f32 v41, s20, v41
    v_mul_f32 v42, s20, v42
    v_mfma_f32_16x16x32_bf16 v[224:227], a[160:163], v[60:63], v[224:227]
    ds_read_b128 a[100:103], v3 offset:16384
    v_mul_f32 v43, s20, v43
    v_mfma_f32_16x16x32_bf16 v[228:231], a[168:171], v[60:63], v[228:231]
    v_exp_f32 v41, v41
    v_mfma_f32_16x16x32_bf16 v[232:235], a[176:179], v[60:63], v[232:235]
    v_exp_f32 v42, v42
    v_mfma_f32_16x16x32_bf16 v[236:239], a[184:187], v[60:63], v[236:239]
    ds_read_b128 a[104:107], v4 offset:16384
    v_mul_f32 v44, s20, v44
    v_mfma_f32_16x16x32_bf16 v[240:243], a[192:195], v[60:63], v[240:243]
    v_exp_f32 v43, v43
    v_mfma_f32_16x16x32_bf16 v[244:247], a[200:203], v[60:63], v[244:247]
    v_exp_f32 v44, v44
    v_mfma_f32_16x16x32_bf16 v[248:251], a[208:211], v[60:63], v[248:251]
    ds_read_b128 a[108:111], v5 offset:16384
    v_mul_f32 v45, s20, v45
    v_mfma_f32_16x16x32_bf16 v[252:255], a[216:219], v[60:63], v[252:255]
    v_mul_f32 v46, s20, v46
    v_mul_f32 v47, s20, v47
    v_mfma_f32_16x16x32_bf16 v[48:51], a[128:131], a[16:19], 0
    v_exp_f32 v45, v45
    v_mfma_f32_16x16x32_bf16 v[48:51], a[132:135], a[20:23], v[48:51]
    v_cvt_pk_bf16_f32 v56, v40, v41
    v_cvt_pk_bf16_f32 v57, v42, v43
    v_mfma_f32_16x16x32_bf16 v[48:51], a[136:139], a[24:27], v[48:51]
    v_exp_f32 v46, v46
    v_mfma_f32_16x16x32_bf16 v[48:51], a[140:143], a[28:31], v[48:51]
    v_exp_f32 v47, v47
    v_mfma_f32_16x16x32_bf16 v[52:55], a[144:147], a[16:19], 0
    s_add_u32 m0, s35, 8192
    v_cvt_pk_bf16_f32 v58, v44, v45
    v_cvt_pk_bf16_f32 v59, v46, v47
    v_mfma_f32_16x16x32_bf16 v[52:55], a[148:151], a[20:23], v[52:55]
    buffer_load_dwordx4 v18, s[8:11], s22 offen lds
    v_mfma_f32_16x16x32_bf16 v[52:55], a[152:155], a[24:27], v[52:55]
    ds_read_b128 a[112:115], v0 offset:16384
    v_mul_f32 v48, s20, v48
    v_mfma_f32_16x16x32_bf16 v[52:55], a[156:159], a[28:31], v[52:55]
    v_exp_f32 v48, v48

    v_mfma_f32_16x16x32_bf16 v[64:67], a[164:167], v[56:59], v[64:67]
    v_mul_f32 v49, s20, v49
    v_mul_f32 v50, s20, v50
    v_mfma_f32_16x16x32_bf16 v[68:71], a[172:175], v[56:59], v[68:71]
    ds_read_b128 a[116:119], v1 offset:16384
    v_mul_f32 v51, s20, v51
    v_mfma_f32_16x16x32_bf16 v[72:75], a[180:183], v[56:59], v[72:75]
    v_exp_f32 v49, v49
    v_mfma_f32_16x16x32_bf16 v[76:79], a[188:191], v[56:59], v[76:79]
    v_exp_f32 v50, v50
    v_mfma_f32_16x16x32_bf16 v[80:83], a[196:199], v[56:59], v[80:83]
    ds_read_b128 a[120:123], v25 offset:16384
    v_mul_f32 v52, s20, v52
    v_mfma_f32_16x16x32_bf16 v[84:87], a[204:207], v[56:59], v[84:87]
    v_exp_f32 v51, v51
    v_mfma_f32_16x16x32_bf16 v[88:91], a[212:215], v[56:59], v[88:91]
    v_exp_f32 v52, v52
    v_mfma_f32_16x16x32_bf16 v[92:95], a[220:223], v[56:59], v[92:95]
    ds_read_b128 a[124:127], v27 offset:16384
    v_mul_f32 v53, s20, v53
    v_mfma_f32_16x16x32_bf16 v[40:43], a[128:131], a[32:35], 0
    v_mul_f32 v54, s20, v54
    v_mul_f32 v55, s20, v55
    v_mfma_f32_16x16x32_bf16 v[40:43], a[132:135], a[36:39], v[40:43]
    v_exp_f32 v53, v53
    v_mfma_f32_16x16x32_bf16 v[40:43], a[136:139], a[40:43], v[40:43]
    v_cvt_pk_bf16_f32 v60, v48, v49
    v_cvt_pk_bf16_f32 v61, v50, v51
    v_mfma_f32_16x16x32_bf16 v[40:43], a[140:143], a[44:47], v[40:43]
    v_exp_f32 v54, v54
    v_mfma_f32_16x16x32_bf16 v[44:47], a[144:147], a[32:35], 0
    v_exp_f32 v55, v55
    v_mfma_f32_16x16x32_bf16 v[44:47], a[148:151], a[36:39], v[44:47]
    v_cvt_pk_bf16_f32 v62, v52, v53
    v_cvt_pk_bf16_f32 v63, v54, v55
    v_mfma_f32_16x16x32_bf16 v[44:47], a[152:155], a[40:43], v[44:47]
    buffer_load_dwordx4 v18, s[8:11], s22 offen offset:1024 lds
    v_mfma_f32_16x16x32_bf16 v[44:47], a[156:159], a[44:47], v[44:47]
    ds_read_b64_tr_b16 a[160:161], v6 offset:16384
    v_mul_f32 v40, s20, v40
    v_smfmac_f32_16x16x64_bf16 a[224:227], a[238:241], v[56:63], v26
    v_exp_f32 v40, v40
    v_mul_f32 v41, s20, v41
    v_mul_f32 v42, s20, v42
    v_mfma_f32_16x16x32_bf16 v[96:99], a[164:167], v[60:63], v[96:99]
    ds_read_b64_tr_b16 a[162:163], v36 offset:16384
    v_mul_f32 v43, s20, v43
    v_mfma_f32_16x16x32_bf16 v[100:103], a[172:175], v[60:63], v[100:103]
    v_exp_f32 v41, v41
    v_mfma_f32_16x16x32_bf16 v[104:107], a[180:183], v[60:63], v[104:107]
    v_exp_f32 v42, v42
    v_mfma_f32_16x16x32_bf16 v[108:111], a[188:191], v[60:63], v[108:111]
    ds_read_b64_tr_b16 a[168:169], v6 offset:16392
    v_mul_f32 v44, s20, v44
    v_mfma_f32_16x16x32_bf16 v[112:115], a[196:199], v[60:63], v[112:115]
    v_exp_f32 v43, v43
    v_mfma_f32_16x16x32_bf16 v[116:119], a[204:207], v[60:63], v[116:119]
    v_exp_f32 v44, v44
    v_mfma_f32_16x16x32_bf16 v[120:123], a[212:215], v[60:63], v[120:123]
    ds_read_b64_tr_b16 a[170:171], v36 offset:16392
    v_mul_f32 v45, s20, v45
    v_mfma_f32_16x16x32_bf16 v[124:127], a[220:223], v[60:63], v[124:127]
    v_mul_f32 v46, s20, v46
    v_mul_f32 v47, s20, v47
    v_mfma_f32_16x16x32_bf16 v[48:51], a[128:131], a[48:51], 0
    v_exp_f32 v45, v45
    v_mfma_f32_16x16x32_bf16 v[48:51], a[132:135], a[52:55], v[48:51]
    v_cvt_pk_bf16_f32 v56, v40, v41
    v_cvt_pk_bf16_f32 v57, v42, v43
    v_mfma_f32_16x16x32_bf16 v[48:51], a[136:139], a[56:59], v[48:51]
    v_exp_f32 v46, v46
    v_mfma_f32_16x16x32_bf16 v[48:51], a[140:143], a[60:63], v[48:51]
    v_exp_f32 v47, v47
    v_mfma_f32_16x16x32_bf16 v[52:55], a[144:147], a[48:51], 0
    s_add_u32 m0, s35, 40960
    v_cvt_pk_bf16_f32 v58, v44, v45
    v_cvt_pk_bf16_f32 v59, v46, v47
    v_mfma_f32_16x16x32_bf16 v[52:55], a[148:151], a[52:55], v[52:55]
    buffer_load_dwordx4 v19, s[12:15], s22 offen lds
    v_mfma_f32_16x16x32_bf16 v[52:55], a[152:155], a[56:59], v[52:55]
    ds_read_b64_tr_b16 a[176:177], v7 offset:16384
    v_mul_f32 v48, s20, v48
    v_mfma_f32_16x16x32_bf16 v[52:55], a[156:159], a[60:63], v[52:55]
    v_exp_f32 v48, v48

    v_mfma_f32_16x16x32_bf16 v[128:131], a[164:167], v[56:59], v[128:131]
    v_mul_f32 v49, s20, v49
    v_mul_f32 v50, s20, v50
    v_mfma_f32_16x16x32_bf16 v[132:135], a[172:175], v[56:59], v[132:135]
    ds_read_b64_tr_b16 a[178:179], v37 offset:16384
    v_mul_f32 v51, s20, v51
    v_mfma_f32_16x16x32_bf16 v[136:139], a[180:183], v[56:59], v[136:139]
    v_exp_f32 v49, v49
    v_mfma_f32_16x16x32_bf16 v[140:143], a[188:191], v[56:59], v[140:143]
    v_exp_f32 v50, v50
    v_mfma_f32_16x16x32_bf16 v[144:147], a[196:199], v[56:59], v[144:147]
    ds_read_b64_tr_b16 a[184:185], v7 offset:16392
    v_mul_f32 v52, s20, v52
    v_mfma_f32_16x16x32_bf16 v[148:151], a[204:207], v[56:59], v[148:151]
    v_exp_f32 v51, v51
    v_mfma_f32_16x16x32_bf16 v[152:155], a[212:215], v[56:59], v[152:155]
    v_exp_f32 v52, v52
    v_mfma_f32_16x16x32_bf16 v[156:159], a[220:223], v[56:59], v[156:159]
    ds_read_b64_tr_b16 a[186:187], v37 offset:16392
    v_mul_f32 v53, s20, v53
    v_mfma_f32_16x16x32_bf16 v[40:43], a[128:131], a[64:67], 0
    v_mul_f32 v54, s20, v54
    v_mul_f32 v55, s20, v55
    v_mfma_f32_16x16x32_bf16 v[40:43], a[132:135], a[68:71], v[40:43]
    v_exp_f32 v53, v53
    v_mfma_f32_16x16x32_bf16 v[40:43], a[136:139], a[72:75], v[40:43]
    v_cvt_pk_bf16_f32 v60, v48, v49
    v_cvt_pk_bf16_f32 v61, v50, v51
    v_mfma_f32_16x16x32_bf16 v[40:43], a[140:143], a[76:79], v[40:43]
    v_exp_f32 v54, v54
    v_mfma_f32_16x16x32_bf16 v[44:47], a[144:147], a[64:67], 0
    v_exp_f32 v55, v55
    v_mfma_f32_16x16x32_bf16 v[44:47], a[148:151], a[68:71], v[44:47]
    v_cvt_pk_bf16_f32 v62, v52, v53
    v_cvt_pk_bf16_f32 v63, v54, v55
    v_mfma_f32_16x16x32_bf16 v[44:47], a[152:155], a[72:75], v[44:47]
    buffer_load_dwordx4 v19, s[12:15], s22 offen offset:1024 lds
    v_mfma_f32_16x16x32_bf16 v[44:47], a[156:159], a[76:79], v[44:47]
    s_add_u32 m0, s30, 4096
    ds_read_b64_tr_b16 a[192:193], v8 offset:16384
    v_mul_f32 v40, s20, v40
    v_smfmac_f32_16x16x64_bf16 a[228:231], a[238:241], v[56:63], v26
    buffer_store_dwordx4 v[28:31], v17, s[16:19], s32 offen offset:3072 nt
    buffer_load_dwordx4 v17, s[4:7], s28 offen offset:3072 nt lds
    v_exp_f32 v40, v40
    v_mul_f32 v41, s20, v41
    v_mul_f32 v42, s20, v42
    v_mfma_f32_16x16x32_bf16 v[160:163], a[164:167], v[60:63], v[160:163]
    s_xor_b32 s22, s22, 24576
    ds_read_b64_tr_b16 a[194:195], v38 offset:16384
    v_mul_f32 v43, s20, v43
    v_mfma_f32_16x16x32_bf16 v[164:167], a[172:175], v[60:63], v[164:167]
    v_exp_f32 v41, v41
    v_mfma_f32_16x16x32_bf16 v[168:171], a[180:183], v[60:63], v[168:171]
    v_exp_f32 v42, v42
    v_mfma_f32_16x16x32_bf16 v[172:175], a[188:191], v[60:63], v[172:175]
    ds_read_b64_tr_b16 a[200:201], v8 offset:16392
    v_mul_f32 v44, s20, v44
    v_mfma_f32_16x16x32_bf16 v[176:179], a[196:199], v[60:63], v[176:179]
    v_exp_f32 v43, v43
    v_mfma_f32_16x16x32_bf16 v[180:183], a[204:207], v[60:63], v[180:183]
    v_exp_f32 v44, v44
    v_mfma_f32_16x16x32_bf16 v[184:187], a[212:215], v[60:63], v[184:187]
    s_add_u32 m0, s30, 8192
    ds_read_b64_tr_b16 a[202:203], v38 offset:16392
    v_mul_f32 v45, s20, v45
    v_mfma_f32_16x16x32_bf16 v[188:191], a[220:223], v[60:63], v[188:191]
    s_add_u32 s28, s24, 8192
    v_mul_f32 v46, s20, v46
    v_mul_f32 v47, s20, v47
    v_mfma_f32_16x16x32_bf16 v[48:51], a[128:131], a[80:83], 0
    s_add_u32 s32, s31, 8192
    v_exp_f32 v45, v45
    v_mfma_f32_16x16x32_bf16 v[48:51], a[132:135], a[84:87], v[48:51]
    buffer_store_dwordx4 v[32:35], v14, s[16:19], s32 offen nt
    buffer_load_dwordx4 v14, s[4:7], s28 offen nt lds
    v_cvt_pk_bf16_f32 v56, v40, v41
    v_cvt_pk_bf16_f32 v57, v42, v43
    v_mfma_f32_16x16x32_bf16 v[48:51], a[136:139], a[88:91], v[48:51]
    v_exp_f32 v46, v46
    v_mfma_f32_16x16x32_bf16 v[48:51], a[140:143], a[92:95], v[48:51]
    v_exp_f32 v47, v47
    v_mfma_f32_16x16x32_bf16 v[52:55], a[144:147], a[80:83], 0
    v_cvt_pk_bf16_f32 v58, v44, v45
    v_cvt_pk_bf16_f32 v59, v46, v47
    v_mfma_f32_16x16x32_bf16 v[52:55], a[148:151], a[84:87], v[52:55]
    ds_read_b128 v[28:31], v24 offset:9216
    v_mfma_f32_16x16x32_bf16 v[52:55], a[152:155], a[88:91], v[52:55]
    ds_read_b64_tr_b16 a[208:209], v9 offset:16384
    v_mul_f32 v48, s20, v48
    v_mfma_f32_16x16x32_bf16 v[52:55], a[156:159], a[92:95], v[52:55]
    v_exp_f32 v48, v48

    v_mfma_f32_16x16x32_bf16 v[192:195], a[164:167], v[56:59], v[192:195]
    v_mul_f32 v49, s20, v49
    v_mul_f32 v50, s20, v50
    v_mfma_f32_16x16x32_bf16 v[196:199], a[172:175], v[56:59], v[196:199]
    ds_read_b64_tr_b16 a[210:211], v39 offset:16384
    v_mul_f32 v51, s20, v51
    v_mfma_f32_16x16x32_bf16 v[200:203], a[180:183], v[56:59], v[200:203]
    v_exp_f32 v49, v49
    v_mfma_f32_16x16x32_bf16 v[204:207], a[188:191], v[56:59], v[204:207]
    v_exp_f32 v50, v50
    v_mfma_f32_16x16x32_bf16 v[208:211], a[196:199], v[56:59], v[208:211]
    ds_read_b64_tr_b16 a[216:217], v9 offset:16392
    v_mul_f32 v52, s20, v52
    v_mfma_f32_16x16x32_bf16 v[212:215], a[204:207], v[56:59], v[212:215]
    v_exp_f32 v51, v51
    v_mfma_f32_16x16x32_bf16 v[216:219], a[212:215], v[56:59], v[216:219]
    v_exp_f32 v52, v52
    v_mfma_f32_16x16x32_bf16 v[220:223], a[220:223], v[56:59], v[220:223]
    s_waitcnt lgkmcnt(15)
    ds_read_b64_tr_b16 a[218:219], v39 offset:16392
    v_mul_f32 v53, s20, v53
L_A6:
    v_mfma_f32_16x16x32_bf16 v[40:43], a[96:99], a[0:3], 0
    v_mul_f32 v54, s20, v54
    v_mul_f32 v55, s20, v55
    v_mfma_f32_16x16x32_bf16 v[40:43], a[100:103], a[4:7], v[40:43]
    v_exp_f32 v53, v53
    v_mfma_f32_16x16x32_bf16 v[40:43], a[104:107], a[8:11], v[40:43]
    v_cvt_pk_bf16_f32 v60, v48, v49
    v_cvt_pk_bf16_f32 v61, v50, v51
    v_mfma_f32_16x16x32_bf16 v[40:43], a[108:111], a[12:15], v[40:43]
    v_exp_f32 v54, v54
    v_mfma_f32_16x16x32_bf16 v[44:47], a[112:115], a[0:3], 0
    v_exp_f32 v55, v55
    v_mfma_f32_16x16x32_bf16 v[44:47], a[116:119], a[4:7], v[44:47]
    s_waitcnt vmcnt(16) lgkmcnt(0)
    v_cvt_pk_bf16_f32 v62, v52, v53
    v_cvt_pk_bf16_f32 v63, v54, v55
    v_mfma_f32_16x16x32_bf16 v[44:47], a[120:123], a[8:11], v[44:47]
    s_barrier
    v_mfma_f32_16x16x32_bf16 v[44:47], a[124:127], a[12:15], v[44:47]
    ds_read_b128 a[128:131], v2 offset:24576
    v_mul_f32 v40, s20, v40
    v_smfmac_f32_16x16x64_bf16 a[232:235], a[238:241], v[56:63], v26
    v_exp_f32 v40, v40
    v_mul_f32 v41, s20, v41
    v_mul_f32 v42, s20, v42
    v_mfma_f32_16x16x32_bf16 v[224:227], a[164:167], v[60:63], v[224:227]
    ds_read_b128 a[132:135], v3 offset:24576
    v_mul_f32 v43, s20, v43
    v_mfma_f32_16x16x32_bf16 v[228:231], a[172:175], v[60:63], v[228:231]
    v_exp_f32 v41, v41
    v_mfma_f32_16x16x32_bf16 v[232:235], a[180:183], v[60:63], v[232:235]
    v_exp_f32 v42, v42
    v_mfma_f32_16x16x32_bf16 v[236:239], a[188:191], v[60:63], v[236:239]
    ds_read_b128 a[136:139], v4 offset:24576
    v_mul_f32 v44, s20, v44
    v_mfma_f32_16x16x32_bf16 v[240:243], a[196:199], v[60:63], v[240:243]
    v_exp_f32 v43, v43
    v_mfma_f32_16x16x32_bf16 v[244:247], a[204:207], v[60:63], v[244:247]
    v_exp_f32 v44, v44
    v_accvgpr_read_b32 v22, a255
    v_mov_b32 v23, s47
    v_mfma_f32_16x16x32_bf16 v[248:251], a[212:215], v[60:63], v[248:251]
    ds_read_b128 a[140:143], v5 offset:24576
    v_mul_f32 v45, s20, v45
    v_mfma_f32_16x16x32_bf16 v[252:255], a[220:223], v[60:63], v[252:255]
    global_load_dword v22, v[22:23], off
    v_mul_f32 v46, s20, v46
    v_mul_f32 v47, s20, v47
    v_mfma_f32_16x16x32_bf16 v[48:51], a[96:99], a[16:19], 0
    v_exp_f32 v45, v45
    v_mfma_f32_16x16x32_bf16 v[48:51], a[100:103], a[20:23], v[48:51]
    v_cvt_pk_bf16_f32 v56, v40, v41
    v_cvt_pk_bf16_f32 v57, v42, v43
    v_mfma_f32_16x16x32_bf16 v[48:51], a[104:107], a[24:27], v[48:51]
    v_exp_f32 v46, v46
    v_mfma_f32_16x16x32_bf16 v[48:51], a[108:111], a[28:31], v[48:51]
    v_exp_f32 v47, v47
    v_mfma_f32_16x16x32_bf16 v[52:55], a[112:115], a[16:19], 0
    s_add_u32 m0, s35, 16384
    v_cvt_pk_bf16_f32 v58, v44, v45
    v_cvt_pk_bf16_f32 v59, v46, v47
    v_mfma_f32_16x16x32_bf16 v[52:55], a[116:119], a[20:23], v[52:55]
    buffer_load_dwordx4 v18, s[8:11], s22 offen lds
    v_mfma_f32_16x16x32_bf16 v[52:55], a[120:123], a[24:27], v[52:55]
    ds_read_b128 a[144:147], v0 offset:24576
    v_mul_f32 v48, s20, v48
    v_mfma_f32_16x16x32_bf16 v[52:55], a[124:127], a[28:31], v[52:55]
    v_exp_f32 v48, v48

    v_mfma_f32_16x16x32_bf16 v[64:67], a[160:163], v[56:59], v[64:67]
    v_mul_f32 v49, s20, v49
    v_mul_f32 v50, s20, v50
    v_mfma_f32_16x16x32_bf16 v[68:71], a[168:171], v[56:59], v[68:71]
    ds_read_b128 a[148:151], v1 offset:24576
    v_mul_f32 v51, s20, v51
    v_mfma_f32_16x16x32_bf16 v[72:75], a[176:179], v[56:59], v[72:75]
    v_exp_f32 v49, v49
    v_mfma_f32_16x16x32_bf16 v[76:79], a[184:187], v[56:59], v[76:79]
    v_exp_f32 v50, v50
    v_mfma_f32_16x16x32_bf16 v[80:83], a[192:195], v[56:59], v[80:83]
    ds_read_b128 a[152:155], v25 offset:24576
    v_mul_f32 v52, s20, v52
    v_mfma_f32_16x16x32_bf16 v[84:87], a[200:203], v[56:59], v[84:87]
    v_exp_f32 v51, v51
    v_mfma_f32_16x16x32_bf16 v[88:91], a[208:211], v[56:59], v[88:91]
    v_exp_f32 v52, v52
    v_mfma_f32_16x16x32_bf16 v[92:95], a[216:219], v[56:59], v[92:95]
    ds_read_b128 a[156:159], v27 offset:24576
    v_mul_f32 v53, s20, v53
    v_mfma_f32_16x16x32_bf16 v[40:43], a[96:99], a[32:35], 0
    v_mul_f32 v54, s20, v54
    v_mul_f32 v55, s20, v55
    v_mfma_f32_16x16x32_bf16 v[40:43], a[100:103], a[36:39], v[40:43]
    v_exp_f32 v53, v53
    v_mfma_f32_16x16x32_bf16 v[40:43], a[104:107], a[40:43], v[40:43]
    v_cvt_pk_bf16_f32 v60, v48, v49
    v_cvt_pk_bf16_f32 v61, v50, v51
    v_mfma_f32_16x16x32_bf16 v[40:43], a[108:111], a[44:47], v[40:43]
    v_exp_f32 v54, v54
    v_mfma_f32_16x16x32_bf16 v[44:47], a[112:115], a[32:35], 0
    v_exp_f32 v55, v55
    v_mfma_f32_16x16x32_bf16 v[44:47], a[116:119], a[36:39], v[44:47]
    v_cvt_pk_bf16_f32 v62, v52, v53
    v_cvt_pk_bf16_f32 v63, v54, v55
    v_mfma_f32_16x16x32_bf16 v[44:47], a[120:123], a[40:43], v[44:47]
    buffer_load_dwordx4 v18, s[8:11], s22 offen offset:1024 lds
    v_mfma_f32_16x16x32_bf16 v[44:47], a[124:127], a[44:47], v[44:47]
    ds_read_b64_tr_b16 a[164:165], v6 offset:24576
    v_mul_f32 v40, s20, v40
    v_smfmac_f32_16x16x64_bf16 a[224:227], a[238:241], v[56:63], v26
    v_exp_f32 v40, v40
    v_mul_f32 v41, s20, v41
    v_mul_f32 v42, s20, v42
    v_mfma_f32_16x16x32_bf16 v[96:99], a[160:163], v[60:63], v[96:99]
    ds_read_b64_tr_b16 a[166:167], v36 offset:24576
    v_mul_f32 v43, s20, v43
    v_mfma_f32_16x16x32_bf16 v[100:103], a[168:171], v[60:63], v[100:103]
    v_exp_f32 v41, v41
    v_mfma_f32_16x16x32_bf16 v[104:107], a[176:179], v[60:63], v[104:107]
    v_exp_f32 v42, v42
    v_mfma_f32_16x16x32_bf16 v[108:111], a[184:187], v[60:63], v[108:111]
    ds_read_b64_tr_b16 a[172:173], v6 offset:24584
    v_mul_f32 v44, s20, v44
    v_mfma_f32_16x16x32_bf16 v[112:115], a[192:195], v[60:63], v[112:115]
    v_exp_f32 v43, v43
    v_mfma_f32_16x16x32_bf16 v[116:119], a[200:203], v[60:63], v[116:119]
    v_exp_f32 v44, v44
    v_mfma_f32_16x16x32_bf16 v[120:123], a[208:211], v[60:63], v[120:123]
    ds_read_b64_tr_b16 a[174:175], v36 offset:24584
    v_mul_f32 v45, s20, v45
    v_mfma_f32_16x16x32_bf16 v[124:127], a[216:219], v[60:63], v[124:127]
    v_mul_f32 v46, s20, v46
    v_mul_f32 v47, s20, v47
    v_mfma_f32_16x16x32_bf16 v[48:51], a[96:99], a[48:51], 0
    v_exp_f32 v45, v45
    v_mfma_f32_16x16x32_bf16 v[48:51], a[100:103], a[52:55], v[48:51]
    v_cvt_pk_bf16_f32 v56, v40, v41
    v_cvt_pk_bf16_f32 v57, v42, v43
    v_mfma_f32_16x16x32_bf16 v[48:51], a[104:107], a[56:59], v[48:51]
    v_exp_f32 v46, v46
    v_mfma_f32_16x16x32_bf16 v[48:51], a[108:111], a[60:63], v[48:51]
    v_exp_f32 v47, v47
    v_mfma_f32_16x16x32_bf16 v[52:55], a[112:115], a[48:51], 0
    s_add_u32 m0, s35, 49152
    v_cvt_pk_bf16_f32 v58, v44, v45
    v_cvt_pk_bf16_f32 v59, v46, v47
    v_mfma_f32_16x16x32_bf16 v[52:55], a[116:119], a[52:55], v[52:55]
    buffer_load_dwordx4 v19, s[12:15], s22 offen lds
    v_mfma_f32_16x16x32_bf16 v[52:55], a[120:123], a[56:59], v[52:55]
    ds_read_b64_tr_b16 a[180:181], v7 offset:24576
    v_mul_f32 v48, s20, v48
    v_mfma_f32_16x16x32_bf16 v[52:55], a[124:127], a[60:63], v[52:55]
    v_exp_f32 v48, v48

    v_mfma_f32_16x16x32_bf16 v[128:131], a[160:163], v[56:59], v[128:131]
    v_mul_f32 v49, s20, v49
    v_mul_f32 v50, s20, v50
    v_mfma_f32_16x16x32_bf16 v[132:135], a[168:171], v[56:59], v[132:135]
    ds_read_b64_tr_b16 a[182:183], v37 offset:24576
    v_mul_f32 v51, s20, v51
    v_mfma_f32_16x16x32_bf16 v[136:139], a[176:179], v[56:59], v[136:139]
    v_exp_f32 v49, v49
    v_mfma_f32_16x16x32_bf16 v[140:143], a[184:187], v[56:59], v[140:143]
    v_exp_f32 v50, v50
    v_mfma_f32_16x16x32_bf16 v[144:147], a[192:195], v[56:59], v[144:147]
    ds_read_b64_tr_b16 a[188:189], v7 offset:24584
    v_mul_f32 v52, s20, v52
    v_mfma_f32_16x16x32_bf16 v[148:151], a[200:203], v[56:59], v[148:151]
    v_exp_f32 v51, v51
    v_mfma_f32_16x16x32_bf16 v[152:155], a[208:211], v[56:59], v[152:155]
    v_exp_f32 v52, v52
    v_mfma_f32_16x16x32_bf16 v[156:159], a[216:219], v[56:59], v[156:159]
    ds_read_b64_tr_b16 a[190:191], v37 offset:24584
    v_mul_f32 v53, s20, v53
    v_mfma_f32_16x16x32_bf16 v[40:43], a[96:99], a[64:67], 0
    v_mul_f32 v54, s20, v54
    v_mul_f32 v55, s20, v55
    v_mfma_f32_16x16x32_bf16 v[40:43], a[100:103], a[68:71], v[40:43]
    v_exp_f32 v53, v53
    v_mfma_f32_16x16x32_bf16 v[40:43], a[104:107], a[72:75], v[40:43]
    v_cvt_pk_bf16_f32 v60, v48, v49
    v_cvt_pk_bf16_f32 v61, v50, v51
    v_mfma_f32_16x16x32_bf16 v[40:43], a[108:111], a[76:79], v[40:43]
    v_exp_f32 v54, v54
    v_mfma_f32_16x16x32_bf16 v[44:47], a[112:115], a[64:67], 0
    v_exp_f32 v55, v55
    v_mfma_f32_16x16x32_bf16 v[44:47], a[116:119], a[68:71], v[44:47]
    v_cvt_pk_bf16_f32 v62, v52, v53
    v_cvt_pk_bf16_f32 v63, v54, v55
    v_mfma_f32_16x16x32_bf16 v[44:47], a[120:123], a[72:75], v[44:47]
    buffer_load_dwordx4 v19, s[12:15], s22 offen offset:1024 lds
    v_mfma_f32_16x16x32_bf16 v[44:47], a[124:127], a[76:79], v[44:47]
    s_add_u32 m0, s30, 8192
    ds_read_b64_tr_b16 a[196:197], v8 offset:24576
    v_mul_f32 v40, s20, v40
    v_smfmac_f32_16x16x64_bf16 a[228:231], a[238:241], v[56:63], v26
    buffer_store_dwordx4 v[28:31], v15, s[16:19], s32 offen offset:1024 nt
    buffer_load_dwordx4 v15, s[4:7], s28 offen offset:1024 nt lds
    v_exp_f32 v40, v40
    v_mul_f32 v41, s20, v41
    v_mul_f32 v42, s20, v42
    v_mfma_f32_16x16x32_bf16 v[160:163], a[160:163], v[60:63], v[160:163]
    s_xor_b32 s22, s22, 8192
    ds_read_b64_tr_b16 a[198:199], v38 offset:24576
    v_mul_f32 v43, s20, v43
    v_mfma_f32_16x16x32_bf16 v[164:167], a[168:171], v[60:63], v[164:167]
    v_exp_f32 v41, v41
    v_mfma_f32_16x16x32_bf16 v[168:171], a[176:179], v[60:63], v[168:171]
    v_exp_f32 v42, v42
    v_mfma_f32_16x16x32_bf16 v[172:175], a[184:187], v[60:63], v[172:175]
    ds_read_b64_tr_b16 a[204:205], v8 offset:24584
    v_mul_f32 v44, s20, v44
    v_mfma_f32_16x16x32_bf16 v[176:179], a[192:195], v[60:63], v[176:179]
    v_exp_f32 v43, v43
    v_mfma_f32_16x16x32_bf16 v[180:183], a[200:203], v[60:63], v[180:183]
    v_exp_f32 v44, v44
    v_mfma_f32_16x16x32_bf16 v[184:187], a[208:211], v[60:63], v[184:187]
    ds_read_b64_tr_b16 a[206:207], v38 offset:24584
    v_mul_f32 v45, s20, v45
    v_mfma_f32_16x16x32_bf16 v[188:191], a[216:219], v[60:63], v[188:191]
    v_mul_f32 v46, s20, v46
    v_mul_f32 v47, s20, v47
    v_mfma_f32_16x16x32_bf16 v[48:51], a[96:99], a[80:83], 0
    v_exp_f32 v45, v45
    v_mfma_f32_16x16x32_bf16 v[48:51], a[100:103], a[84:87], v[48:51]
    v_cvt_pk_bf16_f32 v56, v40, v41
    v_cvt_pk_bf16_f32 v57, v42, v43
    v_mfma_f32_16x16x32_bf16 v[48:51], a[104:107], a[88:91], v[48:51]
    v_exp_f32 v46, v46
    v_mfma_f32_16x16x32_bf16 v[48:51], a[108:111], a[92:95], v[48:51]
    v_exp_f32 v47, v47
    v_mfma_f32_16x16x32_bf16 v[52:55], a[112:115], a[80:83], 0
    v_cvt_pk_bf16_f32 v58, v44, v45
    v_cvt_pk_bf16_f32 v59, v46, v47
    v_mfma_f32_16x16x32_bf16 v[52:55], a[116:119], a[84:87], v[52:55]
    ds_read_b128 v[28:31], v24 offset:10240
    ds_read_b128 v[32:35], v24 offset:11264
    v_mfma_f32_16x16x32_bf16 v[52:55], a[120:123], a[88:91], v[52:55]
    ds_read_b64_tr_b16 a[212:213], v9 offset:24576
    v_mul_f32 v48, s20, v48
    v_mfma_f32_16x16x32_bf16 v[52:55], a[124:127], a[92:95], v[52:55]
    v_exp_f32 v48, v48

    v_mfma_f32_16x16x32_bf16 v[192:195], a[160:163], v[56:59], v[192:195]
    v_mul_f32 v49, s20, v49
    v_mul_f32 v50, s20, v50
    v_mfma_f32_16x16x32_bf16 v[196:199], a[168:171], v[56:59], v[196:199]
    ds_read_b64_tr_b16 a[214:215], v39 offset:24576
    v_mul_f32 v51, s20, v51
    v_mfma_f32_16x16x32_bf16 v[200:203], a[176:179], v[56:59], v[200:203]
    v_exp_f32 v49, v49
    v_mfma_f32_16x16x32_bf16 v[204:207], a[184:187], v[56:59], v[204:207]
    v_exp_f32 v50, v50
    v_mfma_f32_16x16x32_bf16 v[208:211], a[192:195], v[56:59], v[208:211]
    ds_read_b64_tr_b16 a[220:221], v9 offset:24584
    v_mul_f32 v52, s20, v52
    v_mfma_f32_16x16x32_bf16 v[212:215], a[200:203], v[56:59], v[212:215]
    v_exp_f32 v51, v51
    v_mfma_f32_16x16x32_bf16 v[216:219], a[208:211], v[56:59], v[216:219]
    v_exp_f32 v52, v52
    v_mfma_f32_16x16x32_bf16 v[220:223], a[216:219], v[56:59], v[220:223]
    s_waitcnt lgkmcnt(15)
    ds_read_b64_tr_b16 a[222:223], v39 offset:24584
    v_mul_f32 v53, s20, v53
L_A7:
    v_mfma_f32_16x16x32_bf16 v[40:43], a[128:131], a[0:3], 0
    v_mul_f32 v54, s20, v54
    v_mul_f32 v55, s20, v55
    v_mfma_f32_16x16x32_bf16 v[40:43], a[132:135], a[4:7], v[40:43]
    v_exp_f32 v53, v53
    v_mfma_f32_16x16x32_bf16 v[40:43], a[136:139], a[8:11], v[40:43]
    v_cvt_pk_bf16_f32 v60, v48, v49
    v_cvt_pk_bf16_f32 v61, v50, v51
    v_mfma_f32_16x16x32_bf16 v[40:43], a[140:143], a[12:15], v[40:43]
    v_exp_f32 v54, v54
    v_mfma_f32_16x16x32_bf16 v[44:47], a[144:147], a[0:3], 0
    v_exp_f32 v55, v55
    v_mfma_f32_16x16x32_bf16 v[44:47], a[148:151], a[4:7], v[44:47]
    s_waitcnt vmcnt(17) lgkmcnt(0)
    v_cvt_pk_bf16_f32 v62, v52, v53
    v_cvt_pk_bf16_f32 v63, v54, v55
    v_mfma_f32_16x16x32_bf16 v[44:47], a[152:155], a[8:11], v[44:47]
    s_barrier
    v_mfma_f32_16x16x32_bf16 v[44:47], a[156:159], a[12:15], v[44:47]
    ds_read_b128 a[96:99], v2 offset:0
    v_mul_f32 v40, s20, v40
    v_smfmac_f32_16x16x64_bf16 a[232:235], a[238:241], v[56:63], v26
    v_exp_f32 v40, v40
    v_mul_f32 v41, s20, v41
    v_mul_f32 v42, s20, v42
    v_mfma_f32_16x16x32_bf16 v[224:227], a[160:163], v[60:63], v[224:227]
    ds_read_b128 a[100:103], v3 offset:0
    v_mul_f32 v43, s20, v43
    v_mfma_f32_16x16x32_bf16 v[228:231], a[168:171], v[60:63], v[228:231]
    v_exp_f32 v41, v41
    v_mfma_f32_16x16x32_bf16 v[232:235], a[176:179], v[60:63], v[232:235]
    v_exp_f32 v42, v42
    v_mfma_f32_16x16x32_bf16 v[236:239], a[184:187], v[60:63], v[236:239]
    ds_read_b128 a[104:107], v4 offset:0
    v_mul_f32 v44, s20, v44
    v_mfma_f32_16x16x32_bf16 v[240:243], a[192:195], v[60:63], v[240:243]
    v_exp_f32 v43, v43
    v_mfma_f32_16x16x32_bf16 v[244:247], a[200:203], v[60:63], v[244:247]
    v_exp_f32 v44, v44
    v_mfma_f32_16x16x32_bf16 v[248:251], a[208:211], v[60:63], v[248:251]
    ds_read_b128 a[108:111], v5 offset:0
    v_mul_f32 v45, s20, v45
    v_mfma_f32_16x16x32_bf16 v[252:255], a[216:219], v[60:63], v[252:255]
    v_mul_f32 v46, s20, v46
    v_mul_f32 v47, s20, v47
    v_mfma_f32_16x16x32_bf16 v[48:51], a[128:131], a[16:19], 0
    v_exp_f32 v45, v45
    v_mfma_f32_16x16x32_bf16 v[48:51], a[132:135], a[20:23], v[48:51]
    v_cvt_pk_bf16_f32 v56, v40, v41
    v_cvt_pk_bf16_f32 v57, v42, v43
    v_mfma_f32_16x16x32_bf16 v[48:51], a[136:139], a[24:27], v[48:51]
    v_exp_f32 v46, v46
    v_mfma_f32_16x16x32_bf16 v[48:51], a[140:143], a[28:31], v[48:51]
    v_exp_f32 v47, v47
    v_mfma_f32_16x16x32_bf16 v[52:55], a[144:147], a[16:19], 0
    s_add_u32 m0, s35, 24576
    v_cvt_pk_bf16_f32 v58, v44, v45
    v_cvt_pk_bf16_f32 v59, v46, v47
    v_mfma_f32_16x16x32_bf16 v[52:55], a[148:151], a[20:23], v[52:55]
    buffer_load_dwordx4 v18, s[8:11], s22 offen lds
    v_mfma_f32_16x16x32_bf16 v[52:55], a[152:155], a[24:27], v[52:55]
    ds_read_b128 a[112:115], v0 offset:0
    v_mul_f32 v48, s20, v48
    v_mfma_f32_16x16x32_bf16 v[52:55], a[156:159], a[28:31], v[52:55]
    v_exp_f32 v48, v48

    v_mfma_f32_16x16x32_bf16 v[64:67], a[164:167], v[56:59], v[64:67]
    v_mul_f32 v49, s20, v49
    v_mul_f32 v50, s20, v50
    v_mfma_f32_16x16x32_bf16 v[68:71], a[172:175], v[56:59], v[68:71]
    ds_read_b128 a[116:119], v1 offset:0
    v_mul_f32 v51, s20, v51
    v_mfma_f32_16x16x32_bf16 v[72:75], a[180:183], v[56:59], v[72:75]
    v_exp_f32 v49, v49
    v_mfma_f32_16x16x32_bf16 v[76:79], a[188:191], v[56:59], v[76:79]
    v_exp_f32 v50, v50
    v_mfma_f32_16x16x32_bf16 v[80:83], a[196:199], v[56:59], v[80:83]
    ds_read_b128 a[120:123], v25 offset:0
    v_mul_f32 v52, s20, v52
    v_mfma_f32_16x16x32_bf16 v[84:87], a[204:207], v[56:59], v[84:87]
    v_exp_f32 v51, v51
    v_mfma_f32_16x16x32_bf16 v[88:91], a[212:215], v[56:59], v[88:91]
    v_exp_f32 v52, v52
    v_mfma_f32_16x16x32_bf16 v[92:95], a[220:223], v[56:59], v[92:95]
    ds_read_b128 a[124:127], v27 offset:0
    v_mul_f32 v53, s20, v53
    v_mfma_f32_16x16x32_bf16 v[40:43], a[128:131], a[32:35], 0
    v_mul_f32 v54, s20, v54
    v_mul_f32 v55, s20, v55
    v_mfma_f32_16x16x32_bf16 v[40:43], a[132:135], a[36:39], v[40:43]
    v_exp_f32 v53, v53
    v_mfma_f32_16x16x32_bf16 v[40:43], a[136:139], a[40:43], v[40:43]
    v_cvt_pk_bf16_f32 v60, v48, v49
    v_cvt_pk_bf16_f32 v61, v50, v51
    v_mfma_f32_16x16x32_bf16 v[40:43], a[140:143], a[44:47], v[40:43]
    v_exp_f32 v54, v54
    v_mfma_f32_16x16x32_bf16 v[44:47], a[144:147], a[32:35], 0
    v_exp_f32 v55, v55
    v_mfma_f32_16x16x32_bf16 v[44:47], a[148:151], a[36:39], v[44:47]
    v_cvt_pk_bf16_f32 v62, v52, v53
    v_cvt_pk_bf16_f32 v63, v54, v55
    v_mfma_f32_16x16x32_bf16 v[44:47], a[152:155], a[40:43], v[44:47]
    buffer_load_dwordx4 v18, s[8:11], s22 offen offset:1024 lds
    v_mfma_f32_16x16x32_bf16 v[44:47], a[156:159], a[44:47], v[44:47]
    ds_read_b64_tr_b16 a[160:161], v6 offset:0
    v_mul_f32 v40, s20, v40
    v_smfmac_f32_16x16x64_bf16 a[224:227], a[238:241], v[56:63], v26
    v_exp_f32 v40, v40
    v_mul_f32 v41, s20, v41
    v_mul_f32 v42, s20, v42
    v_mfma_f32_16x16x32_bf16 v[96:99], a[164:167], v[60:63], v[96:99]
    ds_read_b64_tr_b16 a[162:163], v36 offset:0
    v_mul_f32 v43, s20, v43
    v_mfma_f32_16x16x32_bf16 v[100:103], a[172:175], v[60:63], v[100:103]
    v_exp_f32 v41, v41
    v_mfma_f32_16x16x32_bf16 v[104:107], a[180:183], v[60:63], v[104:107]
    v_exp_f32 v42, v42
    v_mfma_f32_16x16x32_bf16 v[108:111], a[188:191], v[60:63], v[108:111]
    ds_read_b64_tr_b16 a[168:169], v6 offset:8
    v_mul_f32 v44, s20, v44
    v_mfma_f32_16x16x32_bf16 v[112:115], a[196:199], v[60:63], v[112:115]
    v_exp_f32 v43, v43
    v_mfma_f32_16x16x32_bf16 v[116:119], a[204:207], v[60:63], v[116:119]
    v_exp_f32 v44, v44
    v_mfma_f32_16x16x32_bf16 v[120:123], a[212:215], v[60:63], v[120:123]
    ds_read_b64_tr_b16 a[170:171], v36 offset:8
    v_mul_f32 v45, s20, v45
    v_mfma_f32_16x16x32_bf16 v[124:127], a[220:223], v[60:63], v[124:127]
    v_mul_f32 v46, s20, v46
    v_mul_f32 v47, s20, v47
    v_mfma_f32_16x16x32_bf16 v[48:51], a[128:131], a[48:51], 0
    v_exp_f32 v45, v45
    v_mfma_f32_16x16x32_bf16 v[48:51], a[132:135], a[52:55], v[48:51]
    v_cvt_pk_bf16_f32 v56, v40, v41
    v_cvt_pk_bf16_f32 v57, v42, v43
    v_mfma_f32_16x16x32_bf16 v[48:51], a[136:139], a[56:59], v[48:51]
    v_exp_f32 v46, v46
    v_mfma_f32_16x16x32_bf16 v[48:51], a[140:143], a[60:63], v[48:51]
    v_exp_f32 v47, v47
    v_mfma_f32_16x16x32_bf16 v[52:55], a[144:147], a[48:51], 0
    s_add_u32 m0, s35, 57344
    v_cvt_pk_bf16_f32 v58, v44, v45
    v_cvt_pk_bf16_f32 v59, v46, v47
    v_mfma_f32_16x16x32_bf16 v[52:55], a[148:151], a[52:55], v[52:55]
    buffer_load_dwordx4 v19, s[12:15], s22 offen lds
    v_mfma_f32_16x16x32_bf16 v[52:55], a[152:155], a[56:59], v[52:55]
    ds_read_b64_tr_b16 a[176:177], v7 offset:0
    v_mul_f32 v48, s20, v48
    v_mfma_f32_16x16x32_bf16 v[52:55], a[156:159], a[60:63], v[52:55]
    v_exp_f32 v48, v48

    v_mfma_f32_16x16x32_bf16 v[128:131], a[164:167], v[56:59], v[128:131]
    v_mul_f32 v49, s20, v49
    v_mul_f32 v50, s20, v50
    v_mfma_f32_16x16x32_bf16 v[132:135], a[172:175], v[56:59], v[132:135]
    ds_read_b64_tr_b16 a[178:179], v37 offset:0
    v_mul_f32 v51, s20, v51
    v_mfma_f32_16x16x32_bf16 v[136:139], a[180:183], v[56:59], v[136:139]
    v_exp_f32 v49, v49
    v_mfma_f32_16x16x32_bf16 v[140:143], a[188:191], v[56:59], v[140:143]
    v_exp_f32 v50, v50
    v_mfma_f32_16x16x32_bf16 v[144:147], a[196:199], v[56:59], v[144:147]
    ds_read_b64_tr_b16 a[184:185], v7 offset:8
    v_mul_f32 v52, s20, v52
    v_mfma_f32_16x16x32_bf16 v[148:151], a[204:207], v[56:59], v[148:151]
    v_exp_f32 v51, v51
    v_mfma_f32_16x16x32_bf16 v[152:155], a[212:215], v[56:59], v[152:155]
    v_exp_f32 v52, v52
    v_mfma_f32_16x16x32_bf16 v[156:159], a[220:223], v[56:59], v[156:159]
    ds_read_b64_tr_b16 a[186:187], v37 offset:8
    v_mul_f32 v53, s20, v53
    v_mfma_f32_16x16x32_bf16 v[40:43], a[128:131], a[64:67], 0
    v_mul_f32 v54, s20, v54
    v_mul_f32 v55, s20, v55
    v_mfma_f32_16x16x32_bf16 v[40:43], a[132:135], a[68:71], v[40:43]
    v_exp_f32 v53, v53
    v_mfma_f32_16x16x32_bf16 v[40:43], a[136:139], a[72:75], v[40:43]
    v_cvt_pk_bf16_f32 v60, v48, v49
    v_cvt_pk_bf16_f32 v61, v50, v51
    v_mfma_f32_16x16x32_bf16 v[40:43], a[140:143], a[76:79], v[40:43]
    v_exp_f32 v54, v54
    v_mfma_f32_16x16x32_bf16 v[44:47], a[144:147], a[64:67], 0
    v_exp_f32 v55, v55
    v_mfma_f32_16x16x32_bf16 v[44:47], a[148:151], a[68:71], v[44:47]
    v_cvt_pk_bf16_f32 v62, v52, v53
    v_cvt_pk_bf16_f32 v63, v54, v55
    v_mfma_f32_16x16x32_bf16 v[44:47], a[152:155], a[72:75], v[44:47]
    buffer_load_dwordx4 v19, s[12:15], s22 offen offset:1024 lds
    v_mfma_f32_16x16x32_bf16 v[44:47], a[156:159], a[76:79], v[44:47]
    s_add_u32 m0, s30, 8192
    ds_read_b64_tr_b16 a[192:193], v8 offset:0
    v_mul_f32 v40, s20, v40
    v_smfmac_f32_16x16x64_bf16 a[228:231], a[238:241], v[56:63], v26
    buffer_store_dwordx4 v[28:31], v16, s[16:19], s32 offen offset:2048 nt
    buffer_load_dwordx4 v16, s[4:7], s28 offen offset:2048 nt lds
    v_exp_f32 v40, v40
    v_mul_f32 v41, s20, v41
    v_mul_f32 v42, s20, v42
    v_mfma_f32_16x16x32_bf16 v[160:163], a[164:167], v[60:63], v[160:163]
    s_xor_b32 s22, s22, 57344
    ds_read_b64_tr_b16 a[194:195], v38 offset:0
    v_mul_f32 v43, s20, v43
    v_mfma_f32_16x16x32_bf16 v[164:167], a[172:175], v[60:63], v[164:167]
    v_exp_f32 v41, v41
    v_mfma_f32_16x16x32_bf16 v[168:171], a[180:183], v[60:63], v[168:171]
    v_exp_f32 v42, v42
    v_mfma_f32_16x16x32_bf16 v[172:175], a[188:191], v[60:63], v[172:175]
    ds_read_b64_tr_b16 a[200:201], v8 offset:8
    v_mul_f32 v44, s20, v44
    v_mfma_f32_16x16x32_bf16 v[176:179], a[196:199], v[60:63], v[176:179]
    v_exp_f32 v43, v43
    v_mfma_f32_16x16x32_bf16 v[180:183], a[204:207], v[60:63], v[180:183]
    v_exp_f32 v44, v44
    v_mfma_f32_16x16x32_bf16 v[184:187], a[212:215], v[60:63], v[184:187]
    ds_read_b64_tr_b16 a[202:203], v38 offset:8
    v_mul_f32 v45, s20, v45
    v_mfma_f32_16x16x32_bf16 v[188:191], a[220:223], v[60:63], v[188:191]
    v_mul_f32 v46, s20, v46
    v_mul_f32 v47, s20, v47
    v_mfma_f32_16x16x32_bf16 v[48:51], a[128:131], a[80:83], 0
    v_exp_f32 v45, v45
    v_mfma_f32_16x16x32_bf16 v[48:51], a[132:135], a[84:87], v[48:51]
    buffer_store_dwordx4 v[32:35], v17, s[16:19], s32 offen offset:3072 nt
    buffer_load_dwordx4 v17, s[4:7], s28 offen offset:3072 nt lds
    v_cvt_pk_bf16_f32 v56, v40, v41
    v_cvt_pk_bf16_f32 v57, v42, v43
    v_mfma_f32_16x16x32_bf16 v[48:51], a[136:139], a[88:91], v[48:51]
    v_exp_f32 v46, v46
    v_mfma_f32_16x16x32_bf16 v[48:51], a[140:143], a[92:95], v[48:51]
    v_exp_f32 v47, v47
    v_mfma_f32_16x16x32_bf16 v[52:55], a[144:147], a[80:83], 0
    v_cvt_pk_bf16_f32 v58, v44, v45
    v_cvt_pk_bf16_f32 v59, v46, v47
    v_mfma_f32_16x16x32_bf16 v[52:55], a[148:151], a[84:87], v[52:55]
    ds_read_b128 v[28:31], v24 offset:12288
    v_mfma_f32_16x16x32_bf16 v[52:55], a[152:155], a[88:91], v[52:55]
    ds_read_b64_tr_b16 a[208:209], v9 offset:0
    v_mul_f32 v48, s20, v48
    v_mfma_f32_16x16x32_bf16 v[52:55], a[156:159], a[92:95], v[52:55]
    v_exp_f32 v48, v48

    v_mfma_f32_16x16x32_bf16 v[192:195], a[164:167], v[56:59], v[192:195]
    v_mul_f32 v49, s20, v49
    v_mul_f32 v50, s20, v50
    v_mfma_f32_16x16x32_bf16 v[196:199], a[172:175], v[56:59], v[196:199]
    ds_read_b64_tr_b16 a[210:211], v39 offset:0
    v_mul_f32 v51, s20, v51
    v_mfma_f32_16x16x32_bf16 v[200:203], a[180:183], v[56:59], v[200:203]
    v_exp_f32 v49, v49
    v_mfma_f32_16x16x32_bf16 v[204:207], a[188:191], v[56:59], v[204:207]
    v_exp_f32 v50, v50
    v_mfma_f32_16x16x32_bf16 v[208:211], a[196:199], v[56:59], v[208:211]
    ds_read_b64_tr_b16 a[216:217], v9 offset:8
    v_mul_f32 v52, s20, v52
    v_mfma_f32_16x16x32_bf16 v[212:215], a[204:207], v[56:59], v[212:215]
    v_exp_f32 v51, v51
    v_mfma_f32_16x16x32_bf16 v[216:219], a[212:215], v[56:59], v[216:219]
    v_exp_f32 v52, v52
    v_mfma_f32_16x16x32_bf16 v[220:223], a[220:223], v[56:59], v[220:223]
    s_waitcnt lgkmcnt(15)
    ds_read_b64_tr_b16 a[218:219], v39 offset:8
    v_mul_f32 v53, s20, v53
L_A8:
    v_mfma_f32_16x16x32_bf16 v[40:43], a[96:99], a[0:3], 0
    v_mul_f32 v54, s20, v54
    v_mul_f32 v55, s20, v55
    v_mfma_f32_16x16x32_bf16 v[40:43], a[100:103], a[4:7], v[40:43]
    v_exp_f32 v53, v53
    v_mfma_f32_16x16x32_bf16 v[40:43], a[104:107], a[8:11], v[40:43]
    v_cvt_pk_bf16_f32 v60, v48, v49
    v_cvt_pk_bf16_f32 v61, v50, v51
    v_mfma_f32_16x16x32_bf16 v[40:43], a[108:111], a[12:15], v[40:43]
    v_exp_f32 v54, v54
    v_mfma_f32_16x16x32_bf16 v[44:47], a[112:115], a[0:3], 0
    v_exp_f32 v55, v55
    v_mfma_f32_16x16x32_bf16 v[44:47], a[116:119], a[4:7], v[44:47]
    s_waitcnt vmcnt(19) lgkmcnt(0)
    v_cvt_pk_bf16_f32 v62, v52, v53
    v_cvt_pk_bf16_f32 v63, v54, v55
    v_mfma_f32_16x16x32_bf16 v[44:47], a[120:123], a[8:11], v[44:47]
    s_barrier
    v_mfma_f32_16x16x32_bf16 v[44:47], a[124:127], a[12:15], v[44:47]
    ds_read_b128 a[128:131], v2 offset:8192
    v_mul_f32 v40, s20, v40
    v_smfmac_f32_16x16x64_bf16 a[232:235], a[238:241], v[56:63], v26
    v_exp_f32 v40, v40
    v_mul_f32 v41, s20, v41
    v_mul_f32 v42, s20, v42
    v_mfma_f32_16x16x32_bf16 v[224:227], a[164:167], v[60:63], v[224:227]
    ds_read_b128 a[132:135], v3 offset:8192
    v_mul_f32 v43, s20, v43
    v_mfma_f32_16x16x32_bf16 v[228:231], a[172:175], v[60:63], v[228:231]
    v_exp_f32 v41, v41
    v_mfma_f32_16x16x32_bf16 v[232:235], a[180:183], v[60:63], v[232:235]
    v_exp_f32 v42, v42
    v_mfma_f32_16x16x32_bf16 v[236:239], a[188:191], v[60:63], v[236:239]
    ds_read_b128 a[136:139], v4 offset:8192
    v_mul_f32 v44, s20, v44
    v_mfma_f32_16x16x32_bf16 v[240:243], a[196:199], v[60:63], v[240:243]
    v_exp_f32 v43, v43
    v_mfma_f32_16x16x32_bf16 v[244:247], a[204:207], v[60:63], v[244:247]
    v_exp_f32 v44, v44
    v_mfma_f32_16x16x32_bf16 v[248:251], a[212:215], v[60:63], v[248:251]
    ds_read_b128 a[140:143], v5 offset:8192
    v_mul_f32 v45, s20, v45
    v_mfma_f32_16x16x32_bf16 v[252:255], a[220:223], v[60:63], v[252:255]
    v_mul_f32 v46, s20, v46
    v_mul_f32 v47, s20, v47
    v_mfma_f32_16x16x32_bf16 v[48:51], a[96:99], a[16:19], 0
    v_exp_f32 v45, v45
    v_mfma_f32_16x16x32_bf16 v[48:51], a[100:103], a[20:23], v[48:51]
    v_cvt_pk_bf16_f32 v56, v40, v41
    v_cvt_pk_bf16_f32 v57, v42, v43
    v_mfma_f32_16x16x32_bf16 v[48:51], a[104:107], a[24:27], v[48:51]
    v_exp_f32 v46, v46
    v_mfma_f32_16x16x32_bf16 v[48:51], a[108:111], a[28:31], v[48:51]
    v_exp_f32 v47, v47
    v_mfma_f32_16x16x32_bf16 v[52:55], a[112:115], a[16:19], 0
    s_add_u32 m0, s35, 0
    v_cvt_pk_bf16_f32 v58, v44, v45
    v_cvt_pk_bf16_f32 v59, v46, v47
    v_mfma_f32_16x16x32_bf16 v[52:55], a[116:119], a[20:23], v[52:55]
    buffer_load_dwordx4 v18, s[8:11], s22 offen lds
    v_mfma_f32_16x16x32_bf16 v[52:55], a[120:123], a[24:27], v[52:55]
    ds_read_b128 a[144:147], v0 offset:8192
    v_mul_f32 v48, s20, v48
    v_mfma_f32_16x16x32_bf16 v[52:55], a[124:127], a[28:31], v[52:55]
    v_exp_f32 v48, v48

    v_mfma_f32_16x16x32_bf16 v[64:67], a[160:163], v[56:59], v[64:67]
    v_mul_f32 v49, s20, v49
    v_mul_f32 v50, s20, v50
    v_mfma_f32_16x16x32_bf16 v[68:71], a[168:171], v[56:59], v[68:71]
    ds_read_b128 a[148:151], v1 offset:8192
    v_mul_f32 v51, s20, v51
    v_mfma_f32_16x16x32_bf16 v[72:75], a[176:179], v[56:59], v[72:75]
    v_exp_f32 v49, v49
    v_mfma_f32_16x16x32_bf16 v[76:79], a[184:187], v[56:59], v[76:79]
    v_exp_f32 v50, v50
    v_mfma_f32_16x16x32_bf16 v[80:83], a[192:195], v[56:59], v[80:83]
    ds_read_b128 a[152:155], v25 offset:8192
    v_mul_f32 v52, s20, v52
    v_mfma_f32_16x16x32_bf16 v[84:87], a[200:203], v[56:59], v[84:87]
    v_exp_f32 v51, v51
    v_mfma_f32_16x16x32_bf16 v[88:91], a[208:211], v[56:59], v[88:91]
    v_exp_f32 v52, v52
    v_mfma_f32_16x16x32_bf16 v[92:95], a[216:219], v[56:59], v[92:95]
    ds_read_b128 a[156:159], v27 offset:8192
    v_mul_f32 v53, s20, v53
    v_mfma_f32_16x16x32_bf16 v[40:43], a[96:99], a[32:35], 0
    v_mul_f32 v54, s20, v54
    v_mul_f32 v55, s20, v55
    v_mfma_f32_16x16x32_bf16 v[40:43], a[100:103], a[36:39], v[40:43]
    v_exp_f32 v53, v53
    v_mfma_f32_16x16x32_bf16 v[40:43], a[104:107], a[40:43], v[40:43]
    v_cvt_pk_bf16_f32 v60, v48, v49
    v_cvt_pk_bf16_f32 v61, v50, v51
    v_mfma_f32_16x16x32_bf16 v[40:43], a[108:111], a[44:47], v[40:43]
    v_exp_f32 v54, v54
    v_mfma_f32_16x16x32_bf16 v[44:47], a[112:115], a[32:35], 0
    v_exp_f32 v55, v55
    v_mfma_f32_16x16x32_bf16 v[44:47], a[116:119], a[36:39], v[44:47]
    v_cvt_pk_bf16_f32 v62, v52, v53
    v_cvt_pk_bf16_f32 v63, v54, v55
    v_mfma_f32_16x16x32_bf16 v[44:47], a[120:123], a[40:43], v[44:47]
    buffer_load_dwordx4 v18, s[8:11], s22 offen offset:1024 lds
    v_mfma_f32_16x16x32_bf16 v[44:47], a[124:127], a[44:47], v[44:47]
    ds_read_b64_tr_b16 a[164:165], v6 offset:8192
    v_mul_f32 v40, s20, v40
    v_smfmac_f32_16x16x64_bf16 a[224:227], a[238:241], v[56:63], v26
    v_exp_f32 v40, v40
    v_mul_f32 v41, s20, v41
    v_mul_f32 v42, s20, v42
    v_mfma_f32_16x16x32_bf16 v[96:99], a[160:163], v[60:63], v[96:99]
    ds_read_b64_tr_b16 a[166:167], v36 offset:8192
    v_mul_f32 v43, s20, v43
    v_mfma_f32_16x16x32_bf16 v[100:103], a[168:171], v[60:63], v[100:103]
    v_exp_f32 v41, v41
    v_mfma_f32_16x16x32_bf16 v[104:107], a[176:179], v[60:63], v[104:107]
    v_exp_f32 v42, v42
    v_mfma_f32_16x16x32_bf16 v[108:111], a[184:187], v[60:63], v[108:111]
    ds_read_b64_tr_b16 a[172:173], v6 offset:8200
    v_mul_f32 v44, s20, v44
    v_mfma_f32_16x16x32_bf16 v[112:115], a[192:195], v[60:63], v[112:115]
    v_exp_f32 v43, v43
    v_mfma_f32_16x16x32_bf16 v[116:119], a[200:203], v[60:63], v[116:119]
    v_exp_f32 v44, v44
    v_mfma_f32_16x16x32_bf16 v[120:123], a[208:211], v[60:63], v[120:123]
    ds_read_b64_tr_b16 a[174:175], v36 offset:8200
    v_mul_f32 v45, s20, v45
    v_mfma_f32_16x16x32_bf16 v[124:127], a[216:219], v[60:63], v[124:127]
    v_mul_f32 v46, s20, v46
    v_mul_f32 v47, s20, v47
    v_mfma_f32_16x16x32_bf16 v[48:51], a[96:99], a[48:51], 0
    v_exp_f32 v45, v45
    v_mfma_f32_16x16x32_bf16 v[48:51], a[100:103], a[52:55], v[48:51]
    v_cvt_pk_bf16_f32 v56, v40, v41
    v_cvt_pk_bf16_f32 v57, v42, v43
    v_mfma_f32_16x16x32_bf16 v[48:51], a[104:107], a[56:59], v[48:51]
    v_exp_f32 v46, v46
    v_mfma_f32_16x16x32_bf16 v[48:51], a[108:111], a[60:63], v[48:51]
    v_exp_f32 v47, v47
    v_mfma_f32_16x16x32_bf16 v[52:55], a[112:115], a[48:51], 0
    s_add_u32 m0, s35, 32768
    v_cvt_pk_bf16_f32 v58, v44, v45
    v_cvt_pk_bf16_f32 v59, v46, v47
    v_mfma_f32_16x16x32_bf16 v[52:55], a[116:119], a[52:55], v[52:55]
    buffer_load_dwordx4 v19, s[12:15], s22 offen lds
    v_mfma_f32_16x16x32_bf16 v[52:55], a[120:123], a[56:59], v[52:55]
    ds_read_b64_tr_b16 a[180:181], v7 offset:8192
    v_mul_f32 v48, s20, v48
    v_mfma_f32_16x16x32_bf16 v[52:55], a[124:127], a[60:63], v[52:55]
    v_exp_f32 v48, v48

    v_mfma_f32_16x16x32_bf16 v[128:131], a[160:163], v[56:59], v[128:131]
    v_mul_f32 v49, s20, v49
    v_mul_f32 v50, s20, v50
    v_mfma_f32_16x16x32_bf16 v[132:135], a[168:171], v[56:59], v[132:135]
    ds_read_b64_tr_b16 a[182:183], v37 offset:8192
    v_mul_f32 v51, s20, v51
    v_mfma_f32_16x16x32_bf16 v[136:139], a[176:179], v[56:59], v[136:139]
    v_exp_f32 v49, v49
    v_mfma_f32_16x16x32_bf16 v[140:143], a[184:187], v[56:59], v[140:143]
    v_exp_f32 v50, v50
    v_mfma_f32_16x16x32_bf16 v[144:147], a[192:195], v[56:59], v[144:147]
    ds_read_b64_tr_b16 a[188:189], v7 offset:8200
    v_mul_f32 v52, s20, v52
    v_mfma_f32_16x16x32_bf16 v[148:151], a[200:203], v[56:59], v[148:151]
    v_exp_f32 v51, v51
    v_mfma_f32_16x16x32_bf16 v[152:155], a[208:211], v[56:59], v[152:155]
    v_exp_f32 v52, v52
    v_mfma_f32_16x16x32_bf16 v[156:159], a[216:219], v[56:59], v[156:159]
    ds_read_b64_tr_b16 a[190:191], v37 offset:8200
    v_mul_f32 v53, s20, v53
    v_mfma_f32_16x16x32_bf16 v[40:43], a[96:99], a[64:67], 0
    v_mul_f32 v54, s20, v54
    v_mul_f32 v55, s20, v55
    v_mfma_f32_16x16x32_bf16 v[40:43], a[100:103], a[68:71], v[40:43]
    v_exp_f32 v53, v53
    v_mfma_f32_16x16x32_bf16 v[40:43], a[104:107], a[72:75], v[40:43]
    v_cvt_pk_bf16_f32 v60, v48, v49
    v_cvt_pk_bf16_f32 v61, v50, v51
    v_mfma_f32_16x16x32_bf16 v[40:43], a[108:111], a[76:79], v[40:43]
    v_exp_f32 v54, v54
    v_mfma_f32_16x16x32_bf16 v[44:47], a[112:115], a[64:67], 0
    s_add_u32 s28, s24, 12288
    v_exp_f32 v55, v55
    v_mfma_f32_16x16x32_bf16 v[44:47], a[116:119], a[68:71], v[44:47]
    s_add_u32 s32, s31, 12288
    v_cvt_pk_bf16_f32 v62, v52, v53
    v_cvt_pk_bf16_f32 v63, v54, v55
    v_mfma_f32_16x16x32_bf16 v[44:47], a[120:123], a[72:75], v[44:47]
    buffer_load_dwordx4 v19, s[12:15], s22 offen offset:1024 lds
    v_mfma_f32_16x16x32_bf16 v[44:47], a[124:127], a[76:79], v[44:47]
    s_add_u32 m0, s30, 12288
    ds_read_b64_tr_b16 a[196:197], v8 offset:8192
    v_mul_f32 v40, s20, v40
    v_smfmac_f32_16x16x64_bf16 a[228:231], a[238:241], v[56:63], v26
    buffer_store_dwordx4 v[28:31], v14, s[16:19], s32 offen nt
    buffer_load_dwordx4 v14, s[4:7], s28 offen nt lds
    v_exp_f32 v40, v40
    v_mul_f32 v41, s20, v41
    v_mul_f32 v42, s20, v42
    v_mfma_f32_16x16x32_bf16 v[160:163], a[160:163], v[60:63], v[160:163]
    s_xor_b32 s22, s22, 8192
    ds_read_b64_tr_b16 a[198:199], v38 offset:8192
    v_mul_f32 v43, s20, v43
    v_mfma_f32_16x16x32_bf16 v[164:167], a[168:171], v[60:63], v[164:167]
    v_exp_f32 v41, v41
    v_mfma_f32_16x16x32_bf16 v[168:171], a[176:179], v[60:63], v[168:171]
    v_exp_f32 v42, v42
    v_mfma_f32_16x16x32_bf16 v[172:175], a[184:187], v[60:63], v[172:175]
    ds_read_b64_tr_b16 a[204:205], v8 offset:8200
    v_mul_f32 v44, s20, v44
    v_mfma_f32_16x16x32_bf16 v[176:179], a[192:195], v[60:63], v[176:179]
    v_exp_f32 v43, v43
    v_mfma_f32_16x16x32_bf16 v[180:183], a[200:203], v[60:63], v[180:183]
    v_exp_f32 v44, v44
    v_mfma_f32_16x16x32_bf16 v[184:187], a[208:211], v[60:63], v[184:187]
    ds_read_b64_tr_b16 a[206:207], v38 offset:8200
    v_mul_f32 v45, s20, v45
    v_mfma_f32_16x16x32_bf16 v[188:191], a[216:219], v[60:63], v[188:191]
    v_mul_f32 v46, s20, v46
    v_mul_f32 v47, s20, v47
    v_mfma_f32_16x16x32_bf16 v[48:51], a[96:99], a[80:83], 0
    v_exp_f32 v45, v45
    v_mfma_f32_16x16x32_bf16 v[48:51], a[100:103], a[84:87], v[48:51]
    v_cvt_pk_bf16_f32 v56, v40, v41
    v_cvt_pk_bf16_f32 v57, v42, v43
    v_mfma_f32_16x16x32_bf16 v[48:51], a[104:107], a[88:91], v[48:51]
    v_exp_f32 v46, v46
    v_mfma_f32_16x16x32_bf16 v[48:51], a[108:111], a[92:95], v[48:51]
    v_exp_f32 v47, v47
    v_mfma_f32_16x16x32_bf16 v[52:55], a[112:115], a[80:83], 0
    v_cvt_pk_bf16_f32 v58, v44, v45
    v_cvt_pk_bf16_f32 v59, v46, v47
    v_mfma_f32_16x16x32_bf16 v[52:55], a[116:119], a[84:87], v[52:55]
    ds_read_b128 v[28:31], v24 offset:13312
    ds_read_b128 v[32:35], v24 offset:14336
    v_mfma_f32_16x16x32_bf16 v[52:55], a[120:123], a[88:91], v[52:55]
    ds_read_b64_tr_b16 a[212:213], v9 offset:8192
    v_mul_f32 v48, s20, v48
    v_mfma_f32_16x16x32_bf16 v[52:55], a[124:127], a[92:95], v[52:55]
    v_exp_f32 v48, v48

    v_mfma_f32_16x16x32_bf16 v[192:195], a[160:163], v[56:59], v[192:195]
    v_mul_f32 v49, s20, v49
    v_mul_f32 v50, s20, v50
    v_mfma_f32_16x16x32_bf16 v[196:199], a[168:171], v[56:59], v[196:199]
    ds_read_b64_tr_b16 a[214:215], v39 offset:8192
    v_mul_f32 v51, s20, v51
    v_mfma_f32_16x16x32_bf16 v[200:203], a[176:179], v[56:59], v[200:203]
    v_exp_f32 v49, v49
    v_mfma_f32_16x16x32_bf16 v[204:207], a[184:187], v[56:59], v[204:207]
    v_exp_f32 v50, v50
    v_mfma_f32_16x16x32_bf16 v[208:211], a[192:195], v[56:59], v[208:211]
    ds_read_b64_tr_b16 a[220:221], v9 offset:8200
    v_mul_f32 v52, s20, v52
    v_mfma_f32_16x16x32_bf16 v[212:215], a[200:203], v[56:59], v[212:215]
    v_exp_f32 v51, v51
    v_mfma_f32_16x16x32_bf16 v[216:219], a[208:211], v[56:59], v[216:219]
    v_exp_f32 v52, v52
    v_mfma_f32_16x16x32_bf16 v[220:223], a[216:219], v[56:59], v[220:223]
    s_cmp_eq_u32 s33, 1
    s_waitcnt lgkmcnt(15)
    ds_read_b64_tr_b16 a[222:223], v39 offset:8200
    v_mul_f32 v53, s20, v53
    s_cbranch_scc1 L_lateA
L_A9:
    v_mfma_f32_16x16x32_bf16 v[40:43], a[128:131], a[0:3], 0
    v_mul_f32 v54, s20, v54
    v_mul_f32 v55, s20, v55
    v_mfma_f32_16x16x32_bf16 v[40:43], a[132:135], a[4:7], v[40:43]
    v_exp_f32 v53, v53
    v_mfma_f32_16x16x32_bf16 v[40:43], a[136:139], a[8:11], v[40:43]
    v_cvt_pk_bf16_f32 v60, v48, v49
    v_cvt_pk_bf16_f32 v61, v50, v51
    v_mfma_f32_16x16x32_bf16 v[40:43], a[140:143], a[12:15], v[40:43]
    v_exp_f32 v54, v54
    v_mfma_f32_16x16x32_bf16 v[44:47], a[144:147], a[0:3], 0
    v_exp_f32 v55, v55
    v_mfma_f32_16x16x32_bf16 v[44:47], a[148:151], a[4:7], v[44:47]
    s_waitcnt vmcnt(16) lgkmcnt(0)
    v_cvt_pk_bf16_f32 v62, v52, v53
    v_cvt_pk_bf16_f32 v63, v54, v55
    v_mfma_f32_16x16x32_bf16 v[44:47], a[152:155], a[8:11], v[44:47]
    s_barrier
    v_mfma_f32_16x16x32_bf16 v[44:47], a[156:159], a[12:15], v[44:47]
    ds_read_b128 a[96:99], v2 offset:16384
    v_mul_f32 v40, s20, v40
    v_smfmac_f32_16x16x64_bf16 a[232:235], a[238:241], v[56:63], v26
    v_exp_f32 v40, v40
    v_mul_f32 v41, s20, v41
    v_mul_f32 v42, s20, v42
    v_mfma_f32_16x16x32_bf16 v[224:227], a[160:163], v[60:63], v[224:227]
    ds_read_b128 a[100:103], v3 offset:16384
    v_mul_f32 v43, s20, v43
    v_mfma_f32_16x16x32_bf16 v[228:231], a[168:171], v[60:63], v[228:231]
    v_exp_f32 v41, v41
    v_mfma_f32_16x16x32_bf16 v[232:235], a[176:179], v[60:63], v[232:235]
    v_exp_f32 v42, v42
    v_mfma_f32_16x16x32_bf16 v[236:239], a[184:187], v[60:63], v[236:239]
    ds_read_b128 a[104:107], v4 offset:16384
    v_mul_f32 v44, s20, v44
    v_mfma_f32_16x16x32_bf16 v[240:243], a[192:195], v[60:63], v[240:243]
    v_exp_f32 v43, v43
    v_mfma_f32_16x16x32_bf16 v[244:247], a[200:203], v[60:63], v[244:247]
    v_exp_f32 v44, v44
    v_mfma_f32_16x16x32_bf16 v[248:251], a[208:211], v[60:63], v[248:251]
    ds_read_b128 a[108:111], v5 offset:16384
    v_mul_f32 v45, s20, v45
    v_mfma_f32_16x16x32_bf16 v[252:255], a[216:219], v[60:63], v[252:255]
    v_mul_f32 v46, s20, v46
    v_mul_f32 v47, s20, v47
    v_mfma_f32_16x16x32_bf16 v[48:51], a[128:131], a[16:19], 0
    v_exp_f32 v45, v45
    v_mfma_f32_16x16x32_bf16 v[48:51], a[132:135], a[20:23], v[48:51]
    v_cvt_pk_bf16_f32 v56, v40, v41
    v_cvt_pk_bf16_f32 v57, v42, v43
    v_mfma_f32_16x16x32_bf16 v[48:51], a[136:139], a[24:27], v[48:51]
    v_exp_f32 v46, v46
    v_mfma_f32_16x16x32_bf16 v[48:51], a[140:143], a[28:31], v[48:51]
    v_exp_f32 v47, v47
    v_mfma_f32_16x16x32_bf16 v[52:55], a[144:147], a[16:19], 0
    s_add_u32 m0, s35, 8192
    v_cvt_pk_bf16_f32 v58, v44, v45
    v_cvt_pk_bf16_f32 v59, v46, v47
    v_mfma_f32_16x16x32_bf16 v[52:55], a[148:151], a[20:23], v[52:55]
    buffer_load_dwordx4 v18, s[8:11], s22 offen lds
    v_mfma_f32_16x16x32_bf16 v[52:55], a[152:155], a[24:27], v[52:55]
    ds_read_b128 a[112:115], v0 offset:16384
    v_mul_f32 v48, s20, v48
    v_mfma_f32_16x16x32_bf16 v[52:55], a[156:159], a[28:31], v[52:55]
    v_exp_f32 v48, v48

    v_mfma_f32_16x16x32_bf16 v[64:67], a[164:167], v[56:59], v[64:67]
    v_mul_f32 v49, s20, v49
    v_mul_f32 v50, s20, v50
    v_mfma_f32_16x16x32_bf16 v[68:71], a[172:175], v[56:59], v[68:71]
    ds_read_b128 a[116:119], v1 offset:16384
    v_mul_f32 v51, s20, v51
    v_mfma_f32_16x16x32_bf16 v[72:75], a[180:183], v[56:59], v[72:75]
    v_exp_f32 v49, v49
    v_mfma_f32_16x16x32_bf16 v[76:79], a[188:191], v[56:59], v[76:79]
    v_exp_f32 v50, v50
    v_mfma_f32_16x16x32_bf16 v[80:83], a[196:199], v[56:59], v[80:83]
    ds_read_b128 a[120:123], v25 offset:16384
    v_mul_f32 v52, s20, v52
    v_mfma_f32_16x16x32_bf16 v[84:87], a[204:207], v[56:59], v[84:87]
    v_exp_f32 v51, v51
    v_mfma_f32_16x16x32_bf16 v[88:91], a[212:215], v[56:59], v[88:91]
    v_exp_f32 v52, v52
    v_mfma_f32_16x16x32_bf16 v[92:95], a[220:223], v[56:59], v[92:95]
    ds_read_b128 a[124:127], v27 offset:16384
    v_mul_f32 v53, s20, v53
    v_mfma_f32_16x16x32_bf16 v[40:43], a[128:131], a[32:35], 0
    v_mul_f32 v54, s20, v54
    v_mul_f32 v55, s20, v55
    v_mfma_f32_16x16x32_bf16 v[40:43], a[132:135], a[36:39], v[40:43]
    v_exp_f32 v53, v53
    v_mfma_f32_16x16x32_bf16 v[40:43], a[136:139], a[40:43], v[40:43]
    v_cvt_pk_bf16_f32 v60, v48, v49
    v_cvt_pk_bf16_f32 v61, v50, v51
    v_mfma_f32_16x16x32_bf16 v[40:43], a[140:143], a[44:47], v[40:43]
    v_exp_f32 v54, v54
    v_mfma_f32_16x16x32_bf16 v[44:47], a[144:147], a[32:35], 0
    v_exp_f32 v55, v55
    v_mfma_f32_16x16x32_bf16 v[44:47], a[148:151], a[36:39], v[44:47]
    v_cvt_pk_bf16_f32 v62, v52, v53
    v_cvt_pk_bf16_f32 v63, v54, v55
    v_mfma_f32_16x16x32_bf16 v[44:47], a[152:155], a[40:43], v[44:47]
    buffer_load_dwordx4 v18, s[8:11], s22 offen offset:1024 lds
    v_mfma_f32_16x16x32_bf16 v[44:47], a[156:159], a[44:47], v[44:47]
    ds_read_b64_tr_b16 a[160:161], v6 offset:16384
    v_mul_f32 v40, s20, v40
    v_smfmac_f32_16x16x64_bf16 a[224:227], a[238:241], v[56:63], v26
    v_exp_f32 v40, v40
    v_mul_f32 v41, s20, v41
    v_mul_f32 v42, s20, v42
    v_mfma_f32_16x16x32_bf16 v[96:99], a[164:167], v[60:63], v[96:99]
    ds_read_b64_tr_b16 a[162:163], v36 offset:16384
    v_mul_f32 v43, s20, v43
    v_mfma_f32_16x16x32_bf16 v[100:103], a[172:175], v[60:63], v[100:103]
    v_exp_f32 v41, v41
    v_mfma_f32_16x16x32_bf16 v[104:107], a[180:183], v[60:63], v[104:107]
    v_exp_f32 v42, v42
    v_mfma_f32_16x16x32_bf16 v[108:111], a[188:191], v[60:63], v[108:111]
    ds_read_b64_tr_b16 a[168:169], v6 offset:16392
    v_mul_f32 v44, s20, v44
    v_mfma_f32_16x16x32_bf16 v[112:115], a[196:199], v[60:63], v[112:115]
    v_exp_f32 v43, v43
    v_mfma_f32_16x16x32_bf16 v[116:119], a[204:207], v[60:63], v[116:119]
    v_exp_f32 v44, v44
    v_mfma_f32_16x16x32_bf16 v[120:123], a[212:215], v[60:63], v[120:123]
    ds_read_b64_tr_b16 a[170:171], v36 offset:16392
    v_mul_f32 v45, s20, v45
    v_mfma_f32_16x16x32_bf16 v[124:127], a[220:223], v[60:63], v[124:127]
    v_mul_f32 v46, s20, v46
    v_mul_f32 v47, s20, v47
    v_mfma_f32_16x16x32_bf16 v[48:51], a[128:131], a[48:51], 0
    v_exp_f32 v45, v45
    v_mfma_f32_16x16x32_bf16 v[48:51], a[132:135], a[52:55], v[48:51]
    v_cvt_pk_bf16_f32 v56, v40, v41
    v_cvt_pk_bf16_f32 v57, v42, v43
    v_mfma_f32_16x16x32_bf16 v[48:51], a[136:139], a[56:59], v[48:51]
    v_exp_f32 v46, v46
    v_mfma_f32_16x16x32_bf16 v[48:51], a[140:143], a[60:63], v[48:51]
    v_exp_f32 v47, v47
    v_mfma_f32_16x16x32_bf16 v[52:55], a[144:147], a[48:51], 0
    s_add_u32 m0, s35, 40960
    v_cvt_pk_bf16_f32 v58, v44, v45
    v_cvt_pk_bf16_f32 v59, v46, v47
    v_mfma_f32_16x16x32_bf16 v[52:55], a[148:151], a[52:55], v[52:55]
    buffer_load_dwordx4 v19, s[12:15], s22 offen lds
    v_mfma_f32_16x16x32_bf16 v[52:55], a[152:155], a[56:59], v[52:55]
    ds_read_b64_tr_b16 a[176:177], v7 offset:16384
    v_mul_f32 v48, s20, v48
    v_mfma_f32_16x16x32_bf16 v[52:55], a[156:159], a[60:63], v[52:55]
    v_exp_f32 v48, v48

    v_mfma_f32_16x16x32_bf16 v[128:131], a[164:167], v[56:59], v[128:131]
    v_mul_f32 v49, s20, v49
    v_mul_f32 v50, s20, v50
    v_mfma_f32_16x16x32_bf16 v[132:135], a[172:175], v[56:59], v[132:135]
    ds_read_b64_tr_b16 a[178:179], v37 offset:16384
    v_mul_f32 v51, s20, v51
    v_mfma_f32_16x16x32_bf16 v[136:139], a[180:183], v[56:59], v[136:139]
    v_exp_f32 v49, v49
    v_mfma_f32_16x16x32_bf16 v[140:143], a[188:191], v[56:59], v[140:143]
    v_exp_f32 v50, v50
    v_mfma_f32_16x16x32_bf16 v[144:147], a[196:199], v[56:59], v[144:147]
    ds_read_b64_tr_b16 a[184:185], v7 offset:16392
    v_mul_f32 v52, s20, v52
    v_mfma_f32_16x16x32_bf16 v[148:151], a[204:207], v[56:59], v[148:151]
    v_exp_f32 v51, v51
    v_mfma_f32_16x16x32_bf16 v[152:155], a[212:215], v[56:59], v[152:155]
    v_exp_f32 v52, v52
    v_mfma_f32_16x16x32_bf16 v[156:159], a[220:223], v[56:59], v[156:159]
    ds_read_b64_tr_b16 a[186:187], v37 offset:16392
    v_mul_f32 v53, s20, v53
    v_mfma_f32_16x16x32_bf16 v[40:43], a[128:131], a[64:67], 0
    v_mul_f32 v54, s20, v54
    v_mul_f32 v55, s20, v55
    v_mfma_f32_16x16x32_bf16 v[40:43], a[132:135], a[68:71], v[40:43]
    v_exp_f32 v53, v53
    v_mfma_f32_16x16x32_bf16 v[40:43], a[136:139], a[72:75], v[40:43]
    v_cvt_pk_bf16_f32 v60, v48, v49
    v_cvt_pk_bf16_f32 v61, v50, v51
    v_mfma_f32_16x16x32_bf16 v[40:43], a[140:143], a[76:79], v[40:43]
    v_exp_f32 v54, v54
    v_mfma_f32_16x16x32_bf16 v[44:47], a[144:147], a[64:67], 0
    v_exp_f32 v55, v55
    v_mfma_f32_16x16x32_bf16 v[44:47], a[148:151], a[68:71], v[44:47]
    v_cvt_pk_bf16_f32 v62, v52, v53
    v_cvt_pk_bf16_f32 v63, v54, v55
    v_mfma_f32_16x16x32_bf16 v[44:47], a[152:155], a[72:75], v[44:47]
    buffer_load_dwordx4 v19, s[12:15], s22 offen offset:1024 lds
    v_mfma_f32_16x16x32_bf16 v[44:47], a[156:159], a[76:79], v[44:47]
    s_add_u32 m0, s30, 12288
    ds_read_b64_tr_b16 a[192:193], v8 offset:16384
    v_mul_f32 v40, s20, v40
    v_smfmac_f32_16x16x64_bf16 a[228:231], a[238:241], v[56:63], v26
    buffer_store_dwordx4 v[28:31], v15, s[16:19], s32 offen offset:1024 nt
    buffer_load_dwordx4 v15, s[4:7], s28 offen offset:1024 nt lds
    v_exp_f32 v40, v40
    v_mul_f32 v41, s20, v41
    v_mul_f32 v42, s20, v42
    v_mfma_f32_16x16x32_bf16 v[160:163], a[164:167], v[60:63], v[160:163]
    s_xor_b32 s22, s22, 24576
    ds_read_b64_tr_b16 a[194:195], v38 offset:16384
    v_mul_f32 v43, s20, v43
    v_mfma_f32_16x16x32_bf16 v[164:167], a[172:175], v[60:63], v[164:167]
    v_exp_f32 v41, v41
    v_mfma_f32_16x16x32_bf16 v[168:171], a[180:183], v[60:63], v[168:171]
    v_exp_f32 v42, v42
    v_mfma_f32_16x16x32_bf16 v[172:175], a[188:191], v[60:63], v[172:175]
    ds_read_b64_tr_b16 a[200:201], v8 offset:16392
    v_mul_f32 v44, s20, v44
    v_mfma_f32_16x16x32_bf16 v[176:179], a[196:199], v[60:63], v[176:179]
    v_exp_f32 v43, v43
    v_mfma_f32_16x16x32_bf16 v[180:183], a[204:207], v[60:63], v[180:183]
    v_exp_f32 v44, v44
    v_mfma_f32_16x16x32_bf16 v[184:187], a[212:215], v[60:63], v[184:187]
    ds_read_b64_tr_b16 a[202:203], v38 offset:16392
    v_mul_f32 v45, s20, v45
    v_mfma_f32_16x16x32_bf16 v[188:191], a[220:223], v[60:63], v[188:191]
    v_mul_f32 v46, s20, v46
    v_mul_f32 v47, s20, v47
    v_mfma_f32_16x16x32_bf16 v[48:51], a[128:131], a[80:83], 0
    v_exp_f32 v45, v45
    v_mfma_f32_16x16x32_bf16 v[48:51], a[132:135], a[84:87], v[48:51]
    buffer_store_dwordx4 v[32:35], v16, s[16:19], s32 offen offset:2048 nt
    buffer_load_dwordx4 v16, s[4:7], s28 offen offset:2048 nt lds
    v_cvt_pk_bf16_f32 v56, v40, v41
    v_cvt_pk_bf16_f32 v57, v42, v43
    v_mfma_f32_16x16x32_bf16 v[48:51], a[136:139], a[88:91], v[48:51]
    v_exp_f32 v46, v46
    v_mfma_f32_16x16x32_bf16 v[48:51], a[140:143], a[92:95], v[48:51]
    v_exp_f32 v47, v47
    v_mfma_f32_16x16x32_bf16 v[52:55], a[144:147], a[80:83], 0
    v_cvt_pk_bf16_f32 v58, v44, v45
    v_cvt_pk_bf16_f32 v59, v46, v47
    v_mfma_f32_16x16x32_bf16 v[52:55], a[148:151], a[84:87], v[52:55]
    ds_read_b128 v[28:31], v24 offset:15360
    v_mfma_f32_16x16x32_bf16 v[52:55], a[152:155], a[88:91], v[52:55]
    ds_read_b64_tr_b16 a[208:209], v9 offset:16384
    v_mul_f32 v48, s20, v48
    v_mfma_f32_16x16x32_bf16 v[52:55], a[156:159], a[92:95], v[52:55]
    v_exp_f32 v48, v48

    v_mfma_f32_16x16x32_bf16 v[192:195], a[164:167], v[56:59], v[192:195]
    v_mul_f32 v49, s20, v49
    v_mul_f32 v50, s20, v50
    v_mfma_f32_16x16x32_bf16 v[196:199], a[172:175], v[56:59], v[196:199]
    ds_read_b64_tr_b16 a[210:211], v39 offset:16384
    v_mul_f32 v51, s20, v51
    v_mfma_f32_16x16x32_bf16 v[200:203], a[180:183], v[56:59], v[200:203]
    v_exp_f32 v49, v49
    v_mfma_f32_16x16x32_bf16 v[204:207], a[188:191], v[56:59], v[204:207]
    v_exp_f32 v50, v50
    v_mfma_f32_16x16x32_bf16 v[208:211], a[196:199], v[56:59], v[208:211]
    ds_read_b64_tr_b16 a[216:217], v9 offset:16392
    v_mul_f32 v52, s20, v52
    v_mfma_f32_16x16x32_bf16 v[212:215], a[204:207], v[56:59], v[212:215]
    v_exp_f32 v51, v51
    v_mfma_f32_16x16x32_bf16 v[216:219], a[212:215], v[56:59], v[216:219]
    v_exp_f32 v52, v52
    v_mfma_f32_16x16x32_bf16 v[220:223], a[220:223], v[56:59], v[220:223]
    s_waitcnt lgkmcnt(15)
    ds_read_b64_tr_b16 a[218:219], v39 offset:16392
    v_mul_f32 v53, s20, v53
L_A10:
    v_mfma_f32_16x16x32_bf16 v[40:43], a[96:99], a[0:3], 0
    v_mul_f32 v54, s20, v54
    v_mul_f32 v55, s20, v55
    v_mfma_f32_16x16x32_bf16 v[40:43], a[100:103], a[4:7], v[40:43]
    v_exp_f32 v53, v53
    v_mfma_f32_16x16x32_bf16 v[40:43], a[104:107], a[8:11], v[40:43]
    v_cvt_pk_bf16_f32 v60, v48, v49
    v_cvt_pk_bf16_f32 v61, v50, v51
    v_mfma_f32_16x16x32_bf16 v[40:43], a[108:111], a[12:15], v[40:43]
    v_exp_f32 v54, v54
    v_mfma_f32_16x16x32_bf16 v[44:47], a[112:115], a[0:3], 0
    v_exp_f32 v55, v55
    v_mfma_f32_16x16x32_bf16 v[44:47], a[116:119], a[4:7], v[44:47]
    s_waitcnt vmcnt(18) lgkmcnt(0)
    v_cvt_pk_bf16_f32 v62, v52, v53
    v_cvt_pk_bf16_f32 v63, v54, v55
    v_mfma_f32_16x16x32_bf16 v[44:47], a[120:123], a[8:11], v[44:47]
    s_barrier
    v_mfma_f32_16x16x32_bf16 v[44:47], a[124:127], a[12:15], v[44:47]
    ds_read_b128 a[128:131], v2 offset:24576
    v_mul_f32 v40, s20, v40
    v_smfmac_f32_16x16x64_bf16 a[232:235], a[238:241], v[56:63], v26
    v_exp_f32 v40, v40
    v_mul_f32 v41, s20, v41
    v_mul_f32 v42, s20, v42
    v_mfma_f32_16x16x32_bf16 v[224:227], a[164:167], v[60:63], v[224:227]
    ds_read_b128 a[132:135], v3 offset:24576
    v_mul_f32 v43, s20, v43
    v_mfma_f32_16x16x32_bf16 v[228:231], a[172:175], v[60:63], v[228:231]
    v_exp_f32 v41, v41
    v_mfma_f32_16x16x32_bf16 v[232:235], a[180:183], v[60:63], v[232:235]
    v_exp_f32 v42, v42
    v_mfma_f32_16x16x32_bf16 v[236:239], a[188:191], v[60:63], v[236:239]
    ds_read_b128 a[136:139], v4 offset:24576
    v_mul_f32 v44, s20, v44
    v_mfma_f32_16x16x32_bf16 v[240:243], a[196:199], v[60:63], v[240:243]
    v_exp_f32 v43, v43
    v_mfma_f32_16x16x32_bf16 v[244:247], a[204:207], v[60:63], v[244:247]
    v_exp_f32 v44, v44
    v_mfma_f32_16x16x32_bf16 v[248:251], a[212:215], v[60:63], v[248:251]
    ds_read_b128 a[140:143], v5 offset:24576
    v_mul_f32 v45, s20, v45
    v_mfma_f32_16x16x32_bf16 v[252:255], a[220:223], v[60:63], v[252:255]
    v_mul_f32 v46, s20, v46
    v_mul_f32 v47, s20, v47
    v_mfma_f32_16x16x32_bf16 v[48:51], a[96:99], a[16:19], 0
    v_exp_f32 v45, v45
    v_mfma_f32_16x16x32_bf16 v[48:51], a[100:103], a[20:23], v[48:51]
    v_cvt_pk_bf16_f32 v56, v40, v41
    v_cvt_pk_bf16_f32 v57, v42, v43
    v_mfma_f32_16x16x32_bf16 v[48:51], a[104:107], a[24:27], v[48:51]
    v_exp_f32 v46, v46
    v_mfma_f32_16x16x32_bf16 v[48:51], a[108:111], a[28:31], v[48:51]
    v_exp_f32 v47, v47
    v_mfma_f32_16x16x32_bf16 v[52:55], a[112:115], a[16:19], 0
    s_add_u32 m0, s35, 16384
    v_cvt_pk_bf16_f32 v58, v44, v45
    v_cvt_pk_bf16_f32 v59, v46, v47
    v_mfma_f32_16x16x32_bf16 v[52:55], a[116:119], a[20:23], v[52:55]
    buffer_load_dwordx4 v18, s[8:11], s22 offen lds
    v_mfma_f32_16x16x32_bf16 v[52:55], a[120:123], a[24:27], v[52:55]
    ds_read_b128 a[144:147], v0 offset:24576
    v_mul_f32 v48, s20, v48
    v_mfma_f32_16x16x32_bf16 v[52:55], a[124:127], a[28:31], v[52:55]
    v_exp_f32 v48, v48

    v_mfma_f32_16x16x32_bf16 v[64:67], a[160:163], v[56:59], v[64:67]
    v_mul_f32 v49, s20, v49
    v_mul_f32 v50, s20, v50
    v_mfma_f32_16x16x32_bf16 v[68:71], a[168:171], v[56:59], v[68:71]
    ds_read_b128 a[148:151], v1 offset:24576
    v_mul_f32 v51, s20, v51
    v_mfma_f32_16x16x32_bf16 v[72:75], a[176:179], v[56:59], v[72:75]
    v_exp_f32 v49, v49
    v_mfma_f32_16x16x32_bf16 v[76:79], a[184:187], v[56:59], v[76:79]
    v_exp_f32 v50, v50
    v_mfma_f32_16x16x32_bf16 v[80:83], a[192:195], v[56:59], v[80:83]
    ds_read_b128 a[152:155], v25 offset:24576
    v_mul_f32 v52, s20, v52
    v_mfma_f32_16x16x32_bf16 v[84:87], a[200:203], v[56:59], v[84:87]
    v_exp_f32 v51, v51
    v_mfma_f32_16x16x32_bf16 v[88:91], a[208:211], v[56:59], v[88:91]
    v_exp_f32 v52, v52
    v_mfma_f32_16x16x32_bf16 v[92:95], a[216:219], v[56:59], v[92:95]
    ds_read_b128 a[156:159], v27 offset:24576
    v_mul_f32 v53, s20, v53
    v_mfma_f32_16x16x32_bf16 v[40:43], a[96:99], a[32:35], 0
    v_mul_f32 v54, s20, v54
    v_mul_f32 v55, s20, v55
    v_mfma_f32_16x16x32_bf16 v[40:43], a[100:103], a[36:39], v[40:43]
    v_exp_f32 v53, v53
    v_mfma_f32_16x16x32_bf16 v[40:43], a[104:107], a[40:43], v[40:43]
    v_cvt_pk_bf16_f32 v60, v48, v49
    v_cvt_pk_bf16_f32 v61, v50, v51
    v_mfma_f32_16x16x32_bf16 v[40:43], a[108:111], a[44:47], v[40:43]
    v_exp_f32 v54, v54
    v_mfma_f32_16x16x32_bf16 v[44:47], a[112:115], a[32:35], 0
    v_exp_f32 v55, v55
    v_mfma_f32_16x16x32_bf16 v[44:47], a[116:119], a[36:39], v[44:47]
    v_cvt_pk_bf16_f32 v62, v52, v53
    v_cvt_pk_bf16_f32 v63, v54, v55
    v_mfma_f32_16x16x32_bf16 v[44:47], a[120:123], a[40:43], v[44:47]
    buffer_load_dwordx4 v18, s[8:11], s22 offen offset:1024 lds
    v_mfma_f32_16x16x32_bf16 v[44:47], a[124:127], a[44:47], v[44:47]
    ds_read_b64_tr_b16 a[164:165], v6 offset:24576
    v_mul_f32 v40, s20, v40
    v_smfmac_f32_16x16x64_bf16 a[224:227], a[238:241], v[56:63], v26
    v_exp_f32 v40, v40
    v_mul_f32 v41, s20, v41
    v_mul_f32 v42, s20, v42
    v_mfma_f32_16x16x32_bf16 v[96:99], a[160:163], v[60:63], v[96:99]
    ds_read_b64_tr_b16 a[166:167], v36 offset:24576
    v_mul_f32 v43, s20, v43
    v_mfma_f32_16x16x32_bf16 v[100:103], a[168:171], v[60:63], v[100:103]
    v_exp_f32 v41, v41
    v_mfma_f32_16x16x32_bf16 v[104:107], a[176:179], v[60:63], v[104:107]
    v_exp_f32 v42, v42
    v_mfma_f32_16x16x32_bf16 v[108:111], a[184:187], v[60:63], v[108:111]
    ds_read_b64_tr_b16 a[172:173], v6 offset:24584
    v_mul_f32 v44, s20, v44
    v_mfma_f32_16x16x32_bf16 v[112:115], a[192:195], v[60:63], v[112:115]
    v_exp_f32 v43, v43
    v_mfma_f32_16x16x32_bf16 v[116:119], a[200:203], v[60:63], v[116:119]
    v_exp_f32 v44, v44
    v_mfma_f32_16x16x32_bf16 v[120:123], a[208:211], v[60:63], v[120:123]
    ds_read_b64_tr_b16 a[174:175], v36 offset:24584
    v_mul_f32 v45, s20, v45
    v_mfma_f32_16x16x32_bf16 v[124:127], a[216:219], v[60:63], v[124:127]
    v_mul_f32 v46, s20, v46
    v_mul_f32 v47, s20, v47
    v_mfma_f32_16x16x32_bf16 v[48:51], a[96:99], a[48:51], 0
    v_exp_f32 v45, v45
    v_mfma_f32_16x16x32_bf16 v[48:51], a[100:103], a[52:55], v[48:51]
    v_cvt_pk_bf16_f32 v56, v40, v41
    v_cvt_pk_bf16_f32 v57, v42, v43
    v_mfma_f32_16x16x32_bf16 v[48:51], a[104:107], a[56:59], v[48:51]
    v_exp_f32 v46, v46
    v_mfma_f32_16x16x32_bf16 v[48:51], a[108:111], a[60:63], v[48:51]
    v_exp_f32 v47, v47
    v_mfma_f32_16x16x32_bf16 v[52:55], a[112:115], a[48:51], 0
    s_add_u32 m0, s35, 49152
    v_cvt_pk_bf16_f32 v58, v44, v45
    v_cvt_pk_bf16_f32 v59, v46, v47
    v_mfma_f32_16x16x32_bf16 v[52:55], a[116:119], a[52:55], v[52:55]
    buffer_load_dwordx4 v19, s[12:15], s22 offen lds
    v_mfma_f32_16x16x32_bf16 v[52:55], a[120:123], a[56:59], v[52:55]
    ds_read_b64_tr_b16 a[180:181], v7 offset:24576
    v_mul_f32 v48, s20, v48
    v_mfma_f32_16x16x32_bf16 v[52:55], a[124:127], a[60:63], v[52:55]
    v_exp_f32 v48, v48

    v_mfma_f32_16x16x32_bf16 v[128:131], a[160:163], v[56:59], v[128:131]
    v_mul_f32 v49, s20, v49
    v_mul_f32 v50, s20, v50
    v_mfma_f32_16x16x32_bf16 v[132:135], a[168:171], v[56:59], v[132:135]
    ds_read_b64_tr_b16 a[182:183], v37 offset:24576
    v_mul_f32 v51, s20, v51
    v_mfma_f32_16x16x32_bf16 v[136:139], a[176:179], v[56:59], v[136:139]
    v_exp_f32 v49, v49
    v_mfma_f32_16x16x32_bf16 v[140:143], a[184:187], v[56:59], v[140:143]
    v_exp_f32 v50, v50
    v_mfma_f32_16x16x32_bf16 v[144:147], a[192:195], v[56:59], v[144:147]
    ds_read_b64_tr_b16 a[188:189], v7 offset:24584
    v_mul_f32 v52, s20, v52
    v_mfma_f32_16x16x32_bf16 v[148:151], a[200:203], v[56:59], v[148:151]
    v_exp_f32 v51, v51
    v_mfma_f32_16x16x32_bf16 v[152:155], a[208:211], v[56:59], v[152:155]
    v_exp_f32 v52, v52
    v_mfma_f32_16x16x32_bf16 v[156:159], a[216:219], v[56:59], v[156:159]
    ds_read_b64_tr_b16 a[190:191], v37 offset:24584
    v_mul_f32 v53, s20, v53
    v_mfma_f32_16x16x32_bf16 v[40:43], a[96:99], a[64:67], 0
    v_mul_f32 v54, s20, v54
    v_mul_f32 v55, s20, v55
    v_mfma_f32_16x16x32_bf16 v[40:43], a[100:103], a[68:71], v[40:43]
    v_exp_f32 v53, v53
    v_mfma_f32_16x16x32_bf16 v[40:43], a[104:107], a[72:75], v[40:43]
    v_cvt_pk_bf16_f32 v60, v48, v49
    v_cvt_pk_bf16_f32 v61, v50, v51
    v_mfma_f32_16x16x32_bf16 v[40:43], a[108:111], a[76:79], v[40:43]
    v_exp_f32 v54, v54
    v_mfma_f32_16x16x32_bf16 v[44:47], a[112:115], a[64:67], 0
    v_exp_f32 v55, v55
    v_mfma_f32_16x16x32_bf16 v[44:47], a[116:119], a[68:71], v[44:47]
    v_cvt_pk_bf16_f32 v62, v52, v53
    v_cvt_pk_bf16_f32 v63, v54, v55
    v_mfma_f32_16x16x32_bf16 v[44:47], a[120:123], a[72:75], v[44:47]
    buffer_load_dwordx4 v19, s[12:15], s22 offen offset:1024 lds
    v_mfma_f32_16x16x32_bf16 v[44:47], a[124:127], a[76:79], v[44:47]
    s_add_u32 m0, s30, 12288
    ds_read_b64_tr_b16 a[196:197], v8 offset:24576
    v_mul_f32 v40, s20, v40
    v_smfmac_f32_16x16x64_bf16 a[228:231], a[238:241], v[56:63], v26
    buffer_store_dwordx4 v[28:31], v17, s[16:19], s32 offen offset:3072 nt
    buffer_load_dwordx4 v17, s[4:7], s28 offen offset:3072 nt lds
    v_exp_f32 v40, v40
    v_mul_f32 v41, s20, v41
    v_mul_f32 v42, s20, v42
    v_mfma_f32_16x16x32_bf16 v[160:163], a[160:163], v[60:63], v[160:163]
    s_xor_b32 s22, s22, 8192
    ds_read_b64_tr_b16 a[198:199], v38 offset:24576
    v_mul_f32 v43, s20, v43
    v_mfma_f32_16x16x32_bf16 v[164:167], a[168:171], v[60:63], v[164:167]
    v_exp_f32 v41, v41
    v_mfma_f32_16x16x32_bf16 v[168:171], a[176:179], v[60:63], v[168:171]
    v_exp_f32 v42, v42
    v_mfma_f32_16x16x32_bf16 v[172:175], a[184:187], v[60:63], v[172:175]
    ds_read_b64_tr_b16 a[204:205], v8 offset:24584
    v_mul_f32 v44, s20, v44
    v_mfma_f32_16x16x32_bf16 v[176:179], a[192:195], v[60:63], v[176:179]
    v_exp_f32 v43, v43
    v_mfma_f32_16x16x32_bf16 v[180:183], a[200:203], v[60:63], v[180:183]
    v_exp_f32 v44, v44
    v_mfma_f32_16x16x32_bf16 v[184:187], a[208:211], v[60:63], v[184:187]
    ds_read_b64_tr_b16 a[206:207], v38 offset:24584
    v_mul_f32 v45, s20, v45
    v_mfma_f32_16x16x32_bf16 v[188:191], a[216:219], v[60:63], v[188:191]
    v_mul_f32 v46, s20, v46
    v_mul_f32 v47, s20, v47
    v_mfma_f32_16x16x32_bf16 v[48:51], a[96:99], a[80:83], 0
    v_exp_f32 v45, v45
    v_mfma_f32_16x16x32_bf16 v[48:51], a[100:103], a[84:87], v[48:51]
    v_cvt_pk_bf16_f32 v56, v40, v41
    v_cvt_pk_bf16_f32 v57, v42, v43
    v_mfma_f32_16x16x32_bf16 v[48:51], a[104:107], a[88:91], v[48:51]
    v_exp_f32 v46, v46
    v_mfma_f32_16x16x32_bf16 v[48:51], a[108:111], a[92:95], v[48:51]
    v_exp_f32 v47, v47
    v_mfma_f32_16x16x32_bf16 v[52:55], a[112:115], a[80:83], 0
    v_cvt_pk_bf16_f32 v58, v44, v45
    v_cvt_pk_bf16_f32 v59, v46, v47
    v_mfma_f32_16x16x32_bf16 v[52:55], a[116:119], a[84:87], v[52:55]
    ds_read_b128 v[28:31], v24 offset:16384
    ds_read_b128 v[32:35], v24 offset:17408
    v_mfma_f32_16x16x32_bf16 v[52:55], a[120:123], a[88:91], v[52:55]
    ds_read_b64_tr_b16 a[212:213], v9 offset:24576
    v_mul_f32 v48, s20, v48
    v_mfma_f32_16x16x32_bf16 v[52:55], a[124:127], a[92:95], v[52:55]
    v_exp_f32 v48, v48

    v_mfma_f32_16x16x32_bf16 v[192:195], a[160:163], v[56:59], v[192:195]
    v_mul_f32 v49, s20, v49
    v_mul_f32 v50, s20, v50
    v_mfma_f32_16x16x32_bf16 v[196:199], a[168:171], v[56:59], v[196:199]
    ds_read_b64_tr_b16 a[214:215], v39 offset:24576
    v_mul_f32 v51, s20, v51
    v_mfma_f32_16x16x32_bf16 v[200:203], a[176:179], v[56:59], v[200:203]
    v_exp_f32 v49, v49
    v_mfma_f32_16x16x32_bf16 v[204:207], a[184:187], v[56:59], v[204:207]
    v_exp_f32 v50, v50
    v_mfma_f32_16x16x32_bf16 v[208:211], a[192:195], v[56:59], v[208:211]
    ds_read_b64_tr_b16 a[220:221], v9 offset:24584
    v_mul_f32 v52, s20, v52
    v_mfma_f32_16x16x32_bf16 v[212:215], a[200:203], v[56:59], v[212:215]
    v_exp_f32 v51, v51
    v_mfma_f32_16x16x32_bf16 v[216:219], a[208:211], v[56:59], v[216:219]
    v_exp_f32 v52, v52
    v_mfma_f32_16x16x32_bf16 v[220:223], a[216:219], v[56:59], v[220:223]
    s_waitcnt lgkmcnt(15)
    ds_read_b64_tr_b16 a[222:223], v39 offset:24584
    v_mul_f32 v53, s20, v53
L_A11:
    v_mfma_f32_16x16x32_bf16 v[40:43], a[128:131], a[0:3], 0
    v_mul_f32 v54, s20, v54
    v_mul_f32 v55, s20, v55
    v_mfma_f32_16x16x32_bf16 v[40:43], a[132:135], a[4:7], v[40:43]
    v_exp_f32 v53, v53
    v_mfma_f32_16x16x32_bf16 v[40:43], a[136:139], a[8:11], v[40:43]
    v_cvt_pk_bf16_f32 v60, v48, v49
    v_cvt_pk_bf16_f32 v61, v50, v51
    v_mfma_f32_16x16x32_bf16 v[40:43], a[140:143], a[12:15], v[40:43]
    v_exp_f32 v54, v54
    v_mfma_f32_16x16x32_bf16 v[44:47], a[144:147], a[0:3], 0
    v_exp_f32 v55, v55
    v_mfma_f32_16x16x32_bf16 v[44:47], a[148:151], a[4:7], v[44:47]
    s_waitcnt vmcnt(16) lgkmcnt(0)
    v_cvt_pk_bf16_f32 v62, v52, v53
    v_cvt_pk_bf16_f32 v63, v54, v55
    v_mfma_f32_16x16x32_bf16 v[44:47], a[152:155], a[8:11], v[44:47]
    s_barrier
    v_mfma_f32_16x16x32_bf16 v[44:47], a[156:159], a[12:15], v[44:47]
    ds_read_b128 a[96:99], v2 offset:0
    v_mul_f32 v40, s20, v40
    v_smfmac_f32_16x16x64_bf16 a[232:235], a[238:241], v[56:63], v26
    v_exp_f32 v40, v40
    v_mul_f32 v41, s20, v41
    v_mul_f32 v42, s20, v42
    v_mfma_f32_16x16x32_bf16 v[224:227], a[160:163], v[60:63], v[224:227]
    ds_read_b128 a[100:103], v3 offset:0
    v_mul_f32 v43, s20, v43
    v_mfma_f32_16x16x32_bf16 v[228:231], a[168:171], v[60:63], v[228:231]
    v_exp_f32 v41, v41
    v_mfma_f32_16x16x32_bf16 v[232:235], a[176:179], v[60:63], v[232:235]
    v_exp_f32 v42, v42
    v_mfma_f32_16x16x32_bf16 v[236:239], a[184:187], v[60:63], v[236:239]
    ds_read_b128 a[104:107], v4 offset:0
    v_mul_f32 v44, s20, v44
    v_mfma_f32_16x16x32_bf16 v[240:243], a[192:195], v[60:63], v[240:243]
    v_exp_f32 v43, v43
    v_mfma_f32_16x16x32_bf16 v[244:247], a[200:203], v[60:63], v[244:247]
    v_exp_f32 v44, v44
    v_mfma_f32_16x16x32_bf16 v[248:251], a[208:211], v[60:63], v[248:251]
    ds_read_b128 a[108:111], v5 offset:0
    v_mul_f32 v45, s20, v45
    v_mfma_f32_16x16x32_bf16 v[252:255], a[216:219], v[60:63], v[252:255]
    v_mul_f32 v46, s20, v46
    v_mul_f32 v47, s20, v47
    v_mfma_f32_16x16x32_bf16 v[48:51], a[128:131], a[16:19], 0
    v_exp_f32 v45, v45
    v_mfma_f32_16x16x32_bf16 v[48:51], a[132:135], a[20:23], v[48:51]
    v_cvt_pk_bf16_f32 v56, v40, v41
    v_cvt_pk_bf16_f32 v57, v42, v43
    v_mfma_f32_16x16x32_bf16 v[48:51], a[136:139], a[24:27], v[48:51]
    v_exp_f32 v46, v46
    v_mfma_f32_16x16x32_bf16 v[48:51], a[140:143], a[28:31], v[48:51]
    v_exp_f32 v47, v47
    v_mfma_f32_16x16x32_bf16 v[52:55], a[144:147], a[16:19], 0
    s_add_u32 m0, s35, 24576
    v_cvt_pk_bf16_f32 v58, v44, v45
    v_cvt_pk_bf16_f32 v59, v46, v47
    v_mfma_f32_16x16x32_bf16 v[52:55], a[148:151], a[20:23], v[52:55]
    buffer_load_dwordx4 v18, s[8:11], s22 offen lds
    v_mfma_f32_16x16x32_bf16 v[52:55], a[152:155], a[24:27], v[52:55]
    ds_read_b128 a[112:115], v0 offset:0
    v_mul_f32 v48, s20, v48
    v_mfma_f32_16x16x32_bf16 v[52:55], a[156:159], a[28:31], v[52:55]
    v_exp_f32 v48, v48

    v_mfma_f32_16x16x32_bf16 v[64:67], a[164:167], v[56:59], v[64:67]
    v_mul_f32 v49, s20, v49
    v_mul_f32 v50, s20, v50
    v_mfma_f32_16x16x32_bf16 v[68:71], a[172:175], v[56:59], v[68:71]
    ds_read_b128 a[116:119], v1 offset:0
    v_mul_f32 v51, s20, v51
    v_mfma_f32_16x16x32_bf16 v[72:75], a[180:183], v[56:59], v[72:75]
    v_exp_f32 v49, v49
    v_mfma_f32_16x16x32_bf16 v[76:79], a[188:191], v[56:59], v[76:79]
    v_exp_f32 v50, v50
    v_mfma_f32_16x16x32_bf16 v[80:83], a[196:199], v[56:59], v[80:83]
    ds_read_b128 a[120:123], v25 offset:0
    v_mul_f32 v52, s20, v52
    v_mfma_f32_16x16x32_bf16 v[84:87], a[204:207], v[56:59], v[84:87]
    v_exp_f32 v51, v51
    v_mfma_f32_16x16x32_bf16 v[88:91], a[212:215], v[56:59], v[88:91]
    v_exp_f32 v52, v52
    v_mfma_f32_16x16x32_bf16 v[92:95], a[220:223], v[56:59], v[92:95]
    ds_read_b128 a[124:127], v27 offset:0
    v_mul_f32 v53, s20, v53
    v_mfma_f32_16x16x32_bf16 v[40:43], a[128:131], a[32:35], 0
    v_mul_f32 v54, s20, v54
    v_mul_f32 v55, s20, v55
    v_mfma_f32_16x16x32_bf16 v[40:43], a[132:135], a[36:39], v[40:43]
    v_exp_f32 v53, v53
    v_mfma_f32_16x16x32_bf16 v[40:43], a[136:139], a[40:43], v[40:43]
    v_cvt_pk_bf16_f32 v60, v48, v49
    v_cvt_pk_bf16_f32 v61, v50, v51
    v_mfma_f32_16x16x32_bf16 v[40:43], a[140:143], a[44:47], v[40:43]
    v_exp_f32 v54, v54
    v_mfma_f32_16x16x32_bf16 v[44:47], a[144:147], a[32:35], 0
    v_exp_f32 v55, v55
    v_mfma_f32_16x16x32_bf16 v[44:47], a[148:151], a[36:39], v[44:47]
    v_cvt_pk_bf16_f32 v62, v52, v53
    v_cvt_pk_bf16_f32 v63, v54, v55
    v_mfma_f32_16x16x32_bf16 v[44:47], a[152:155], a[40:43], v[44:47]
    buffer_load_dwordx4 v18, s[8:11], s22 offen offset:1024 lds
    v_mfma_f32_16x16x32_bf16 v[44:47], a[156:159], a[44:47], v[44:47]
    ds_read_b64_tr_b16 a[160:161], v6 offset:0
    v_mul_f32 v40, s20, v40
    v_smfmac_f32_16x16x64_bf16 a[224:227], a[238:241], v[56:63], v26
    v_exp_f32 v40, v40
    v_mul_f32 v41, s20, v41
    v_mul_f32 v42, s20, v42
    v_mfma_f32_16x16x32_bf16 v[96:99], a[164:167], v[60:63], v[96:99]
    ds_read_b64_tr_b16 a[162:163], v36 offset:0
    v_mul_f32 v43, s20, v43
    v_mfma_f32_16x16x32_bf16 v[100:103], a[172:175], v[60:63], v[100:103]
    v_exp_f32 v41, v41
    v_mfma_f32_16x16x32_bf16 v[104:107], a[180:183], v[60:63], v[104:107]
    v_exp_f32 v42, v42
    v_mfma_f32_16x16x32_bf16 v[108:111], a[188:191], v[60:63], v[108:111]
    ds_read_b64_tr_b16 a[168:169], v6 offset:8
    v_mul_f32 v44, s20, v44
    v_mfma_f32_16x16x32_bf16 v[112:115], a[196:199], v[60:63], v[112:115]
    v_exp_f32 v43, v43
    v_mfma_f32_16x16x32_bf16 v[116:119], a[204:207], v[60:63], v[116:119]
    v_exp_f32 v44, v44
    v_mfma_f32_16x16x32_bf16 v[120:123], a[212:215], v[60:63], v[120:123]
    ds_read_b64_tr_b16 a[170:171], v36 offset:8
    v_mul_f32 v45, s20, v45
    v_mfma_f32_16x16x32_bf16 v[124:127], a[220:223], v[60:63], v[124:127]
    v_mul_f32 v46, s20, v46
    v_mul_f32 v47, s20, v47
    v_mfma_f32_16x16x32_bf16 v[48:51], a[128:131], a[48:51], 0
    v_exp_f32 v45, v45
    v_mfma_f32_16x16x32_bf16 v[48:51], a[132:135], a[52:55], v[48:51]
    v_cvt_pk_bf16_f32 v56, v40, v41
    v_cvt_pk_bf16_f32 v57, v42, v43
    v_mfma_f32_16x16x32_bf16 v[48:51], a[136:139], a[56:59], v[48:51]
    v_exp_f32 v46, v46
    v_mfma_f32_16x16x32_bf16 v[48:51], a[140:143], a[60:63], v[48:51]
    v_exp_f32 v47, v47
    v_mfma_f32_16x16x32_bf16 v[52:55], a[144:147], a[48:51], 0
    s_add_u32 m0, s35, 57344
    v_cvt_pk_bf16_f32 v58, v44, v45
    v_cvt_pk_bf16_f32 v59, v46, v47
    v_mfma_f32_16x16x32_bf16 v[52:55], a[148:151], a[52:55], v[52:55]
    buffer_load_dwordx4 v19, s[12:15], s22 offen lds
    v_mfma_f32_16x16x32_bf16 v[52:55], a[152:155], a[56:59], v[52:55]
    ds_read_b64_tr_b16 a[176:177], v7 offset:0
    v_mul_f32 v48, s20, v48
    v_mfma_f32_16x16x32_bf16 v[52:55], a[156:159], a[60:63], v[52:55]
    v_exp_f32 v48, v48

    v_mfma_f32_16x16x32_bf16 v[128:131], a[164:167], v[56:59], v[128:131]
    v_mul_f32 v49, s20, v49
    v_mul_f32 v50, s20, v50
    v_mfma_f32_16x16x32_bf16 v[132:135], a[172:175], v[56:59], v[132:135]
    ds_read_b64_tr_b16 a[178:179], v37 offset:0
    v_mul_f32 v51, s20, v51
    v_mfma_f32_16x16x32_bf16 v[136:139], a[180:183], v[56:59], v[136:139]
    v_exp_f32 v49, v49
    v_mfma_f32_16x16x32_bf16 v[140:143], a[188:191], v[56:59], v[140:143]
    v_exp_f32 v50, v50
    v_mfma_f32_16x16x32_bf16 v[144:147], a[196:199], v[56:59], v[144:147]
    ds_read_b64_tr_b16 a[184:185], v7 offset:8
    v_mul_f32 v52, s20, v52
    v_mfma_f32_16x16x32_bf16 v[148:151], a[204:207], v[56:59], v[148:151]
    v_exp_f32 v51, v51
    v_mfma_f32_16x16x32_bf16 v[152:155], a[212:215], v[56:59], v[152:155]
    v_exp_f32 v52, v52
    v_mfma_f32_16x16x32_bf16 v[156:159], a[220:223], v[56:59], v[156:159]
    ds_read_b64_tr_b16 a[186:187], v37 offset:8
    v_mul_f32 v53, s20, v53
    v_mfma_f32_16x16x32_bf16 v[40:43], a[128:131], a[64:67], 0
    v_mul_f32 v54, s20, v54
    v_mul_f32 v55, s20, v55
    v_mfma_f32_16x16x32_bf16 v[40:43], a[132:135], a[68:71], v[40:43]
    v_exp_f32 v53, v53
    v_mfma_f32_16x16x32_bf16 v[40:43], a[136:139], a[72:75], v[40:43]
    v_cvt_pk_bf16_f32 v60, v48, v49
    v_cvt_pk_bf16_f32 v61, v50, v51
    v_mfma_f32_16x16x32_bf16 v[40:43], a[140:143], a[76:79], v[40:43]
    v_exp_f32 v54, v54
    v_mfma_f32_16x16x32_bf16 v[44:47], a[144:147], a[64:67], 0
    s_add_u32 s28, s24, 16384
    v_exp_f32 v55, v55
    v_mfma_f32_16x16x32_bf16 v[44:47], a[148:151], a[68:71], v[44:47]
    s_add_u32 s32, s31, 16384
    v_cvt_pk_bf16_f32 v62, v52, v53
    v_cvt_pk_bf16_f32 v63, v54, v55
    v_mfma_f32_16x16x32_bf16 v[44:47], a[152:155], a[72:75], v[44:47]
    buffer_load_dwordx4 v19, s[12:15], s22 offen offset:1024 lds
    v_mfma_f32_16x16x32_bf16 v[44:47], a[156:159], a[76:79], v[44:47]
    s_add_u32 m0, s30, 16384
    ds_read_b64_tr_b16 a[192:193], v8 offset:0
    v_mul_f32 v40, s20, v40
    v_smfmac_f32_16x16x64_bf16 a[228:231], a[238:241], v[56:63], v26
    buffer_store_dwordx4 v[28:31], v14, s[16:19], s32 offen nt
    buffer_load_dwordx4 v14, s[4:7], s28 offen nt lds
    v_exp_f32 v40, v40
    v_mul_f32 v41, s20, v41
    v_mul_f32 v42, s20, v42
    v_mfma_f32_16x16x32_bf16 v[160:163], a[164:167], v[60:63], v[160:163]
    s_xor_b32 s22, s22, 122880
    ds_read_b64_tr_b16 a[194:195], v38 offset:0
    v_mul_f32 v43, s20, v43
    v_mfma_f32_16x16x32_bf16 v[164:167], a[172:175], v[60:63], v[164:167]
    v_exp_f32 v41, v41
    v_mfma_f32_16x16x32_bf16 v[168:171], a[180:183], v[60:63], v[168:171]
    v_exp_f32 v42, v42
    v_mfma_f32_16x16x32_bf16 v[172:175], a[188:191], v[60:63], v[172:175]
    ds_read_b64_tr_b16 a[200:201], v8 offset:8
    v_mul_f32 v44, s20, v44
    v_mfma_f32_16x16x32_bf16 v[176:179], a[196:199], v[60:63], v[176:179]
    v_exp_f32 v43, v43
    v_mfma_f32_16x16x32_bf16 v[180:183], a[204:207], v[60:63], v[180:183]
    v_exp_f32 v44, v44
    v_mfma_f32_16x16x32_bf16 v[184:187], a[212:215], v[60:63], v[184:187]
    ds_read_b64_tr_b16 a[202:203], v38 offset:8
    v_mul_f32 v45, s20, v45
    v_mfma_f32_16x16x32_bf16 v[188:191], a[220:223], v[60:63], v[188:191]
    v_mul_f32 v46, s20, v46
    v_mul_f32 v47, s20, v47
    v_mfma_f32_16x16x32_bf16 v[48:51], a[128:131], a[80:83], 0
    v_exp_f32 v45, v45
    v_mfma_f32_16x16x32_bf16 v[48:51], a[132:135], a[84:87], v[48:51]
    buffer_store_dwordx4 v[32:35], v15, s[16:19], s32 offen offset:1024 nt
    buffer_load_dwordx4 v15, s[4:7], s28 offen offset:1024 nt lds
    v_cvt_pk_bf16_f32 v56, v40, v41
    v_cvt_pk_bf16_f32 v57, v42, v43
    v_mfma_f32_16x16x32_bf16 v[48:51], a[136:139], a[88:91], v[48:51]
    v_exp_f32 v46, v46
    v_mfma_f32_16x16x32_bf16 v[48:51], a[140:143], a[92:95], v[48:51]
    v_exp_f32 v47, v47
    v_mfma_f32_16x16x32_bf16 v[52:55], a[144:147], a[80:83], 0
    v_cvt_pk_bf16_f32 v58, v44, v45
    v_cvt_pk_bf16_f32 v59, v46, v47
    v_mfma_f32_16x16x32_bf16 v[52:55], a[148:151], a[84:87], v[52:55]
    ds_read_b128 v[28:31], v24 offset:18432
    ds_read_b128 v[32:35], v24 offset:19456
    v_mfma_f32_16x16x32_bf16 v[52:55], a[152:155], a[88:91], v[52:55]
    ds_read_b64_tr_b16 a[208:209], v9 offset:0
    v_mul_f32 v48, s20, v48
    v_mfma_f32_16x16x32_bf16 v[52:55], a[156:159], a[92:95], v[52:55]
    v_exp_f32 v48, v48

    v_mfma_f32_16x16x32_bf16 v[192:195], a[164:167], v[56:59], v[192:195]
    v_mul_f32 v49, s20, v49
    v_mul_f32 v50, s20, v50
    v_mfma_f32_16x16x32_bf16 v[196:199], a[172:175], v[56:59], v[196:199]
    ds_read_b64_tr_b16 a[210:211], v39 offset:0
    v_mul_f32 v51, s20, v51
    v_mfma_f32_16x16x32_bf16 v[200:203], a[180:183], v[56:59], v[200:203]
    v_exp_f32 v49, v49
    v_mfma_f32_16x16x32_bf16 v[204:207], a[188:191], v[56:59], v[204:207]
    v_exp_f32 v50, v50
    v_mfma_f32_16x16x32_bf16 v[208:211], a[196:199], v[56:59], v[208:211]
    ds_read_b64_tr_b16 a[216:217], v9 offset:8
    v_mul_f32 v52, s20, v52
    v_mfma_f32_16x16x32_bf16 v[212:215], a[204:207], v[56:59], v[212:215]
    v_exp_f32 v51, v51
    v_mfma_f32_16x16x32_bf16 v[216:219], a[212:215], v[56:59], v[216:219]
    v_exp_f32 v52, v52
    v_mfma_f32_16x16x32_bf16 v[220:223], a[220:223], v[56:59], v[220:223]
    s_waitcnt lgkmcnt(15)
    ds_read_b64_tr_b16 a[218:219], v39 offset:8
    v_mul_f32 v53, s20, v53
L_A12:
    v_mfma_f32_16x16x32_bf16 v[40:43], a[96:99], a[0:3], 0
    s_mov_b32 s22, s23
    v_mul_f32 v54, s20, v54
    v_mul_f32 v55, s20, v55
    v_mfma_f32_16x16x32_bf16 v[40:43], a[100:103], a[4:7], v[40:43]
    v_exp_f32 v53, v53
    v_mfma_f32_16x16x32_bf16 v[40:43], a[104:107], a[8:11], v[40:43]
    v_cvt_pk_bf16_f32 v60, v48, v49
    v_cvt_pk_bf16_f32 v61, v50, v51
    v_mfma_f32_16x16x32_bf16 v[40:43], a[108:111], a[12:15], v[40:43]
    v_exp_f32 v54, v54
    v_mfma_f32_16x16x32_bf16 v[44:47], a[112:115], a[0:3], 0
    v_exp_f32 v55, v55
    v_mfma_f32_16x16x32_bf16 v[44:47], a[116:119], a[4:7], v[44:47]
    s_waitcnt vmcnt(18) lgkmcnt(0)
    v_cvt_pk_bf16_f32 v62, v52, v53
    v_cvt_pk_bf16_f32 v63, v54, v55
    v_mfma_f32_16x16x32_bf16 v[44:47], a[120:123], a[8:11], v[44:47]
    s_barrier
    v_mfma_f32_16x16x32_bf16 v[44:47], a[124:127], a[12:15], v[44:47]
    ds_read_b128 a[128:131], v2 offset:8192
    v_mul_f32 v40, s20, v40
    v_smfmac_f32_16x16x64_bf16 a[232:235], a[238:241], v[56:63], v26
    v_exp_f32 v40, v40
    v_mul_f32 v41, s20, v41
    v_mul_f32 v42, s20, v42
    v_mfma_f32_16x16x32_bf16 v[224:227], a[164:167], v[60:63], v[224:227]
    ds_read_b128 a[132:135], v3 offset:8192
    v_mul_f32 v43, s20, v43
    v_mfma_f32_16x16x32_bf16 v[228:231], a[172:175], v[60:63], v[228:231]
    v_exp_f32 v41, v41
    v_mfma_f32_16x16x32_bf16 v[232:235], a[180:183], v[60:63], v[232:235]
    v_exp_f32 v42, v42
    v_mfma_f32_16x16x32_bf16 v[236:239], a[188:191], v[60:63], v[236:239]
    ds_read_b128 a[136:139], v4 offset:8192
    v_mul_f32 v44, s20, v44
    v_mfma_f32_16x16x32_bf16 v[240:243], a[196:199], v[60:63], v[240:243]
    v_exp_f32 v43, v43
    v_mfma_f32_16x16x32_bf16 v[244:247], a[204:207], v[60:63], v[244:247]
    v_exp_f32 v44, v44
    v_mfma_f32_16x16x32_bf16 v[248:251], a[212:215], v[60:63], v[248:251]
    ds_read_b128 a[140:143], v5 offset:8192
    v_mul_f32 v45, s20, v45
    v_mfma_f32_16x16x32_bf16 v[252:255], a[220:223], v[60:63], v[252:255]
    v_mul_f32 v46, s20, v46
    v_mul_f32 v47, s20, v47
    v_mfma_f32_16x16x32_bf16 v[48:51], a[96:99], a[16:19], 0
    v_exp_f32 v45, v45
    v_mfma_f32_16x16x32_bf16 v[48:51], a[100:103], a[20:23], v[48:51]
    v_cvt_pk_bf16_f32 v56, v40, v41
    v_cvt_pk_bf16_f32 v57, v42, v43
    v_mfma_f32_16x16x32_bf16 v[48:51], a[104:107], a[24:27], v[48:51]
    v_exp_f32 v46, v46
    v_mfma_f32_16x16x32_bf16 v[48:51], a[108:111], a[28:31], v[48:51]
    v_exp_f32 v47, v47
    v_mfma_f32_16x16x32_bf16 v[52:55], a[112:115], a[16:19], 0
    s_add_u32 m0, s35, 0
    v_cvt_pk_bf16_f32 v58, v44, v45
    v_cvt_pk_bf16_f32 v59, v46, v47
    v_mfma_f32_16x16x32_bf16 v[52:55], a[116:119], a[20:23], v[52:55]
    buffer_load_dwordx4 v18, s[8:11], s22 offen lds
    v_mfma_f32_16x16x32_bf16 v[52:55], a[120:123], a[24:27], v[52:55]
    ds_read_b128 a[144:147], v0 offset:8192
    v_mul_f32 v48, s20, v48
    v_mfma_f32_16x16x32_bf16 v[52:55], a[124:127], a[28:31], v[52:55]
    v_exp_f32 v48, v48

    v_mfma_f32_16x16x32_bf16 v[64:67], a[160:163], v[56:59], v[64:67]
    v_mul_f32 v49, s20, v49
    v_mul_f32 v50, s20, v50
    v_mfma_f32_16x16x32_bf16 v[68:71], a[168:171], v[56:59], v[68:71]
    ds_read_b128 a[148:151], v1 offset:8192
    v_mul_f32 v51, s20, v51
    v_mfma_f32_16x16x32_bf16 v[72:75], a[176:179], v[56:59], v[72:75]
    v_exp_f32 v49, v49
    v_mfma_f32_16x16x32_bf16 v[76:79], a[184:187], v[56:59], v[76:79]
    v_exp_f32 v50, v50
    v_mfma_f32_16x16x32_bf16 v[80:83], a[192:195], v[56:59], v[80:83]
    ds_read_b128 a[152:155], v25 offset:8192
    v_mul_f32 v52, s20, v52
    v_mfma_f32_16x16x32_bf16 v[84:87], a[200:203], v[56:59], v[84:87]
    v_exp_f32 v51, v51
    v_mfma_f32_16x16x32_bf16 v[88:91], a[208:211], v[56:59], v[88:91]
    v_exp_f32 v52, v52
    v_mfma_f32_16x16x32_bf16 v[92:95], a[216:219], v[56:59], v[92:95]
    ds_read_b128 a[156:159], v27 offset:8192
    v_mul_f32 v53, s20, v53
    v_mfma_f32_16x16x32_bf16 v[40:43], a[96:99], a[32:35], 0
    v_mul_f32 v54, s20, v54
    v_mul_f32 v55, s20, v55
    v_mfma_f32_16x16x32_bf16 v[40:43], a[100:103], a[36:39], v[40:43]
    v_exp_f32 v53, v53
    v_mfma_f32_16x16x32_bf16 v[40:43], a[104:107], a[40:43], v[40:43]
    v_cvt_pk_bf16_f32 v60, v48, v49
    v_cvt_pk_bf16_f32 v61, v50, v51
    v_mfma_f32_16x16x32_bf16 v[40:43], a[108:111], a[44:47], v[40:43]
    v_exp_f32 v54, v54
    v_mfma_f32_16x16x32_bf16 v[44:47], a[112:115], a[32:35], 0
    v_exp_f32 v55, v55
    v_mfma_f32_16x16x32_bf16 v[44:47], a[116:119], a[36:39], v[44:47]
    v_cvt_pk_bf16_f32 v62, v52, v53
    v_cvt_pk_bf16_f32 v63, v54, v55
    v_mfma_f32_16x16x32_bf16 v[44:47], a[120:123], a[40:43], v[44:47]
    buffer_load_dwordx4 v18, s[8:11], s22 offen offset:1024 lds
    v_mfma_f32_16x16x32_bf16 v[44:47], a[124:127], a[44:47], v[44:47]
    ds_read_b64_tr_b16 a[164:165], v6 offset:8192
    v_mul_f32 v40, s20, v40
    v_smfmac_f32_16x16x64_bf16 a[224:227], a[238:241], v[56:63], v26
    v_exp_f32 v40, v40
    v_mul_f32 v41, s20, v41
    v_mul_f32 v42, s20, v42
    v_mfma_f32_16x16x32_bf16 v[96:99], a[160:163], v[60:63], v[96:99]
    ds_read_b64_tr_b16 a[166:167], v36 offset:8192
    v_mul_f32 v43, s20, v43
    v_mfma_f32_16x16x32_bf16 v[100:103], a[168:171], v[60:63], v[100:103]
    v_exp_f32 v41, v41
    v_mfma_f32_16x16x32_bf16 v[104:107], a[176:179], v[60:63], v[104:107]
    v_exp_f32 v42, v42
    v_mfma_f32_16x16x32_bf16 v[108:111], a[184:187], v[60:63], v[108:111]
    ds_read_b64_tr_b16 a[172:173], v6 offset:8200
    v_mul_f32 v44, s20, v44
    v_mfma_f32_16x16x32_bf16 v[112:115], a[192:195], v[60:63], v[112:115]
    v_exp_f32 v43, v43
    v_mfma_f32_16x16x32_bf16 v[116:119], a[200:203], v[60:63], v[116:119]
    v_exp_f32 v44, v44
    v_mfma_f32_16x16x32_bf16 v[120:123], a[208:211], v[60:63], v[120:123]
    ds_read_b64_tr_b16 a[174:175], v36 offset:8200
    v_mul_f32 v45, s20, v45
    v_mfma_f32_16x16x32_bf16 v[124:127], a[216:219], v[60:63], v[124:127]
    v_mul_f32 v46, s20, v46
    v_mul_f32 v47, s20, v47
    v_mfma_f32_16x16x32_bf16 v[48:51], a[96:99], a[48:51], 0
    v_exp_f32 v45, v45
    v_mfma_f32_16x16x32_bf16 v[48:51], a[100:103], a[52:55], v[48:51]
    v_cvt_pk_bf16_f32 v56, v40, v41
    v_cvt_pk_bf16_f32 v57, v42, v43
    v_mfma_f32_16x16x32_bf16 v[48:51], a[104:107], a[56:59], v[48:51]
    v_exp_f32 v46, v46
    v_mfma_f32_16x16x32_bf16 v[48:51], a[108:111], a[60:63], v[48:51]
    v_exp_f32 v47, v47
    v_mfma_f32_16x16x32_bf16 v[52:55], a[112:115], a[48:51], 0
    s_add_u32 m0, s35, 32768
    v_cvt_pk_bf16_f32 v58, v44, v45
    v_cvt_pk_bf16_f32 v59, v46, v47
    v_mfma_f32_16x16x32_bf16 v[52:55], a[116:119], a[52:55], v[52:55]
    buffer_load_dwordx4 v19, s[12:15], s22 offen lds
    v_mfma_f32_16x16x32_bf16 v[52:55], a[120:123], a[56:59], v[52:55]
    ds_read_b64_tr_b16 a[180:181], v7 offset:8192
    v_mul_f32 v48, s20, v48
    v_mfma_f32_16x16x32_bf16 v[52:55], a[124:127], a[60:63], v[52:55]
    v_exp_f32 v48, v48

    v_mfma_f32_16x16x32_bf16 v[128:131], a[160:163], v[56:59], v[128:131]
    v_mul_f32 v49, s20, v49
    v_mul_f32 v50, s20, v50
    v_mfma_f32_16x16x32_bf16 v[132:135], a[168:171], v[56:59], v[132:135]
    ds_read_b64_tr_b16 a[182:183], v37 offset:8192
    v_mul_f32 v51, s20, v51
    v_mfma_f32_16x16x32_bf16 v[136:139], a[176:179], v[56:59], v[136:139]
    v_exp_f32 v49, v49
    v_mfma_f32_16x16x32_bf16 v[140:143], a[184:187], v[56:59], v[140:143]
    v_exp_f32 v50, v50
    v_mfma_f32_16x16x32_bf16 v[144:147], a[192:195], v[56:59], v[144:147]
    ds_read_b64_tr_b16 a[188:189], v7 offset:8200
    v_mul_f32 v52, s20, v52
    v_mfma_f32_16x16x32_bf16 v[148:151], a[200:203], v[56:59], v[148:151]
    v_exp_f32 v51, v51
    v_mfma_f32_16x16x32_bf16 v[152:155], a[208:211], v[56:59], v[152:155]
    v_exp_f32 v52, v52
    v_mfma_f32_16x16x32_bf16 v[156:159], a[216:219], v[56:59], v[156:159]
    ds_read_b64_tr_b16 a[190:191], v37 offset:8200
    v_mul_f32 v53, s20, v53
    v_mfma_f32_16x16x32_bf16 v[40:43], a[96:99], a[64:67], 0
    v_mul_f32 v54, s20, v54
    v_mul_f32 v55, s20, v55
    v_mfma_f32_16x16x32_bf16 v[40:43], a[100:103], a[68:71], v[40:43]
    v_exp_f32 v53, v53
    v_mfma_f32_16x16x32_bf16 v[40:43], a[104:107], a[72:75], v[40:43]
    v_cvt_pk_bf16_f32 v60, v48, v49
    v_cvt_pk_bf16_f32 v61, v50, v51
    v_mfma_f32_16x16x32_bf16 v[40:43], a[108:111], a[76:79], v[40:43]
    v_exp_f32 v54, v54
    v_mfma_f32_16x16x32_bf16 v[44:47], a[112:115], a[64:67], 0
    v_exp_f32 v55, v55
    v_mfma_f32_16x16x32_bf16 v[44:47], a[116:119], a[68:71], v[44:47]
    v_cvt_pk_bf16_f32 v62, v52, v53
    v_cvt_pk_bf16_f32 v63, v54, v55
    v_mfma_f32_16x16x32_bf16 v[44:47], a[120:123], a[72:75], v[44:47]
    buffer_load_dwordx4 v19, s[12:15], s22 offen offset:1024 lds
    v_mfma_f32_16x16x32_bf16 v[44:47], a[124:127], a[76:79], v[44:47]
    s_add_u32 m0, s30, 16384
    ds_read_b64_tr_b16 a[196:197], v8 offset:8192
    v_mul_f32 v40, s20, v40
    v_smfmac_f32_16x16x64_bf16 a[228:231], a[238:241], v[56:63], v26
    buffer_store_dwordx4 v[28:31], v16, s[16:19], s32 offen offset:2048 nt
    buffer_load_dwordx4 v16, s[4:7], s28 offen offset:2048 nt lds
    v_exp_f32 v40, v40
    v_mul_f32 v41, s20, v41
    v_mul_f32 v42, s20, v42
    v_mfma_f32_16x16x32_bf16 v[160:163], a[160:163], v[60:63], v[160:163]
    s_xor_b32 s22, s22, 8192
    ds_read_b64_tr_b16 a[198:199], v38 offset:8192
    v_mul_f32 v43, s20, v43
    v_mfma_f32_16x16x32_bf16 v[164:167], a[168:171], v[60:63], v[164:167]
    v_exp_f32 v41, v41
    v_mfma_f32_16x16x32_bf16 v[168:171], a[176:179], v[60:63], v[168:171]
    v_exp_f32 v42, v42
    v_mfma_f32_16x16x32_bf16 v[172:175], a[184:187], v[60:63], v[172:175]
    ds_read_b64_tr_b16 a[204:205], v8 offset:8200
    v_mul_f32 v44, s20, v44
    v_mfma_f32_16x16x32_bf16 v[176:179], a[192:195], v[60:63], v[176:179]
    v_exp_f32 v43, v43
    v_mfma_f32_16x16x32_bf16 v[180:183], a[200:203], v[60:63], v[180:183]
    v_exp_f32 v44, v44
    v_mfma_f32_16x16x32_bf16 v[184:187], a[208:211], v[60:63], v[184:187]
    ds_read_b64_tr_b16 a[206:207], v38 offset:8200
    v_mul_f32 v45, s20, v45
    v_mfma_f32_16x16x32_bf16 v[188:191], a[216:219], v[60:63], v[188:191]
    v_mul_f32 v46, s20, v46
    v_mul_f32 v47, s20, v47
    v_mfma_f32_16x16x32_bf16 v[48:51], a[96:99], a[80:83], 0
    v_exp_f32 v45, v45
    v_mfma_f32_16x16x32_bf16 v[48:51], a[100:103], a[84:87], v[48:51]
    buffer_store_dwordx4 v[32:35], v17, s[16:19], s32 offen offset:3072 nt
    buffer_load_dwordx4 v17, s[4:7], s28 offen offset:3072 nt lds
    v_cvt_pk_bf16_f32 v56, v40, v41
    v_cvt_pk_bf16_f32 v57, v42, v43
    v_mfma_f32_16x16x32_bf16 v[48:51], a[104:107], a[88:91], v[48:51]
    v_exp_f32 v46, v46
    v_mfma_f32_16x16x32_bf16 v[48:51], a[108:111], a[92:95], v[48:51]
    v_exp_f32 v47, v47
    v_mfma_f32_16x16x32_bf16 v[52:55], a[112:115], a[80:83], 0
    v_cvt_pk_bf16_f32 v58, v44, v45
    v_cvt_pk_bf16_f32 v59, v46, v47
    v_mfma_f32_16x16x32_bf16 v[52:55], a[116:119], a[84:87], v[52:55]
    s_nop 0
    v_mfma_f32_16x16x32_bf16 v[52:55], a[120:123], a[88:91], v[52:55]
    ds_read_b64_tr_b16 a[212:213], v9 offset:8192
    v_mul_f32 v48, s20, v48
    v_mfma_f32_16x16x32_bf16 v[52:55], a[124:127], a[92:95], v[52:55]
    v_exp_f32 v48, v48

    v_mfma_f32_16x16x32_bf16 v[192:195], a[160:163], v[56:59], v[192:195]
    v_mul_f32 v49, s20, v49
    v_mul_f32 v50, s20, v50
    v_mfma_f32_16x16x32_bf16 v[196:199], a[168:171], v[56:59], v[196:199]
    ds_read_b64_tr_b16 a[214:215], v39 offset:8192
    v_mul_f32 v51, s20, v51
    v_mfma_f32_16x16x32_bf16 v[200:203], a[176:179], v[56:59], v[200:203]
    v_exp_f32 v49, v49
    v_mfma_f32_16x16x32_bf16 v[204:207], a[184:187], v[56:59], v[204:207]
    v_exp_f32 v50, v50
    v_mfma_f32_16x16x32_bf16 v[208:211], a[192:195], v[56:59], v[208:211]
    ds_read_b64_tr_b16 a[220:221], v9 offset:8200
    v_mul_f32 v52, s20, v52
    v_mfma_f32_16x16x32_bf16 v[212:215], a[200:203], v[56:59], v[212:215]
    v_exp_f32 v51, v51
    v_mfma_f32_16x16x32_bf16 v[216:219], a[208:211], v[56:59], v[216:219]
    v_exp_f32 v52, v52
    v_mfma_f32_16x16x32_bf16 v[220:223], a[216:219], v[56:59], v[220:223]
    s_waitcnt lgkmcnt(15)
    ds_read_b64_tr_b16 a[222:223], v39 offset:8200
    v_mul_f32 v53, s20, v53
L_A13:
    v_mfma_f32_16x16x32_bf16 v[40:43], a[128:131], a[0:3], 0
    v_mul_f32 v54, s20, v54
    v_mul_f32 v55, s20, v55
    v_mfma_f32_16x16x32_bf16 v[40:43], a[132:135], a[4:7], v[40:43]
    v_exp_f32 v53, v53
    v_mfma_f32_16x16x32_bf16 v[40:43], a[136:139], a[8:11], v[40:43]
    v_cvt_pk_bf16_f32 v60, v48, v49
    v_cvt_pk_bf16_f32 v61, v50, v51
    v_mfma_f32_16x16x32_bf16 v[40:43], a[140:143], a[12:15], v[40:43]
    v_exp_f32 v54, v54
    v_mfma_f32_16x16x32_bf16 v[44:47], a[144:147], a[0:3], 0
    v_exp_f32 v55, v55
    v_mfma_f32_16x16x32_bf16 v[44:47], a[148:151], a[4:7], v[44:47]
    s_waitcnt vmcnt(18) lgkmcnt(0)
    v_cvt_pk_bf16_f32 v62, v52, v53
    v_cvt_pk_bf16_f32 v63, v54, v55
    v_mfma_f32_16x16x32_bf16 v[44:47], a[152:155], a[8:11], v[44:47]
    s_barrier
    v_mfma_f32_16x16x32_bf16 v[44:47], a[156:159], a[12:15], v[44:47]
    ds_read_b128 a[96:99], v2 offset:16384
    v_mul_f32 v40, s20, v40
    v_smfmac_f32_16x16x64_bf16 a[232:235], a[238:241], v[56:63], v26
    v_exp_f32 v40, v40
    v_mul_f32 v41, s20, v41
    v_mul_f32 v42, s20, v42
    v_mfma_f32_16x16x32_bf16 v[224:227], a[160:163], v[60:63], v[224:227]
    ds_read_b128 a[100:103], v3 offset:16384
    v_mul_f32 v43, s20, v43
    v_mfma_f32_16x16x32_bf16 v[228:231], a[168:171], v[60:63], v[228:231]
    v_exp_f32 v41, v41
    v_mfma_f32_16x16x32_bf16 v[232:235], a[176:179], v[60:63], v[232:235]
    v_exp_f32 v42, v42
    v_mfma_f32_16x16x32_bf16 v[236:239], a[184:187], v[60:63], v[236:239]
    ds_read_b128 a[104:107], v4 offset:16384
    v_mul_f32 v44, s20, v44
    v_mfma_f32_16x16x32_bf16 v[240:243], a[192:195], v[60:63], v[240:243]
    v_exp_f32 v43, v43
    v_mfma_f32_16x16x32_bf16 v[244:247], a[200:203], v[60:63], v[244:247]
    v_exp_f32 v44, v44
    v_mfma_f32_16x16x32_bf16 v[248:251], a[208:211], v[60:63], v[248:251]
    ds_read_b128 a[108:111], v5 offset:16384
    v_mul_f32 v45, s20, v45
    v_mfma_f32_16x16x32_bf16 v[252:255], a[216:219], v[60:63], v[252:255]
    v_mul_f32 v46, s20, v46
    v_mul_f32 v47, s20, v47
    v_mfma_f32_16x16x32_bf16 v[48:51], a[128:131], a[16:19], 0
    v_exp_f32 v45, v45
    v_mfma_f32_16x16x32_bf16 v[48:51], a[132:135], a[20:23], v[48:51]
    v_cvt_pk_bf16_f32 v56, v40, v41
    v_cvt_pk_bf16_f32 v57, v42, v43
    v_mfma_f32_16x16x32_bf16 v[48:51], a[136:139], a[24:27], v[48:51]
    v_exp_f32 v46, v46
    v_mfma_f32_16x16x32_bf16 v[48:51], a[140:143], a[28:31], v[48:51]
    v_exp_f32 v47, v47
    v_mfma_f32_16x16x32_bf16 v[52:55], a[144:147], a[16:19], 0
    s_add_u32 m0, s35, 8192
    v_cvt_pk_bf16_f32 v58, v44, v45
    v_cvt_pk_bf16_f32 v59, v46, v47
    v_mfma_f32_16x16x32_bf16 v[52:55], a[148:151], a[20:23], v[52:55]
    buffer_load_dwordx4 v18, s[8:11], s22 offen lds
    v_mfma_f32_16x16x32_bf16 v[52:55], a[152:155], a[24:27], v[52:55]
    ds_read_b128 a[112:115], v0 offset:16384
    v_mul_f32 v48, s20, v48
    v_mfma_f32_16x16x32_bf16 v[52:55], a[156:159], a[28:31], v[52:55]
    v_exp_f32 v48, v48

    v_mfma_f32_16x16x32_bf16 v[64:67], a[164:167], v[56:59], v[64:67]
    v_mul_f32 v49, s20, v49
    v_mul_f32 v50, s20, v50
    v_mfma_f32_16x16x32_bf16 v[68:71], a[172:175], v[56:59], v[68:71]
    ds_read_b128 a[116:119], v1 offset:16384
    v_mul_f32 v51, s20, v51
    v_mfma_f32_16x16x32_bf16 v[72:75], a[180:183], v[56:59], v[72:75]
    v_exp_f32 v49, v49
    v_mfma_f32_16x16x32_bf16 v[76:79], a[188:191], v[56:59], v[76:79]
    v_exp_f32 v50, v50
    v_mfma_f32_16x16x32_bf16 v[80:83], a[196:199], v[56:59], v[80:83]
    ds_read_b128 a[120:123], v25 offset:16384
    v_mul_f32 v52, s20, v52
    v_mfma_f32_16x16x32_bf16 v[84:87], a[204:207], v[56:59], v[84:87]
    v_exp_f32 v51, v51
    v_mfma_f32_16x16x32_bf16 v[88:91], a[212:215], v[56:59], v[88:91]
    v_exp_f32 v52, v52
    v_mfma_f32_16x16x32_bf16 v[92:95], a[220:223], v[56:59], v[92:95]
    ds_read_b128 a[124:127], v27 offset:16384
    v_mul_f32 v53, s20, v53
    v_mfma_f32_16x16x32_bf16 v[40:43], a[128:131], a[32:35], 0
    v_mul_f32 v54, s20, v54
    v_mul_f32 v55, s20, v55
    v_mfma_f32_16x16x32_bf16 v[40:43], a[132:135], a[36:39], v[40:43]
    v_exp_f32 v53, v53
    v_mfma_f32_16x16x32_bf16 v[40:43], a[136:139], a[40:43], v[40:43]
    v_cvt_pk_bf16_f32 v60, v48, v49
    v_cvt_pk_bf16_f32 v61, v50, v51
    v_mfma_f32_16x16x32_bf16 v[40:43], a[140:143], a[44:47], v[40:43]
    v_exp_f32 v54, v54
    v_mfma_f32_16x16x32_bf16 v[44:47], a[144:147], a[32:35], 0
    v_exp_f32 v55, v55
    v_mfma_f32_16x16x32_bf16 v[44:47], a[148:151], a[36:39], v[44:47]
    v_cvt_pk_bf16_f32 v62, v52, v53
    v_cvt_pk_bf16_f32 v63, v54, v55
    v_mfma_f32_16x16x32_bf16 v[44:47], a[152:155], a[40:43], v[44:47]
    buffer_load_dwordx4 v18, s[8:11], s22 offen offset:1024 lds
    v_mfma_f32_16x16x32_bf16 v[44:47], a[156:159], a[44:47], v[44:47]
    ds_read_b64_tr_b16 a[160:161], v6 offset:16384
    v_mul_f32 v40, s20, v40
    v_smfmac_f32_16x16x64_bf16 a[224:227], a[238:241], v[56:63], v26
    v_exp_f32 v40, v40
    v_mul_f32 v41, s20, v41
    v_mul_f32 v42, s20, v42
    v_mfma_f32_16x16x32_bf16 v[96:99], a[164:167], v[60:63], v[96:99]
    ds_read_b64_tr_b16 a[162:163], v36 offset:16384
    v_mul_f32 v43, s20, v43
    v_mfma_f32_16x16x32_bf16 v[100:103], a[172:175], v[60:63], v[100:103]
    v_exp_f32 v41, v41
    v_mfma_f32_16x16x32_bf16 v[104:107], a[180:183], v[60:63], v[104:107]
    v_exp_f32 v42, v42
    v_mfma_f32_16x16x32_bf16 v[108:111], a[188:191], v[60:63], v[108:111]
    ds_read_b64_tr_b16 a[168:169], v6 offset:16392
    v_mul_f32 v44, s20, v44
    v_mfma_f32_16x16x32_bf16 v[112:115], a[196:199], v[60:63], v[112:115]
    v_exp_f32 v43, v43
    v_mfma_f32_16x16x32_bf16 v[116:119], a[204:207], v[60:63], v[116:119]
    v_exp_f32 v44, v44
    v_mfma_f32_16x16x32_bf16 v[120:123], a[212:215], v[60:63], v[120:123]
    ds_read_b64_tr_b16 a[170:171], v36 offset:16392
    v_mul_f32 v45, s20, v45
    v_mfma_f32_16x16x32_bf16 v[124:127], a[220:223], v[60:63], v[124:127]
    v_mul_f32 v46, s20, v46
    v_mul_f32 v47, s20, v47
    v_mfma_f32_16x16x32_bf16 v[48:51], a[128:131], a[48:51], 0
    v_exp_f32 v45, v45
    v_mfma_f32_16x16x32_bf16 v[48:51], a[132:135], a[52:55], v[48:51]
    v_cvt_pk_bf16_f32 v56, v40, v41
    v_cvt_pk_bf16_f32 v57, v42, v43
    v_mfma_f32_16x16x32_bf16 v[48:51], a[136:139], a[56:59], v[48:51]
    v_exp_f32 v46, v46
    v_mfma_f32_16x16x32_bf16 v[48:51], a[140:143], a[60:63], v[48:51]
    v_exp_f32 v47, v47
    v_mfma_f32_16x16x32_bf16 v[52:55], a[144:147], a[48:51], 0
    s_add_u32 m0, s35, 40960
    v_cvt_pk_bf16_f32 v58, v44, v45
    v_cvt_pk_bf16_f32 v59, v46, v47
    v_mfma_f32_16x16x32_bf16 v[52:55], a[148:151], a[52:55], v[52:55]
    buffer_load_dwordx4 v19, s[12:15], s22 offen lds
    v_mfma_f32_16x16x32_bf16 v[52:55], a[152:155], a[56:59], v[52:55]
    ds_read_b64_tr_b16 a[176:177], v7 offset:16384
    v_mul_f32 v48, s20, v48
    v_mfma_f32_16x16x32_bf16 v[52:55], a[156:159], a[60:63], v[52:55]
    v_exp_f32 v48, v48

    v_mfma_f32_16x16x32_bf16 v[128:131], a[164:167], v[56:59], v[128:131]
    v_mul_f32 v49, s20, v49
    v_mul_f32 v50, s20, v50
    v_mfma_f32_16x16x32_bf16 v[132:135], a[172:175], v[56:59], v[132:135]
    ds_read_b64_tr_b16 a[178:179], v37 offset:16384
    v_mul_f32 v51, s20, v51
    v_mfma_f32_16x16x32_bf16 v[136:139], a[180:183], v[56:59], v[136:139]
    v_exp_f32 v49, v49
    v_mfma_f32_16x16x32_bf16 v[140:143], a[188:191], v[56:59], v[140:143]
    v_exp_f32 v50, v50
    v_mfma_f32_16x16x32_bf16 v[144:147], a[196:199], v[56:59], v[144:147]
    ds_read_b64_tr_b16 a[184:185], v7 offset:16392
    v_mul_f32 v52, s20, v52
    v_mfma_f32_16x16x32_bf16 v[148:151], a[204:207], v[56:59], v[148:151]
    v_exp_f32 v51, v51
    v_mfma_f32_16x16x32_bf16 v[152:155], a[212:215], v[56:59], v[152:155]
    v_exp_f32 v52, v52
    v_mfma_f32_16x16x32_bf16 v[156:159], a[220:223], v[56:59], v[156:159]
    ds_read_b64_tr_b16 a[186:187], v37 offset:16392
    v_mul_f32 v53, s20, v53
    v_mfma_f32_16x16x32_bf16 v[40:43], a[128:131], a[64:67], 0
    v_mul_f32 v54, s20, v54
    v_mul_f32 v55, s20, v55
    v_mfma_f32_16x16x32_bf16 v[40:43], a[132:135], a[68:71], v[40:43]
    v_exp_f32 v53, v53
    v_mfma_f32_16x16x32_bf16 v[40:43], a[136:139], a[72:75], v[40:43]
    v_cvt_pk_bf16_f32 v60, v48, v49
    v_cvt_pk_bf16_f32 v61, v50, v51
    v_mfma_f32_16x16x32_bf16 v[40:43], a[140:143], a[76:79], v[40:43]
    v_exp_f32 v54, v54
    v_mfma_f32_16x16x32_bf16 v[44:47], a[144:147], a[64:67], 0
    v_exp_f32 v55, v55
    v_mfma_f32_16x16x32_bf16 v[44:47], a[148:151], a[68:71], v[44:47]
    s_add_u32 s28, s24, s48
    v_cvt_pk_bf16_f32 v62, v52, v53
    v_cvt_pk_bf16_f32 v63, v54, v55
    v_mfma_f32_16x16x32_bf16 v[44:47], a[152:155], a[72:75], v[44:47]
    buffer_load_dwordx4 v19, s[12:15], s22 offen offset:1024 lds
    v_mfma_f32_16x16x32_bf16 v[44:47], a[156:159], a[76:79], v[44:47]
    s_add_u32 m0, s30, 20480
    ds_read_b64_tr_b16 a[192:193], v8 offset:16384
    v_mul_f32 v40, s20, v40
    v_smfmac_f32_16x16x64_bf16 a[228:231], a[238:241], v[56:63], v26
    buffer_load_dwordx4 v14, s[4:7], s28 offen nt lds
    v_exp_f32 v40, v40
    v_mul_f32 v41, s20, v41
    v_mul_f32 v42, s20, v42
    v_mfma_f32_16x16x32_bf16 v[160:163], a[164:167], v[60:63], v[160:163]
    s_xor_b32 s22, s22, 24576
    ds_read_b64_tr_b16 a[194:195], v38 offset:16384
    v_mul_f32 v43, s20, v43
    v_mfma_f32_16x16x32_bf16 v[164:167], a[172:175], v[60:63], v[164:167]
    v_exp_f32 v41, v41
    v_mfma_f32_16x16x32_bf16 v[168:171], a[180:183], v[60:63], v[168:171]
    v_exp_f32 v42, v42
    v_mfma_f32_16x16x32_bf16 v[172:175], a[188:191], v[60:63], v[172:175]
    ds_read_b64_tr_b16 a[200:201], v8 offset:16392
    v_mul_f32 v44, s20, v44
    v_mfma_f32_16x16x32_bf16 v[176:179], a[196:199], v[60:63], v[176:179]
    v_exp_f32 v43, v43
    v_mfma_f32_16x16x32_bf16 v[180:183], a[204:207], v[60:63], v[180:183]
    v_exp_f32 v44, v44
    v_mfma_f32_16x16x32_bf16 v[184:187], a[212:215], v[60:63], v[184:187]
    ds_read_b64_tr_b16 a[202:203], v38 offset:16392
    v_mul_f32 v45, s20, v45
    v_mfma_f32_16x16x32_bf16 v[188:191], a[220:223], v[60:63], v[188:191]
    v_mul_f32 v46, s20, v46
    v_mul_f32 v47, s20, v47
    v_mfma_f32_16x16x32_bf16 v[48:51], a[128:131], a[80:83], 0
    v_exp_f32 v45, v45
    v_mfma_f32_16x16x32_bf16 v[48:51], a[132:135], a[84:87], v[48:51]
    buffer_load_dwordx4 v15, s[4:7], s28 offen offset:1024 nt lds
    v_cvt_pk_bf16_f32 v56, v40, v41
    v_cvt_pk_bf16_f32 v57, v42, v43
    v_mfma_f32_16x16x32_bf16 v[48:51], a[136:139], a[88:91], v[48:51]
    v_exp_f32 v46, v46
    v_mfma_f32_16x16x32_bf16 v[48:51], a[140:143], a[92:95], v[48:51]
    v_exp_f32 v47, v47
    v_mfma_f32_16x16x32_bf16 v[52:55], a[144:147], a[80:83], 0
    v_cvt_pk_bf16_f32 v58, v44, v45
    v_cvt_pk_bf16_f32 v59, v46, v47
    v_mfma_f32_16x16x32_bf16 v[52:55], a[148:151], a[84:87], v[52:55]
    s_nop 0
    v_mfma_f32_16x16x32_bf16 v[52:55], a[152:155], a[88:91], v[52:55]
    ds_read_b64_tr_b16 a[208:209], v9 offset:16384
    v_mul_f32 v48, s20, v48
    v_mfma_f32_16x16x32_bf16 v[52:55], a[156:159], a[92:95], v[52:55]
    v_exp_f32 v48, v48

    v_mfma_f32_16x16x32_bf16 v[192:195], a[164:167], v[56:59], v[192:195]
    v_mul_f32 v49, s20, v49
    v_mul_f32 v50, s20, v50
    v_mfma_f32_16x16x32_bf16 v[196:199], a[172:175], v[56:59], v[196:199]
    ds_read_b64_tr_b16 a[210:211], v39 offset:16384
    v_mul_f32 v51, s20, v51
    v_mfma_f32_16x16x32_bf16 v[200:203], a[180:183], v[56:59], v[200:203]
    v_exp_f32 v49, v49
    v_mfma_f32_16x16x32_bf16 v[204:207], a[188:191], v[56:59], v[204:207]
    v_exp_f32 v50, v50
    v_mfma_f32_16x16x32_bf16 v[208:211], a[196:199], v[56:59], v[208:211]
    ds_read_b64_tr_b16 a[216:217], v9 offset:16392
    v_mul_f32 v52, s20, v52
    v_mfma_f32_16x16x32_bf16 v[212:215], a[204:207], v[56:59], v[212:215]
    v_exp_f32 v51, v51
    v_mfma_f32_16x16x32_bf16 v[216:219], a[212:215], v[56:59], v[216:219]
    v_exp_f32 v52, v52
    v_mfma_f32_16x16x32_bf16 v[220:223], a[220:223], v[56:59], v[220:223]
    s_waitcnt lgkmcnt(15)
    ds_read_b64_tr_b16 a[218:219], v39 offset:16392
    v_mul_f32 v53, s20, v53
L_A14:
    v_mfma_f32_16x16x32_bf16 v[40:43], a[96:99], a[0:3], 0
    s_mov_b32 s31, s26
    v_mul_f32 v54, s20, v54
    v_mul_f32 v55, s20, v55
    v_mfma_f32_16x16x32_bf16 v[40:43], a[100:103], a[4:7], v[40:43]
    s_mov_b32 s45, s27
    v_exp_f32 v53, v53
    v_mfma_f32_16x16x32_bf16 v[40:43], a[104:107], a[8:11], v[40:43]
    s_mov_b32 s26, s24
    v_cvt_pk_bf16_f32 v60, v48, v49
    v_cvt_pk_bf16_f32 v61, v50, v51
    v_mfma_f32_16x16x32_bf16 v[40:43], a[108:111], a[12:15], v[40:43]
    s_mov_b32 s27, s25
    v_exp_f32 v54, v54
    v_mfma_f32_16x16x32_bf16 v[44:47], a[112:115], a[0:3], 0
    s_add_u32 s33, s33, 1
    v_exp_f32 v55, v55
    v_mfma_f32_16x16x32_bf16 v[44:47], a[116:119], a[4:7], v[44:47]
    s_waitcnt vmcnt(18) lgkmcnt(0)
    v_cvt_pk_bf16_f32 v62, v52, v53
    v_cvt_pk_bf16_f32 v63, v54, v55
    v_mfma_f32_16x16x32_bf16 v[44:47], a[120:123], a[8:11], v[44:47]
    s_barrier
    v_mfma_f32_16x16x32_bf16 v[44:47], a[124:127], a[12:15], v[44:47]
    s_lshl_b32 s41, s33, 5
    ds_read_b128 a[128:131], v2 offset:24576
    v_mul_f32 v40, s20, v40
    v_smfmac_f32_16x16x64_bf16 a[232:235], a[238:241], v[56:63], v26
    s_add_u32 s41, s41, s37
    v_exp_f32 v40, v40
    v_mul_f32 v41, s20, v41
    v_mul_f32 v42, s20, v42
    v_mfma_f32_16x16x32_bf16 v[224:227], a[164:167], v[60:63], v[224:227]
    s_lshr_b32 s42, s41, 1
    ds_read_b128 a[132:135], v3 offset:24576
    v_mul_f32 v43, s20, v43
    v_mfma_f32_16x16x32_bf16 v[228:231], a[172:175], v[60:63], v[228:231]
    s_xor_b32 s43, s33, s37
    v_exp_f32 v41, v41
    v_mfma_f32_16x16x32_bf16 v[232:235], a[180:183], v[60:63], v[232:235]
    s_and_b32 s43, s43, 1
    v_exp_f32 v42, v42
    v_mfma_f32_16x16x32_bf16 v[236:239], a[188:191], v[60:63], v[236:239]
    s_mul_i32 s44, s43, s58
    ds_read_b128 a[136:139], v4 offset:24576
    v_mul_f32 v44, s20, v44
    v_mfma_f32_16x16x32_bf16 v[240:243], a[196:199], v[60:63], v[240:243]
    s_mul_i32 s43, s43, 22
    v_exp_f32 v43, v43
    v_mfma_f32_16x16x32_bf16 v[244:247], a[204:207], v[60:63], v[244:247]
    s_add_u32 s43, s43, 24
    v_exp_f32 v44, v44
    v_mfma_f32_16x16x32_bf16 v[248:251], a[212:215], v[60:63], v[248:251]
    s_lshl_b32 s42, s42, 3
    ds_read_b128 a[140:143], v5 offset:24576
    v_mul_f32 v45, s20, v45
    v_mfma_f32_16x16x32_bf16 v[252:255], a[220:223], v[60:63], v[252:255]
    s_add_u32 s42, s42, s38
    v_mul_f32 v46, s20, v46
    v_mul_f32 v47, s20, v47
    v_mfma_f32_16x16x32_bf16 v[48:51], a[96:99], a[16:19], 0
    s_lshl_b32 s23, s42, 17
    v_exp_f32 v45, v45
    v_mfma_f32_16x16x32_bf16 v[48:51], a[100:103], a[20:23], v[48:51]
    s_mul_i32 s42, s42, 46
    v_cvt_pk_bf16_f32 v56, v40, v41
    v_cvt_pk_bf16_f32 v57, v42, v43
    v_mfma_f32_16x16x32_bf16 v[48:51], a[104:107], a[24:27], v[48:51]
    s_add_u32 s44, s44, s36
    v_exp_f32 v46, v46
    v_mfma_f32_16x16x32_bf16 v[48:51], a[108:111], a[28:31], v[48:51]
    s_add_u32 s44, s44, s42
    v_exp_f32 v47, v47
    v_mfma_f32_16x16x32_bf16 v[52:55], a[112:115], a[16:19], 0
    s_add_u32 m0, s35, 16384
    v_cvt_pk_bf16_f32 v58, v44, v45
    v_cvt_pk_bf16_f32 v59, v46, v47
    v_mfma_f32_16x16x32_bf16 v[52:55], a[116:119], a[20:23], v[52:55]
    buffer_load_dwordx4 v18, s[8:11], s22 offen lds
    v_mfma_f32_16x16x32_bf16 v[52:55], a[120:123], a[24:27], v[52:55]
    s_lshl_b32 s24, s44, 12
    ds_read_b128 a[144:147], v0 offset:24576
    v_mul_f32 v48, s20, v48
    v_mfma_f32_16x16x32_bf16 v[52:55], a[124:127], a[28:31], v[52:55]
    s_add_u32 s43, s43, s42
    v_exp_f32 v48, v48

    s_lshl_b32 s43, s43, 12
    v_mfma_f32_16x16x32_bf16 v[64:67], a[160:163], v[56:59], v[64:67]
    s_min_u32 s25, s43, 96468992
    v_mul_f32 v49, s20, v49
    v_mul_f32 v50, s20, v50
    v_mfma_f32_16x16x32_bf16 v[68:71], a[168:171], v[56:59], v[68:71]
    ds_read_b128 a[148:151], v1 offset:24576
    v_mul_f32 v51, s20, v51
    v_mfma_f32_16x16x32_bf16 v[72:75], a[176:179], v[56:59], v[72:75]
    v_exp_f32 v49, v49
    v_mfma_f32_16x16x32_bf16 v[76:79], a[184:187], v[56:59], v[76:79]
    v_exp_f32 v50, v50
    v_mfma_f32_16x16x32_bf16 v[80:83], a[192:195], v[56:59], v[80:83]
    ds_read_b128 a[152:155], v25 offset:24576
    v_mul_f32 v52, s20, v52
    v_mfma_f32_16x16x32_bf16 v[84:87], a[200:203], v[56:59], v[84:87]
    v_exp_f32 v51, v51
    v_mfma_f32_16x16x32_bf16 v[88:91], a[208:211], v[56:59], v[88:91]
    v_exp_f32 v52, v52
    v_mfma_f32_16x16x32_bf16 v[92:95], a[216:219], v[56:59], v[92:95]
    ds_read_b128 a[156:159], v27 offset:24576
    v_mul_f32 v53, s20, v53
    v_mfma_f32_16x16x32_bf16 v[40:43], a[96:99], a[32:35], 0
    v_mul_f32 v54, s20, v54
    v_mul_f32 v55, s20, v55
    v_mfma_f32_16x16x32_bf16 v[40:43], a[100:103], a[36:39], v[40:43]
    v_exp_f32 v53, v53
    v_mfma_f32_16x16x32_bf16 v[40:43], a[104:107], a[40:43], v[40:43]
    v_cvt_pk_bf16_f32 v60, v48, v49
    v_cvt_pk_bf16_f32 v61, v50, v51
    v_mfma_f32_16x16x32_bf16 v[40:43], a[108:111], a[44:47], v[40:43]
    v_exp_f32 v54, v54
    v_mfma_f32_16x16x32_bf16 v[44:47], a[112:115], a[32:35], 0
    v_exp_f32 v55, v55
    v_mfma_f32_16x16x32_bf16 v[44:47], a[116:119], a[36:39], v[44:47]
    v_cvt_pk_bf16_f32 v62, v52, v53
    v_cvt_pk_bf16_f32 v63, v54, v55
    v_mfma_f32_16x16x32_bf16 v[44:47], a[120:123], a[40:43], v[44:47]
    buffer_load_dwordx4 v18, s[8:11], s22 offen offset:1024 lds
    v_mfma_f32_16x16x32_bf16 v[44:47], a[124:127], a[44:47], v[44:47]
    ds_read_b64_tr_b16 a[164:165], v6 offset:24576
    v_mul_f32 v40, s20, v40
    v_smfmac_f32_16x16x64_bf16 a[224:227], a[238:241], v[56:63], v26
    v_exp_f32 v40, v40
    v_mul_f32 v41, s20, v41
    v_mul_f32 v42, s20, v42
    v_mfma_f32_16x16x32_bf16 v[96:99], a[160:163], v[60:63], v[96:99]
    ds_read_b64_tr_b16 a[166:167], v36 offset:24576
    v_mul_f32 v43, s20, v43
    v_mfma_f32_16x16x32_bf16 v[100:103], a[168:171], v[60:63], v[100:103]
    v_exp_f32 v41, v41
    v_mfma_f32_16x16x32_bf16 v[104:107], a[176:179], v[60:63], v[104:107]
    v_exp_f32 v42, v42
    v_mfma_f32_16x16x32_bf16 v[108:111], a[184:187], v[60:63], v[108:111]
    ds_read_b64_tr_b16 a[172:173], v6 offset:24584
    v_mul_f32 v44, s20, v44
    v_mfma_f32_16x16x32_bf16 v[112:115], a[192:195], v[60:63], v[112:115]
    v_exp_f32 v43, v43
    v_mfma_f32_16x16x32_bf16 v[116:119], a[200:203], v[60:63], v[116:119]
    v_exp_f32 v44, v44
    v_mfma_f32_16x16x32_bf16 v[120:123], a[208:211], v[60:63], v[120:123]
    ds_read_b64_tr_b16 a[174:175], v36 offset:24584
    v_mul_f32 v45, s20, v45
    v_mfma_f32_16x16x32_bf16 v[124:127], a[216:219], v[60:63], v[124:127]
    v_mul_f32 v46, s20, v46
    v_mul_f32 v47, s20, v47
    v_mfma_f32_16x16x32_bf16 v[48:51], a[96:99], a[48:51], 0
    v_exp_f32 v45, v45
    v_mfma_f32_16x16x32_bf16 v[48:51], a[100:103], a[52:55], v[48:51]
    v_cvt_pk_bf16_f32 v56, v40, v41
    v_cvt_pk_bf16_f32 v57, v42, v43
    v_mfma_f32_16x16x32_bf16 v[48:51], a[104:107], a[56:59], v[48:51]
    v_exp_f32 v46, v46
    v_mfma_f32_16x16x32_bf16 v[48:51], a[108:111], a[60:63], v[48:51]
    v_exp_f32 v47, v47
    v_mfma_f32_16x16x32_bf16 v[52:55], a[112:115], a[48:51], 0
    s_add_u32 m0, s35, 49152
    v_cvt_pk_bf16_f32 v58, v44, v45
    v_cvt_pk_bf16_f32 v59, v46, v47
    v_mfma_f32_16x16x32_bf16 v[52:55], a[116:119], a[52:55], v[52:55]
    buffer_load_dwordx4 v19, s[12:15], s22 offen lds
    v_mfma_f32_16x16x32_bf16 v[52:55], a[120:123], a[56:59], v[52:55]
    ds_read_b64_tr_b16 a[180:181], v7 offset:24576
    v_mul_f32 v48, s20, v48
    v_mfma_f32_16x16x32_bf16 v[52:55], a[124:127], a[60:63], v[52:55]
    v_exp_f32 v48, v48

    v_mfma_f32_16x16x32_bf16 v[128:131], a[160:163], v[56:59], v[128:131]
    v_mul_f32 v49, s20, v49
    v_mul_f32 v50, s20, v50
    v_mfma_f32_16x16x32_bf16 v[132:135], a[168:171], v[56:59], v[132:135]
    ds_read_b64_tr_b16 a[182:183], v37 offset:24576
    v_mul_f32 v51, s20, v51
    v_mfma_f32_16x16x32_bf16 v[136:139], a[176:179], v[56:59], v[136:139]
    v_exp_f32 v49, v49
    v_mfma_f32_16x16x32_bf16 v[140:143], a[184:187], v[56:59], v[140:143]
    v_exp_f32 v50, v50
    v_mfma_f32_16x16x32_bf16 v[144:147], a[192:195], v[56:59], v[144:147]
    ds_read_b64_tr_b16 a[188:189], v7 offset:24584
    v_mul_f32 v52, s20, v52
    v_mfma_f32_16x16x32_bf16 v[148:151], a[200:203], v[56:59], v[148:151]
    v_exp_f32 v51, v51
    v_mfma_f32_16x16x32_bf16 v[152:155], a[208:211], v[56:59], v[152:155]
    v_exp_f32 v52, v52
    v_mfma_f32_16x16x32_bf16 v[156:159], a[216:219], v[56:59], v[156:159]
    ds_read_b64_tr_b16 a[190:191], v37 offset:24584
    v_mul_f32 v53, s20, v53
    v_mfma_f32_16x16x32_bf16 v[40:43], a[96:99], a[64:67], 0
    v_mul_f32 v54, s20, v54
    v_mul_f32 v55, s20, v55
    v_mfma_f32_16x16x32_bf16 v[40:43], a[100:103], a[68:71], v[40:43]
    v_exp_f32 v53, v53
    v_mfma_f32_16x16x32_bf16 v[40:43], a[104:107], a[72:75], v[40:43]
    v_cvt_pk_bf16_f32 v60, v48, v49
    v_cvt_pk_bf16_f32 v61, v50, v51
    v_mfma_f32_16x16x32_bf16 v[40:43], a[108:111], a[76:79], v[40:43]
    v_exp_f32 v54, v54
    v_mfma_f32_16x16x32_bf16 v[44:47], a[112:115], a[64:67], 0
    v_exp_f32 v55, v55
    v_mfma_f32_16x16x32_bf16 v[44:47], a[116:119], a[68:71], v[44:47]
    v_cvt_pk_bf16_f32 v62, v52, v53
    v_cvt_pk_bf16_f32 v63, v54, v55
    v_mfma_f32_16x16x32_bf16 v[44:47], a[120:123], a[72:75], v[44:47]
    buffer_load_dwordx4 v19, s[12:15], s22 offen offset:1024 lds
    v_mfma_f32_16x16x32_bf16 v[44:47], a[124:127], a[76:79], v[44:47]
    s_add_u32 m0, s30, 20480
    ds_read_b64_tr_b16 a[196:197], v8 offset:24576
    v_mul_f32 v40, s20, v40
    v_smfmac_f32_16x16x64_bf16 a[228:231], a[238:241], v[56:63], v26
    buffer_load_dwordx4 v16, s[4:7], s28 offen offset:2048 nt lds
    v_exp_f32 v40, v40
    v_mul_f32 v41, s20, v41
    v_mul_f32 v42, s20, v42
    v_mfma_f32_16x16x32_bf16 v[160:163], a[160:163], v[60:63], v[160:163]
    s_xor_b32 s22, s22, 8192
    ds_read_b64_tr_b16 a[198:199], v38 offset:24576
    v_mul_f32 v43, s20, v43
    v_mfma_f32_16x16x32_bf16 v[164:167], a[168:171], v[60:63], v[164:167]
    v_exp_f32 v41, v41
    v_mfma_f32_16x16x32_bf16 v[168:171], a[176:179], v[60:63], v[168:171]
    v_exp_f32 v42, v42
    v_mfma_f32_16x16x32_bf16 v[172:175], a[184:187], v[60:63], v[172:175]
    ds_read_b64_tr_b16 a[204:205], v8 offset:24584
    v_mul_f32 v44, s20, v44
    v_mfma_f32_16x16x32_bf16 v[176:179], a[192:195], v[60:63], v[176:179]
    v_exp_f32 v43, v43
    v_mfma_f32_16x16x32_bf16 v[180:183], a[200:203], v[60:63], v[180:183]
    v_exp_f32 v44, v44
    v_mfma_f32_16x16x32_bf16 v[184:187], a[208:211], v[60:63], v[184:187]
    ds_read_b64_tr_b16 a[206:207], v38 offset:24584
    v_mul_f32 v45, s20, v45
    v_mfma_f32_16x16x32_bf16 v[188:191], a[216:219], v[60:63], v[188:191]
    v_mul_f32 v46, s20, v46
    v_mul_f32 v47, s20, v47
    v_mfma_f32_16x16x32_bf16 v[48:51], a[96:99], a[80:83], 0
    v_exp_f32 v45, v45
    v_mfma_f32_16x16x32_bf16 v[48:51], a[100:103], a[84:87], v[48:51]
    buffer_load_dwordx4 v17, s[4:7], s28 offen offset:3072 nt lds
    v_cvt_pk_bf16_f32 v56, v40, v41
    v_cvt_pk_bf16_f32 v57, v42, v43
    v_mfma_f32_16x16x32_bf16 v[48:51], a[104:107], a[88:91], v[48:51]
    v_exp_f32 v46, v46
    v_mfma_f32_16x16x32_bf16 v[48:51], a[108:111], a[92:95], v[48:51]
    s_mov_b32 s18, s45
    v_exp_f32 v47, v47
    v_mfma_f32_16x16x32_bf16 v[52:55], a[112:115], a[80:83], 0
    v_cvt_pk_bf16_f32 v58, v44, v45
    v_cvt_pk_bf16_f32 v59, v46, v47
    v_mfma_f32_16x16x32_bf16 v[52:55], a[116:119], a[84:87], v[52:55]
    s_mov_b32 s6, s25
    v_mfma_f32_16x16x32_bf16 v[52:55], a[120:123], a[88:91], v[52:55]
    ds_read_b64_tr_b16 a[212:213], v9 offset:24576
    v_mul_f32 v48, s20, v48
    v_mfma_f32_16x16x32_bf16 v[52:55], a[124:127], a[92:95], v[52:55]
    v_exp_f32 v48, v48

    v_mfma_f32_16x16x32_bf16 v[192:195], a[160:163], v[56:59], v[192:195]
    v_mul_f32 v49, s20, v49
    v_mul_f32 v50, s20, v50
    v_mfma_f32_16x16x32_bf16 v[196:199], a[168:171], v[56:59], v[196:199]
    ds_read_b64_tr_b16 a[214:215], v39 offset:24576
    v_mul_f32 v51, s20, v51
    v_mfma_f32_16x16x32_bf16 v[200:203], a[176:179], v[56:59], v[200:203]
    v_exp_f32 v49, v49
    v_mfma_f32_16x16x32_bf16 v[204:207], a[184:187], v[56:59], v[204:207]
    v_exp_f32 v50, v50
    v_mfma_f32_16x16x32_bf16 v[208:211], a[192:195], v[56:59], v[208:211]
    ds_read_b64_tr_b16 a[220:221], v9 offset:24584
    v_mul_f32 v52, s20, v52
    v_mfma_f32_16x16x32_bf16 v[212:215], a[200:203], v[56:59], v[212:215]
    v_exp_f32 v51, v51
    v_mfma_f32_16x16x32_bf16 v[216:219], a[208:211], v[56:59], v[216:219]
    v_exp_f32 v52, v52
    v_mfma_f32_16x16x32_bf16 v[220:223], a[216:219], v[56:59], v[220:223]
    s_waitcnt lgkmcnt(15)
    ds_read_b64_tr_b16 a[222:223], v39 offset:24584
    v_mul_f32 v53, s20, v53
    s_cmp_gt_u32 s33, 4
    s_cbranch_scc1 L_finA
L_A15:
    v_mfma_f32_16x16x32_bf16 v[40:43], a[128:131], a[0:3], 0
    v_mul_f32 v54, s20, v54
    v_mul_f32 v55, s20, v55
    v_mfma_f32_16x16x32_bf16 v[40:43], a[132:135], a[4:7], v[40:43]
    v_exp_f32 v53, v53
    v_mfma_f32_16x16x32_bf16 v[40:43], a[136:139], a[8:11], v[40:43]
    v_cvt_pk_bf16_f32 v60, v48, v49
    v_cvt_pk_bf16_f32 v61, v50, v51
    v_mfma_f32_16x16x32_bf16 v[40:43], a[140:143], a[12:15], v[40:43]
    v_exp_f32 v54, v54
    v_mfma_f32_16x16x32_bf16 v[44:47], a[144:147], a[0:3], 0
    v_exp_f32 v55, v55
    v_mfma_f32_16x16x32_bf16 v[44:47], a[148:151], a[4:7], v[44:47]
    s_waitcnt vmcnt(16) lgkmcnt(0)
    v_cvt_pk_bf16_f32 v62, v52, v53
    v_cvt_pk_bf16_f32 v63, v54, v55
    v_mfma_f32_16x16x32_bf16 v[44:47], a[152:155], a[8:11], v[44:47]
    s_barrier
    v_mfma_f32_16x16x32_bf16 v[44:47], a[156:159], a[12:15], v[44:47]
    ds_read_b128 a[96:99], v2 offset:0
    v_mul_f32 v40, s20, v40
    v_smfmac_f32_16x16x64_bf16 a[232:235], a[238:241], v[56:63], v26
    v_exp_f32 v40, v40
    v_mfma_f32_16x16x32_bf16 v[224:227], a[160:163], v[60:63], v[224:227]
    v_mul_f32 v41, s20, v41
    v_mul_f32 v42, s20, v42
    v_mfma_f32_16x16x32_bf16 v[228:231], a[168:171], v[60:63], v[228:231]
    ds_read_b128 a[100:103], v3 offset:0
    ds_read_b128 a[0:3], v10 offset:0
    v_mul_f32 v43, s20, v43
    v_mfma_f32_16x16x32_bf16 v[232:235], a[176:179], v[60:63], v[232:235]
    ds_read_b128 a[4:7], v11 offset:0
    v_exp_f32 v41, v41
    v_mfma_f32_16x16x32_bf16 v[236:239], a[184:187], v[60:63], v[236:239]
    ds_read_b128 a[8:11], v12 offset:0
    v_exp_f32 v42, v42
    v_mfma_f32_16x16x32_bf16 v[240:243], a[192:195], v[60:63], v[240:243]
    ds_read_b128 a[104:107], v4 offset:0
    ds_read_b128 a[12:15], v13 offset:0
    v_mul_f32 v44, s20, v44
    v_mfma_f32_16x16x32_bf16 v[244:247], a[200:203], v[60:63], v[244:247]
    v_exp_f32 v43, v43
    v_mfma_f32_16x16x32_bf16 v[248:251], a[208:211], v[60:63], v[248:251]
    v_exp_f32 v44, v44
    v_mfma_f32_16x16x32_bf16 v[252:255], a[216:219], v[60:63], v[252:255]
    ds_read_b128 a[108:111], v5 offset:0
    v_mul_f32 v45, s20, v45
    v_mfma_f32_16x16x32_bf16 v[48:51], a[128:131], a[16:19], 0
    v_mul_f32 v46, s20, v46
    v_mul_f32 v47, s20, v47
    v_mfma_f32_16x16x32_bf16 v[48:51], a[132:135], a[20:23], v[48:51]
    v_exp_f32 v45, v45
    v_mfma_f32_16x16x32_bf16 v[48:51], a[136:139], a[24:27], v[48:51]
    v_cvt_pk_bf16_f32 v56, v40, v41
    v_cvt_pk_bf16_f32 v57, v42, v43
    v_mfma_f32_16x16x32_bf16 v[48:51], a[140:143], a[28:31], v[48:51]
    v_exp_f32 v46, v46
    v_mfma_f32_16x16x32_bf16 v[52:55], a[144:147], a[16:19], 0
    v_exp_f32 v47, v47
    v_mfma_f32_16x16x32_bf16 v[52:55], a[148:151], a[20:23], v[52:55]
    s_add_u32 m0, s35, 24576
    v_cvt_pk_bf16_f32 v58, v44, v45
    v_cvt_pk_bf16_f32 v59, v46, v47
    v_mfma_f32_16x16x32_bf16 v[52:55], a[152:155], a[24:27], v[52:55]
    buffer_load_dwordx4 v18, s[8:11], s22 offen lds
    v_mfma_f32_16x16x32_bf16 v[52:55], a[156:159], a[28:31], v[52:55]
    ds_read_b128 a[112:115], v0 offset:0
    v_mul_f32 v48, s20, v48
    v_mfma_f32_16x16x32_bf16 a[224:227], a[248:251], v[56:59], a[224:227]
    v_exp_f32 v48, v48
    v_mfma_f32_16x16x32_bf16 v[64:67], a[164:167], v[56:59], v[64:67]
    v_mul_f32 v49, s20, v49
    v_mul_f32 v50, s20, v50
    v_mfma_f32_16x16x32_bf16 v[68:71], a[172:175], v[56:59], v[68:71]
    ds_read_b128 a[116:119], v1 offset:0
    ds_read_b128 a[16:19], v10 offset:4096
    v_mul_f32 v51, s20, v51
    v_mfma_f32_16x16x32_bf16 v[72:75], a[180:183], v[56:59], v[72:75]
    ds_read_b128 a[20:23], v11 offset:4096
    v_exp_f32 v49, v49
    v_accvgpr_read_b32 v23, a224
    v_accvgpr_read_b32 v22, a225
    v_add_f32 v23, v23, v22
    v_mfma_f32_16x16x32_bf16 v[76:79], a[188:191], v[56:59], v[76:79]
    ds_read_b128 a[24:27], v12 offset:4096
    v_exp_f32 v50, v50
    v_mfma_f32_16x16x32_bf16 v[80:83], a[196:199], v[56:59], v[80:83]
    ds_read_b128 a[120:123], v25 offset:0
    ds_read_b128 a[28:31], v13 offset:4096
    v_mul_f32 v52, s20, v52
    v_rcp_f32 v22, v23
    v_mfma_f32_16x16x32_bf16 v[84:87], a[204:207], v[56:59], v[84:87]
    v_exp_f32 v51, v51
    v_mfma_f32_16x16x32_bf16 v[88:91], a[212:215], v[56:59], v[88:91]
    v_exp_f32 v52, v52
    v_pk_mul_f32 v[64:65], v[64:65], v[22:23] op_sel_hi:[1,0]
    v_pk_mul_f32 v[66:67], v[66:67], v[22:23] op_sel_hi:[1,0]
    v_pk_mul_f32 v[68:69], v[68:69], v[22:23] op_sel_hi:[1,0]
    v_pk_mul_f32 v[70:71], v[70:71], v[22:23] op_sel_hi:[1,0]
    v_max3_u32 v21, v21, v22, v23
    v_cvt_pk_bf16_f32 v64, v64, v65
    v_cvt_pk_bf16_f32 v65, v66, v67
    v_cvt_pk_bf16_f32 v66, v68, v69
    v_cvt_pk_bf16_f32 v67, v70, v71
    v_mfma_f32_16x16x32_bf16 v[92:95], a[220:223], v[56:59], v[92:95]
    ds_read_b128 a[124:127], v27 offset:0
    v_mul_f32 v53, s20, v53
    v_mfma_f32_16x16x32_bf16 v[40:43], a[128:131], a[32:35], 0
    v_mul_f32 v54, s20, v54
    v_mul_f32 v55, s20, v55
    v_mfma_f32_16x16x32_bf16 v[40:43], a[132:135], a[36:39], v[40:43]
    ds_write_b128 v10, v[64:67] offset:0
    v_exp_f32 v53, v53
    v_pk_mul_f32 v[72:73], v[72:73], v[22:23] op_sel_hi:[1,0]
    v_pk_mul_f32 v[74:75], v[74:75], v[22:23] op_sel_hi:[1,0]
    v_pk_mul_f32 v[76:77], v[76:77], v[22:23] op_sel_hi:[1,0]
    v_pk_mul_f32 v[78:79], v[78:79], v[22:23] op_sel_hi:[1,0]
    v_cvt_pk_bf16_f32 v72, v72, v73
    v_cvt_pk_bf16_f32 v73, v74, v75
    v_cvt_pk_bf16_f32 v74, v76, v77
    v_cvt_pk_bf16_f32 v75, v78, v79
    v_mfma_f32_16x16x32_bf16 v[40:43], a[136:139], a[40:43], v[40:43]
    v_cvt_pk_bf16_f32 v60, v48, v49
    v_cvt_pk_bf16_f32 v61, v50, v51
    v_mfma_f32_16x16x32_bf16 v[40:43], a[140:143], a[44:47], v[40:43]
    v_exp_f32 v54, v54
    v_mfma_f32_16x16x32_bf16 v[44:47], a[144:147], a[32:35], 0
    ds_write_b128 v11, v[72:75] offset:0
    v_exp_f32 v55, v55
    v_pk_mul_f32 v[80:81], v[80:81], v[22:23] op_sel_hi:[1,0]
    v_pk_mul_f32 v[82:83], v[82:83], v[22:23] op_sel_hi:[1,0]
    v_pk_mul_f32 v[84:85], v[84:85], v[22:23] op_sel_hi:[1,0]
    v_pk_mul_f32 v[86:87], v[86:87], v[22:23] op_sel_hi:[1,0]
    v_cvt_pk_bf16_f32 v80, v80, v81
    v_cvt_pk_bf16_f32 v81, v82, v83
    v_cvt_pk_bf16_f32 v82, v84, v85
    v_cvt_pk_bf16_f32 v83, v86, v87
    v_mfma_f32_16x16x32_bf16 v[44:47], a[148:151], a[36:39], v[44:47]
    v_cvt_pk_bf16_f32 v62, v52, v53
    v_cvt_pk_bf16_f32 v63, v54, v55
    v_mfma_f32_16x16x32_bf16 v[44:47], a[152:155], a[40:43], v[44:47]
    buffer_load_dwordx4 v18, s[8:11], s22 offen offset:1024 lds
    v_mfma_f32_16x16x32_bf16 v[44:47], a[156:159], a[44:47], v[44:47]
    ds_read_b64_tr_b16 a[160:161], v6 offset:0
    v_mul_f32 v40, s20, v40
    v_mfma_f32_16x16x32_bf16 a[226:229], a[248:251], v[60:63], a[226:229]
    v_exp_f32 v40, v40
    v_mfma_f32_16x16x32_bf16 v[96:99], a[164:167], v[60:63], v[96:99]
    ds_write_b128 v12, v[80:83] offset:0
    v_mul_f32 v41, s20, v41
    v_mul_f32 v42, s20, v42
    v_pk_mul_f32 v[88:89], v[88:89], v[22:23] op_sel_hi:[1,0]
    v_pk_mul_f32 v[90:91], v[90:91], v[22:23] op_sel_hi:[1,0]
    v_pk_mul_f32 v[92:93], v[92:93], v[22:23] op_sel_hi:[1,0]
    v_pk_mul_f32 v[94:95], v[94:95], v[22:23] op_sel_hi:[1,0]
    v_cvt_pk_bf16_f32 v88, v88, v89
    v_cvt_pk_bf16_f32 v89, v90, v91
    v_cvt_pk_bf16_f32 v90, v92, v93
    v_cvt_pk_bf16_f32 v91, v94, v95
    v_mfma_f32_16x16x32_bf16 v[100:103], a[172:175], v[60:63], v[100:103]
    ds_read_b64_tr_b16 a[162:163], v36 offset:0
    ds_read_b128 a[32:35], v10 offset:8192
    v_mul_f32 v43, s20, v43
    v_mfma_f32_16x16x32_bf16 v[104:107], a[180:183], v[60:63], v[104:107]
    ds_read_b128 a[36:39], v11 offset:8192
    v_exp_f32 v41, v41
    v_accvgpr_read_b32 v23, a226
    v_accvgpr_read_b32 v22, a227
    v_add_f32 v23, v23, v22
    v_mfma_f32_16x16x32_bf16 v[108:111], a[188:191], v[60:63], v[108:111]
    ds_read_b128 a[40:43], v12 offset:8192
    v_exp_f32 v42, v42
    v_mfma_f32_16x16x32_bf16 v[112:115], a[196:199], v[60:63], v[112:115]
    ds_read_b64_tr_b16 a[168:169], v6 offset:8
    ds_read_b128 a[44:47], v13 offset:8192
    v_mul_f32 v44, s20, v44
    v_rcp_f32 v22, v23
    v_mfma_f32_16x16x32_bf16 v[116:119], a[204:207], v[60:63], v[116:119]
    v_exp_f32 v43, v43
    v_mfma_f32_16x16x32_bf16 v[120:123], a[212:215], v[60:63], v[120:123]
    ds_write_b128 v13, v[88:91] offset:0
    v_exp_f32 v44, v44
    v_pk_mul_f32 v[96:97], v[96:97], v[22:23] op_sel_hi:[1,0]
    v_pk_mul_f32 v[98:99], v[98:99], v[22:23] op_sel_hi:[1,0]
    v_pk_mul_f32 v[100:101], v[100:101], v[22:23] op_sel_hi:[1,0]
    v_pk_mul_f32 v[102:103], v[102:103], v[22:23] op_sel_hi:[1,0]
    v_max3_u32 v21, v21, v22, v23
    v_cvt_pk_bf16_f32 v96, v96, v97
    v_cvt_pk_bf16_f32 v97, v98, v99
    v_cvt_pk_bf16_f32 v98, v100, v101
    v_cvt_pk_bf16_f32 v99, v102, v103
    v_mfma_f32_16x16x32_bf16 v[124:127], a[220:223], v[60:63], v[124:127]
    ds_read_b64_tr_b16 a[170:171], v36 offset:8
    v_mul_f32 v45, s20, v45
    v_mfma_f32_16x16x32_bf16 v[48:51], a[128:131], a[48:51], 0
    v_mul_f32 v46, s20, v46
    v_mul_f32 v47, s20, v47
    v_mfma_f32_16x16x32_bf16 v[48:51], a[132:135], a[52:55], v[48:51]
    ds_write_b128 v10, v[96:99] offset:4096
    v_exp_f32 v45, v45
    v_pk_mul_f32 v[104:105], v[104:105], v[22:23] op_sel_hi:[1,0]
    v_pk_mul_f32 v[106:107], v[106:107], v[22:23] op_sel_hi:[1,0]
    v_pk_mul_f32 v[108:109], v[108:109], v[22:23] op_sel_hi:[1,0]
    v_pk_mul_f32 v[110:111], v[110:111], v[22:23] op_sel_hi:[1,0]
    v_cvt_pk_bf16_f32 v104, v104, v105
    v_cvt_pk_bf16_f32 v105, v106, v107
    v_cvt_pk_bf16_f32 v106, v108, v109
    v_cvt_pk_bf16_f32 v107, v110, v111
    v_mfma_f32_16x16x32_bf16 v[48:51], a[136:139], a[56:59], v[48:51]
    v_cvt_pk_bf16_f32 v56, v40, v41
    v_cvt_pk_bf16_f32 v57, v42, v43
    v_mfma_f32_16x16x32_bf16 v[48:51], a[140:143], a[60:63], v[48:51]
    v_exp_f32 v46, v46
    v_mfma_f32_16x16x32_bf16 v[52:55], a[144:147], a[48:51], 0
    ds_write_b128 v11, v[104:107] offset:4096
    v_exp_f32 v47, v47
    v_pk_mul_f32 v[112:113], v[112:113], v[22:23] op_sel_hi:[1,0]
    v_pk_mul_f32 v[114:115], v[114:115], v[22:23] op_sel_hi:[1,0]
    v_pk_mul_f32 v[116:117], v[116:117], v[22:23] op_sel_hi:[1,0]
    v_pk_mul_f32 v[118:119], v[118:119], v[22:23] op_sel_hi:[1,0]
    v_cvt_pk_bf16_f32 v112, v112, v113
    v_cvt_pk_bf16_f32 v113, v114, v115
    v_cvt_pk_bf16_f32 v114, v116, v117
    v_cvt_pk_bf16_f32 v115, v118, v119
    v_mfma_f32_16x16x32_bf16 v[52:55], a[148:151], a[52:55], v[52:55]
    s_add_u32 m0, s35, 57344
    v_cvt_pk_bf16_f32 v58, v44, v45
    v_cvt_pk_bf16_f32 v59, v46, v47
    v_mfma_f32_16x16x32_bf16 v[52:55], a[152:155], a[56:59], v[52:55]
    buffer_load_dwordx4 v19, s[12:15], s22 offen lds
    v_mfma_f32_16x16x32_bf16 v[52:55], a[156:159], a[60:63], v[52:55]
    ds_read_b64_tr_b16 a[176:177], v7 offset:0
    v_mul_f32 v48, s20, v48
    v_mfma_f32_16x16x32_bf16 a[228:231], a[248:251], v[56:59], a[228:231]
    s_waitcnt vmcnt(63)
    v_exp_f32 v48, v48
    v_mfma_f32_16x16x32_bf16 v[128:131], a[164:167], v[56:59], v[128:131]
    ds_write_b128 v12, v[112:115] offset:4096
    ds_read_b128 v[28:31], v24 offset:0
    ds_read_b128 v[32:35], v24 offset:1024
    v_mul_f32 v49, s20, v49
    v_mul_f32 v50, s20, v50
    v_pk_mul_f32 v[120:121], v[120:121], v[22:23] op_sel_hi:[1,0]
    v_pk_mul_f32 v[122:123], v[122:123], v[22:23] op_sel_hi:[1,0]
    v_pk_mul_f32 v[124:125], v[124:125], v[22:23] op_sel_hi:[1,0]
    v_pk_mul_f32 v[126:127], v[126:127], v[22:23] op_sel_hi:[1,0]
    v_cvt_pk_bf16_f32 v120, v120, v121
    v_cvt_pk_bf16_f32 v121, v122, v123
    v_cvt_pk_bf16_f32 v122, v124, v125
    v_cvt_pk_bf16_f32 v123, v126, v127
    v_mfma_f32_16x16x32_bf16 v[132:135], a[172:175], v[56:59], v[132:135]
    ds_read_b64_tr_b16 a[178:179], v37 offset:0
    ds_read_b128 a[48:51], v10 offset:12288
    v_mul_f32 v51, s20, v51
    v_mfma_f32_16x16x32_bf16 v[136:139], a[180:183], v[56:59], v[136:139]
    ds_read_b128 a[52:55], v11 offset:12288
    v_exp_f32 v49, v49
    v_accvgpr_read_b32 v23, a228
    v_accvgpr_read_b32 v22, a229
    v_add_f32 v23, v23, v22
    v_mfma_f32_16x16x32_bf16 v[140:143], a[188:191], v[56:59], v[140:143]
    ds_read_b128 a[56:59], v12 offset:12288
    v_exp_f32 v50, v50
    v_mfma_f32_16x16x32_bf16 v[144:147], a[196:199], v[56:59], v[144:147]
    ds_read_b64_tr_b16 a[184:185], v7 offset:8
    ds_read_b128 a[60:63], v13 offset:12288
    v_mul_f32 v52, s20, v52
    v_rcp_f32 v22, v23
    v_mfma_f32_16x16x32_bf16 v[148:151], a[204:207], v[56:59], v[148:151]
    v_exp_f32 v51, v51
    v_mfma_f32_16x16x32_bf16 v[152:155], a[212:215], v[56:59], v[152:155]
    ds_write_b128 v13, v[120:123] offset:4096
    v_exp_f32 v52, v52
    v_pk_mul_f32 v[128:129], v[128:129], v[22:23] op_sel_hi:[1,0]
    v_pk_mul_f32 v[130:131], v[130:131], v[22:23] op_sel_hi:[1,0]
    v_pk_mul_f32 v[132:133], v[132:133], v[22:23] op_sel_hi:[1,0]
    v_pk_mul_f32 v[134:135], v[134:135], v[22:23] op_sel_hi:[1,0]
    v_max3_u32 v21, v21, v22, v23
    v_cvt_pk_bf16_f32 v128, v128, v129
    v_cvt_pk_bf16_f32 v129, v130, v131
    v_cvt_pk_bf16_f32 v130, v132, v133
    v_cvt_pk_bf16_f32 v131, v134, v135
    v_mfma_f32_16x16x32_bf16 v[156:159], a[220:223], v[56:59], v[156:159]
    ds_read_b64_tr_b16 a[186:187], v37 offset:8
    v_mul_f32 v53, s20, v53
    v_mfma_f32_16x16x32_bf16 v[40:43], a[128:131], a[64:67], 0
    v_mul_f32 v54, s20, v54
    v_mul_f32 v55, s20, v55
    v_mfma_f32_16x16x32_bf16 v[40:43], a[132:135], a[68:71], v[40:43]
    ds_write_b128 v10, v[128:131] offset:8192
    v_exp_f32 v53, v53
    v_pk_mul_f32 v[136:137], v[136:137], v[22:23] op_sel_hi:[1,0]
    v_pk_mul_f32 v[138:139], v[138:139], v[22:23] op_sel_hi:[1,0]
    v_pk_mul_f32 v[140:141], v[140:141], v[22:23] op_sel_hi:[1,0]
    v_pk_mul_f32 v[142:143], v[142:143], v[22:23] op_sel_hi:[1,0]
    v_cvt_pk_bf16_f32 v136, v136, v137
    v_cvt_pk_bf16_f32 v137, v138, v139
    v_cvt_pk_bf16_f32 v138, v140, v141
    v_cvt_pk_bf16_f32 v139, v142, v143
    v_mfma_f32_16x16x32_bf16 v[40:43], a[136:139], a[72:75], v[40:43]
    v_cvt_pk_bf16_f32 v60, v48, v49
    v_cvt_pk_bf16_f32 v61, v50, v51
    v_mfma_f32_16x16x32_bf16 v[40:43], a[140:143], a[76:79], v[40:43]
    s_add_u32 s28, s24, 0
    v_exp_f32 v54, v54
    v_mfma_f32_16x16x32_bf16 v[44:47], a[144:147], a[64:67], 0
    ds_write_b128 v11, v[136:139] offset:8192
    v_exp_f32 v55, v55
    v_pk_mul_f32 v[144:145], v[144:145], v[22:23] op_sel_hi:[1,0]
    v_pk_mul_f32 v[146:147], v[146:147], v[22:23] op_sel_hi:[1,0]
    v_pk_mul_f32 v[148:149], v[148:149], v[22:23] op_sel_hi:[1,0]
    v_pk_mul_f32 v[150:151], v[150:151], v[22:23] op_sel_hi:[1,0]
    v_cvt_pk_bf16_f32 v144, v144, v145
    v_cvt_pk_bf16_f32 v145, v146, v147
    v_cvt_pk_bf16_f32 v146, v148, v149
    v_cvt_pk_bf16_f32 v147, v150, v151
    v_mfma_f32_16x16x32_bf16 v[44:47], a[148:151], a[68:71], v[44:47]
    s_add_u32 s32, s31, 0
    v_cvt_pk_bf16_f32 v62, v52, v53
    v_cvt_pk_bf16_f32 v63, v54, v55
    v_mfma_f32_16x16x32_bf16 v[44:47], a[152:155], a[72:75], v[44:47]
    buffer_load_dwordx4 v19, s[12:15], s22 offen offset:1024 lds
    v_mfma_f32_16x16x32_bf16 v[44:47], a[156:159], a[76:79], v[44:47]
    s_add_u32 m0, s30, 0
    ds_read_b64_tr_b16 a[192:193], v8 offset:0
    v_mul_f32 v40, s20, v40
    v_mfma_f32_16x16x32_bf16 a[230:233], a[248:251], v[60:63], a[230:233]
    s_waitcnt lgkmcnt(11)
    s_waitcnt vmcnt(16)
    v_exp_f32 v40, v40
    v_mfma_f32_16x16x32_bf16 v[160:163], a[164:167], v[60:63], v[160:163]
    buffer_store_dwordx4 v[28:31], v14, s[16:19], s32 offen nt
    buffer_load_dwordx4 v14, s[4:7], s28 offen nt lds
    ds_write_b128 v12, v[144:147] offset:8192
    v_mul_f32 v41, s20, v41
    v_mul_f32 v42, s20, v42
    v_pk_mul_f32 v[152:153], v[152:153], v[22:23] op_sel_hi:[1,0]
    v_pk_mul_f32 v[154:155], v[154:155], v[22:23] op_sel_hi:[1,0]
    v_pk_mul_f32 v[156:157], v[156:157], v[22:23] op_sel_hi:[1,0]
    v_pk_mul_f32 v[158:159], v[158:159], v[22:23] op_sel_hi:[1,0]
    v_cvt_pk_bf16_f32 v152, v152, v153
    v_cvt_pk_bf16_f32 v153, v154, v155
    v_cvt_pk_bf16_f32 v154, v156, v157
    v_cvt_pk_bf16_f32 v155, v158, v159
    v_mfma_f32_16x16x32_bf16 v[164:167], a[172:175], v[60:63], v[164:167]
    ds_read_b64_tr_b16 a[194:195], v38 offset:0
    ds_read_b128 a[64:67], v10 offset:16384
    v_mul_f32 v43, s20, v43
    v_mfma_f32_16x16x32_bf16 v[168:171], a[180:183], v[60:63], v[168:171]
    s_xor_b32 s22, s22, 57344
    ds_read_b128 a[68:71], v11 offset:16384
    v_exp_f32 v41, v41
    v_accvgpr_read_b32 v23, a230
    v_accvgpr_read_b32 v22, a231
    v_add_f32 v23, v23, v22
    v_mfma_f32_16x16x32_bf16 v[172:175], a[188:191], v[60:63], v[172:175]
    ds_read_b128 a[72:75], v12 offset:16384
    v_exp_f32 v42, v42
    v_mfma_f32_16x16x32_bf16 v[176:179], a[196:199], v[60:63], v[176:179]
    ds_read_b64_tr_b16 a[200:201], v8 offset:8
    ds_read_b128 a[76:79], v13 offset:16384
    v_mul_f32 v44, s20, v44
    v_rcp_f32 v22, v23
    v_mfma_f32_16x16x32_bf16 v[180:183], a[204:207], v[60:63], v[180:183]
    v_exp_f32 v43, v43
    v_mfma_f32_16x16x32_bf16 v[184:187], a[212:215], v[60:63], v[184:187]
    ds_write_b128 v13, v[152:155] offset:8192
    v_exp_f32 v44, v44
    v_pk_mul_f32 v[160:161], v[160:161], v[22:23] op_sel_hi:[1,0]
    v_pk_mul_f32 v[162:163], v[162:163], v[22:23] op_sel_hi:[1,0]
    v_pk_mul_f32 v[164:165], v[164:165], v[22:23] op_sel_hi:[1,0]
    v_pk_mul_f32 v[166:167], v[166:167], v[22:23] op_sel_hi:[1,0]
    v_max3_u32 v21, v21, v22, v23
    v_cvt_pk_bf16_f32 v160, v160, v161
    v_cvt_pk_bf16_f32 v161, v162, v163
    v_cvt_pk_bf16_f32 v162, v164, v165
    v_cvt_pk_bf16_f32 v163, v166, v167
    v_mfma_f32_16x16x32_bf16 v[188:191], a[220:223], v[60:63], v[188:191]
    ds_read_b64_tr_b16 a[202:203], v38 offset:8
    v_mul_f32 v45, s20, v45
    v_mfma_f32_16x16x32_bf16 v[48:51], a[128:131], a[80:83], 0
    v_mul_f32 v46, s20, v46
    v_mul_f32 v47, s20, v47
    v_mfma_f32_16x16x32_bf16 v[48:51], a[132:135], a[84:87], v[48:51]
    ds_write_b128 v10, v[160:163] offset:12288
    v_exp_f32 v45, v45
    v_pk_mul_f32 v[168:169], v[168:169], v[22:23] op_sel_hi:[1,0]
    v_pk_mul_f32 v[170:171], v[170:171], v[22:23] op_sel_hi:[1,0]
    v_pk_mul_f32 v[172:173], v[172:173], v[22:23] op_sel_hi:[1,0]
    v_pk_mul_f32 v[174:175], v[174:175], v[22:23] op_sel_hi:[1,0]
    v_cvt_pk_bf16_f32 v168, v168, v169
    v_cvt_pk_bf16_f32 v169, v170, v171
    v_cvt_pk_bf16_f32 v170, v172, v173
    v_cvt_pk_bf16_f32 v171, v174, v175
    v_mfma_f32_16x16x32_bf16 v[48:51], a[136:139], a[88:91], v[48:51]
    buffer_store_dwordx4 v[32:35], v15, s[16:19], s32 offen offset:1024 nt
    buffer_load_dwordx4 v15, s[4:7], s28 offen offset:1024 nt lds
    v_cvt_pk_bf16_f32 v56, v40, v41
    v_cvt_pk_bf16_f32 v57, v42, v43
    v_mfma_f32_16x16x32_bf16 v[48:51], a[140:143], a[92:95], v[48:51]
    v_exp_f32 v46, v46
    v_mfma_f32_16x16x32_bf16 v[52:55], a[144:147], a[80:83], 0
    ds_write_b128 v11, v[168:171] offset:12288
    v_exp_f32 v47, v47
    v_pk_mul_f32 v[176:177], v[176:177], v[22:23] op_sel_hi:[1,0]
    v_pk_mul_f32 v[178:179], v[178:179], v[22:23] op_sel_hi:[1,0]
    v_pk_mul_f32 v[180:181], v[180:181], v[22:23] op_sel_hi:[1,0]
    v_pk_mul_f32 v[182:183], v[182:183], v[22:23] op_sel_hi:[1,0]
    v_cvt_pk_bf16_f32 v176, v176, v177
    v_cvt_pk_bf16_f32 v177, v178, v179
    v_cvt_pk_bf16_f32 v178, v180, v181
    v_cvt_pk_bf16_f32 v179, v182, v183
    v_mfma_f32_16x16x32_bf16 v[52:55], a[148:151], a[84:87], v[52:55]
    v_cvt_pk_bf16_f32 v58, v44, v45
    v_cvt_pk_bf16_f32 v59, v46, v47
    v_mfma_f32_16x16x32_bf16 v[52:55], a[152:155], a[88:91], v[52:55]
    ds_read_b128 v[28:31], v24 offset:2048
    v_mfma_f32_16x16x32_bf16 v[52:55], a[156:159], a[92:95], v[52:55]
    ds_read_b64_tr_b16 a[208:209], v9 offset:0
    v_mul_f32 v48, s20, v48
    v_mfma_f32_16x16x32_bf16 a[232:235], a[248:251], v[56:59], a[232:235]
    s_waitcnt vmcnt(8)
    v_exp_f32 v48, v48
    v_mfma_f32_16x16x32_bf16 v[192:195], a[164:167], v[56:59], v[192:195]
    ds_write_b128 v12, v[176:179] offset:12288
    v_mul_f32 v49, s20, v49
    v_mul_f32 v50, s20, v50
    v_pk_mul_f32 v[184:185], v[184:185], v[22:23] op_sel_hi:[1,0]
    v_pk_mul_f32 v[186:187], v[186:187], v[22:23] op_sel_hi:[1,0]
    v_pk_mul_f32 v[188:189], v[188:189], v[22:23] op_sel_hi:[1,0]
    v_pk_mul_f32 v[190:191], v[190:191], v[22:23] op_sel_hi:[1,0]
    v_cvt_pk_bf16_f32 v184, v184, v185
    v_cvt_pk_bf16_f32 v185, v186, v187
    v_cvt_pk_bf16_f32 v186, v188, v189
    v_cvt_pk_bf16_f32 v187, v190, v191
    v_mfma_f32_16x16x32_bf16 v[196:199], a[172:175], v[56:59], v[196:199]
    ds_read_b64_tr_b16 a[210:211], v39 offset:0
    ds_read_b128 a[80:83], v10 offset:20480
    v_mul_f32 v51, s20, v51
    v_mfma_f32_16x16x32_bf16 v[200:203], a[180:183], v[56:59], v[200:203]
    ds_read_b128 a[84:87], v11 offset:20480
    v_exp_f32 v49, v49
    v_accvgpr_read_b32 v23, a232
    v_accvgpr_read_b32 v22, a233
    v_add_f32 v23, v23, v22
    v_mfma_f32_16x16x32_bf16 v[204:207], a[188:191], v[56:59], v[204:207]
    ds_read_b128 a[88:91], v12 offset:20480
    v_exp_f32 v50, v50
    v_mfma_f32_16x16x32_bf16 v[208:211], a[196:199], v[56:59], v[208:211]
    ds_read_b64_tr_b16 a[216:217], v9 offset:8
    ds_read_b128 a[92:95], v13 offset:20480
    v_mul_f32 v52, s20, v52
    v_rcp_f32 v22, v23
    v_mfma_f32_16x16x32_bf16 v[212:215], a[204:207], v[56:59], v[212:215]
    v_exp_f32 v51, v51
    v_mfma_f32_16x16x32_bf16 v[216:219], a[212:215], v[56:59], v[216:219]
    ds_write_b128 v13, v[184:187] offset:12288
    v_exp_f32 v52, v52
    v_pk_mul_f32 v[192:193], v[192:193], v[22:23] op_sel_hi:[1,0]
    v_pk_mul_f32 v[194:195], v[194:195], v[22:23] op_sel_hi:[1,0]
    v_pk_mul_f32 v[196:197], v[196:197], v[22:23] op_sel_hi:[1,0]
    v_pk_mul_f32 v[198:199], v[198:199], v[22:23] op_sel_hi:[1,0]
    v_max3_u32 v21, v21, v22, v23
    v_cvt_pk_bf16_f32 v192, v192, v193
    v_cvt_pk_bf16_f32 v193, v194, v195
    v_cvt_pk_bf16_f32 v194, v196, v197
    v_cvt_pk_bf16_f32 v195, v198, v199
    v_mfma_f32_16x16x32_bf16 v[220:223], a[220:223], v[56:59], v[220:223]
    s_waitcnt lgkmcnt(15)
    ds_read_b64_tr_b16 a[218:219], v39 offset:8
    v_mul_f32 v53, s20, v53
L_B0:
    v_mfma_f32_16x16x32_bf16 v[40:43], a[96:99], a[0:3], 0
    v_mul_f32 v54, s20, v54
    v_mul_f32 v55, s20, v55
    v_mfma_f32_16x16x32_bf16 v[40:43], a[100:103], a[4:7], v[40:43]
    ds_write_b128 v10, v[192:195] offset:16384
    v_exp_f32 v53, v53
    v_pk_mul_f32 v[200:201], v[200:201], v[22:23] op_sel_hi:[1,0]
    v_pk_mul_f32 v[202:203], v[202:203], v[22:23] op_sel_hi:[1,0]
    v_pk_mul_f32 v[204:205], v[204:205], v[22:23] op_sel_hi:[1,0]
    v_pk_mul_f32 v[206:207], v[206:207], v[22:23] op_sel_hi:[1,0]
    v_cvt_pk_bf16_f32 v200, v200, v201
    v_cvt_pk_bf16_f32 v201, v202, v203
    v_cvt_pk_bf16_f32 v202, v204, v205
    v_cvt_pk_bf16_f32 v203, v206, v207
    v_mfma_f32_16x16x32_bf16 v[40:43], a[104:107], a[8:11], v[40:43]
    v_cvt_pk_bf16_f32 v60, v48, v49
    v_cvt_pk_bf16_f32 v61, v50, v51
    v_mfma_f32_16x16x32_bf16 v[40:43], a[108:111], a[12:15], v[40:43]
    v_exp_f32 v54, v54
    v_mfma_f32_16x16x32_bf16 v[44:47], a[112:115], a[0:3], 0
    ds_write_b128 v11, v[200:203] offset:16384
    v_exp_f32 v55, v55
    v_pk_mul_f32 v[208:209], v[208:209], v[22:23] op_sel_hi:[1,0]
    v_pk_mul_f32 v[210:211], v[210:211], v[22:23] op_sel_hi:[1,0]
    v_pk_mul_f32 v[212:213], v[212:213], v[22:23] op_sel_hi:[1,0]
    v_pk_mul_f32 v[214:215], v[214:215], v[22:23] op_sel_hi:[1,0]
    v_cvt_pk_bf16_f32 v208, v208, v209
    v_cvt_pk_bf16_f32 v209, v210, v211
    v_cvt_pk_bf16_f32 v210, v212, v213
    v_cvt_pk_bf16_f32 v211, v214, v215
    v_mfma_f32_16x16x32_bf16 v[44:47], a[116:119], a[4:7], v[44:47]
    s_waitcnt vmcnt(63) lgkmcnt(2)
    v_cvt_pk_bf16_f32 v62, v52, v53
    v_cvt_pk_bf16_f32 v63, v54, v55
    v_mfma_f32_16x16x32_bf16 v[44:47], a[120:123], a[8:11], v[44:47]
    s_barrier
    v_mfma_f32_16x16x32_bf16 v[44:47], a[124:127], a[12:15], v[44:47]
    ds_read_b128 a[128:131], v2 offset:8192
    v_mul_f32 v40, s20, v40
    v_mfma_f32_16x16x32_bf16 a[234:237], a[248:251], v[60:63], a[234:237]
    v_exp_f32 v40, v40
    v_mfma_f32_16x16x32_bf16 v[224:227], a[164:167], v[60:63], v[224:227]
    ds_write_b128 v12, v[208:211] offset:16384
    v_mul_f32 v41, s20, v41
    v_mul_f32 v42, s20, v42
    v_pk_mul_f32 v[216:217], v[216:217], v[22:23] op_sel_hi:[1,0]
    v_pk_mul_f32 v[218:219], v[218:219], v[22:23] op_sel_hi:[1,0]
    v_pk_mul_f32 v[220:221], v[220:221], v[22:23] op_sel_hi:[1,0]
    v_pk_mul_f32 v[222:223], v[222:223], v[22:23] op_sel_hi:[1,0]
    v_cvt_pk_bf16_f32 v216, v216, v217
    v_cvt_pk_bf16_f32 v217, v218, v219
    v_cvt_pk_bf16_f32 v218, v220, v221
    v_cvt_pk_bf16_f32 v219, v222, v223
    v_mfma_f32_16x16x32_bf16 v[228:231], a[172:175], v[60:63], v[228:231]
    ds_read_b128 a[132:135], v3 offset:8192
    v_mul_f32 v43, s20, v43
    v_mfma_f32_16x16x32_bf16 v[232:235], a[180:183], v[60:63], v[232:235]
    v_exp_f32 v41, v41
    v_accvgpr_read_b32 v23, a234
    v_accvgpr_read_b32 v22, a235
    v_add_f32 v23, v23, v22
    v_mfma_f32_16x16x32_bf16 v[236:239], a[188:191], v[60:63], v[236:239]
    v_exp_f32 v42, v42
    v_mfma_f32_16x16x32_bf16 v[240:243], a[196:199], v[60:63], v[240:243]
    ds_read_b128 a[136:139], v4 offset:8192
    v_mul_f32 v44, s20, v44
    v_rcp_f32 v22, v23
    v_mfma_f32_16x16x32_bf16 v[244:247], a[204:207], v[60:63], v[244:247]
    v_exp_f32 v43, v43
    v_mfma_f32_16x16x32_bf16 v[248:251], a[212:215], v[60:63], v[248:251]
    ds_write_b128 v13, v[216:219] offset:16384
    v_exp_f32 v44, v44
    v_pk_mul_f32 v[224:225], v[224:225], v[22:23] op_sel_hi:[1,0]
    v_pk_mul_f32 v[226:227], v[226:227], v[22:23] op_sel_hi:[1,0]
    v_pk_mul_f32 v[228:229], v[228:229], v[22:23] op_sel_hi:[1,0]
    v_pk_mul_f32 v[230:231], v[230:231], v[22:23] op_sel_hi:[1,0]
    v_max3_u32 v21, v21, v22, v23
    v_cvt_pk_bf16_f32 v224, v224, v225
    v_cvt_pk_bf16_f32 v225, v226, v227
    v_cvt_pk_bf16_f32 v226, v228, v229
    v_cvt_pk_bf16_f32 v227, v230, v231
    v_cmp_lt_u32 vcc, s21, v21
    v_mov_b32 v21, 0
    v_mfma_f32_16x16x32_bf16 v[252:255], a[220:223], v[60:63], v[252:255]
    ds_read_b128 a[140:143], v5 offset:8192
    v_mul_f32 v45, s20, v45
    v_mfma_f32_16x16x32_bf16 v[48:51], a[96:99], a[16:19], 0
    s_or_b32 s41, vcc_lo, vcc_hi
    v_mul_f32 v46, s20, v46
    v_mul_f32 v47, s20, v47
    v_mfma_f32_16x16x32_bf16 v[48:51], a[100:103], a[20:23], v[48:51]
    ds_write_b128 v10, v[224:227] offset:20480
    v_exp_f32 v45, v45
    v_pk_mul_f32 v[232:233], v[232:233], v[22:23] op_sel_hi:[1,0]
    v_pk_mul_f32 v[234:235], v[234:235], v[22:23] op_sel_hi:[1,0]
    v_pk_mul_f32 v[236:237], v[236:237], v[22:23] op_sel_hi:[1,0]
    v_pk_mul_f32 v[238:239], v[238:239], v[22:23] op_sel_hi:[1,0]
    v_cvt_pk_bf16_f32 v232, v232, v233
    v_cvt_pk_bf16_f32 v233, v234, v235
    v_cvt_pk_bf16_f32 v234, v236, v237
    v_cvt_pk_bf16_f32 v235, v238, v239
    v_mfma_f32_16x16x32_bf16 v[48:51], a[104:107], a[24:27], v[48:51]
    s_min_u32 s41, s41, 1
    v_cvt_pk_bf16_f32 v56, v40, v41
    v_cvt_pk_bf16_f32 v57, v42, v43
    v_mfma_f32_16x16x32_bf16 v[48:51], a[108:111], a[28:31], v[48:51]
    s_lshl_b32 s41, s41, s33
    v_exp_f32 v46, v46
    v_mfma_f32_16x16x32_bf16 v[52:55], a[112:115], a[16:19], 0
    ds_write_b128 v11, v[232:235] offset:20480
    v_exp_f32 v47, v47
    v_pk_mul_f32 v[240:241], v[240:241], v[22:23] op_sel_hi:[1,0]
    v_pk_mul_f32 v[242:243], v[242:243], v[22:23] op_sel_hi:[1,0]
    v_pk_mul_f32 v[244:245], v[244:245], v[22:23] op_sel_hi:[1,0]
    v_pk_mul_f32 v[246:247], v[246:247], v[22:23] op_sel_hi:[1,0]
    v_cvt_pk_bf16_f32 v240, v240, v241
    v_cvt_pk_bf16_f32 v241, v242, v243
    v_cvt_pk_bf16_f32 v242, v244, v245
    v_cvt_pk_bf16_f32 v243, v246, v247
    v_mfma_f32_16x16x32_bf16 v[52:55], a[116:119], a[20:23], v[52:55]
    s_add_u32 m0, s35, 0
    v_cvt_pk_bf16_f32 v58, v44, v45
    v_cvt_pk_bf16_f32 v59, v46, v47
    v_mfma_f32_16x16x32_bf16 v[52:55], a[120:123], a[24:27], v[52:55]
    buffer_load_dwordx4 v18, s[8:11], s22 offen lds
    v_mfma_f32_16x16x32_bf16 v[52:55], a[124:127], a[28:31], v[52:55]
    s_or_b32 s34, s34, s41
    ds_read_b128 a[144:147], v0 offset:8192
    v_mul_f32 v48, s20, v48

    v_exp_f32 v48, v48
    v_accvgpr_write_b32 a224, 0
    v_accvgpr_write_b32 a225, 0
    v_accvgpr_write_b32 a226, 0
    v_accvgpr_write_b32 a227, 0
    v_mfma_f32_16x16x32_bf16 v[64:67], a[160:163], v[56:59], 0
    ds_write_b128 v12, v[240:243] offset:20480
    v_mul_f32 v49, s20, v49
    v_mul_f32 v50, s20, v50
    v_pk_mul_f32 v[248:249], v[248:249], v[22:23] op_sel_hi:[1,0]
    v_pk_mul_f32 v[250:251], v[250:251], v[22:23] op_sel_hi:[1,0]
    v_pk_mul_f32 v[252:253], v[252:253], v[22:23] op_sel_hi:[1,0]
    v_pk_mul_f32 v[254:255], v[254:255], v[22:23] op_sel_hi:[1,0]
    v_cvt_pk_bf16_f32 v248, v248, v249
    v_cvt_pk_bf16_f32 v249, v250, v251
    v_cvt_pk_bf16_f32 v250, v252, v253
    v_cvt_pk_bf16_f32 v251, v254, v255
    v_mfma_f32_16x16x32_bf16 v[68:71], a[168:171], v[56:59], 0
    ds_read_b128 a[148:151], v1 offset:8192
    v_mul_f32 v51, s20, v51
    v_mfma_f32_16x16x32_bf16 v[72:75], a[176:179], v[56:59], 0
    v_exp_f32 v49, v49
    v_mfma_f32_16x16x32_bf16 v[76:79], a[184:187], v[56:59], 0
    v_exp_f32 v50, v50
    v_mfma_f32_16x16x32_bf16 v[80:83], a[192:195], v[56:59], 0
    ds_read_b128 a[152:155], v25 offset:8192
    v_mul_f32 v52, s20, v52
    v_mfma_f32_16x16x32_bf16 v[84:87], a[200:203], v[56:59], 0
    v_exp_f32 v51, v51
    v_mfma_f32_16x16x32_bf16 v[88:91], a[208:211], v[56:59], 0
    ds_write_b128 v13, v[248:251] offset:20480
    v_exp_f32 v52, v52
    v_mfma_f32_16x16x32_bf16 v[92:95], a[216:219], v[56:59], 0
    ds_read_b128 a[156:159], v27 offset:8192
    v_mul_f32 v53, s20, v53
    v_mfma_f32_16x16x32_bf16 v[40:43], a[96:99], a[32:35], 0
    v_mul_f32 v54, s20, v54
    v_mul_f32 v55, s20, v55
    v_mfma_f32_16x16x32_bf16 v[40:43], a[100:103], a[36:39], v[40:43]
    v_exp_f32 v53, v53
    v_mfma_f32_16x16x32_bf16 v[40:43], a[104:107], a[40:43], v[40:43]
    v_cvt_pk_bf16_f32 v60, v48, v49
    v_cvt_pk_bf16_f32 v61, v50, v51
    v_mfma_f32_16x16x32_bf16 v[40:43], a[108:111], a[44:47], v[40:43]
    v_exp_f32 v54, v54
    v_mfma_f32_16x16x32_bf16 v[44:47], a[112:115], a[32:35], 0
    v_exp_f32 v55, v55
    v_mfma_f32_16x16x32_bf16 v[44:47], a[116:119], a[36:39], v[44:47]
    v_cvt_pk_bf16_f32 v62, v52, v53
    v_cvt_pk_bf16_f32 v63, v54, v55
    v_mfma_f32_16x16x32_bf16 v[44:47], a[120:123], a[40:43], v[44:47]
    buffer_load_dwordx4 v18, s[8:11], s22 offen offset:1024 lds
    v_mfma_f32_16x16x32_bf16 v[44:47], a[124:127], a[44:47], v[44:47]
    ds_read_b64_tr_b16 a[164:165], v6 offset:8192
    v_mul_f32 v40, s20, v40
    v_smfmac_f32_16x16x64_bf16 a[224:227], a[238:241], v[56:63], v26
    v_exp_f32 v40, v40
    v_mfma_f32_16x16x32_bf16 v[96:99], a[160:163], v[60:63], 0
    v_mul_f32 v41, s20, v41
    v_mul_f32 v42, s20, v42
    v_mfma_f32_16x16x32_bf16 v[100:103], a[168:171], v[60:63], 0
    ds_read_b64_tr_b16 a[166:167], v36 offset:8192
    v_mul_f32 v43, s20, v43
    v_mfma_f32_16x16x32_bf16 v[104:107], a[176:179], v[60:63], 0
    v_exp_f32 v41, v41
    v_mfma_f32_16x16x32_bf16 v[108:111], a[184:187], v[60:63], 0
    v_exp_f32 v42, v42
    v_mfma_f32_16x16x32_bf16 v[112:115], a[192:195], v[60:63], 0
    ds_read_b64_tr_b16 a[172:173], v6 offset:8200
    v_mul_f32 v44, s20, v44
    v_mfma_f32_16x16x32_bf16 v[116:119], a[200:203], v[60:63], 0
    v_exp_f32 v43, v43
    v_mfma_f32_16x16x32_bf16 v[120:123], a[208:211], v[60:63], 0
    v_exp_f32 v44, v44
    v_mfma_f32_16x16x32_bf16 v[124:127], a[216:219], v[60:63], 0
    ds_read_b64_tr_b16 a[174:175], v36 offset:8200
    v_mul_f32 v45, s20, v45
    v_mfma_f32_16x16x32_bf16 v[48:51], a[96:99], a[48:51], 0
    v_mul_f32 v46, s20, v46
    v_mul_f32 v47, s20, v47
    v_mfma_f32_16x16x32_bf16 v[48:51], a[100:103], a[52:55], v[48:51]
    v_exp_f32 v45, v45
    v_mfma_f32_16x16x32_bf16 v[48:51], a[104:107], a[56:59], v[48:51]
    v_cvt_pk_bf16_f32 v56, v40, v41
    v_cvt_pk_bf16_f32 v57, v42, v43
    v_mfma_f32_16x16x32_bf16 v[48:51], a[108:111], a[60:63], v[48:51]
    v_exp_f32 v46, v46
    v_mfma_f32_16x16x32_bf16 v[52:55], a[112:115], a[48:51], 0
    v_exp_f32 v47, v47
    v_mfma_f32_16x16x32_bf16 v[52:55], a[116:119], a[52:55], v[52:55]
    s_add_u32 m0, s35, 32768
    v_cvt_pk_bf16_f32 v58, v44, v45
    v_cvt_pk_bf16_f32 v59, v46, v47
    v_mfma_f32_16x16x32_bf16 v[52:55], a[120:123], a[56:59], v[52:55]
    buffer_load_dwordx4 v19, s[12:15], s22 offen lds
    v_mfma_f32_16x16x32_bf16 v[52:55], a[124:127], a[60:63], v[52:55]
    ds_read_b64_tr_b16 a[180:181], v7 offset:8192
    v_mul_f32 v48, s20, v48

    v_exp_f32 v48, v48
    v_accvgpr_write_b32 a228, 0
    v_accvgpr_write_b32 a229, 0
    v_accvgpr_write_b32 a230, 0
    v_accvgpr_write_b32 a231, 0
    v_mfma_f32_16x16x32_bf16 v[128:131], a[160:163], v[56:59], 0
    v_mul_f32 v49, s20, v49
    v_mul_f32 v50, s20, v50
    v_mfma_f32_16x16x32_bf16 v[132:135], a[168:171], v[56:59], 0
    ds_read_b64_tr_b16 a[182:183], v37 offset:8192
    v_mul_f32 v51, s20, v51
    v_mfma_f32_16x16x32_bf16 v[136:139], a[176:179], v[56:59], 0
    v_exp_f32 v49, v49
    v_mfma_f32_16x16x32_bf16 v[140:143], a[184:187], v[56:59], 0
    v_exp_f32 v50, v50
    v_mfma_f32_16x16x32_bf16 v[144:147], a[192:195], v[56:59], 0
    ds_read_b64_tr_b16 a[188:189], v7 offset:8200
    v_mul_f32 v52, s20, v52
    v_mfma_f32_16x16x32_bf16 v[148:151], a[200:203], v[56:59], 0
    v_exp_f32 v51, v51
    v_mfma_f32_16x16x32_bf16 v[152:155], a[208:211], v[56:59], 0
    v_exp_f32 v52, v52
    v_mfma_f32_16x16x32_bf16 v[156:159], a[216:219], v[56:59], 0
    ds_read_b64_tr_b16 a[190:191], v37 offset:8200
    v_mul_f32 v53, s20, v53
    v_mfma_f32_16x16x32_bf16 v[40:43], a[96:99], a[64:67], 0
    v_mul_f32 v54, s20, v54
    v_mul_f32 v55, s20, v55
    v_mfma_f32_16x16x32_bf16 v[40:43], a[100:103], a[68:71], v[40:43]
    v_exp_f32 v53, v53
    v_mfma_f32_16x16x32_bf16 v[40:43], a[104:107], a[72:75], v[40:43]
    v_cvt_pk_bf16_f32 v60, v48, v49
    v_cvt_pk_bf16_f32 v61, v50, v51
    v_mfma_f32_16x16x32_bf16 v[40:43], a[108:111], a[76:79], v[40:43]
    v_exp_f32 v54, v54
    v_mfma_f32_16x16x32_bf16 v[44:47], a[112:115], a[64:67], 0
    v_exp_f32 v55, v55
    v_mfma_f32_16x16x32_bf16 v[44:47], a[116:119], a[68:71], v[44:47]
    s_add_u32 s28, s24, 0
    v_cvt_pk_bf16_f32 v62, v52, v53
    v_cvt_pk_bf16_f32 v63, v54, v55
    v_mfma_f32_16x16x32_bf16 v[44:47], a[120:123], a[72:75], v[44:47]
    buffer_load_dwordx4 v19, s[12:15], s22 offen offset:1024 lds
    v_mfma_f32_16x16x32_bf16 v[44:47], a[124:127], a[76:79], v[44:47]
    s_add_u32 s32, s31, 0
    ds_read_b64_tr_b16 a[196:197], v8 offset:8192
    v_mul_f32 v40, s20, v40
    v_smfmac_f32_16x16x64_bf16 a[228:231], a[238:241], v[56:63], v26
    s_add_u32 m0, s30, 0
    v_exp_f32 v40, v40
    v_mfma_f32_16x16x32_bf16 v[160:163], a[160:163], v[60:63], 0
    buffer_store_dwordx4 v[28:31], v16, s[16:19], s32 offen offset:2048 nt
    buffer_load_dwordx4 v16, s[4:7], s28 offen offset:2048 nt lds
    v_mul_f32 v41, s20, v41
    v_mul_f32 v42, s20, v42
    v_mfma_f32_16x16x32_bf16 v[164:167], a[168:171], v[60:63], 0
    s_xor_b32 s22, s22, 8192
    ds_read_b64_tr_b16 a[198:199], v38 offset:8192
    v_mul_f32 v43, s20, v43
    v_mfma_f32_16x16x32_bf16 v[168:171], a[176:179], v[60:63], 0
    v_exp_f32 v41, v41
    v_mfma_f32_16x16x32_bf16 v[172:175], a[184:187], v[60:63], 0
    v_exp_f32 v42, v42
    v_mfma_f32_16x16x32_bf16 v[176:179], a[192:195], v[60:63], 0
    ds_read_b64_tr_b16 a[204:205], v8 offset:8200
    v_mul_f32 v44, s20, v44
    v_mfma_f32_16x16x32_bf16 v[180:183], a[200:203], v[60:63], 0
    v_exp_f32 v43, v43
    v_mfma_f32_16x16x32_bf16 v[184:187], a[208:211], v[60:63], 0
    v_exp_f32 v44, v44
    v_mfma_f32_16x16x32_bf16 v[188:191], a[216:219], v[60:63], 0
    s_waitcnt lgkmcnt(11)
    ds_read_b64_tr_b16 a[206:207], v38 offset:8200
    v_mul_f32 v45, s20, v45
    v_mfma_f32_16x16x32_bf16 v[48:51], a[112:115], a[80:83], 0
    v_mul_f32 v46, s20, v46
    v_mul_f32 v47, s20, v47
    v_mfma_f32_16x16x32_bf16 v[48:51], a[116:119], a[84:87], v[48:51]
    v_exp_f32 v45, v45
    v_mfma_f32_16x16x32_bf16 v[48:51], a[120:123], a[88:91], v[48:51]
    v_cvt_pk_bf16_f32 v56, v40, v41
    v_cvt_pk_bf16_f32 v57, v42, v43
    v_mfma_f32_16x16x32_bf16 v[48:51], a[124:127], a[92:95], v[48:51]
    v_exp_f32 v46, v46
    v_mfma_f32_16x16x32_bf16 v[52:55], a[128:131], a[80:83], 0
    v_exp_f32 v47, v47
    v_mfma_f32_16x16x32_bf16 v[52:55], a[132:135], a[84:87], v[52:55]
    v_cvt_pk_bf16_f32 v58, v44, v45
    v_cvt_pk_bf16_f32 v59, v46, v47
    v_mfma_f32_16x16x32_bf16 v[52:55], a[136:139], a[88:91], v[52:55]
    ds_read_b128 v[28:31], v24 offset:3072
    v_mfma_f32_16x16x32_bf16 v[52:55], a[140:143], a[92:95], v[52:55]
    ds_read_b64_tr_b16 a[212:213], v9 offset:8192
    v_mul_f32 v48, s20, v48

    v_exp_f32 v48, v48
    v_accvgpr_write_b32 a232, 0
    v_accvgpr_write_b32 a233, 0
    v_accvgpr_write_b32 a234, 0
    v_accvgpr_write_b32 a235, 0
    v_mfma_f32_16x16x32_bf16 v[192:195], a[160:163], v[56:59], 0
    v_mul_f32 v49, s20, v49
    v_mul_f32 v50, s20, v50
    v_mfma_f32_16x16x32_bf16 v[196:199], a[168:171], v[56:59], 0
    ds_read_b64_tr_b16 a[214:215], v39 offset:8192
    v_mul_f32 v51, s20, v51
    v_mfma_f32_16x16x32_bf16 v[200:203], a[176:179], v[56:59], 0
    v_exp_f32 v49, v49
    v_mfma_f32_16x16x32_bf16 v[204:207], a[184:187], v[56:59], 0
    v_exp_f32 v50, v50
    v_mfma_f32_16x16x32_bf16 v[208:211], a[192:195], v[56:59], 0
    ds_read_b64_tr_b16 a[220:221], v9 offset:8200
    v_mul_f32 v52, s20, v52
    v_mfma_f32_16x16x32_bf16 v[212:215], a[200:203], v[56:59], 0
    v_exp_f32 v51, v51
    v_mfma_f32_16x16x32_bf16 v[216:219], a[208:211], v[56:59], 0
    v_exp_f32 v52, v52
    v_mfma_f32_16x16x32_bf16 v[220:223], a[216:219], v[56:59], 0
    ds_read_b64_tr_b16 a[222:223], v39 offset:8200
    v_mul_f32 v53, s20, v53
L_B1:
    v_mfma_f32_16x16x32_bf16 v[40:43], a[128:131], a[0:3], 0
    v_mul_f32 v54, s20, v54
    v_mul_f32 v55, s20, v55
    v_mfma_f32_16x16x32_bf16 v[40:43], a[132:135], a[4:7], v[40:43]
    v_exp_f32 v53, v53
    v_mfma_f32_16x16x32_bf16 v[40:43], a[136:139], a[8:11], v[40:43]
    v_cvt_pk_bf16_f32 v60, v48, v49
    v_cvt_pk_bf16_f32 v61, v50, v51
    v_mfma_f32_16x16x32_bf16 v[40:43], a[140:143], a[12:15], v[40:43]
    v_exp_f32 v54, v54
    v_mfma_f32_16x16x32_bf16 v[44:47], a[144:147], a[0:3], 0
    v_exp_f32 v55, v55
    v_mfma_f32_16x16x32_bf16 v[44:47], a[148:151], a[4:7], v[44:47]
    s_waitcnt vmcnt(12) lgkmcnt(0)
    v_cvt_pk_bf16_f32 v62, v52, v53
    v_cvt_pk_bf16_f32 v63, v54, v55
    v_mfma_f32_16x16x32_bf16 v[44:47], a[152:155], a[8:11], v[44:47]
    s_barrier
    v_mfma_f32_16x16x32_bf16 v[44:47], a[156:159], a[12:15], v[44:47]
    ds_read_b128 a[96:99], v2 offset:16384
    v_mul_f32 v40, s20, v40
    v_smfmac_f32_16x16x64_bf16 a[232:235], a[238:241], v[56:63], v26
    ds_read_b128 a[100:103], v3 offset:16384
    v_exp_f32 v40, v40
    v_mul_f32 v41, s20, v41
    v_mul_f32 v42, s20, v42
    v_mfma_f32_16x16x32_bf16 v[224:227], a[162:165], v[60:63], 0
    ds_read_b128 a[104:107], v4 offset:16384
    v_mul_f32 v43, s20, v43
    v_mfma_f32_16x16x32_bf16 v[228:231], a[170:173], v[60:63], 0
    v_exp_f32 v41, v41
    v_mfma_f32_16x16x32_bf16 v[232:235], a[178:181], v[60:63], 0
    v_exp_f32 v42, v42
    v_mfma_f32_16x16x32_bf16 v[236:239], a[186:189], v[60:63], 0
    ds_read_b128 a[108:111], v5 offset:16384
    v_mul_f32 v44, s20, v44
    v_mfma_f32_16x16x32_bf16 v[240:243], a[194:197], v[60:63], 0
    v_exp_f32 v43, v43
    v_mfma_f32_16x16x32_bf16 v[244:247], a[202:205], v[60:63], 0
    v_exp_f32 v44, v44
    v_mfma_f32_16x16x32_bf16 v[248:251], a[210:213], v[60:63], 0
    ds_read_b128 a[112:115], v0 offset:16384
    v_mul_f32 v45, s20, v45
    v_mfma_f32_16x16x32_bf16 v[252:255], a[218:221], v[60:63], 0
    v_mul_f32 v46, s20, v46
    v_mul_f32 v47, s20, v47
    v_mfma_f32_16x16x32_bf16 v[48:51], a[128:131], a[16:19], 0
    v_exp_f32 v45, v45
    v_mfma_f32_16x16x32_bf16 v[48:51], a[132:135], a[20:23], v[48:51]
    v_cvt_pk_bf16_f32 v56, v40, v41
    v_cvt_pk_bf16_f32 v57, v42, v43
    v_mfma_f32_16x16x32_bf16 v[48:51], a[136:139], a[24:27], v[48:51]
    v_exp_f32 v46, v46
    v_mfma_f32_16x16x32_bf16 v[48:51], a[140:143], a[28:31], v[48:51]
    v_exp_f32 v47, v47
    v_mfma_f32_16x16x32_bf16 v[52:55], a[144:147], a[16:19], 0
    s_add_u32 m0, s35, 8192
    v_cvt_pk_bf16_f32 v58, v44, v45
    v_cvt_pk_bf16_f32 v59, v46, v47
    v_mfma_f32_16x16x32_bf16 v[52:55], a[148:151], a[20:23], v[52:55]
    buffer_load_dwordx4 v18, s[8:11], s22 offen lds
    v_mfma_f32_16x16x32_bf16 v[52:55], a[152:155], a[24:27], v[52:55]
    ds_read_b128 a[116:119], v1 offset:16384
    v_mul_f32 v48, s20, v48
    v_mfma_f32_16x16x32_bf16 v[52:55], a[156:159], a[28:31], v[52:55]
    v_exp_f32 v48, v48

    v_mfma_f32_16x16x32_bf16 v[64:67], a[164:167], v[56:59], v[64:67]
    ds_read_b128 a[120:123], v25 offset:16384
    v_mul_f32 v49, s20, v49
    v_mul_f32 v50, s20, v50
    v_mfma_f32_16x16x32_bf16 v[68:71], a[172:175], v[56:59], v[68:71]
    ds_read_b128 a[124:127], v27 offset:16384
    v_mul_f32 v51, s20, v51
    v_mfma_f32_16x16x32_bf16 v[72:75], a[180:183], v[56:59], v[72:75]
    v_exp_f32 v49, v49
    v_mfma_f32_16x16x32_bf16 v[76:79], a[188:191], v[56:59], v[76:79]
    v_exp_f32 v50, v50
    v_mfma_f32_16x16x32_bf16 v[80:83], a[196:199], v[56:59], v[80:83]
    ds_read_b64_tr_b16 a[160:161], v6 offset:16384
    v_mul_f32 v52, s20, v52
    v_mfma_f32_16x16x32_bf16 v[84:87], a[204:207], v[56:59], v[84:87]
    v_exp_f32 v51, v51
    v_mfma_f32_16x16x32_bf16 v[88:91], a[212:215], v[56:59], v[88:91]
    v_exp_f32 v52, v52
    v_mfma_f32_16x16x32_bf16 v[92:95], a[220:223], v[56:59], v[92:95]
    ds_read_b64_tr_b16 a[162:163], v36 offset:16384
    v_mul_f32 v53, s20, v53
    v_mfma_f32_16x16x32_bf16 v[40:43], a[128:131], a[32:35], 0
    v_mul_f32 v54, s20, v54
    v_mul_f32 v55, s20, v55
    v_mfma_f32_16x16x32_bf16 v[40:43], a[132:135], a[36:39], v[40:43]
    v_exp_f32 v53, v53
    v_mfma_f32_16x16x32_bf16 v[40:43], a[136:139], a[40:43], v[40:43]
    v_cvt_pk_bf16_f32 v60, v48, v49
    v_cvt_pk_bf16_f32 v61, v50, v51
    v_mfma_f32_16x16x32_bf16 v[40:43], a[140:143], a[44:47], v[40:43]
    v_exp_f32 v54, v54
    v_mfma_f32_16x16x32_bf16 v[44:47], a[144:147], a[32:35], 0
    v_exp_f32 v55, v55
    v_mfma_f32_16x16x32_bf16 v[44:47], a[148:151], a[36:39], v[44:47]
    v_cvt_pk_bf16_f32 v62, v52, v53
    v_cvt_pk_bf16_f32 v63, v54, v55
    v_mfma_f32_16x16x32_bf16 v[44:47], a[152:155], a[40:43], v[44:47]
    buffer_load_dwordx4 v18, s[8:11], s22 offen offset:1024 lds
    v_mfma_f32_16x16x32_bf16 v[44:47], a[156:159], a[44:47], v[44:47]
    ds_read_b64_tr_b16 a[168:169], v6 offset:16392
    v_mul_f32 v40, s20, v40
    v_smfmac_f32_16x16x64_bf16 a[224:227], a[238:241], v[56:63], v26
    ds_read_b64_tr_b16 a[170:171], v36 offset:16392
    v_exp_f32 v40, v40
    v_mul_f32 v41, s20, v41
    v_mul_f32 v42, s20, v42
    v_mfma_f32_16x16x32_bf16 v[96:99], a[164:167], v[60:63], v[96:99]
    ds_read_b64_tr_b16 a[176:177], v7 offset:16384
    v_mul_f32 v43, s20, v43
    v_mfma_f32_16x16x32_bf16 v[100:103], a[172:175], v[60:63], v[100:103]
    v_exp_f32 v41, v41
    v_mfma_f32_16x16x32_bf16 v[104:107], a[180:183], v[60:63], v[104:107]
    v_exp_f32 v42, v42
    v_mfma_f32_16x16x32_bf16 v[108:111], a[188:191], v[60:63], v[108:111]
    ds_read_b64_tr_b16 a[178:179], v37 offset:16384
    v_mul_f32 v44, s20, v44
    v_mfma_f32_16x16x32_bf16 v[112:115], a[196:199], v[60:63], v[112:115]
    v_exp_f32 v43, v43
    v_mfma_f32_16x16x32_bf16 v[116:119], a[204:207], v[60:63], v[116:119]
    v_exp_f32 v44, v44
    v_mfma_f32_16x16x32_bf16 v[120:123], a[212:215], v[60:63], v[120:123]
    ds_read_b64_tr_b16 a[184:185], v7 offset:16392
    v_mul_f32 v45, s20, v45
    v_mfma_f32_16x16x32_bf16 v[124:127], a[220:223], v[60:63], v[124:127]
    v_mul_f32 v46, s20, v46
    v_mul_f32 v47, s20, v47
    v_mfma_f32_16x16x32_bf16 v[48:51], a[128:131], a[48:51], 0
    v_exp_f32 v45, v45
    v_mfma_f32_16x16x32_bf16 v[48:51], a[132:135], a[52:55], v[48:51]
    v_cvt_pk_bf16_f32 v56, v40, v41
    v_cvt_pk_bf16_f32 v57, v42, v43
    v_mfma_f32_16x16x32_bf16 v[48:51], a[136:139], a[56:59], v[48:51]
    v_exp_f32 v46, v46
    v_mfma_f32_16x16x32_bf16 v[48:51], a[140:143], a[60:63], v[48:51]
    v_exp_f32 v47, v47
    v_mfma_f32_16x16x32_bf16 v[52:55], a[144:147], a[48:51], 0
    s_add_u32 m0, s35, 40960
    v_cvt_pk_bf16_f32 v58, v44, v45
    v_cvt_pk_bf16_f32 v59, v46, v47
    v_mfma_f32_16x16x32_bf16 v[52:55], a[148:151], a[52:55], v[52:55]
    buffer_load_dwordx4 v19, s[12:15], s22 offen lds
    v_mfma_f32_16x16x32_bf16 v[52:55], a[152:155], a[56:59], v[52:55]
    s_add_u32 s28, s24, 0
    ds_read_b64_tr_b16 a[186:187], v37 offset:16392
    v_mul_f32 v48, s20, v48
    v_mfma_f32_16x16x32_bf16 v[52:55], a[156:159], a[60:63], v[52:55]
    s_add_u32 s32, s31, 0
    v_exp_f32 v48, v48

    s_add_u32 m0, s30, 0
    v_mfma_f32_16x16x32_bf16 v[128:131], a[164:167], v[56:59], v[128:131]
    buffer_store_dwordx4 v[28:31], v17, s[16:19], s32 offen offset:3072 nt
    buffer_load_dwordx4 v17, s[4:7], s28 offen offset:3072 nt lds
    ds_read_b64_tr_b16 a[192:193], v8 offset:16384
    v_mul_f32 v49, s20, v49
    v_mul_f32 v50, s20, v50
    v_mfma_f32_16x16x32_bf16 v[132:135], a[172:175], v[56:59], v[132:135]
    ds_read_b64_tr_b16 a[194:195], v38 offset:16384
    v_mul_f32 v51, s20, v51
    v_mfma_f32_16x16x32_bf16 v[136:139], a[180:183], v[56:59], v[136:139]
    v_exp_f32 v49, v49
    v_mfma_f32_16x16x32_bf16 v[140:143], a[188:191], v[56:59], v[140:143]
    v_exp_f32 v50, v50
    v_mfma_f32_16x16x32_bf16 v[144:147], a[196:199], v[56:59], v[144:147]
    ds_read_b64_tr_b16 a[200:201], v8 offset:16392
    v_mul_f32 v52, s20, v52
    v_mfma_f32_16x16x32_bf16 v[148:151], a[204:207], v[56:59], v[148:151]
    v_exp_f32 v51, v51
    v_mfma_f32_16x16x32_bf16 v[152:155], a[212:215], v[56:59], v[152:155]
    v_exp_f32 v52, v52
    v_mfma_f32_16x16x32_bf16 v[156:159], a[220:223], v[56:59], v[156:159]
    ds_read_b64_tr_b16 a[202:203], v38 offset:16392
    v_mul_f32 v53, s20, v53
    v_mfma_f32_16x16x32_bf16 v[40:43], a[128:131], a[64:67], 0
    v_mul_f32 v54, s20, v54
    v_mul_f32 v55, s20, v55
    v_mfma_f32_16x16x32_bf16 v[40:43], a[132:135], a[68:71], v[40:43]
    v_exp_f32 v53, v53
    v_mfma_f32_16x16x32_bf16 v[40:43], a[136:139], a[72:75], v[40:43]
    v_cvt_pk_bf16_f32 v60, v48, v49
    v_cvt_pk_bf16_f32 v61, v50, v51
    v_mfma_f32_16x16x32_bf16 v[40:43], a[140:143], a[76:79], v[40:43]
    v_exp_f32 v54, v54
    v_mfma_f32_16x16x32_bf16 v[44:47], a[144:147], a[64:67], 0
    v_exp_f32 v55, v55
    v_mfma_f32_16x16x32_bf16 v[44:47], a[148:151], a[68:71], v[44:47]
    s_add_u32 m0, s35, 40960
    v_cvt_pk_bf16_f32 v62, v52, v53
    v_cvt_pk_bf16_f32 v63, v54, v55
    v_mfma_f32_16x16x32_bf16 v[44:47], a[152:155], a[72:75], v[44:47]
    buffer_load_dwordx4 v19, s[12:15], s22 offen offset:1024 lds
    v_mfma_f32_16x16x32_bf16 v[44:47], a[156:159], a[76:79], v[44:47]
    s_xor_b32 s22, s22, 24576
    ds_read_b64_tr_b16 a[208:209], v9 offset:16384
    v_mul_f32 v40, s20, v40
    v_smfmac_f32_16x16x64_bf16 a[228:231], a[238:241], v[56:63], v26
    v_exp_f32 v40, v40
    v_mfma_f32_16x16x32_bf16 v[160:163], a[164:167], v[60:63], v[160:163]
    ds_read_b128 v[28:31], v24 offset:4096
    v_mul_f32 v41, s20, v41
    v_mul_f32 v42, s20, v42
    v_mfma_f32_16x16x32_bf16 v[164:167], a[172:175], v[60:63], v[164:167]
    ds_read_b64_tr_b16 a[210:211], v39 offset:16384
    v_mul_f32 v43, s20, v43
    v_mfma_f32_16x16x32_bf16 v[168:171], a[180:183], v[60:63], v[168:171]
    v_exp_f32 v41, v41
    v_mfma_f32_16x16x32_bf16 v[172:175], a[188:191], v[60:63], v[172:175]
    v_exp_f32 v42, v42
    v_mfma_f32_16x16x32_bf16 v[176:179], a[196:199], v[60:63], v[176:179]
    ds_read_b64_tr_b16 a[216:217], v9 offset:16392
    v_mul_f32 v44, s20, v44
    v_mfma_f32_16x16x32_bf16 v[180:183], a[204:207], v[60:63], v[180:183]
    v_exp_f32 v43, v43
    v_mfma_f32_16x16x32_bf16 v[184:187], a[212:215], v[60:63], v[184:187]
    v_exp_f32 v44, v44
    v_mfma_f32_16x16x32_bf16 v[188:191], a[220:223], v[60:63], v[188:191]
    s_waitcnt lgkmcnt(15)
    ds_read_b64_tr_b16 a[218:219], v39 offset:16392
    v_mul_f32 v45, s20, v45
L_B2:
    v_mfma_f32_16x16x32_bf16 v[48:51], a[96:99], a[0:3], 0
    v_mul_f32 v46, s20, v46
    v_mul_f32 v47, s20, v47
    v_mfma_f32_16x16x32_bf16 v[48:51], a[100:103], a[4:7], v[48:51]
    v_exp_f32 v45, v45
    v_mfma_f32_16x16x32_bf16 v[48:51], a[104:107], a[8:11], v[48:51]
    v_cvt_pk_bf16_f32 v56, v40, v41
    v_cvt_pk_bf16_f32 v57, v42, v43
    v_mfma_f32_16x16x32_bf16 v[48:51], a[108:111], a[12:15], v[48:51]
    v_exp_f32 v46, v46
    v_mfma_f32_16x16x32_bf16 v[52:55], a[112:115], a[0:3], 0
    v_exp_f32 v47, v47
    v_mfma_f32_16x16x32_bf16 v[52:55], a[116:119], a[4:7], v[52:55]
    s_waitcnt vmcnt(14) lgkmcnt(0)
    v_cvt_pk_bf16_f32 v58, v44, v45
    v_cvt_pk_bf16_f32 v59, v46, v47
    v_mfma_f32_16x16x32_bf16 v[52:55], a[120:123], a[8:11], v[52:55]
    s_barrier
    v_mfma_f32_16x16x32_bf16 v[52:55], a[124:127], a[12:15], v[52:55]
    ds_read_b128 a[128:131], v2 offset:24576
    v_mul_f32 v48, s20, v48
    v_mfma_f32_16x16x32_bf16 a[232:235], a[248:251], v[56:59], a[232:235]
    v_exp_f32 v48, v48
    v_mul_f32 v49, s20, v49
    v_mul_f32 v50, s20, v50
    v_mfma_f32_16x16x32_bf16 v[192:195], a[164:167], v[56:59], v[192:195]
    ds_read_b128 a[132:135], v3 offset:24576
    v_mul_f32 v51, s20, v51
    v_mfma_f32_16x16x32_bf16 v[196:199], a[172:175], v[56:59], v[196:199]
    v_exp_f32 v49, v49
    v_mfma_f32_16x16x32_bf16 v[200:203], a[180:183], v[56:59], v[200:203]
    v_exp_f32 v50, v50
    v_mfma_f32_16x16x32_bf16 v[204:207], a[188:191], v[56:59], v[204:207]
    ds_read_b128 a[136:139], v4 offset:24576
    v_mul_f32 v52, s20, v52
    v_mfma_f32_16x16x32_bf16 v[208:211], a[196:199], v[56:59], v[208:211]
    v_exp_f32 v51, v51
    v_mfma_f32_16x16x32_bf16 v[212:215], a[204:207], v[56:59], v[212:215]
    v_exp_f32 v52, v52
    v_mfma_f32_16x16x32_bf16 v[216:219], a[212:215], v[56:59], v[216:219]
    ds_read_b128 a[140:143], v5 offset:24576
    v_mul_f32 v53, s20, v53
    v_mfma_f32_16x16x32_bf16 v[220:223], a[220:223], v[56:59], v[220:223]
    v_mul_f32 v54, s20, v54
    v_mul_f32 v55, s20, v55
    v_mfma_f32_16x16x32_bf16 v[40:43], a[96:99], a[16:19], 0
    v_exp_f32 v53, v53
    v_mfma_f32_16x16x32_bf16 v[40:43], a[100:103], a[20:23], v[40:43]
    v_cvt_pk_bf16_f32 v60, v48, v49
    v_cvt_pk_bf16_f32 v61, v50, v51
    v_mfma_f32_16x16x32_bf16 v[40:43], a[104:107], a[24:27], v[40:43]
    v_exp_f32 v54, v54
    v_mfma_f32_16x16x32_bf16 v[40:43], a[108:111], a[28:31], v[40:43]
    v_exp_f32 v55, v55
    v_mfma_f32_16x16x32_bf16 v[44:47], a[112:115], a[16:19], 0
    s_add_u32 m0, s35, 16384
    v_cvt_pk_bf16_f32 v62, v52, v53
    v_cvt_pk_bf16_f32 v63, v54, v55
    v_mfma_f32_16x16x32_bf16 v[44:47], a[116:119], a[20:23], v[44:47]
    buffer_load_dwordx4 v18, s[8:11], s22 offen lds
    v_mfma_f32_16x16x32_bf16 v[44:47], a[120:123], a[24:27], v[44:47]
    ds_read_b128 a[144:147], v0 offset:24576
    v_mul_f32 v40, s20, v40
    v_mfma_f32_16x16x32_bf16 v[44:47], a[124:127], a[28:31], v[44:47]
    v_exp_f32 v40, v40

    v_mfma_f32_16x16x32_bf16 v[64:67], a[160:163], v[60:63], v[64:67]
    v_mul_f32 v41, s20, v41
    v_mul_f32 v42, s20, v42
    v_mfma_f32_16x16x32_bf16 v[68:71], a[168:171], v[60:63], v[68:71]
    ds_read_b128 a[148:151], v1 offset:24576
    v_mul_f32 v43, s20, v43
    v_mfma_f32_16x16x32_bf16 v[72:75], a[176:179], v[60:63], v[72:75]
    v_exp_f32 v41, v41
    v_mfma_f32_16x16x32_bf16 v[76:79], a[184:187], v[60:63], v[76:79]
    v_exp_f32 v42, v42
    v_mfma_f32_16x16x32_bf16 v[80:83], a[192:195], v[60:63], v[80:83]
    ds_read_b128 a[152:155], v25 offset:24576
    v_mul_f32 v44, s20, v44
    v_mfma_f32_16x16x32_bf16 v[84:87], a[200:203], v[60:63], v[84:87]
    v_exp_f32 v43, v43
    v_mfma_f32_16x16x32_bf16 v[88:91], a[208:211], v[60:63], v[88:91]
    v_exp_f32 v44, v44
    v_mfma_f32_16x16x32_bf16 v[92:95], a[216:219], v[60:63], v[92:95]
    ds_read_b128 a[156:159], v27 offset:24576
    v_mul_f32 v45, s20, v45
    v_mfma_f32_16x16x32_bf16 v[48:51], a[96:99], a[32:35], 0
    v_mul_f32 v46, s20, v46
    v_mul_f32 v47, s20, v47
    v_mfma_f32_16x16x32_bf16 v[48:51], a[100:103], a[36:39], v[48:51]
    v_exp_f32 v45, v45
    v_mfma_f32_16x16x32_bf16 v[48:51], a[104:107], a[40:43], v[48:51]
    v_cvt_pk_bf16_f32 v56, v40, v41
    v_cvt_pk_bf16_f32 v57, v42, v43
    v_mfma_f32_16x16x32_bf16 v[48:51], a[108:111], a[44:47], v[48:51]
    v_exp_f32 v46, v46
    v_mfma_f32_16x16x32_bf16 v[52:55], a[112:115], a[32:35], 0
    v_exp_f32 v47, v47
    v_mfma_f32_16x16x32_bf16 v[52:55], a[116:119], a[36:39], v[52:55]
    v_cvt_pk_bf16_f32 v58, v44, v45
    v_cvt_pk_bf16_f32 v59, v46, v47
    v_mfma_f32_16x16x32_bf16 v[52:55], a[120:123], a[40:43], v[52:55]
    buffer_load_dwordx4 v18, s[8:11], s22 offen offset:1024 lds
    v_mfma_f32_16x16x32_bf16 v[52:55], a[124:127], a[44:47], v[52:55]
    ds_read_b64_tr_b16 a[164:165], v6 offset:24576
    v_mul_f32 v48, s20, v48
    v_smfmac_f32_16x16x64_bf16 a[224:227], a[242:245], v[56:63], v26
    v_exp_f32 v48, v48
    v_mul_f32 v49, s20, v49
    v_mul_f32 v50, s20, v50
    v_mfma_f32_16x16x32_bf16 v[96:99], a[160:163], v[56:59], v[96:99]
    ds_read_b64_tr_b16 a[166:167], v36 offset:24576
    v_mul_f32 v51, s20, v51
    v_mfma_f32_16x16x32_bf16 v[100:103], a[168:171], v[56:59], v[100:103]
    v_exp_f32 v49, v49
    v_mfma_f32_16x16x32_bf16 v[104:107], a[176:179], v[56:59], v[104:107]
    v_exp_f32 v50, v50
    v_mfma_f32_16x16x32_bf16 v[108:111], a[184:187], v[56:59], v[108:111]
    ds_read_b64_tr_b16 a[172:173], v6 offset:24584
    v_mul_f32 v52, s20, v52
    v_mfma_f32_16x16x32_bf16 v[112:115], a[192:195], v[56:59], v[112:115]
    v_exp_f32 v51, v51
    v_mfma_f32_16x16x32_bf16 v[116:119], a[200:203], v[56:59], v[116:119]
    v_exp_f32 v52, v52
    v_mfma_f32_16x16x32_bf16 v[120:123], a[208:211], v[56:59], v[120:123]
    ds_read_b64_tr_b16 a[174:175], v36 offset:24584
    v_mul_f32 v53, s20, v53
    v_mfma_f32_16x16x32_bf16 v[124:127], a[216:219], v[56:59], v[124:127]
    v_mul_f32 v54, s20, v54
    v_mul_f32 v55, s20, v55
    v_mfma_f32_16x16x32_bf16 v[40:43], a[96:99], a[48:51], 0
    v_exp_f32 v53, v53
    v_mfma_f32_16x16x32_bf16 v[40:43], a[100:103], a[52:55], v[40:43]
    v_cvt_pk_bf16_f32 v60, v48, v49
    v_cvt_pk_bf16_f32 v61, v50, v51
    v_mfma_f32_16x16x32_bf16 v[40:43], a[104:107], a[56:59], v[40:43]
    v_exp_f32 v54, v54
    v_mfma_f32_16x16x32_bf16 v[40:43], a[108:111], a[60:63], v[40:43]
    v_exp_f32 v55, v55
    v_mfma_f32_16x16x32_bf16 v[44:47], a[112:115], a[48:51], 0
    s_add_u32 m0, s35, 49152
    v_cvt_pk_bf16_f32 v62, v52, v53
    v_cvt_pk_bf16_f32 v63, v54, v55
    v_mfma_f32_16x16x32_bf16 v[44:47], a[116:119], a[52:55], v[44:47]
    buffer_load_dwordx4 v19, s[12:15], s22 offen lds
    v_mfma_f32_16x16x32_bf16 v[44:47], a[120:123], a[56:59], v[44:47]
    ds_read_b64_tr_b16 a[180:181], v7 offset:24576
    v_mul_f32 v40, s20, v40
    v_mfma_f32_16x16x32_bf16 v[44:47], a[124:127], a[60:63], v[44:47]
    v_exp_f32 v40, v40

    v_mfma_f32_16x16x32_bf16 v[128:131], a[160:163], v[60:63], v[128:131]
    v_mul_f32 v41, s20, v41
    v_mul_f32 v42, s20, v42
    v_mfma_f32_16x16x32_bf16 v[132:135], a[168:171], v[60:63], v[132:135]
    ds_read_b64_tr_b16 a[182:183], v37 offset:24576
    v_mul_f32 v43, s20, v43
    v_mfma_f32_16x16x32_bf16 v[136:139], a[176:179], v[60:63], v[136:139]
    v_exp_f32 v41, v41
    v_mfma_f32_16x16x32_bf16 v[140:143], a[184:187], v[60:63], v[140:143]
    v_exp_f32 v42, v42
    v_mfma_f32_16x16x32_bf16 v[144:147], a[192:195], v[60:63], v[144:147]
    ds_read_b64_tr_b16 a[188:189], v7 offset:24584
    v_mul_f32 v44, s20, v44
    v_mfma_f32_16x16x32_bf16 v[148:151], a[200:203], v[60:63], v[148:151]
    v_exp_f32 v43, v43
    v_mfma_f32_16x16x32_bf16 v[152:155], a[208:211], v[60:63], v[152:155]
    v_exp_f32 v44, v44
    v_mfma_f32_16x16x32_bf16 v[156:159], a[216:219], v[60:63], v[156:159]
    ds_read_b64_tr_b16 a[190:191], v37 offset:24584
    v_mul_f32 v45, s20, v45
    v_mfma_f32_16x16x32_bf16 v[48:51], a[96:99], a[64:67], 0
    v_mul_f32 v46, s20, v46
    v_mul_f32 v47, s20, v47
    v_mfma_f32_16x16x32_bf16 v[48:51], a[100:103], a[68:71], v[48:51]
    v_exp_f32 v45, v45
    v_mfma_f32_16x16x32_bf16 v[48:51], a[104:107], a[72:75], v[48:51]
    v_cvt_pk_bf16_f32 v56, v40, v41
    v_cvt_pk_bf16_f32 v57, v42, v43
    v_mfma_f32_16x16x32_bf16 v[48:51], a[108:111], a[76:79], v[48:51]
    v_exp_f32 v46, v46
    v_mfma_f32_16x16x32_bf16 v[52:55], a[112:115], a[64:67], 0
    s_add_u32 s28, s24, 4096
    v_exp_f32 v47, v47
    v_mfma_f32_16x16x32_bf16 v[52:55], a[116:119], a[68:71], v[52:55]
    s_add_u32 s32, s31, 4096
    v_cvt_pk_bf16_f32 v58, v44, v45
    v_cvt_pk_bf16_f32 v59, v46, v47
    v_mfma_f32_16x16x32_bf16 v[52:55], a[120:123], a[72:75], v[52:55]
    buffer_load_dwordx4 v19, s[12:15], s22 offen offset:1024 lds
    v_mfma_f32_16x16x32_bf16 v[52:55], a[124:127], a[76:79], v[52:55]
    s_add_u32 m0, s30, 4096
    ds_read_b64_tr_b16 a[196:197], v8 offset:24576
    v_mul_f32 v48, s20, v48
    v_smfmac_f32_16x16x64_bf16 a[228:231], a[242:245], v[56:63], v26
    buffer_store_dwordx4 v[28:31], v14, s[16:19], s32 offen nt
    buffer_load_dwordx4 v14, s[4:7], s28 offen nt lds
    v_exp_f32 v48, v48
    v_mul_f32 v49, s20, v49
    v_mul_f32 v50, s20, v50
    v_mfma_f32_16x16x32_bf16 v[160:163], a[160:163], v[56:59], v[160:163]
    s_xor_b32 s22, s22, 8192
    ds_read_b64_tr_b16 a[198:199], v38 offset:24576
    v_mul_f32 v51, s20, v51
    v_mfma_f32_16x16x32_bf16 v[164:167], a[168:171], v[56:59], v[164:167]
    v_exp_f32 v49, v49
    v_mfma_f32_16x16x32_bf16 v[168:171], a[176:179], v[56:59], v[168:171]
    v_exp_f32 v50, v50
    v_mfma_f32_16x16x32_bf16 v[172:175], a[184:187], v[56:59], v[172:175]
    ds_read_b64_tr_b16 a[204:205], v8 offset:24584
    v_mul_f32 v52, s20, v52
    v_mfma_f32_16x16x32_bf16 v[176:179], a[192:195], v[56:59], v[176:179]
    v_exp_f32 v51, v51
    v_mfma_f32_16x16x32_bf16 v[180:183], a[200:203], v[56:59], v[180:183]
    v_exp_f32 v52, v52
    v_mfma_f32_16x16x32_bf16 v[184:187], a[208:211], v[56:59], v[184:187]
    ds_read_b64_tr_b16 a[206:207], v38 offset:24584
    v_mul_f32 v53, s20, v53
    v_mfma_f32_16x16x32_bf16 v[188:191], a[216:219], v[56:59], v[188:191]
    s_waitcnt lgkmcnt(12)
    v_mul_f32 v54, s20, v54
    v_mul_f32 v55, s20, v55
    v_mfma_f32_16x16x32_bf16 v[40:43], a[112:115], a[80:83], 0
    v_exp_f32 v53, v53
    v_mfma_f32_16x16x32_bf16 v[40:43], a[116:119], a[84:87], v[40:43]
    v_cvt_pk_bf16_f32 v60, v48, v49
    v_cvt_pk_bf16_f32 v61, v50, v51
    v_mfma_f32_16x16x32_bf16 v[40:43], a[120:123], a[88:91], v[40:43]
    v_exp_f32 v54, v54
    v_mfma_f32_16x16x32_bf16 v[40:43], a[124:127], a[92:95], v[40:43]
    v_exp_f32 v55, v55
    v_mfma_f32_16x16x32_bf16 v[44:47], a[128:131], a[80:83], 0
    v_cvt_pk_bf16_f32 v62, v52, v53
    v_cvt_pk_bf16_f32 v63, v54, v55
    v_mfma_f32_16x16x32_bf16 v[44:47], a[132:135], a[84:87], v[44:47]
    ds_read_b128 v[28:31], v24 offset:5120
    v_mfma_f32_16x16x32_bf16 v[44:47], a[136:139], a[88:91], v[44:47]
    ds_read_b64_tr_b16 a[212:213], v9 offset:24576
    v_mul_f32 v40, s20, v40
    v_mfma_f32_16x16x32_bf16 v[44:47], a[140:143], a[92:95], v[44:47]
    v_exp_f32 v40, v40

    v_mfma_f32_16x16x32_bf16 v[192:195], a[160:163], v[60:63], v[192:195]
    v_mul_f32 v41, s20, v41
    v_mul_f32 v42, s20, v42
    v_mfma_f32_16x16x32_bf16 v[196:199], a[168:171], v[60:63], v[196:199]
    ds_read_b64_tr_b16 a[214:215], v39 offset:24576
    v_mul_f32 v43, s20, v43
    v_mfma_f32_16x16x32_bf16 v[200:203], a[176:179], v[60:63], v[200:203]
    v_exp_f32 v41, v41
    v_mfma_f32_16x16x32_bf16 v[204:207], a[184:187], v[60:63], v[204:207]
    v_exp_f32 v42, v42
    v_mfma_f32_16x16x32_bf16 v[208:211], a[192:195], v[60:63], v[208:211]
    ds_read_b64_tr_b16 a[220:221], v9 offset:24584
    v_mul_f32 v44, s20, v44
    v_mfma_f32_16x16x32_bf16 v[212:215], a[200:203], v[60:63], v[212:215]
    v_exp_f32 v43, v43
    v_mfma_f32_16x16x32_bf16 v[216:219], a[208:211], v[60:63], v[216:219]
    v_exp_f32 v44, v44
    v_mfma_f32_16x16x32_bf16 v[220:223], a[216:219], v[60:63], v[220:223]
    ds_read_b64_tr_b16 a[222:223], v39 offset:24584
    v_mul_f32 v45, s20, v45
L_B3:
    v_mfma_f32_16x16x32_bf16 v[48:51], a[128:131], a[0:3], 0
    v_mul_f32 v46, s20, v46
    v_mul_f32 v47, s20, v47
    v_mfma_f32_16x16x32_bf16 v[48:51], a[132:135], a[4:7], v[48:51]
    v_exp_f32 v45, v45
    v_mfma_f32_16x16x32_bf16 v[48:51], a[136:139], a[8:11], v[48:51]
    v_cvt_pk_bf16_f32 v56, v40, v41
    v_cvt_pk_bf16_f32 v57, v42, v43
    v_mfma_f32_16x16x32_bf16 v[48:51], a[140:143], a[12:15], v[48:51]
    v_exp_f32 v46, v46
    v_mfma_f32_16x16x32_bf16 v[52:55], a[144:147], a[0:3], 0
    v_exp_f32 v47, v47
    v_mfma_f32_16x16x32_bf16 v[52:55], a[148:151], a[4:7], v[52:55]
    s_waitcnt vmcnt(14) lgkmcnt(0)
    v_cvt_pk_bf16_f32 v58, v44, v45
    v_cvt_pk_bf16_f32 v59, v46, v47
    v_mfma_f32_16x16x32_bf16 v[52:55], a[152:155], a[8:11], v[52:55]
    s_barrier
    v_mfma_f32_16x16x32_bf16 v[52:55], a[156:159], a[12:15], v[52:55]
    ds_read_b128 a[96:99], v2 offset:0
    v_mul_f32 v48, s20, v48
    v_smfmac_f32_16x16x64_bf16 a[232:235], a[242:245], v[56:63], v26
    ds_read_b128 a[100:103], v3 offset:0
    v_exp_f32 v48, v48
    v_mul_f32 v49, s20, v49
    v_mul_f32 v50, s20, v50
    v_mfma_f32_16x16x32_bf16 v[224:227], a[162:165], v[56:59], v[224:227]
    ds_read_b128 a[104:107], v4 offset:0
    v_mul_f32 v51, s20, v51
    v_mfma_f32_16x16x32_bf16 v[228:231], a[170:173], v[56:59], v[228:231]
    v_exp_f32 v49, v49
    v_mfma_f32_16x16x32_bf16 v[232:235], a[178:181], v[56:59], v[232:235]
    v_exp_f32 v50, v50
    v_mfma_f32_16x16x32_bf16 v[236:239], a[186:189], v[56:59], v[236:239]
    ds_read_b128 a[108:111], v5 offset:0
    v_mul_f32 v52, s20, v52
    v_mfma_f32_16x16x32_bf16 v[240:243], a[194:197], v[56:59], v[240:243]
    v_exp_f32 v51, v51
    v_mfma_f32_16x16x32_bf16 v[244:247], a[202:205], v[56:59], v[244:247]
    v_exp_f32 v52, v52
    v_mfma_f32_16x16x32_bf16 v[248:251], a[210:213], v[56:59], v[248:251]
    ds_read_b128 a[112:115], v0 offset:0
    v_mul_f32 v53, s20, v53
    v_mfma_f32_16x16x32_bf16 v[252:255], a[218:221], v[56:59], v[252:255]
    v_mul_f32 v54, s20, v54
    v_mul_f32 v55, s20, v55
    v_mfma_f32_16x16x32_bf16 v[40:43], a[128:131], a[16:19], 0
    v_exp_f32 v53, v53
    v_mfma_f32_16x16x32_bf16 v[40:43], a[132:135], a[20:23], v[40:43]
    v_cvt_pk_bf16_f32 v60, v48, v49
    v_cvt_pk_bf16_f32 v61, v50, v51
    v_mfma_f32_16x16x32_bf16 v[40:43], a[136:139], a[24:27], v[40:43]
    v_exp_f32 v54, v54
    v_mfma_f32_16x16x32_bf16 v[40:43], a[140:143], a[28:31], v[40:43]
    v_exp_f32 v55, v55
    v_mfma_f32_16x16x32_bf16 v[44:47], a[144:147], a[16:19], 0
    s_add_u32 m0, s35, 24576
    v_cvt_pk_bf16_f32 v62, v52, v53
    v_cvt_pk_bf16_f32 v63, v54, v55
    v_mfma_f32_16x16x32_bf16 v[44:47], a[148:151], a[20:23], v[44:47]
    buffer_load_dwordx4 v18, s[8:11], s22 offen lds
    v_mfma_f32_16x16x32_bf16 v[44:47], a[152:155], a[24:27], v[44:47]
    ds_read_b128 a[116:119], v1 offset:0
    v_mul_f32 v40, s20, v40
    v_mfma_f32_16x16x32_bf16 v[44:47], a[156:159], a[28:31], v[44:47]
    v_exp_f32 v40, v40

    v_mfma_f32_16x16x32_bf16 v[64:67], a[164:167], v[60:63], v[64:67]
    ds_read_b128 a[120:123], v25 offset:0
    v_mul_f32 v41, s20, v41
    v_mul_f32 v42, s20, v42
    v_mfma_f32_16x16x32_bf16 v[68:71], a[172:175], v[60:63], v[68:71]
    ds_read_b128 a[124:127], v27 offset:0
    v_mul_f32 v43, s20, v43
    v_mfma_f32_16x16x32_bf16 v[72:75], a[180:183], v[60:63], v[72:75]
    v_exp_f32 v41, v41
    v_mfma_f32_16x16x32_bf16 v[76:79], a[188:191], v[60:63], v[76:79]
    v_exp_f32 v42, v42
    v_mfma_f32_16x16x32_bf16 v[80:83], a[196:199], v[60:63], v[80:83]
    ds_read_b64_tr_b16 a[160:161], v6 offset:0
    v_mul_f32 v44, s20, v44
    v_mfma_f32_16x16x32_bf16 v[84:87], a[204:207], v[60:63], v[84:87]
    v_exp_f32 v43, v43
    v_mfma_f32_16x16x32_bf16 v[88:91], a[212:215], v[60:63], v[88:91]
    v_exp_f32 v44, v44
    v_mfma_f32_16x16x32_bf16 v[92:95], a[220:223], v[60:63], v[92:95]
    ds_read_b64_tr_b16 a[162:163], v36 offset:0
    v_mul_f32 v45, s20, v45
    v_mfma_f32_16x16x32_bf16 v[48:51], a[128:131], a[32:35], 0
    v_mul_f32 v46, s20, v46
    v_mul_f32 v47, s20, v47
    v_mfma_f32_16x16x32_bf16 v[48:51], a[132:135], a[36:39], v[48:51]
    v_exp_f32 v45, v45
    v_mfma_f32_16x16x32_bf16 v[48:51], a[136:139], a[40:43], v[48:51]
    v_cvt_pk_bf16_f32 v56, v40, v41
    v_cvt_pk_bf16_f32 v57, v42, v43
    v_mfma_f32_16x16x32_bf16 v[48:51], a[140:143], a[44:47], v[48:51]
    v_exp_f32 v46, v46
    v_mfma_f32_16x16x32_bf16 v[52:55], a[144:147], a[32:35], 0
    v_exp_f32 v47, v47
    v_mfma_f32_16x16x32_bf16 v[52:55], a[148:151], a[36:39], v[52:55]
    v_cvt_pk_bf16_f32 v58, v44, v45
    v_cvt_pk_bf16_f32 v59, v46, v47
    v_mfma_f32_16x16x32_bf16 v[52:55], a[152:155], a[40:43], v[52:55]
    buffer_load_dwordx4 v18, s[8:11], s22 offen offset:1024 lds
    v_mfma_f32_16x16x32_bf16 v[52:55], a[156:159], a[44:47], v[52:55]
    ds_read_b64_tr_b16 a[168:169], v6 offset:8
    v_mul_f32 v48, s20, v48
    v_smfmac_f32_16x16x64_bf16 a[224:227], a[242:245], v[56:63], v26
    ds_read_b64_tr_b16 a[170:171], v36 offset:8
    v_exp_f32 v48, v48
    v_mul_f32 v49, s20, v49
    v_mul_f32 v50, s20, v50
    v_mfma_f32_16x16x32_bf16 v[96:99], a[164:167], v[56:59], v[96:99]
    ds_read_b64_tr_b16 a[176:177], v7 offset:0
    v_mul_f32 v51, s20, v51
    v_mfma_f32_16x16x32_bf16 v[100:103], a[172:175], v[56:59], v[100:103]
    v_exp_f32 v49, v49
    v_mfma_f32_16x16x32_bf16 v[104:107], a[180:183], v[56:59], v[104:107]
    v_exp_f32 v50, v50
    v_mfma_f32_16x16x32_bf16 v[108:111], a[188:191], v[56:59], v[108:111]
    ds_read_b64_tr_b16 a[178:179], v37 offset:0
    v_mul_f32 v52, s20, v52
    v_mfma_f32_16x16x32_bf16 v[112:115], a[196:199], v[56:59], v[112:115]
    v_exp_f32 v51, v51
    v_mfma_f32_16x16x32_bf16 v[116:119], a[204:207], v[56:59], v[116:119]
    v_exp_f32 v52, v52
    v_mfma_f32_16x16x32_bf16 v[120:123], a[212:215], v[56:59], v[120:123]
    ds_read_b64_tr_b16 a[184:185], v7 offset:8
    v_mul_f32 v53, s20, v53
    v_mfma_f32_16x16x32_bf16 v[124:127], a[220:223], v[56:59], v[124:127]
    v_mul_f32 v54, s20, v54
    v_mul_f32 v55, s20, v55
    v_mfma_f32_16x16x32_bf16 v[40:43], a[128:131], a[48:51], 0
    v_exp_f32 v53, v53
    v_mfma_f32_16x16x32_bf16 v[40:43], a[132:135], a[52:55], v[40:43]
    v_cvt_pk_bf16_f32 v60, v48, v49
    v_cvt_pk_bf16_f32 v61, v50, v51
    v_mfma_f32_16x16x32_bf16 v[40:43], a[136:139], a[56:59], v[40:43]
    v_exp_f32 v54, v54
    v_mfma_f32_16x16x32_bf16 v[40:43], a[140:143], a[60:63], v[40:43]
    v_exp_f32 v55, v55
    v_mfma_f32_16x16x32_bf16 v[44:47], a[144:147], a[48:51], 0
    s_add_u32 m0, s35, 57344
    v_cvt_pk_bf16_f32 v62, v52, v53
    v_cvt_pk_bf16_f32 v63, v54, v55
    v_mfma_f32_16x16x32_bf16 v[44:47], a[148:151], a[52:55], v[44:47]
    buffer_load_dwordx4 v19, s[12:15], s22 offen lds
    v_mfma_f32_16x16x32_bf16 v[44:47], a[152:155], a[56:59], v[44:47]
    ds_read_b64_tr_b16 a[186:187], v37 offset:8
    v_mul_f32 v40, s20, v40
    v_mfma_f32_16x16x32_bf16 v[44:47], a[156:159], a[60:63], v[44:47]
    v_exp_f32 v40, v40

    s_add_u32 m0, s30, 4096
    v_mfma_f32_16x16x32_bf16 v[128:131], a[164:167], v[60:63], v[128:131]
    buffer_store_dwordx4 v[28:31], v15, s[16:19], s32 offen offset:1024 nt
    buffer_load_dwordx4 v15, s[4:7], s28 offen offset:1024 nt lds
    ds_read_b64_tr_b16 a[192:193], v8 offset:0
    v_mul_f32 v41, s20, v41
    v_mul_f32 v42, s20, v42
    v_mfma_f32_16x16x32_bf16 v[132:135], a[172:175], v[60:63], v[132:135]
    ds_read_b64_tr_b16 a[194:195], v38 offset:0
    v_mul_f32 v43, s20, v43
    v_mfma_f32_16x16x32_bf16 v[136:139], a[180:183], v[60:63], v[136:139]
    v_exp_f32 v41, v41
    v_mfma_f32_16x16x32_bf16 v[140:143], a[188:191], v[60:63], v[140:143]
    v_exp_f32 v42, v42
    v_mfma_f32_16x16x32_bf16 v[144:147], a[196:199], v[60:63], v[144:147]
    ds_read_b64_tr_b16 a[200:201], v8 offset:8
    v_mul_f32 v44, s20, v44
    v_mfma_f32_16x16x32_bf16 v[148:151], a[204:207], v[60:63], v[148:151]
    v_exp_f32 v43, v43
    v_mfma_f32_16x16x32_bf16 v[152:155], a[212:215], v[60:63], v[152:155]
    v_exp_f32 v44, v44
    v_mfma_f32_16x16x32_bf16 v[156:159], a[220:223], v[60:63], v[156:159]
    ds_read_b64_tr_b16 a[202:203], v38 offset:8
    v_mul_f32 v45, s20, v45
    v_mfma_f32_16x16x32_bf16 v[48:51], a[128:131], a[64:67], 0
    v_mul_f32 v46, s20, v46
    v_mul_f32 v47, s20, v47
    v_mfma_f32_16x16x32_bf16 v[48:51], a[132:135], a[68:71], v[48:51]
    v_exp_f32 v45, v45
    v_mfma_f32_16x16x32_bf16 v[48:51], a[136:139], a[72:75], v[48:51]
    v_cvt_pk_bf16_f32 v56, v40, v41
    v_cvt_pk_bf16_f32 v57, v42, v43
    v_mfma_f32_16x16x32_bf16 v[48:51], a[140:143], a[76:79], v[48:51]
    v_exp_f32 v46, v46
    v_mfma_f32_16x16x32_bf16 v[52:55], a[144:147], a[64:67], 0
    v_exp_f32 v47, v47
    v_mfma_f32_16x16x32_bf16 v[52:55], a[148:151], a[68:71], v[52:55]
    s_add_u32 m0, s35, 57344
    v_cvt_pk_bf16_f32 v58, v44, v45
    v_cvt_pk_bf16_f32 v59, v46, v47
    v_mfma_f32_16x16x32_bf16 v[52:55], a[152:155], a[72:75], v[52:55]
    buffer_load_dwordx4 v19, s[12:15], s22 offen offset:1024 lds
    v_mfma_f32_16x16x32_bf16 v[52:55], a[156:159], a[76:79], v[52:55]
    s_xor_b32 s22, s22, 122880
    ds_read_b64_tr_b16 a[208:209], v9 offset:0
    v_mul_f32 v48, s20, v48
    v_smfmac_f32_16x16x64_bf16 a[228:231], a[242:245], v[56:63], v26
    v_exp_f32 v48, v48
    v_mfma_f32_16x16x32_bf16 v[160:163], a[164:167], v[56:59], v[160:163]
    ds_read_b128 v[28:31], v24 offset:6144
    v_mul_f32 v49, s20, v49
    v_mul_f32 v50, s20, v50
    v_mfma_f32_16x16x32_bf16 v[164:167], a[172:175], v[56:59], v[164:167]
    ds_read_b64_tr_b16 a[210:211], v39 offset:0
    v_mul_f32 v51, s20, v51
    v_mfma_f32_16x16x32_bf16 v[168:171], a[180:183], v[56:59], v[168:171]
    v_exp_f32 v49, v49
    v_mfma_f32_16x16x32_bf16 v[172:175], a[188:191], v[56:59], v[172:175]
    v_exp_f32 v50, v50
    v_mfma_f32_16x16x32_bf16 v[176:179], a[196:199], v[56:59], v[176:179]
    ds_read_b64_tr_b16 a[216:217], v9 offset:8
    v_mul_f32 v52, s20, v52
    v_mfma_f32_16x16x32_bf16 v[180:183], a[204:207], v[56:59], v[180:183]
    v_exp_f32 v51, v51
    v_mfma_f32_16x16x32_bf16 v[184:187], a[212:215], v[56:59], v[184:187]
    v_exp_f32 v52, v52
    v_mfma_f32_16x16x32_bf16 v[188:191], a[220:223], v[56:59], v[188:191]
    s_waitcnt lgkmcnt(15)
    ds_read_b64_tr_b16 a[218:219], v39 offset:8
    v_mul_f32 v53, s20, v53
L_B4:
    v_mfma_f32_16x16x32_bf16 v[40:43], a[96:99], a[0:3], 0
    v_mul_f32 v54, s20, v54
    v_mul_f32 v55, s20, v55
    v_mfma_f32_16x16x32_bf16 v[40:43], a[100:103], a[4:7], v[40:43]
    v_exp_f32 v53, v53
    v_mfma_f32_16x16x32_bf16 v[40:43], a[104:107], a[8:11], v[40:43]
    v_cvt_pk_bf16_f32 v60, v48, v49
    v_cvt_pk_bf16_f32 v61, v50, v51
    v_mfma_f32_16x16x32_bf16 v[40:43], a[108:111], a[12:15], v[40:43]
    v_exp_f32 v54, v54
    v_mfma_f32_16x16x32_bf16 v[44:47], a[112:115], a[0:3], 0
    v_exp_f32 v55, v55
    v_mfma_f32_16x16x32_bf16 v[44:47], a[116:119], a[4:7], v[44:47]
    s_waitcnt vmcnt(12) lgkmcnt(0)
    v_cvt_pk_bf16_f32 v62, v52, v53
    v_cvt_pk_bf16_f32 v63, v54, v55
    v_mfma_f32_16x16x32_bf16 v[44:47], a[120:123], a[8:11], v[44:47]
    s_barrier
    v_mfma_f32_16x16x32_bf16 v[44:47], a[124:127], a[12:15], v[44:47]
    ds_read_b128 a[128:131], v2 offset:8192
    v_mul_f32 v40, s20, v40
    v_mfma_f32_16x16x32_bf16 a[232:235], a[248:251], v[60:63], a[232:235]
    v_exp_f32 v40, v40
    v_mul_f32 v41, s20, v41
    v_mul_f32 v42, s20, v42
    v_mfma_f32_16x16x32_bf16 v[192:195], a[164:167], v[60:63], v[192:195]
    ds_read_b128 a[132:135], v3 offset:8192
    v_mul_f32 v43, s20, v43
    v_mfma_f32_16x16x32_bf16 v[196:199], a[172:175], v[60:63], v[196:199]
    v_exp_f32 v41, v41
    v_mfma_f32_16x16x32_bf16 v[200:203], a[180:183], v[60:63], v[200:203]
    v_exp_f32 v42, v42
    v_mfma_f32_16x16x32_bf16 v[204:207], a[188:191], v[60:63], v[204:207]
    ds_read_b128 a[136:139], v4 offset:8192
    v_mul_f32 v44, s20, v44
    v_mfma_f32_16x16x32_bf16 v[208:211], a[196:199], v[60:63], v[208:211]
    v_exp_f32 v43, v43
    v_mfma_f32_16x16x32_bf16 v[212:215], a[204:207], v[60:63], v[212:215]
    v_exp_f32 v44, v44
    v_mfma_f32_16x16x32_bf16 v[216:219], a[212:215], v[60:63], v[216:219]
    ds_read_b128 a[140:143], v5 offset:8192
    v_mul_f32 v45, s20, v45
    v_mfma_f32_16x16x32_bf16 v[220:223], a[220:223], v[60:63], v[220:223]
    v_mul_f32 v46, s20, v46
    v_mul_f32 v47, s20, v47
    v_mfma_f32_16x16x32_bf16 v[48:51], a[96:99], a[16:19], 0
    v_exp_f32 v45, v45
    v_mfma_f32_16x16x32_bf16 v[48:51], a[100:103], a[20:23], v[48:51]
    v_cvt_pk_bf16_f32 v56, v40, v41
    v_cvt_pk_bf16_f32 v57, v42, v43
    v_mfma_f32_16x16x32_bf16 v[48:51], a[104:107], a[24:27], v[48:51]
    v_exp_f32 v46, v46
    v_mfma_f32_16x16x32_bf16 v[48:51], a[108:111], a[28:31], v[48:51]
    v_exp_f32 v47, v47
    v_mfma_f32_16x16x32_bf16 v[52:55], a[112:115], a[16:19], 0
    s_add_u32 m0, s35, 0
    v_cvt_pk_bf16_f32 v58, v44, v45
    v_cvt_pk_bf16_f32 v59, v46, v47
    v_mfma_f32_16x16x32_bf16 v[52:55], a[116:119], a[20:23], v[52:55]
    buffer_load_dwordx4 v18, s[8:11], s22 offen lds
    v_mfma_f32_16x16x32_bf16 v[52:55], a[120:123], a[24:27], v[52:55]
    ds_read_b128 a[144:147], v0 offset:8192
    v_mul_f32 v48, s20, v48
    v_mfma_f32_16x16x32_bf16 v[52:55], a[124:127], a[28:31], v[52:55]
    v_exp_f32 v48, v48

    v_mfma_f32_16x16x32_bf16 v[64:67], a[160:163], v[56:59], v[64:67]
    v_mul_f32 v49, s20, v49
    v_mul_f32 v50, s20, v50
    v_mfma_f32_16x16x32_bf16 v[68:71], a[168:171], v[56:59], v[68:71]
    ds_read_b128 a[148:151], v1 offset:8192
    v_mul_f32 v51, s20, v51
    v_mfma_f32_16x16x32_bf16 v[72:75], a[176:179], v[56:59], v[72:75]
    v_exp_f32 v49, v49
    v_mfma_f32_16x16x32_bf16 v[76:79], a[184:187], v[56:59], v[76:79]
    v_exp_f32 v50, v50
    v_mfma_f32_16x16x32_bf16 v[80:83], a[192:195], v[56:59], v[80:83]
    ds_read_b128 a[152:155], v25 offset:8192
    v_mul_f32 v52, s20, v52
    v_mfma_f32_16x16x32_bf16 v[84:87], a[200:203], v[56:59], v[84:87]
    v_exp_f32 v51, v51
    v_mfma_f32_16x16x32_bf16 v[88:91], a[208:211], v[56:59], v[88:91]
    v_exp_f32 v52, v52
    v_mfma_f32_16x16x32_bf16 v[92:95], a[216:219], v[56:59], v[92:95]
    ds_read_b128 a[156:159], v27 offset:8192
    v_mul_f32 v53, s20, v53
    v_mfma_f32_16x16x32_bf16 v[40:43], a[96:99], a[32:35], 0
    v_mul_f32 v54, s20, v54
    v_mul_f32 v55, s20, v55
    v_mfma_f32_16x16x32_bf16 v[40:43], a[100:103], a[36:39], v[40:43]
    v_exp_f32 v53, v53
    v_mfma_f32_16x16x32_bf16 v[40:43], a[104:107], a[40:43], v[40:43]
    v_cvt_pk_bf16_f32 v60, v48, v49
    v_cvt_pk_bf16_f32 v61, v50, v51
    v_mfma_f32_16x16x32_bf16 v[40:43], a[108:111], a[44:47], v[40:43]
    v_exp_f32 v54, v54
    v_mfma_f32_16x16x32_bf16 v[44:47], a[112:115], a[32:35], 0
    v_exp_f32 v55, v55
    v_mfma_f32_16x16x32_bf16 v[44:47], a[116:119], a[36:39], v[44:47]
    v_cvt_pk_bf16_f32 v62, v52, v53
    v_cvt_pk_bf16_f32 v63, v54, v55
    v_mfma_f32_16x16x32_bf16 v[44:47], a[120:123], a[40:43], v[44:47]
    buffer_load_dwordx4 v18, s[8:11], s22 offen offset:1024 lds
    v_mfma_f32_16x16x32_bf16 v[44:47], a[124:127], a[44:47], v[44:47]
    ds_read_b64_tr_b16 a[164:165], v6 offset:8192
    v_mul_f32 v40, s20, v40
    v_smfmac_f32_16x16x64_bf16 a[224:227], a[238:241], v[56:63], v26
    v_exp_f32 v40, v40
    v_mul_f32 v41, s20, v41
    v_mul_f32 v42, s20, v42
    v_mfma_f32_16x16x32_bf16 v[96:99], a[160:163], v[60:63], v[96:99]
    ds_read_b64_tr_b16 a[166:167], v36 offset:8192
    v_mul_f32 v43, s20, v43
    v_mfma_f32_16x16x32_bf16 v[100:103], a[168:171], v[60:63], v[100:103]
    v_exp_f32 v41, v41
    v_mfma_f32_16x16x32_bf16 v[104:107], a[176:179], v[60:63], v[104:107]
    v_exp_f32 v42, v42
    v_mfma_f32_16x16x32_bf16 v[108:111], a[184:187], v[60:63], v[108:111]
    ds_read_b64_tr_b16 a[172:173], v6 offset:8200
    v_mul_f32 v44, s20, v44
    v_mfma_f32_16x16x32_bf16 v[112:115], a[192:195], v[60:63], v[112:115]
    v_exp_f32 v43, v43
    v_mfma_f32_16x16x32_bf16 v[116:119], a[200:203], v[60:63], v[116:119]
    v_exp_f32 v44, v44
    v_mfma_f32_16x16x32_bf16 v[120:123], a[208:211], v[60:63], v[120:123]
    ds_read_b64_tr_b16 a[174:175], v36 offset:8200
    v_mul_f32 v45, s20, v45
    v_mfma_f32_16x16x32_bf16 v[124:127], a[216:219], v[60:63], v[124:127]
    v_mul_f32 v46, s20, v46
    v_mul_f32 v47, s20, v47
    v_mfma_f32_16x16x32_bf16 v[48:51], a[96:99], a[48:51], 0
    v_exp_f32 v45, v45
    v_mfma_f32_16x16x32_bf16 v[48:51], a[100:103], a[52:55], v[48:51]
    v_cvt_pk_bf16_f32 v56, v40, v41
    v_cvt_pk_bf16_f32 v57, v42, v43
    v_mfma_f32_16x16x32_bf16 v[48:51], a[104:107], a[56:59], v[48:51]
    v_exp_f32 v46, v46
    v_mfma_f32_16x16x32_bf16 v[48:51], a[108:111], a[60:63], v[48:51]
    v_exp_f32 v47, v47
    v_mfma_f32_16x16x32_bf16 v[52:55], a[112:115], a[48:51], 0
    s_add_u32 m0, s35, 32768
    v_cvt_pk_bf16_f32 v58, v44, v45
    v_cvt_pk_bf16_f32 v59, v46, v47
    v_mfma_f32_16x16x32_bf16 v[52:55], a[116:119], a[52:55], v[52:55]
    buffer_load_dwordx4 v19, s[12:15], s22 offen lds
    v_mfma_f32_16x16x32_bf16 v[52:55], a[120:123], a[56:59], v[52:55]
    ds_read_b64_tr_b16 a[180:181], v7 offset:8192
    v_mul_f32 v48, s20, v48
    v_mfma_f32_16x16x32_bf16 v[52:55], a[124:127], a[60:63], v[52:55]
    v_exp_f32 v48, v48

    v_mfma_f32_16x16x32_bf16 v[128:131], a[160:163], v[56:59], v[128:131]
    v_mul_f32 v49, s20, v49
    v_mul_f32 v50, s20, v50
    v_mfma_f32_16x16x32_bf16 v[132:135], a[168:171], v[56:59], v[132:135]
    ds_read_b64_tr_b16 a[182:183], v37 offset:8192
    v_mul_f32 v51, s20, v51
    v_mfma_f32_16x16x32_bf16 v[136:139], a[176:179], v[56:59], v[136:139]
    v_exp_f32 v49, v49
    v_mfma_f32_16x16x32_bf16 v[140:143], a[184:187], v[56:59], v[140:143]
    v_exp_f32 v50, v50
    v_mfma_f32_16x16x32_bf16 v[144:147], a[192:195], v[56:59], v[144:147]
    ds_read_b64_tr_b16 a[188:189], v7 offset:8200
    v_mul_f32 v52, s20, v52
    v_mfma_f32_16x16x32_bf16 v[148:151], a[200:203], v[56:59], v[148:151]
    v_exp_f32 v51, v51
    v_mfma_f32_16x16x32_bf16 v[152:155], a[208:211], v[56:59], v[152:155]
    v_exp_f32 v52, v52
    v_mfma_f32_16x16x32_bf16 v[156:159], a[216:219], v[56:59], v[156:159]
    ds_read_b64_tr_b16 a[190:191], v37 offset:8200
    v_mul_f32 v53, s20, v53
    v_mfma_f32_16x16x32_bf16 v[40:43], a[96:99], a[64:67], 0
    v_mul_f32 v54, s20, v54
    v_mul_f32 v55, s20, v55
    v_mfma_f32_16x16x32_bf16 v[40:43], a[100:103], a[68:71], v[40:43]
    v_exp_f32 v53, v53
    v_mfma_f32_16x16x32_bf16 v[40:43], a[104:107], a[72:75], v[40:43]
    v_cvt_pk_bf16_f32 v60, v48, v49
    v_cvt_pk_bf16_f32 v61, v50, v51
    v_mfma_f32_16x16x32_bf16 v[40:43], a[108:111], a[76:79], v[40:43]
    v_exp_f32 v54, v54
    v_mfma_f32_16x16x32_bf16 v[44:47], a[112:115], a[64:67], 0
    v_exp_f32 v55, v55
    v_mfma_f32_16x16x32_bf16 v[44:47], a[116:119], a[68:71], v[44:47]
    v_cvt_pk_bf16_f32 v62, v52, v53
    v_cvt_pk_bf16_f32 v63, v54, v55
    v_mfma_f32_16x16x32_bf16 v[44:47], a[120:123], a[72:75], v[44:47]
    buffer_load_dwordx4 v19, s[12:15], s22 offen offset:1024 lds
    v_mfma_f32_16x16x32_bf16 v[44:47], a[124:127], a[76:79], v[44:47]
    s_add_u32 m0, s30, 4096
    ds_read_b64_tr_b16 a[196:197], v8 offset:8192
    v_mul_f32 v40, s20, v40
    v_smfmac_f32_16x16x64_bf16 a[228:231], a[238:241], v[56:63], v26
    buffer_store_dwordx4 v[28:31], v16, s[16:19], s32 offen offset:2048 nt
    buffer_load_dwordx4 v16, s[4:7], s28 offen offset:2048 nt lds
    v_exp_f32 v40, v40
    v_mul_f32 v41, s20, v41
    v_mul_f32 v42, s20, v42
    v_mfma_f32_16x16x32_bf16 v[160:163], a[160:163], v[60:63], v[160:163]
    s_xor_b32 s22, s22, 8192
    ds_read_b64_tr_b16 a[198:199], v38 offset:8192
    v_mul_f32 v43, s20, v43
    v_mfma_f32_16x16x32_bf16 v[164:167], a[168:171], v[60:63], v[164:167]
    v_exp_f32 v41, v41
    v_mfma_f32_16x16x32_bf16 v[168:171], a[176:179], v[60:63], v[168:171]
    v_exp_f32 v42, v42
    v_mfma_f32_16x16x32_bf16 v[172:175], a[184:187], v[60:63], v[172:175]
    ds_read_b64_tr_b16 a[204:205], v8 offset:8200
    v_mul_f32 v44, s20, v44
    v_mfma_f32_16x16x32_bf16 v[176:179], a[192:195], v[60:63], v[176:179]
    v_exp_f32 v43, v43
    v_mfma_f32_16x16x32_bf16 v[180:183], a[200:203], v[60:63], v[180:183]
    v_exp_f32 v44, v44
    v_mfma_f32_16x16x32_bf16 v[184:187], a[208:211], v[60:63], v[184:187]
    ds_read_b64_tr_b16 a[206:207], v38 offset:8200
    v_mul_f32 v45, s20, v45
    v_mfma_f32_16x16x32_bf16 v[188:191], a[216:219], v[60:63], v[188:191]
    s_waitcnt lgkmcnt(12)
    v_mul_f32 v46, s20, v46
    v_mul_f32 v47, s20, v47
    v_mfma_f32_16x16x32_bf16 v[48:51], a[112:115], a[80:83], 0
    v_exp_f32 v45, v45
    v_mfma_f32_16x16x32_bf16 v[48:51], a[116:119], a[84:87], v[48:51]
    v_cvt_pk_bf16_f32 v56, v40, v41
    v_cvt_pk_bf16_f32 v57, v42, v43
    v_mfma_f32_16x16x32_bf16 v[48:51], a[120:123], a[88:91], v[48:51]
    v_exp_f32 v46, v46
    v_mfma_f32_16x16x32_bf16 v[48:51], a[124:127], a[92:95], v[48:51]
    v_exp_f32 v47, v47
    v_mfma_f32_16x16x32_bf16 v[52:55], a[128:131], a[80:83], 0
    v_cvt_pk_bf16_f32 v58, v44, v45
    v_cvt_pk_bf16_f32 v59, v46, v47
    v_mfma_f32_16x16x32_bf16 v[52:55], a[132:135], a[84:87], v[52:55]
    ds_read_b128 v[28:31], v24 offset:7168
    ds_read_b128 v[32:35], v24 offset:8192
    v_mfma_f32_16x16x32_bf16 v[52:55], a[136:139], a[88:91], v[52:55]
    ds_read_b64_tr_b16 a[212:213], v9 offset:8192
    v_mul_f32 v48, s20, v48
    v_mfma_f32_16x16x32_bf16 v[52:55], a[140:143], a[92:95], v[52:55]
    v_exp_f32 v48, v48

    v_mfma_f32_16x16x32_bf16 v[192:195], a[160:163], v[56:59], v[192:195]
    v_mul_f32 v49, s20, v49
    v_mul_f32 v50, s20, v50
    v_mfma_f32_16x16x32_bf16 v[196:199], a[168:171], v[56:59], v[196:199]
    ds_read_b64_tr_b16 a[214:215], v39 offset:8192
    v_mul_f32 v51, s20, v51
    v_mfma_f32_16x16x32_bf16 v[200:203], a[176:179], v[56:59], v[200:203]
    v_exp_f32 v49, v49
    v_mfma_f32_16x16x32_bf16 v[204:207], a[184:187], v[56:59], v[204:207]
    v_exp_f32 v50, v50
    v_mfma_f32_16x16x32_bf16 v[208:211], a[192:195], v[56:59], v[208:211]
    ds_read_b64_tr_b16 a[220:221], v9 offset:8200
    v_mul_f32 v52, s20, v52
    v_mfma_f32_16x16x32_bf16 v[212:215], a[200:203], v[56:59], v[212:215]
    v_exp_f32 v51, v51
    v_mfma_f32_16x16x32_bf16 v[216:219], a[208:211], v[56:59], v[216:219]
    v_exp_f32 v52, v52
    v_mfma_f32_16x16x32_bf16 v[220:223], a[216:219], v[56:59], v[220:223]
    ds_read_b64_tr_b16 a[222:223], v39 offset:8200
    v_mul_f32 v53, s20, v53
L_B5:
    v_mfma_f32_16x16x32_bf16 v[40:43], a[128:131], a[0:3], 0
    v_mul_f32 v54, s20, v54
    v_mul_f32 v55, s20, v55
    v_mfma_f32_16x16x32_bf16 v[40:43], a[132:135], a[4:7], v[40:43]
    v_exp_f32 v53, v53
    v_mfma_f32_16x16x32_bf16 v[40:43], a[136:139], a[8:11], v[40:43]
    v_cvt_pk_bf16_f32 v60, v48, v49
    v_cvt_pk_bf16_f32 v61, v50, v51
    v_mfma_f32_16x16x32_bf16 v[40:43], a[140:143], a[12:15], v[40:43]
    v_exp_f32 v54, v54
    v_mfma_f32_16x16x32_bf16 v[44:47], a[144:147], a[0:3], 0
    v_exp_f32 v55, v55
    v_mfma_f32_16x16x32_bf16 v[44:47], a[148:151], a[4:7], v[44:47]
    s_waitcnt vmcnt(14) lgkmcnt(0)
    v_cvt_pk_bf16_f32 v62, v52, v53
    v_cvt_pk_bf16_f32 v63, v54, v55
    v_mfma_f32_16x16x32_bf16 v[44:47], a[152:155], a[8:11], v[44:47]
    s_barrier
    v_mfma_f32_16x16x32_bf16 v[44:47], a[156:159], a[12:15], v[44:47]
    ds_read_b128 a[96:99], v2 offset:16384
    v_mul_f32 v40, s20, v40
    v_smfmac_f32_16x16x64_bf16 a[232:235], a[238:241], v[56:63], v26
    ds_read_b128 a[100:103], v3 offset:16384
    v_exp_f32 v40, v40
    v_mul_f32 v41, s20, v41
    v_mul_f32 v42, s20, v42
    v_mfma_f32_16x16x32_bf16 v[224:227], a[162:165], v[60:63], v[224:227]
    ds_read_b128 a[104:107], v4 offset:16384
    v_mul_f32 v43, s20, v43
    v_mfma_f32_16x16x32_bf16 v[228:231], a[170:173], v[60:63], v[228:231]
    v_exp_f32 v41, v41
    v_mfma_f32_16x16x32_bf16 v[232:235], a[178:181], v[60:63], v[232:235]
    v_exp_f32 v42, v42
    v_mfma_f32_16x16x32_bf16 v[236:239], a[186:189], v[60:63], v[236:239]
    ds_read_b128 a[108:111], v5 offset:16384
    v_mul_f32 v44, s20, v44
    v_mfma_f32_16x16x32_bf16 v[240:243], a[194:197], v[60:63], v[240:243]
    v_exp_f32 v43, v43
    v_mfma_f32_16x16x32_bf16 v[244:247], a[202:205], v[60:63], v[244:247]
    v_exp_f32 v44, v44
    v_mfma_f32_16x16x32_bf16 v[248:251], a[210:213], v[60:63], v[248:251]
    ds_read_b128 a[112:115], v0 offset:16384
    v_mul_f32 v45, s20, v45
    v_mfma_f32_16x16x32_bf16 v[252:255], a[218:221], v[60:63], v[252:255]
    v_mul_f32 v46, s20, v46
    v_mul_f32 v47, s20, v47
    v_mfma_f32_16x16x32_bf16 v[48:51], a[128:131], a[16:19], 0
    v_exp_f32 v45, v45
    v_mfma_f32_16x16x32_bf16 v[48:51], a[132:135], a[20:23], v[48:51]
    v_cvt_pk_bf16_f32 v56, v40, v41
    v_cvt_pk_bf16_f32 v57, v42, v43
    v_mfma_f32_16x16x32_bf16 v[48:51], a[136:139], a[24:27], v[48:51]
    v_exp_f32 v46, v46
    v_mfma_f32_16x16x32_bf16 v[48:51], a[140:143], a[28:31], v[48:51]
    v_exp_f32 v47, v47
    v_mfma_f32_16x16x32_bf16 v[52:55], a[144:147], a[16:19], 0
    s_add_u32 m0, s35, 8192
    v_cvt_pk_bf16_f32 v58, v44, v45
    v_cvt_pk_bf16_f32 v59, v46, v47
    v_mfma_f32_16x16x32_bf16 v[52:55], a[148:151], a[20:23], v[52:55]
    buffer_load_dwordx4 v18, s[8:11], s22 offen lds
    v_mfma_f32_16x16x32_bf16 v[52:55], a[152:155], a[24:27], v[52:55]
    ds_read_b128 a[116:119], v1 offset:16384
    v_mul_f32 v48, s20, v48
    v_mfma_f32_16x16x32_bf16 v[52:55], a[156:159], a[28:31], v[52:55]
    v_exp_f32 v48, v48

    v_mfma_f32_16x16x32_bf16 v[64:67], a[164:167], v[56:59], v[64:67]
    ds_read_b128 a[120:123], v25 offset:16384
    v_mul_f32 v49, s20, v49
    v_mul_f32 v50, s20, v50
    v_mfma_f32_16x16x32_bf16 v[68:71], a[172:175], v[56:59], v[68:71]
    ds_read_b128 a[124:127], v27 offset:16384
    v_mul_f32 v51, s20, v51
    v_mfma_f32_16x16x32_bf16 v[72:75], a[180:183], v[56:59], v[72:75]
    v_exp_f32 v49, v49
    v_mfma_f32_16x16x32_bf16 v[76:79], a[188:191], v[56:59], v[76:79]
    v_exp_f32 v50, v50
    v_mfma_f32_16x16x32_bf16 v[80:83], a[196:199], v[56:59], v[80:83]
    ds_read_b64_tr_b16 a[160:161], v6 offset:16384
    v_mul_f32 v52, s20, v52
    v_mfma_f32_16x16x32_bf16 v[84:87], a[204:207], v[56:59], v[84:87]
    v_exp_f32 v51, v51
    v_mfma_f32_16x16x32_bf16 v[88:91], a[212:215], v[56:59], v[88:91]
    v_exp_f32 v52, v52
    v_mfma_f32_16x16x32_bf16 v[92:95], a[220:223], v[56:59], v[92:95]
    ds_read_b64_tr_b16 a[162:163], v36 offset:16384
    v_mul_f32 v53, s20, v53
    v_mfma_f32_16x16x32_bf16 v[40:43], a[128:131], a[32:35], 0
    v_mul_f32 v54, s20, v54
    v_mul_f32 v55, s20, v55
    v_mfma_f32_16x16x32_bf16 v[40:43], a[132:135], a[36:39], v[40:43]
    v_exp_f32 v53, v53
    v_mfma_f32_16x16x32_bf16 v[40:43], a[136:139], a[40:43], v[40:43]
    v_cvt_pk_bf16_f32 v60, v48, v49
    v_cvt_pk_bf16_f32 v61, v50, v51
    v_mfma_f32_16x16x32_bf16 v[40:43], a[140:143], a[44:47], v[40:43]
    v_exp_f32 v54, v54
    v_mfma_f32_16x16x32_bf16 v[44:47], a[144:147], a[32:35], 0
    v_exp_f32 v55, v55
    v_mfma_f32_16x16x32_bf16 v[44:47], a[148:151], a[36:39], v[44:47]
    v_cvt_pk_bf16_f32 v62, v52, v53
    v_cvt_pk_bf16_f32 v63, v54, v55
    v_mfma_f32_16x16x32_bf16 v[44:47], a[152:155], a[40:43], v[44:47]
    buffer_load_dwordx4 v18, s[8:11], s22 offen offset:1024 lds
    v_mfma_f32_16x16x32_bf16 v[44:47], a[156:159], a[44:47], v[44:47]
    ds_read_b64_tr_b16 a[168:169], v6 offset:16392
    v_mul_f32 v40, s20, v40
    v_smfmac_f32_16x16x64_bf16 a[224:227], a[238:241], v[56:63], v26
    ds_read_b64_tr_b16 a[170:171], v36 offset:16392
    v_exp_f32 v40, v40
    v_mul_f32 v41, s20, v41
    v_mul_f32 v42, s20, v42
    v_mfma_f32_16x16x32_bf16 v[96:99], a[164:167], v[60:63], v[96:99]
    ds_read_b64_tr_b16 a[176:177], v7 offset:16384
    v_mul_f32 v43, s20, v43
    v_mfma_f32_16x16x32_bf16 v[100:103], a[172:175], v[60:63], v[100:103]
    v_exp_f32 v41, v41
    v_mfma_f32_16x16x32_bf16 v[104:107], a[180:183], v[60:63], v[104:107]
    v_exp_f32 v42, v42
    v_mfma_f32_16x16x32_bf16 v[108:111], a[188:191], v[60:63], v[108:111]
    ds_read_b64_tr_b16 a[178:179], v37 offset:16384
    v_mul_f32 v44, s20, v44
    v_mfma_f32_16x16x32_bf16 v[112:115], a[196:199], v[60:63], v[112:115]
    v_exp_f32 v43, v43
    v_mfma_f32_16x16x32_bf16 v[116:119], a[204:207], v[60:63], v[116:119]
    v_exp_f32 v44, v44
    v_mfma_f32_16x16x32_bf16 v[120:123], a[212:215], v[60:63], v[120:123]
    ds_read_b64_tr_b16 a[184:185], v7 offset:16392
    v_mul_f32 v45, s20, v45
    v_mfma_f32_16x16x32_bf16 v[124:127], a[220:223], v[60:63], v[124:127]
    v_mul_f32 v46, s20, v46
    v_mul_f32 v47, s20, v47
    v_mfma_f32_16x16x32_bf16 v[48:51], a[128:131], a[48:51], 0
    v_exp_f32 v45, v45
    v_mfma_f32_16x16x32_bf16 v[48:51], a[132:135], a[52:55], v[48:51]
    v_cvt_pk_bf16_f32 v56, v40, v41
    v_cvt_pk_bf16_f32 v57, v42, v43
    v_mfma_f32_16x16x32_bf16 v[48:51], a[136:139], a[56:59], v[48:51]
    v_exp_f32 v46, v46
    v_mfma_f32_16x16x32_bf16 v[48:51], a[140:143], a[60:63], v[48:51]
    v_exp_f32 v47, v47
    v_mfma_f32_16x16x32_bf16 v[52:55], a[144:147], a[48:51], 0
    s_add_u32 m0, s35, 40960
    v_cvt_pk_bf16_f32 v58, v44, v45
    v_cvt_pk_bf16_f32 v59, v46, v47
    v_mfma_f32_16x16x32_bf16 v[52:55], a[148:151], a[52:55], v[52:55]
    buffer_load_dwordx4 v19, s[12:15], s22 offen lds
    v_mfma_f32_16x16x32_bf16 v[52:55], a[152:155], a[56:59], v[52:55]
    ds_read_b64_tr_b16 a[186:187], v37 offset:16392
    v_mul_f32 v48, s20, v48
    v_mfma_f32_16x16x32_bf16 v[52:55], a[156:159], a[60:63], v[52:55]
    v_exp_f32 v48, v48

    s_add_u32 m0, s30, 4096
    v_mfma_f32_16x16x32_bf16 v[128:131], a[164:167], v[56:59], v[128:131]
    buffer_store_dwordx4 v[28:31], v17, s[16:19], s32 offen offset:3072 nt
    buffer_load_dwordx4 v17, s[4:7], s28 offen offset:3072 nt lds
    ds_read_b64_tr_b16 a[192:193], v8 offset:16384
    v_mul_f32 v49, s20, v49
    v_mul_f32 v50, s20, v50
    v_mfma_f32_16x16x32_bf16 v[132:135], a[172:175], v[56:59], v[132:135]
    ds_read_b64_tr_b16 a[194:195], v38 offset:16384
    v_mul_f32 v51, s20, v51
    v_mfma_f32_16x16x32_bf16 v[136:139], a[180:183], v[56:59], v[136:139]
    v_exp_f32 v49, v49
    v_mfma_f32_16x16x32_bf16 v[140:143], a[188:191], v[56:59], v[140:143]
    v_exp_f32 v50, v50
    v_mfma_f32_16x16x32_bf16 v[144:147], a[196:199], v[56:59], v[144:147]
    ds_read_b64_tr_b16 a[200:201], v8 offset:16392
    v_mul_f32 v52, s20, v52
    v_mfma_f32_16x16x32_bf16 v[148:151], a[204:207], v[56:59], v[148:151]
    v_exp_f32 v51, v51
    v_mfma_f32_16x16x32_bf16 v[152:155], a[212:215], v[56:59], v[152:155]
    v_exp_f32 v52, v52
    v_mfma_f32_16x16x32_bf16 v[156:159], a[220:223], v[56:59], v[156:159]
    s_add_u32 m0, s30, 8192
    ds_read_b64_tr_b16 a[202:203], v38 offset:16392
    v_mul_f32 v53, s20, v53
    v_mfma_f32_16x16x32_bf16 v[40:43], a[128:131], a[64:67], 0
    s_add_u32 s28, s24, 8192
    v_mul_f32 v54, s20, v54
    v_mul_f32 v55, s20, v55
    v_mfma_f32_16x16x32_bf16 v[40:43], a[132:135], a[68:71], v[40:43]
    s_add_u32 s32, s31, 8192
    v_exp_f32 v53, v53
    v_mfma_f32_16x16x32_bf16 v[40:43], a[136:139], a[72:75], v[40:43]
    buffer_store_dwordx4 v[32:35], v14, s[16:19], s32 offen nt
    buffer_load_dwordx4 v14, s[4:7], s28 offen nt lds
    v_cvt_pk_bf16_f32 v60, v48, v49
    v_cvt_pk_bf16_f32 v61, v50, v51
    v_mfma_f32_16x16x32_bf16 v[40:43], a[140:143], a[76:79], v[40:43]
    v_exp_f32 v54, v54
    v_mfma_f32_16x16x32_bf16 v[44:47], a[144:147], a[64:67], 0
    v_exp_f32 v55, v55
    v_mfma_f32_16x16x32_bf16 v[44:47], a[148:151], a[68:71], v[44:47]
    s_add_u32 m0, s35, 40960
    v_cvt_pk_bf16_f32 v62, v52, v53
    v_cvt_pk_bf16_f32 v63, v54, v55
    v_mfma_f32_16x16x32_bf16 v[44:47], a[152:155], a[72:75], v[44:47]
    buffer_load_dwordx4 v19, s[12:15], s22 offen offset:1024 lds
    v_mfma_f32_16x16x32_bf16 v[44:47], a[156:159], a[76:79], v[44:47]
    s_xor_b32 s22, s22, 24576
    ds_read_b64_tr_b16 a[208:209], v9 offset:16384
    v_mul_f32 v40, s20, v40
    v_smfmac_f32_16x16x64_bf16 a[228:231], a[238:241], v[56:63], v26
    v_exp_f32 v40, v40
    v_mfma_f32_16x16x32_bf16 v[160:163], a[164:167], v[60:63], v[160:163]
    ds_read_b128 v[28:31], v24 offset:9216
    v_mul_f32 v41, s20, v41
    v_mul_f32 v42, s20, v42
    v_mfma_f32_16x16x32_bf16 v[164:167], a[172:175], v[60:63], v[164:167]
    ds_read_b64_tr_b16 a[210:211], v39 offset:16384
    v_mul_f32 v43, s20, v43
    v_mfma_f32_16x16x32_bf16 v[168:171], a[180:183], v[60:63], v[168:171]
    v_exp_f32 v41, v41
    v_mfma_f32_16x16x32_bf16 v[172:175], a[188:191], v[60:63], v[172:175]
    v_exp_f32 v42, v42
    v_mfma_f32_16x16x32_bf16 v[176:179], a[196:199], v[60:63], v[176:179]
    ds_read_b64_tr_b16 a[216:217], v9 offset:16392
    v_mul_f32 v44, s20, v44
    v_mfma_f32_16x16x32_bf16 v[180:183], a[204:207], v[60:63], v[180:183]
    v_exp_f32 v43, v43
    v_mfma_f32_16x16x32_bf16 v[184:187], a[212:215], v[60:63], v[184:187]
    v_exp_f32 v44, v44
    v_mfma_f32_16x16x32_bf16 v[188:191], a[220:223], v[60:63], v[188:191]
    s_waitcnt lgkmcnt(15)
    ds_read_b64_tr_b16 a[218:219], v39 offset:16392
    v_mul_f32 v45, s20, v45
L_B6:
    v_mfma_f32_16x16x32_bf16 v[48:51], a[96:99], a[0:3], 0
    v_mul_f32 v46, s20, v46
    v_mul_f32 v47, s20, v47
    v_mfma_f32_16x16x32_bf16 v[48:51], a[100:103], a[4:7], v[48:51]
    v_exp_f32 v45, v45
    v_mfma_f32_16x16x32_bf16 v[48:51], a[104:107], a[8:11], v[48:51]
    v_cvt_pk_bf16_f32 v56, v40, v41
    v_cvt_pk_bf16_f32 v57, v42, v43
    v_mfma_f32_16x16x32_bf16 v[48:51], a[108:111], a[12:15], v[48:51]
    v_exp_f32 v46, v46
    v_mfma_f32_16x16x32_bf16 v[52:55], a[112:115], a[0:3], 0
    v_exp_f32 v47, v47
    v_mfma_f32_16x16x32_bf16 v[52:55], a[116:119], a[4:7], v[52:55]
    s_waitcnt vmcnt(14) lgkmcnt(0)
    v_cvt_pk_bf16_f32 v58, v44, v45
    v_cvt_pk_bf16_f32 v59, v46, v47
    v_mfma_f32_16x16x32_bf16 v[52:55], a[120:123], a[8:11], v[52:55]
    s_barrier
    v_mfma_f32_16x16x32_bf16 v[52:55], a[124:127], a[12:15], v[52:55]
    ds_read_b128 a[128:131], v2 offset:24576
    v_mul_f32 v48, s20, v48
    v_mfma_f32_16x16x32_bf16 a[232:235], a[248:251], v[56:59], a[232:235]
    v_exp_f32 v48, v48
    v_mul_f32 v49, s20, v49
    v_mul_f32 v50, s20, v50
    v_mfma_f32_16x16x32_bf16 v[192:195], a[164:167], v[56:59], v[192:195]
    ds_read_b128 a[132:135], v3 offset:24576
    v_mul_f32 v51, s20, v51
    v_mfma_f32_16x16x32_bf16 v[196:199], a[172:175], v[56:59], v[196:199]
    v_exp_f32 v49, v49
    v_mfma_f32_16x16x32_bf16 v[200:203], a[180:183], v[56:59], v[200:203]
    v_exp_f32 v50, v50
    v_mfma_f32_16x16x32_bf16 v[204:207], a[188:191], v[56:59], v[204:207]
    ds_read_b128 a[136:139], v4 offset:24576
    v_mul_f32 v52, s20, v52
    v_mfma_f32_16x16x32_bf16 v[208:211], a[196:199], v[56:59], v[208:211]
    v_exp_f32 v51, v51
    v_mfma_f32_16x16x32_bf16 v[212:215], a[204:207], v[56:59], v[212:215]
    v_exp_f32 v52, v52
    v_accvgpr_read_b32 v22, a255
    v_mov_b32 v23, s47
    v_mfma_f32_16x16x32_bf16 v[216:219], a[212:215], v[56:59], v[216:219]
    ds_read_b128 a[140:143], v5 offset:24576
    v_mul_f32 v53, s20, v53
    v_mfma_f32_16x16x32_bf16 v[220:223], a[220:223], v[56:59], v[220:223]
    global_load_dword v22, v[22:23], off
    v_mul_f32 v54, s20, v54
    v_mul_f32 v55, s20, v55
    v_mfma_f32_16x16x32_bf16 v[40:43], a[96:99], a[16:19], 0
    v_exp_f32 v53, v53
    v_mfma_f32_16x16x32_bf16 v[40:43], a[100:103], a[20:23], v[40:43]
    v_cvt_pk_bf16_f32 v60, v48, v49
    v_cvt_pk_bf16_f32 v61, v50, v51
    v_mfma_f32_16x16x32_bf16 v[40:43], a[104:107], a[24:27], v[40:43]
    v_exp_f32 v54, v54
    v_mfma_f32_16x16x32_bf16 v[40:43], a[108:111], a[28:31], v[40:43]
    v_exp_f32 v55, v55
    v_mfma_f32_16x16x32_bf16 v[44:47], a[112:115], a[16:19], 0
    s_add_u32 m0, s35, 16384
    v_cvt_pk_bf16_f32 v62, v52, v53
    v_cvt_pk_bf16_f32 v63, v54, v55
    v_mfma_f32_16x16x32_bf16 v[44:47], a[116:119], a[20:23], v[44:47]
    buffer_load_dwordx4 v18, s[8:11], s22 offen lds
    v_mfma_f32_16x16x32_bf16 v[44:47], a[120:123], a[24:27], v[44:47]
    ds_read_b128 a[144:147], v0 offset:24576
    v_mul_f32 v40, s20, v40
    v_mfma_f32_16x16x32_bf16 v[44:47], a[124:127], a[28:31], v[44:47]
    v_exp_f32 v40, v40

    v_mfma_f32_16x16x32_bf16 v[64:67], a[160:163], v[60:63], v[64:67]
    v_mul_f32 v41, s20, v41
    v_mul_f32 v42, s20, v42
    v_mfma_f32_16x16x32_bf16 v[68:71], a[168:171], v[60:63], v[68:71]
    ds_read_b128 a[148:151], v1 offset:24576
    v_mul_f32 v43, s20, v43
    v_mfma_f32_16x16x32_bf16 v[72:75], a[176:179], v[60:63], v[72:75]
    v_exp_f32 v41, v41
    v_mfma_f32_16x16x32_bf16 v[76:79], a[184:187], v[60:63], v[76:79]
    v_exp_f32 v42, v42
    v_mfma_f32_16x16x32_bf16 v[80:83], a[192:195], v[60:63], v[80:83]
    ds_read_b128 a[152:155], v25 offset:24576
    v_mul_f32 v44, s20, v44
    v_mfma_f32_16x16x32_bf16 v[84:87], a[200:203], v[60:63], v[84:87]
    v_exp_f32 v43, v43
    v_mfma_f32_16x16x32_bf16 v[88:91], a[208:211], v[60:63], v[88:91]
    v_exp_f32 v44, v44
    v_mfma_f32_16x16x32_bf16 v[92:95], a[216:219], v[60:63], v[92:95]
    ds_read_b128 a[156:159], v27 offset:24576
    v_mul_f32 v45, s20, v45
    v_mfma_f32_16x16x32_bf16 v[48:51], a[96:99], a[32:35], 0
    v_mul_f32 v46, s20, v46
    v_mul_f32 v47, s20, v47
    v_mfma_f32_16x16x32_bf16 v[48:51], a[100:103], a[36:39], v[48:51]
    v_exp_f32 v45, v45
    v_mfma_f32_16x16x32_bf16 v[48:51], a[104:107], a[40:43], v[48:51]
    v_cvt_pk_bf16_f32 v56, v40, v41
    v_cvt_pk_bf16_f32 v57, v42, v43
    v_mfma_f32_16x16x32_bf16 v[48:51], a[108:111], a[44:47], v[48:51]
    v_exp_f32 v46, v46
    v_mfma_f32_16x16x32_bf16 v[52:55], a[112:115], a[32:35], 0
    v_exp_f32 v47, v47
    v_mfma_f32_16x16x32_bf16 v[52:55], a[116:119], a[36:39], v[52:55]
    v_cvt_pk_bf16_f32 v58, v44, v45
    v_cvt_pk_bf16_f32 v59, v46, v47
    v_mfma_f32_16x16x32_bf16 v[52:55], a[120:123], a[40:43], v[52:55]
    buffer_load_dwordx4 v18, s[8:11], s22 offen offset:1024 lds
    v_mfma_f32_16x16x32_bf16 v[52:55], a[124:127], a[44:47], v[52:55]
    ds_read_b64_tr_b16 a[164:165], v6 offset:24576
    v_mul_f32 v48, s20, v48
    v_smfmac_f32_16x16x64_bf16 a[224:227], a[242:245], v[56:63], v26
    v_exp_f32 v48, v48
    v_mul_f32 v49, s20, v49
    v_mul_f32 v50, s20, v50
    v_mfma_f32_16x16x32_bf16 v[96:99], a[160:163], v[56:59], v[96:99]
    ds_read_b64_tr_b16 a[166:167], v36 offset:24576
    v_mul_f32 v51, s20, v51
    v_mfma_f32_16x16x32_bf16 v[100:103], a[168:171], v[56:59], v[100:103]
    v_exp_f32 v49, v49
    v_mfma_f32_16x16x32_bf16 v[104:107], a[176:179], v[56:59], v[104:107]
    v_exp_f32 v50, v50
    v_mfma_f32_16x16x32_bf16 v[108:111], a[184:187], v[56:59], v[108:111]
    ds_read_b64_tr_b16 a[172:173], v6 offset:24584
    v_mul_f32 v52, s20, v52
    v_mfma_f32_16x16x32_bf16 v[112:115], a[192:195], v[56:59], v[112:115]
    v_exp_f32 v51, v51
    v_mfma_f32_16x16x32_bf16 v[116:119], a[200:203], v[56:59], v[116:119]
    v_exp_f32 v52, v52
    v_mfma_f32_16x16x32_bf16 v[120:123], a[208:211], v[56:59], v[120:123]
    ds_read_b64_tr_b16 a[174:175], v36 offset:24584
    v_mul_f32 v53, s20, v53
    v_mfma_f32_16x16x32_bf16 v[124:127], a[216:219], v[56:59], v[124:127]
    v_mul_f32 v54, s20, v54
    v_mul_f32 v55, s20, v55
    v_mfma_f32_16x16x32_bf16 v[40:43], a[96:99], a[48:51], 0
    v_exp_f32 v53, v53
    v_mfma_f32_16x16x32_bf16 v[40:43], a[100:103], a[52:55], v[40:43]
    v_cvt_pk_bf16_f32 v60, v48, v49
    v_cvt_pk_bf16_f32 v61, v50, v51
    v_mfma_f32_16x16x32_bf16 v[40:43], a[104:107], a[56:59], v[40:43]
    v_exp_f32 v54, v54
    v_mfma_f32_16x16x32_bf16 v[40:43], a[108:111], a[60:63], v[40:43]
    v_exp_f32 v55, v55
    v_mfma_f32_16x16x32_bf16 v[44:47], a[112:115], a[48:51], 0
    s_add_u32 m0, s35, 49152
    v_cvt_pk_bf16_f32 v62, v52, v53
    v_cvt_pk_bf16_f32 v63, v54, v55
    v_mfma_f32_16x16x32_bf16 v[44:47], a[116:119], a[52:55], v[44:47]
    buffer_load_dwordx4 v19, s[12:15], s22 offen lds
    v_mfma_f32_16x16x32_bf16 v[44:47], a[120:123], a[56:59], v[44:47]
    ds_read_b64_tr_b16 a[180:181], v7 offset:24576
    v_mul_f32 v40, s20, v40
    v_mfma_f32_16x16x32_bf16 v[44:47], a[124:127], a[60:63], v[44:47]
    v_exp_f32 v40, v40

    v_mfma_f32_16x16x32_bf16 v[128:131], a[160:163], v[60:63], v[128:131]
    v_mul_f32 v41, s20, v41
    v_mul_f32 v42, s20, v42
    v_mfma_f32_16x16x32_bf16 v[132:135], a[168:171], v[60:63], v[132:135]
    ds_read_b64_tr_b16 a[182:183], v37 offset:24576
    v_mul_f32 v43, s20, v43
    v_mfma_f32_16x16x32_bf16 v[136:139], a[176:179], v[60:63], v[136:139]
    v_exp_f32 v41, v41
    v_mfma_f32_16x16x32_bf16 v[140:143], a[184:187], v[60:63], v[140:143]
    v_exp_f32 v42, v42
    v_mfma_f32_16x16x32_bf16 v[144:147], a[192:195], v[60:63], v[144:147]
    ds_read_b64_tr_b16 a[188:189], v7 offset:24584
    v_mul_f32 v44, s20, v44
    v_mfma_f32_16x16x32_bf16 v[148:151], a[200:203], v[60:63], v[148:151]
    v_exp_f32 v43, v43
    v_mfma_f32_16x16x32_bf16 v[152:155], a[208:211], v[60:63], v[152:155]
    v_exp_f32 v44, v44
    v_mfma_f32_16x16x32_bf16 v[156:159], a[216:219], v[60:63], v[156:159]
    ds_read_b64_tr_b16 a[190:191], v37 offset:24584
    v_mul_f32 v45, s20, v45
    v_mfma_f32_16x16x32_bf16 v[48:51], a[96:99], a[64:67], 0
    v_mul_f32 v46, s20, v46
    v_mul_f32 v47, s20, v47
    v_mfma_f32_16x16x32_bf16 v[48:51], a[100:103], a[68:71], v[48:51]
    v_exp_f32 v45, v45
    v_mfma_f32_16x16x32_bf16 v[48:51], a[104:107], a[72:75], v[48:51]
    v_cvt_pk_bf16_f32 v56, v40, v41
    v_cvt_pk_bf16_f32 v57, v42, v43
    v_mfma_f32_16x16x32_bf16 v[48:51], a[108:111], a[76:79], v[48:51]
    v_exp_f32 v46, v46
    v_mfma_f32_16x16x32_bf16 v[52:55], a[112:115], a[64:67], 0
    v_exp_f32 v47, v47
    v_mfma_f32_16x16x32_bf16 v[52:55], a[116:119], a[68:71], v[52:55]
    v_cvt_pk_bf16_f32 v58, v44, v45
    v_cvt_pk_bf16_f32 v59, v46, v47
    v_mfma_f32_16x16x32_bf16 v[52:55], a[120:123], a[72:75], v[52:55]
    buffer_load_dwordx4 v19, s[12:15], s22 offen offset:1024 lds
    v_mfma_f32_16x16x32_bf16 v[52:55], a[124:127], a[76:79], v[52:55]
    s_add_u32 m0, s30, 8192
    ds_read_b64_tr_b16 a[196:197], v8 offset:24576
    v_mul_f32 v48, s20, v48
    v_smfmac_f32_16x16x64_bf16 a[228:231], a[242:245], v[56:63], v26
    buffer_store_dwordx4 v[28:31], v15, s[16:19], s32 offen offset:1024 nt
    buffer_load_dwordx4 v15, s[4:7], s28 offen offset:1024 nt lds
    v_exp_f32 v48, v48
    v_mul_f32 v49, s20, v49
    v_mul_f32 v50, s20, v50
    v_mfma_f32_16x16x32_bf16 v[160:163], a[160:163], v[56:59], v[160:163]
    s_xor_b32 s22, s22, 8192
    ds_read_b64_tr_b16 a[198:199], v38 offset:24576
    v_mul_f32 v51, s20, v51
    v_mfma_f32_16x16x32_bf16 v[164:167], a[168:171], v[56:59], v[164:167]
    v_exp_f32 v49, v49
    v_mfma_f32_16x16x32_bf16 v[168:171], a[176:179], v[56:59], v[168:171]
    v_exp_f32 v50, v50
    v_mfma_f32_16x16x32_bf16 v[172:175], a[184:187], v[56:59], v[172:175]
    ds_read_b64_tr_b16 a[204:205], v8 offset:24584
    v_mul_f32 v52, s20, v52
    v_mfma_f32_16x16x32_bf16 v[176:179], a[192:195], v[56:59], v[176:179]
    v_exp_f32 v51, v51
    v_mfma_f32_16x16x32_bf16 v[180:183], a[200:203], v[56:59], v[180:183]
    v_exp_f32 v52, v52
    v_mfma_f32_16x16x32_bf16 v[184:187], a[208:211], v[56:59], v[184:187]
    ds_read_b64_tr_b16 a[206:207], v38 offset:24584
    v_mul_f32 v53, s20, v53
    v_mfma_f32_16x16x32_bf16 v[188:191], a[216:219], v[56:59], v[188:191]
    s_waitcnt lgkmcnt(12)
    v_mul_f32 v54, s20, v54
    v_mul_f32 v55, s20, v55
    v_mfma_f32_16x16x32_bf16 v[40:43], a[112:115], a[80:83], 0
    v_exp_f32 v53, v53
    v_mfma_f32_16x16x32_bf16 v[40:43], a[116:119], a[84:87], v[40:43]
    v_cvt_pk_bf16_f32 v60, v48, v49
    v_cvt_pk_bf16_f32 v61, v50, v51
    v_mfma_f32_16x16x32_bf16 v[40:43], a[120:123], a[88:91], v[40:43]
    v_exp_f32 v54, v54
    v_mfma_f32_16x16x32_bf16 v[40:43], a[124:127], a[92:95], v[40:43]
    v_exp_f32 v55, v55
    v_mfma_f32_16x16x32_bf16 v[44:47], a[128:131], a[80:83], 0
    v_cvt_pk_bf16_f32 v62, v52, v53
    v_cvt_pk_bf16_f32 v63, v54, v55
    v_mfma_f32_16x16x32_bf16 v[44:47], a[132:135], a[84:87], v[44:47]
    ds_read_b128 v[28:31], v24 offset:10240
    ds_read_b128 v[32:35], v24 offset:11264
    v_mfma_f32_16x16x32_bf16 v[44:47], a[136:139], a[88:91], v[44:47]
    ds_read_b64_tr_b16 a[212:213], v9 offset:24576
    v_mul_f32 v40, s20, v40
    v_mfma_f32_16x16x32_bf16 v[44:47], a[140:143], a[92:95], v[44:47]
    v_exp_f32 v40, v40

    v_mfma_f32_16x16x32_bf16 v[192:195], a[160:163], v[60:63], v[192:195]
    v_mul_f32 v41, s20, v41
    v_mul_f32 v42, s20, v42
    v_mfma_f32_16x16x32_bf16 v[196:199], a[168:171], v[60:63], v[196:199]
    ds_read_b64_tr_b16 a[214:215], v39 offset:24576
    v_mul_f32 v43, s20, v43
    v_mfma_f32_16x16x32_bf16 v[200:203], a[176:179], v[60:63], v[200:203]
    v_exp_f32 v41, v41
    v_mfma_f32_16x16x32_bf16 v[204:207], a[184:187], v[60:63], v[204:207]
    v_exp_f32 v42, v42
    v_mfma_f32_16x16x32_bf16 v[208:211], a[192:195], v[60:63], v[208:211]
    ds_read_b64_tr_b16 a[220:221], v9 offset:24584
    v_mul_f32 v44, s20, v44
    v_mfma_f32_16x16x32_bf16 v[212:215], a[200:203], v[60:63], v[212:215]
    v_exp_f32 v43, v43
    v_mfma_f32_16x16x32_bf16 v[216:219], a[208:211], v[60:63], v[216:219]
    v_exp_f32 v44, v44
    v_mfma_f32_16x16x32_bf16 v[220:223], a[216:219], v[60:63], v[220:223]
    ds_read_b64_tr_b16 a[222:223], v39 offset:24584
    v_mul_f32 v45, s20, v45
L_B7:
    v_mfma_f32_16x16x32_bf16 v[48:51], a[128:131], a[0:3], 0
    v_mul_f32 v46, s20, v46
    v_mul_f32 v47, s20, v47
    v_mfma_f32_16x16x32_bf16 v[48:51], a[132:135], a[4:7], v[48:51]
    v_exp_f32 v45, v45
    v_mfma_f32_16x16x32_bf16 v[48:51], a[136:139], a[8:11], v[48:51]
    v_cvt_pk_bf16_f32 v56, v40, v41
    v_cvt_pk_bf16_f32 v57, v42, v43
    v_mfma_f32_16x16x32_bf16 v[48:51], a[140:143], a[12:15], v[48:51]
    v_exp_f32 v46, v46
    v_mfma_f32_16x16x32_bf16 v[52:55], a[144:147], a[0:3], 0
    v_exp_f32 v47, v47
    v_mfma_f32_16x16x32_bf16 v[52:55], a[148:151], a[4:7], v[52:55]
    s_waitcnt vmcnt(17) lgkmcnt(0)
    v_cvt_pk_bf16_f32 v58, v44, v45
    v_cvt_pk_bf16_f32 v59, v46, v47
    v_mfma_f32_16x16x32_bf16 v[52:55], a[152:155], a[8:11], v[52:55]
    s_barrier
    v_mfma_f32_16x16x32_bf16 v[52:55], a[156:159], a[12:15], v[52:55]
    ds_read_b128 a[96:99], v2 offset:0
    v_mul_f32 v48, s20, v48
    v_smfmac_f32_16x16x64_bf16 a[232:235], a[242:245], v[56:63], v26
    ds_read_b128 a[100:103], v3 offset:0
    v_exp_f32 v48, v48
    v_mul_f32 v49, s20, v49
    v_mul_f32 v50, s20, v50
    v_mfma_f32_16x16x32_bf16 v[224:227], a[162:165], v[56:59], v[224:227]
    ds_read_b128 a[104:107], v4 offset:0
    v_mul_f32 v51, s20, v51
    v_mfma_f32_16x16x32_bf16 v[228:231], a[170:173], v[56:59], v[228:231]
    v_exp_f32 v49, v49
    v_mfma_f32_16x16x32_bf16 v[232:235], a[178:181], v[56:59], v[232:235]
    v_exp_f32 v50, v50
    v_mfma_f32_16x16x32_bf16 v[236:239], a[186:189], v[56:59], v[236:239]
    ds_read_b128 a[108:111], v5 offset:0
    v_mul_f32 v52, s20, v52
    v_mfma_f32_16x16x32_bf16 v[240:243], a[194:197], v[56:59], v[240:243]
    v_exp_f32 v51, v51
    v_mfma_f32_16x16x32_bf16 v[244:247], a[202:205], v[56:59], v[244:247]
    v_exp_f32 v52, v52
    v_mfma_f32_16x16x32_bf16 v[248:251], a[210:213], v[56:59], v[248:251]
    ds_read_b128 a[112:115], v0 offset:0
    v_mul_f32 v53, s20, v53
    v_mfma_f32_16x16x32_bf16 v[252:255], a[218:221], v[56:59], v[252:255]
    v_mul_f32 v54, s20, v54
    v_mul_f32 v55, s20, v55
    v_mfma_f32_16x16x32_bf16 v[40:43], a[128:131], a[16:19], 0
    v_exp_f32 v53, v53
    v_mfma_f32_16x16x32_bf16 v[40:43], a[132:135], a[20:23], v[40:43]
    v_cvt_pk_bf16_f32 v60, v48, v49
    v_cvt_pk_bf16_f32 v61, v50, v51
    v_mfma_f32_16x16x32_bf16 v[40:43], a[136:139], a[24:27], v[40:43]
    v_exp_f32 v54, v54
    v_mfma_f32_16x16x32_bf16 v[40:43], a[140:143], a[28:31], v[40:43]
    v_exp_f32 v55, v55
    v_mfma_f32_16x16x32_bf16 v[44:47], a[144:147], a[16:19], 0
    s_add_u32 m0, s35, 24576
    v_cvt_pk_bf16_f32 v62, v52, v53
    v_cvt_pk_bf16_f32 v63, v54, v55
    v_mfma_f32_16x16x32_bf16 v[44:47], a[148:151], a[20:23], v[44:47]
    buffer_load_dwordx4 v18, s[8:11], s22 offen lds
    v_mfma_f32_16x16x32_bf16 v[44:47], a[152:155], a[24:27], v[44:47]
    ds_read_b128 a[116:119], v1 offset:0
    v_mul_f32 v40, s20, v40
    v_mfma_f32_16x16x32_bf16 v[44:47], a[156:159], a[28:31], v[44:47]
    v_exp_f32 v40, v40

    v_mfma_f32_16x16x32_bf16 v[64:67], a[164:167], v[60:63], v[64:67]
    ds_read_b128 a[120:123], v25 offset:0
    v_mul_f32 v41, s20, v41
    v_mul_f32 v42, s20, v42
    v_mfma_f32_16x16x32_bf16 v[68:71], a[172:175], v[60:63], v[68:71]
    ds_read_b128 a[124:127], v27 offset:0
    v_mul_f32 v43, s20, v43
    v_mfma_f32_16x16x32_bf16 v[72:75], a[180:183], v[60:63], v[72:75]
    v_exp_f32 v41, v41
    v_mfma_f32_16x16x32_bf16 v[76:79], a[188:191], v[60:63], v[76:79]
    v_exp_f32 v42, v42
    v_mfma_f32_16x16x32_bf16 v[80:83], a[196:199], v[60:63], v[80:83]
    ds_read_b64_tr_b16 a[160:161], v6 offset:0
    v_mul_f32 v44, s20, v44
    v_mfma_f32_16x16x32_bf16 v[84:87], a[204:207], v[60:63], v[84:87]
    v_exp_f32 v43, v43
    v_mfma_f32_16x16x32_bf16 v[88:91], a[212:215], v[60:63], v[88:91]
    v_exp_f32 v44, v44
    v_mfma_f32_16x16x32_bf16 v[92:95], a[220:223], v[60:63], v[92:95]
    ds_read_b64_tr_b16 a[162:163], v36 offset:0
    v_mul_f32 v45, s20, v45
    v_mfma_f32_16x16x32_bf16 v[48:51], a[128:131], a[32:35], 0
    v_mul_f32 v46, s20, v46
    v_mul_f32 v47, s20, v47
    v_mfma_f32_16x16x32_bf16 v[48:51], a[132:135], a[36:39], v[48:51]
    v_exp_f32 v45, v45
    v_mfma_f32_16x16x32_bf16 v[48:51], a[136:139], a[40:43], v[48:51]
    v_cvt_pk_bf16_f32 v56, v40, v41
    v_cvt_pk_bf16_f32 v57, v42, v43
    v_mfma_f32_16x16x32_bf16 v[48:51], a[140:143], a[44:47], v[48:51]
    v_exp_f32 v46, v46
    v_mfma_f32_16x16x32_bf16 v[52:55], a[144:147], a[32:35], 0
    v_exp_f32 v47, v47
    v_mfma_f32_16x16x32_bf16 v[52:55], a[148:151], a[36:39], v[52:55]
    v_cvt_pk_bf16_f32 v58, v44, v45
    v_cvt_pk_bf16_f32 v59, v46, v47
    v_mfma_f32_16x16x32_bf16 v[52:55], a[152:155], a[40:43], v[52:55]
    buffer_load_dwordx4 v18, s[8:11], s22 offen offset:1024 lds
    v_mfma_f32_16x16x32_bf16 v[52:55], a[156:159], a[44:47], v[52:55]
    ds_read_b64_tr_b16 a[168:169], v6 offset:8
    v_mul_f32 v48, s20, v48
    v_smfmac_f32_16x16x64_bf16 a[224:227], a[242:245], v[56:63], v26
    ds_read_b64_tr_b16 a[170:171], v36 offset:8
    v_exp_f32 v48, v48
    v_mul_f32 v49, s20, v49
    v_mul_f32 v50, s20, v50
    v_mfma_f32_16x16x32_bf16 v[96:99], a[164:167], v[56:59], v[96:99]
    ds_read_b64_tr_b16 a[176:177], v7 offset:0
    v_mul_f32 v51, s20, v51
    v_mfma_f32_16x16x32_bf16 v[100:103], a[172:175], v[56:59], v[100:103]
    v_exp_f32 v49, v49
    v_mfma_f32_16x16x32_bf16 v[104:107], a[180:183], v[56:59], v[104:107]
    v_exp_f32 v50, v50
    v_mfma_f32_16x16x32_bf16 v[108:111], a[188:191], v[56:59], v[108:111]
    ds_read_b64_tr_b16 a[178:179], v37 offset:0
    v_mul_f32 v52, s20, v52
    v_mfma_f32_16x16x32_bf16 v[112:115], a[196:199], v[56:59], v[112:115]
    v_exp_f32 v51, v51
    v_mfma_f32_16x16x32_bf16 v[116:119], a[204:207], v[56:59], v[116:119]
    v_exp_f32 v52, v52
    v_mfma_f32_16x16x32_bf16 v[120:123], a[212:215], v[56:59], v[120:123]
    ds_read_b64_tr_b16 a[184:185], v7 offset:8
    v_mul_f32 v53, s20, v53
    v_mfma_f32_16x16x32_bf16 v[124:127], a[220:223], v[56:59], v[124:127]
    v_mul_f32 v54, s20, v54
    v_mul_f32 v55, s20, v55
    v_mfma_f32_16x16x32_bf16 v[40:43], a[128:131], a[48:51], 0
    v_exp_f32 v53, v53
    v_mfma_f32_16x16x32_bf16 v[40:43], a[132:135], a[52:55], v[40:43]
    v_cvt_pk_bf16_f32 v60, v48, v49
    v_cvt_pk_bf16_f32 v61, v50, v51
    v_mfma_f32_16x16x32_bf16 v[40:43], a[136:139], a[56:59], v[40:43]
    v_exp_f32 v54, v54
    v_mfma_f32_16x16x32_bf16 v[40:43], a[140:143], a[60:63], v[40:43]
    v_exp_f32 v55, v55
    v_mfma_f32_16x16x32_bf16 v[44:47], a[144:147], a[48:51], 0
    s_add_u32 m0, s35, 57344
    v_cvt_pk_bf16_f32 v62, v52, v53
    v_cvt_pk_bf16_f32 v63, v54, v55
    v_mfma_f32_16x16x32_bf16 v[44:47], a[148:151], a[52:55], v[44:47]
    buffer_load_dwordx4 v19, s[12:15], s22 offen lds
    v_mfma_f32_16x16x32_bf16 v[44:47], a[152:155], a[56:59], v[44:47]
    ds_read_b64_tr_b16 a[186:187], v37 offset:8
    v_mul_f32 v40, s20, v40
    v_mfma_f32_16x16x32_bf16 v[44:47], a[156:159], a[60:63], v[44:47]
    v_exp_f32 v40, v40

    s_add_u32 m0, s30, 8192
    v_mfma_f32_16x16x32_bf16 v[128:131], a[164:167], v[60:63], v[128:131]
    buffer_store_dwordx4 v[28:31], v16, s[16:19], s32 offen offset:2048 nt
    buffer_load_dwordx4 v16, s[4:7], s28 offen offset:2048 nt lds
    ds_read_b64_tr_b16 a[192:193], v8 offset:0
    v_mul_f32 v41, s20, v41
    v_mul_f32 v42, s20, v42
    v_mfma_f32_16x16x32_bf16 v[132:135], a[172:175], v[60:63], v[132:135]
    ds_read_b64_tr_b16 a[194:195], v38 offset:0
    v_mul_f32 v43, s20, v43
    v_mfma_f32_16x16x32_bf16 v[136:139], a[180:183], v[60:63], v[136:139]
    v_exp_f32 v41, v41
    v_mfma_f32_16x16x32_bf16 v[140:143], a[188:191], v[60:63], v[140:143]
    v_exp_f32 v42, v42
    v_mfma_f32_16x16x32_bf16 v[144:147], a[196:199], v[60:63], v[144:147]
    ds_read_b64_tr_b16 a[200:201], v8 offset:8
    v_mul_f32 v44, s20, v44
    v_mfma_f32_16x16x32_bf16 v[148:151], a[204:207], v[60:63], v[148:151]
    v_exp_f32 v43, v43
    v_mfma_f32_16x16x32_bf16 v[152:155], a[212:215], v[60:63], v[152:155]
    v_exp_f32 v44, v44
    v_mfma_f32_16x16x32_bf16 v[156:159], a[220:223], v[60:63], v[156:159]
    ds_read_b64_tr_b16 a[202:203], v38 offset:8
    v_mul_f32 v45, s20, v45
    v_mfma_f32_16x16x32_bf16 v[48:51], a[128:131], a[64:67], 0
    v_mul_f32 v46, s20, v46
    v_mul_f32 v47, s20, v47
    v_mfma_f32_16x16x32_bf16 v[48:51], a[132:135], a[68:71], v[48:51]
    v_exp_f32 v45, v45
    v_mfma_f32_16x16x32_bf16 v[48:51], a[136:139], a[72:75], v[48:51]
    buffer_store_dwordx4 v[32:35], v17, s[16:19], s32 offen offset:3072 nt
    buffer_load_dwordx4 v17, s[4:7], s28 offen offset:3072 nt lds
    v_cvt_pk_bf16_f32 v56, v40, v41
    v_cvt_pk_bf16_f32 v57, v42, v43
    v_mfma_f32_16x16x32_bf16 v[48:51], a[140:143], a[76:79], v[48:51]
    v_exp_f32 v46, v46
    v_mfma_f32_16x16x32_bf16 v[52:55], a[144:147], a[64:67], 0
    v_exp_f32 v47, v47
    v_mfma_f32_16x16x32_bf16 v[52:55], a[148:151], a[68:71], v[52:55]
    s_add_u32 m0, s35, 57344
    v_cvt_pk_bf16_f32 v58, v44, v45
    v_cvt_pk_bf16_f32 v59, v46, v47
    v_mfma_f32_16x16x32_bf16 v[52:55], a[152:155], a[72:75], v[52:55]
    buffer_load_dwordx4 v19, s[12:15], s22 offen offset:1024 lds
    v_mfma_f32_16x16x32_bf16 v[52:55], a[156:159], a[76:79], v[52:55]
    s_xor_b32 s22, s22, 57344
    ds_read_b64_tr_b16 a[208:209], v9 offset:0
    v_mul_f32 v48, s20, v48
    v_smfmac_f32_16x16x64_bf16 a[228:231], a[242:245], v[56:63], v26
    v_exp_f32 v48, v48
    v_mfma_f32_16x16x32_bf16 v[160:163], a[164:167], v[56:59], v[160:163]
    ds_read_b128 v[28:31], v24 offset:12288
    v_mul_f32 v49, s20, v49
    v_mul_f32 v50, s20, v50
    v_mfma_f32_16x16x32_bf16 v[164:167], a[172:175], v[56:59], v[164:167]
    ds_read_b64_tr_b16 a[210:211], v39 offset:0
    v_mul_f32 v51, s20, v51
    v_mfma_f32_16x16x32_bf16 v[168:171], a[180:183], v[56:59], v[168:171]
    v_exp_f32 v49, v49
    v_mfma_f32_16x16x32_bf16 v[172:175], a[188:191], v[56:59], v[172:175]
    v_exp_f32 v50, v50
    v_mfma_f32_16x16x32_bf16 v[176:179], a[196:199], v[56:59], v[176:179]
    ds_read_b64_tr_b16 a[216:217], v9 offset:8
    v_mul_f32 v52, s20, v52
    v_mfma_f32_16x16x32_bf16 v[180:183], a[204:207], v[56:59], v[180:183]
    v_exp_f32 v51, v51
    v_mfma_f32_16x16x32_bf16 v[184:187], a[212:215], v[56:59], v[184:187]
    v_exp_f32 v52, v52
    v_mfma_f32_16x16x32_bf16 v[188:191], a[220:223], v[56:59], v[188:191]
    s_waitcnt lgkmcnt(15)
    ds_read_b64_tr_b16 a[218:219], v39 offset:8
    v_mul_f32 v53, s20, v53
L_B8:
    v_mfma_f32_16x16x32_bf16 v[40:43], a[96:99], a[0:3], 0
    v_mul_f32 v54, s20, v54
    v_mul_f32 v55, s20, v55
    v_mfma_f32_16x16x32_bf16 v[40:43], a[100:103], a[4:7], v[40:43]
    v_exp_f32 v53, v53
    v_mfma_f32_16x16x32_bf16 v[40:43], a[104:107], a[8:11], v[40:43]
    v_cvt_pk_bf16_f32 v60, v48, v49
    v_cvt_pk_bf16_f32 v61, v50, v51
    v_mfma_f32_16x16x32_bf16 v[40:43], a[108:111], a[12:15], v[40:43]
    v_exp_f32 v54, v54
    v_mfma_f32_16x16x32_bf16 v[44:47], a[112:115], a[0:3], 0
    v_exp_f32 v55, v55
    v_mfma_f32_16x16x32_bf16 v[44:47], a[116:119], a[4:7], v[44:47]
    s_waitcnt vmcnt(15) lgkmcnt(0)
    v_cvt_pk_bf16_f32 v62, v52, v53
    v_cvt_pk_bf16_f32 v63, v54, v55
    v_mfma_f32_16x16x32_bf16 v[44:47], a[120:123], a[8:11], v[44:47]
    s_barrier
    v_mfma_f32_16x16x32_bf16 v[44:47], a[124:127], a[12:15], v[44:47]
    ds_read_b128 a[128:131], v2 offset:8192
    v_mul_f32 v40, s20, v40
    v_mfma_f32_16x16x32_bf16 a[232:235], a[248:251], v[60:63], a[232:235]
    v_exp_f32 v40, v40
    v_mul_f32 v41, s20, v41
    v_mul_f32 v42, s20, v42
    v_mfma_f32_16x16x32_bf16 v[192:195], a[164:167], v[60:63], v[192:195]
    ds_read_b128 a[132:135], v3 offset:8192
    v_mul_f32 v43, s20, v43
    v_mfma_f32_16x16x32_bf16 v[196:199], a[172:175], v[60:63], v[196:199]
    v_exp_f32 v41, v41
    v_mfma_f32_16x16x32_bf16 v[200:203], a[180:183], v[60:63], v[200:203]
    v_exp_f32 v42, v42
    v_mfma_f32_16x16x32_bf16 v[204:207], a[188:191], v[60:63], v[204:207]
    ds_read_b128 a[136:139], v4 offset:8192
    v_mul_f32 v44, s20, v44
    v_mfma_f32_16x16x32_bf16 v[208:211], a[196:199], v[60:63], v[208:211]
    v_exp_f32 v43, v43
    v_mfma_f32_16x16x32_bf16 v[212:215], a[204:207], v[60:63], v[212:215]
    v_exp_f32 v44, v44
    v_mfma_f32_16x16x32_bf16 v[216:219], a[212:215], v[60:63], v[216:219]
    ds_read_b128 a[140:143], v5 offset:8192
    v_mul_f32 v45, s20, v45
    v_mfma_f32_16x16x32_bf16 v[220:223], a[220:223], v[60:63], v[220:223]
    v_mul_f32 v46, s20, v46
    v_mul_f32 v47, s20, v47
    v_mfma_f32_16x16x32_bf16 v[48:51], a[96:99], a[16:19], 0
    v_exp_f32 v45, v45
    v_mfma_f32_16x16x32_bf16 v[48:51], a[100:103], a[20:23], v[48:51]
    v_cvt_pk_bf16_f32 v56, v40, v41
    v_cvt_pk_bf16_f32 v57, v42, v43
    v_mfma_f32_16x16x32_bf16 v[48:51], a[104:107], a[24:27], v[48:51]
    v_exp_f32 v46, v46
    v_mfma_f32_16x16x32_bf16 v[48:51], a[108:111], a[28:31], v[48:51]
    v_exp_f32 v47, v47
    v_mfma_f32_16x16x32_bf16 v[52:55], a[112:115], a[16:19], 0
    s_add_u32 m0, s35, 0
    v_cvt_pk_bf16_f32 v58, v44, v45
    v_cvt_pk_bf16_f32 v59, v46, v47
    v_mfma_f32_16x16x32_bf16 v[52:55], a[116:119], a[20:23], v[52:55]
    buffer_load_dwordx4 v18, s[8:11], s22 offen lds
    v_mfma_f32_16x16x32_bf16 v[52:55], a[120:123], a[24:27], v[52:55]
    ds_read_b128 a[144:147], v0 offset:8192
    v_mul_f32 v48, s20, v48
    v_mfma_f32_16x16x32_bf16 v[52:55], a[124:127], a[28:31], v[52:55]
    v_exp_f32 v48, v48

    v_mfma_f32_16x16x32_bf16 v[64:67], a[160:163], v[56:59], v[64:67]
    v_mul_f32 v49, s20, v49
    v_mul_f32 v50, s20, v50
    v_mfma_f32_16x16x32_bf16 v[68:71], a[168:171], v[56:59], v[68:71]
    ds_read_b128 a[148:151], v1 offset:8192
    v_mul_f32 v51, s20, v51
    v_mfma_f32_16x16x32_bf16 v[72:75], a[176:179], v[56:59], v[72:75]
    v_exp_f32 v49, v49
    v_mfma_f32_16x16x32_bf16 v[76:79], a[184:187], v[56:59], v[76:79]
    v_exp_f32 v50, v50
    v_mfma_f32_16x16x32_bf16 v[80:83], a[192:195], v[56:59], v[80:83]
    ds_read_b128 a[152:155], v25 offset:8192
    v_mul_f32 v52, s20, v52
    v_mfma_f32_16x16x32_bf16 v[84:87], a[200:203], v[56:59], v[84:87]
    v_exp_f32 v51, v51
    v_mfma_f32_16x16x32_bf16 v[88:91], a[208:211], v[56:59], v[88:91]
    v_exp_f32 v52, v52
    v_mfma_f32_16x16x32_bf16 v[92:95], a[216:219], v[56:59], v[92:95]
    ds_read_b128 a[156:159], v27 offset:8192
    v_mul_f32 v53, s20, v53
    v_mfma_f32_16x16x32_bf16 v[40:43], a[96:99], a[32:35], 0
    v_mul_f32 v54, s20, v54
    v_mul_f32 v55, s20, v55
    v_mfma_f32_16x16x32_bf16 v[40:43], a[100:103], a[36:39], v[40:43]
    v_exp_f32 v53, v53
    v_mfma_f32_16x16x32_bf16 v[40:43], a[104:107], a[40:43], v[40:43]
    v_cvt_pk_bf16_f32 v60, v48, v49
    v_cvt_pk_bf16_f32 v61, v50, v51
    v_mfma_f32_16x16x32_bf16 v[40:43], a[108:111], a[44:47], v[40:43]
    v_exp_f32 v54, v54
    v_mfma_f32_16x16x32_bf16 v[44:47], a[112:115], a[32:35], 0
    v_exp_f32 v55, v55
    v_mfma_f32_16x16x32_bf16 v[44:47], a[116:119], a[36:39], v[44:47]
    v_cvt_pk_bf16_f32 v62, v52, v53
    v_cvt_pk_bf16_f32 v63, v54, v55
    v_mfma_f32_16x16x32_bf16 v[44:47], a[120:123], a[40:43], v[44:47]
    buffer_load_dwordx4 v18, s[8:11], s22 offen offset:1024 lds
    v_mfma_f32_16x16x32_bf16 v[44:47], a[124:127], a[44:47], v[44:47]
    ds_read_b64_tr_b16 a[164:165], v6 offset:8192
    v_mul_f32 v40, s20, v40
    v_smfmac_f32_16x16x64_bf16 a[224:227], a[238:241], v[56:63], v26
    v_exp_f32 v40, v40
    v_mul_f32 v41, s20, v41
    v_mul_f32 v42, s20, v42
    v_mfma_f32_16x16x32_bf16 v[96:99], a[160:163], v[60:63], v[96:99]
    ds_read_b64_tr_b16 a[166:167], v36 offset:8192
    v_mul_f32 v43, s20, v43
    v_mfma_f32_16x16x32_bf16 v[100:103], a[168:171], v[60:63], v[100:103]
    v_exp_f32 v41, v41
    v_mfma_f32_16x16x32_bf16 v[104:107], a[176:179], v[60:63], v[104:107]
    v_exp_f32 v42, v42
    v_mfma_f32_16x16x32_bf16 v[108:111], a[184:187], v[60:63], v[108:111]
    ds_read_b64_tr_b16 a[172:173], v6 offset:8200
    v_mul_f32 v44, s20, v44
    v_mfma_f32_16x16x32_bf16 v[112:115], a[192:195], v[60:63], v[112:115]
    v_exp_f32 v43, v43
    v_mfma_f32_16x16x32_bf16 v[116:119], a[200:203], v[60:63], v[116:119]
    v_exp_f32 v44, v44
    v_mfma_f32_16x16x32_bf16 v[120:123], a[208:211], v[60:63], v[120:123]
    ds_read_b64_tr_b16 a[174:175], v36 offset:8200
    v_mul_f32 v45, s20, v45
    v_mfma_f32_16x16x32_bf16 v[124:127], a[216:219], v[60:63], v[124:127]
    v_mul_f32 v46, s20, v46
    v_mul_f32 v47, s20, v47
    v_mfma_f32_16x16x32_bf16 v[48:51], a[96:99], a[48:51], 0
    v_exp_f32 v45, v45
    v_mfma_f32_16x16x32_bf16 v[48:51], a[100:103], a[52:55], v[48:51]
    v_cvt_pk_bf16_f32 v56, v40, v41
    v_cvt_pk_bf16_f32 v57, v42, v43
    v_mfma_f32_16x16x32_bf16 v[48:51], a[104:107], a[56:59], v[48:51]
    v_exp_f32 v46, v46
    v_mfma_f32_16x16x32_bf16 v[48:51], a[108:111], a[60:63], v[48:51]
    v_exp_f32 v47, v47
    v_mfma_f32_16x16x32_bf16 v[52:55], a[112:115], a[48:51], 0
    s_add_u32 m0, s35, 32768
    v_cvt_pk_bf16_f32 v58, v44, v45
    v_cvt_pk_bf16_f32 v59, v46, v47
    v_mfma_f32_16x16x32_bf16 v[52:55], a[116:119], a[52:55], v[52:55]
    buffer_load_dwordx4 v19, s[12:15], s22 offen lds
    v_mfma_f32_16x16x32_bf16 v[52:55], a[120:123], a[56:59], v[52:55]
    ds_read_b64_tr_b16 a[180:181], v7 offset:8192
    v_mul_f32 v48, s20, v48
    v_mfma_f32_16x16x32_bf16 v[52:55], a[124:127], a[60:63], v[52:55]
    v_exp_f32 v48, v48

    v_mfma_f32_16x16x32_bf16 v[128:131], a[160:163], v[56:59], v[128:131]
    v_mul_f32 v49, s20, v49
    v_mul_f32 v50, s20, v50
    v_mfma_f32_16x16x32_bf16 v[132:135], a[168:171], v[56:59], v[132:135]
    ds_read_b64_tr_b16 a[182:183], v37 offset:8192
    v_mul_f32 v51, s20, v51
    v_mfma_f32_16x16x32_bf16 v[136:139], a[176:179], v[56:59], v[136:139]
    v_exp_f32 v49, v49
    v_mfma_f32_16x16x32_bf16 v[140:143], a[184:187], v[56:59], v[140:143]
    v_exp_f32 v50, v50
    v_mfma_f32_16x16x32_bf16 v[144:147], a[192:195], v[56:59], v[144:147]
    ds_read_b64_tr_b16 a[188:189], v7 offset:8200
    v_mul_f32 v52, s20, v52
    v_mfma_f32_16x16x32_bf16 v[148:151], a[200:203], v[56:59], v[148:151]
    v_exp_f32 v51, v51
    v_mfma_f32_16x16x32_bf16 v[152:155], a[208:211], v[56:59], v[152:155]
    v_exp_f32 v52, v52
    v_mfma_f32_16x16x32_bf16 v[156:159], a[216:219], v[56:59], v[156:159]
    ds_read_b64_tr_b16 a[190:191], v37 offset:8200
    v_mul_f32 v53, s20, v53
    v_mfma_f32_16x16x32_bf16 v[40:43], a[96:99], a[64:67], 0
    v_mul_f32 v54, s20, v54
    v_mul_f32 v55, s20, v55
    v_mfma_f32_16x16x32_bf16 v[40:43], a[100:103], a[68:71], v[40:43]
    v_exp_f32 v53, v53
    v_mfma_f32_16x16x32_bf16 v[40:43], a[104:107], a[72:75], v[40:43]
    v_cvt_pk_bf16_f32 v60, v48, v49
    v_cvt_pk_bf16_f32 v61, v50, v51
    v_mfma_f32_16x16x32_bf16 v[40:43], a[108:111], a[76:79], v[40:43]
    v_exp_f32 v54, v54
    v_mfma_f32_16x16x32_bf16 v[44:47], a[112:115], a[64:67], 0
    s_add_u32 s28, s24, 12288
    v_exp_f32 v55, v55
    v_mfma_f32_16x16x32_bf16 v[44:47], a[116:119], a[68:71], v[44:47]
    s_add_u32 s32, s31, 12288
    v_cvt_pk_bf16_f32 v62, v52, v53
    v_cvt_pk_bf16_f32 v63, v54, v55
    v_mfma_f32_16x16x32_bf16 v[44:47], a[120:123], a[72:75], v[44:47]
    buffer_load_dwordx4 v19, s[12:15], s22 offen offset:1024 lds
    v_mfma_f32_16x16x32_bf16 v[44:47], a[124:127], a[76:79], v[44:47]
    s_add_u32 m0, s30, 12288
    ds_read_b64_tr_b16 a[196:197], v8 offset:8192
    v_mul_f32 v40, s20, v40
    v_smfmac_f32_16x16x64_bf16 a[228:231], a[238:241], v[56:63], v26
    buffer_store_dwordx4 v[28:31], v14, s[16:19], s32 offen nt
    buffer_load_dwordx4 v14, s[4:7], s28 offen nt lds
    v_exp_f32 v40, v40
    v_mul_f32 v41, s20, v41
    v_mul_f32 v42, s20, v42
    v_mfma_f32_16x16x32_bf16 v[160:163], a[160:163], v[60:63], v[160:163]
    s_xor_b32 s22, s22, 8192
    ds_read_b64_tr_b16 a[198:199], v38 offset:8192
    v_mul_f32 v43, s20, v43
    v_mfma_f32_16x16x32_bf16 v[164:167], a[168:171], v[60:63], v[164:167]
    v_exp_f32 v41, v41
    v_mfma_f32_16x16x32_bf16 v[168:171], a[176:179], v[60:63], v[168:171]
    v_exp_f32 v42, v42
    v_mfma_f32_16x16x32_bf16 v[172:175], a[184:187], v[60:63], v[172:175]
    ds_read_b64_tr_b16 a[204:205], v8 offset:8200
    v_mul_f32 v44, s20, v44
    v_mfma_f32_16x16x32_bf16 v[176:179], a[192:195], v[60:63], v[176:179]
    v_exp_f32 v43, v43
    v_mfma_f32_16x16x32_bf16 v[180:183], a[200:203], v[60:63], v[180:183]
    v_exp_f32 v44, v44
    v_mfma_f32_16x16x32_bf16 v[184:187], a[208:211], v[60:63], v[184:187]
    ds_read_b64_tr_b16 a[206:207], v38 offset:8200
    v_mul_f32 v45, s20, v45
    v_mfma_f32_16x16x32_bf16 v[188:191], a[216:219], v[60:63], v[188:191]
    s_waitcnt lgkmcnt(12)
    v_mul_f32 v46, s20, v46
    v_mul_f32 v47, s20, v47
    v_mfma_f32_16x16x32_bf16 v[48:51], a[112:115], a[80:83], 0
    v_exp_f32 v45, v45
    v_mfma_f32_16x16x32_bf16 v[48:51], a[116:119], a[84:87], v[48:51]
    v_cvt_pk_bf16_f32 v56, v40, v41
    v_cvt_pk_bf16_f32 v57, v42, v43
    v_mfma_f32_16x16x32_bf16 v[48:51], a[120:123], a[88:91], v[48:51]
    v_exp_f32 v46, v46
    v_mfma_f32_16x16x32_bf16 v[48:51], a[124:127], a[92:95], v[48:51]
    v_exp_f32 v47, v47
    v_mfma_f32_16x16x32_bf16 v[52:55], a[128:131], a[80:83], 0
    v_cvt_pk_bf16_f32 v58, v44, v45
    v_cvt_pk_bf16_f32 v59, v46, v47
    v_mfma_f32_16x16x32_bf16 v[52:55], a[132:135], a[84:87], v[52:55]
    ds_read_b128 v[28:31], v24 offset:13312
    ds_read_b128 v[32:35], v24 offset:14336
    v_mfma_f32_16x16x32_bf16 v[52:55], a[136:139], a[88:91], v[52:55]
    ds_read_b64_tr_b16 a[212:213], v9 offset:8192
    v_mul_f32 v48, s20, v48
    v_mfma_f32_16x16x32_bf16 v[52:55], a[140:143], a[92:95], v[52:55]
    v_exp_f32 v48, v48

    v_mfma_f32_16x16x32_bf16 v[192:195], a[160:163], v[56:59], v[192:195]
    v_mul_f32 v49, s20, v49
    v_mul_f32 v50, s20, v50
    v_mfma_f32_16x16x32_bf16 v[196:199], a[168:171], v[56:59], v[196:199]
    ds_read_b64_tr_b16 a[214:215], v39 offset:8192
    v_mul_f32 v51, s20, v51
    v_mfma_f32_16x16x32_bf16 v[200:203], a[176:179], v[56:59], v[200:203]
    v_exp_f32 v49, v49
    v_mfma_f32_16x16x32_bf16 v[204:207], a[184:187], v[56:59], v[204:207]
    v_exp_f32 v50, v50
    v_mfma_f32_16x16x32_bf16 v[208:211], a[192:195], v[56:59], v[208:211]
    ds_read_b64_tr_b16 a[220:221], v9 offset:8200
    v_mul_f32 v52, s20, v52
    v_mfma_f32_16x16x32_bf16 v[212:215], a[200:203], v[56:59], v[212:215]
    v_exp_f32 v51, v51
    v_mfma_f32_16x16x32_bf16 v[216:219], a[208:211], v[56:59], v[216:219]
    v_exp_f32 v52, v52
    v_mfma_f32_16x16x32_bf16 v[220:223], a[216:219], v[56:59], v[220:223]
    s_cmp_eq_u32 s33, 1
    ds_read_b64_tr_b16 a[222:223], v39 offset:8200
    v_mul_f32 v53, s20, v53
    s_cbranch_scc1 L_lateB
L_B9:
    v_mfma_f32_16x16x32_bf16 v[40:43], a[128:131], a[0:3], 0
    v_mul_f32 v54, s20, v54
    v_mul_f32 v55, s20, v55
    v_mfma_f32_16x16x32_bf16 v[40:43], a[132:135], a[4:7], v[40:43]
    v_exp_f32 v53, v53
    v_mfma_f32_16x16x32_bf16 v[40:43], a[136:139], a[8:11], v[40:43]
    v_cvt_pk_bf16_f32 v60, v48, v49
    v_cvt_pk_bf16_f32 v61, v50, v51
    v_mfma_f32_16x16x32_bf16 v[40:43], a[140:143], a[12:15], v[40:43]
    v_exp_f32 v54, v54
    v_mfma_f32_16x16x32_bf16 v[44:47], a[144:147], a[0:3], 0
    v_exp_f32 v55, v55
    v_mfma_f32_16x16x32_bf16 v[44:47], a[148:151], a[4:7], v[44:47]
    s_waitcnt vmcnt(16) lgkmcnt(0)
    v_cvt_pk_bf16_f32 v62, v52, v53
    v_cvt_pk_bf16_f32 v63, v54, v55
    v_mfma_f32_16x16x32_bf16 v[44:47], a[152:155], a[8:11], v[44:47]
    s_barrier
    v_mfma_f32_16x16x32_bf16 v[44:47], a[156:159], a[12:15], v[44:47]
    ds_read_b128 a[96:99], v2 offset:16384
    v_mul_f32 v40, s20, v40
    v_smfmac_f32_16x16x64_bf16 a[232:235], a[238:241], v[56:63], v26
    ds_read_b128 a[100:103], v3 offset:16384
    v_exp_f32 v40, v40
    v_mul_f32 v41, s20, v41
    v_mul_f32 v42, s20, v42
    v_mfma_f32_16x16x32_bf16 v[224:227], a[162:165], v[60:63], v[224:227]
    ds_read_b128 a[104:107], v4 offset:16384
    v_mul_f32 v43, s20, v43
    v_mfma_f32_16x16x32_bf16 v[228:231], a[170:173], v[60:63], v[228:231]
    v_exp_f32 v41, v41
    v_mfma_f32_16x16x32_bf16 v[232:235], a[178:181], v[60:63], v[232:235]
    v_exp_f32 v42, v42
    v_mfma_f32_16x16x32_bf16 v[236:239], a[186:189], v[60:63], v[236:239]
    ds_read_b128 a[108:111], v5 offset:16384
    v_mul_f32 v44, s20, v44
    v_mfma_f32_16x16x32_bf16 v[240:243], a[194:197], v[60:63], v[240:243]
    v_exp_f32 v43, v43
    v_mfma_f32_16x16x32_bf16 v[244:247], a[202:205], v[60:63], v[244:247]
    v_exp_f32 v44, v44
    v_mfma_f32_16x16x32_bf16 v[248:251], a[210:213], v[60:63], v[248:251]
    ds_read_b128 a[112:115], v0 offset:16384
    v_mul_f32 v45, s20, v45
    v_mfma_f32_16x16x32_bf16 v[252:255], a[218:221], v[60:63], v[252:255]
    v_mul_f32 v46, s20, v46
    v_mul_f32 v47, s20, v47
    v_mfma_f32_16x16x32_bf16 v[48:51], a[128:131], a[16:19], 0
    v_exp_f32 v45, v45
    v_mfma_f32_16x16x32_bf16 v[48:51], a[132:135], a[20:23], v[48:51]
    v_cvt_pk_bf16_f32 v56, v40, v41
    v_cvt_pk_bf16_f32 v57, v42, v43
    v_mfma_f32_16x16x32_bf16 v[48:51], a[136:139], a[24:27], v[48:51]
    v_exp_f32 v46, v46
    v_mfma_f32_16x16x32_bf16 v[48:51], a[140:143], a[28:31], v[48:51]
    v_exp_f32 v47, v47
    v_mfma_f32_16x16x32_bf16 v[52:55], a[144:147], a[16:19], 0
    s_add_u32 m0, s35, 8192
    v_cvt_pk_bf16_f32 v58, v44, v45
    v_cvt_pk_bf16_f32 v59, v46, v47
    v_mfma_f32_16x16x32_bf16 v[52:55], a[148:151], a[20:23], v[52:55]
    buffer_load_dwordx4 v18, s[8:11], s22 offen lds
    v_mfma_f32_16x16x32_bf16 v[52:55], a[152:155], a[24:27], v[52:55]
    ds_read_b128 a[116:119], v1 offset:16384
    v_mul_f32 v48, s20, v48
    v_mfma_f32_16x16x32_bf16 v[52:55], a[156:159], a[28:31], v[52:55]
    v_exp_f32 v48, v48

    v_mfma_f32_16x16x32_bf16 v[64:67], a[164:167], v[56:59], v[64:67]
    ds_read_b128 a[120:123], v25 offset:16384
    v_mul_f32 v49, s20, v49
    v_mul_f32 v50, s20, v50
    v_mfma_f32_16x16x32_bf16 v[68:71], a[172:175], v[56:59], v[68:71]
    ds_read_b128 a[124:127], v27 offset:16384
    v_mul_f32 v51, s20, v51
    v_mfma_f32_16x16x32_bf16 v[72:75], a[180:183], v[56:59], v[72:75]
    v_exp_f32 v49, v49
    v_mfma_f32_16x16x32_bf16 v[76:79], a[188:191], v[56:59], v[76:79]
    v_exp_f32 v50, v50
    v_mfma_f32_16x16x32_bf16 v[80:83], a[196:199], v[56:59], v[80:83]
    ds_read_b64_tr_b16 a[160:161], v6 offset:16384
    v_mul_f32 v52, s20, v52
    v_mfma_f32_16x16x32_bf16 v[84:87], a[204:207], v[56:59], v[84:87]
    v_exp_f32 v51, v51
    v_mfma_f32_16x16x32_bf16 v[88:91], a[212:215], v[56:59], v[88:91]
    v_exp_f32 v52, v52
    v_mfma_f32_16x16x32_bf16 v[92:95], a[220:223], v[56:59], v[92:95]
    ds_read_b64_tr_b16 a[162:163], v36 offset:16384
    v_mul_f32 v53, s20, v53
    v_mfma_f32_16x16x32_bf16 v[40:43], a[128:131], a[32:35], 0
    v_mul_f32 v54, s20, v54
    v_mul_f32 v55, s20, v55
    v_mfma_f32_16x16x32_bf16 v[40:43], a[132:135], a[36:39], v[40:43]
    v_exp_f32 v53, v53
    v_mfma_f32_16x16x32_bf16 v[40:43], a[136:139], a[40:43], v[40:43]
    v_cvt_pk_bf16_f32 v60, v48, v49
    v_cvt_pk_bf16_f32 v61, v50, v51
    v_mfma_f32_16x16x32_bf16 v[40:43], a[140:143], a[44:47], v[40:43]
    v_exp_f32 v54, v54
    v_mfma_f32_16x16x32_bf16 v[44:47], a[144:147], a[32:35], 0
    v_exp_f32 v55, v55
    v_mfma_f32_16x16x32_bf16 v[44:47], a[148:151], a[36:39], v[44:47]
    v_cvt_pk_bf16_f32 v62, v52, v53
    v_cvt_pk_bf16_f32 v63, v54, v55
    v_mfma_f32_16x16x32_bf16 v[44:47], a[152:155], a[40:43], v[44:47]
    buffer_load_dwordx4 v18, s[8:11], s22 offen offset:1024 lds
    v_mfma_f32_16x16x32_bf16 v[44:47], a[156:159], a[44:47], v[44:47]
    ds_read_b64_tr_b16 a[168:169], v6 offset:16392
    v_mul_f32 v40, s20, v40
    v_smfmac_f32_16x16x64_bf16 a[224:227], a[238:241], v[56:63], v26
    ds_read_b64_tr_b16 a[170:171], v36 offset:16392
    v_exp_f32 v40, v40
    v_mul_f32 v41, s20, v41
    v_mul_f32 v42, s20, v42
    v_mfma_f32_16x16x32_bf16 v[96:99], a[164:167], v[60:63], v[96:99]
    ds_read_b64_tr_b16 a[176:177], v7 offset:16384
    v_mul_f32 v43, s20, v43
    v_mfma_f32_16x16x32_bf16 v[100:103], a[172:175], v[60:63], v[100:103]
    v_exp_f32 v41, v41
    v_mfma_f32_16x16x32_bf16 v[104:107], a[180:183], v[60:63], v[104:107]
    v_exp_f32 v42, v42
    v_mfma_f32_16x16x32_bf16 v[108:111], a[188:191], v[60:63], v[108:111]
    ds_read_b64_tr_b16 a[178:179], v37 offset:16384
    v_mul_f32 v44, s20, v44
    v_mfma_f32_16x16x32_bf16 v[112:115], a[196:199], v[60:63], v[112:115]
    v_exp_f32 v43, v43
    v_mfma_f32_16x16x32_bf16 v[116:119], a[204:207], v[60:63], v[116:119]
    v_exp_f32 v44, v44
    v_mfma_f32_16x16x32_bf16 v[120:123], a[212:215], v[60:63], v[120:123]
    ds_read_b64_tr_b16 a[184:185], v7 offset:16392
    v_mul_f32 v45, s20, v45
    v_mfma_f32_16x16x32_bf16 v[124:127], a[220:223], v[60:63], v[124:127]
    v_mul_f32 v46, s20, v46
    v_mul_f32 v47, s20, v47
    v_mfma_f32_16x16x32_bf16 v[48:51], a[128:131], a[48:51], 0
    v_exp_f32 v45, v45
    v_mfma_f32_16x16x32_bf16 v[48:51], a[132:135], a[52:55], v[48:51]
    v_cvt_pk_bf16_f32 v56, v40, v41
    v_cvt_pk_bf16_f32 v57, v42, v43
    v_mfma_f32_16x16x32_bf16 v[48:51], a[136:139], a[56:59], v[48:51]
    v_exp_f32 v46, v46
    v_mfma_f32_16x16x32_bf16 v[48:51], a[140:143], a[60:63], v[48:51]
    v_exp_f32 v47, v47
    v_mfma_f32_16x16x32_bf16 v[52:55], a[144:147], a[48:51], 0
    s_add_u32 m0, s35, 40960
    v_cvt_pk_bf16_f32 v58, v44, v45
    v_cvt_pk_bf16_f32 v59, v46, v47
    v_mfma_f32_16x16x32_bf16 v[52:55], a[148:151], a[52:55], v[52:55]
    buffer_load_dwordx4 v19, s[12:15], s22 offen lds
    v_mfma_f32_16x16x32_bf16 v[52:55], a[152:155], a[56:59], v[52:55]
    ds_read_b64_tr_b16 a[186:187], v37 offset:16392
    v_mul_f32 v48, s20, v48
    v_mfma_f32_16x16x32_bf16 v[52:55], a[156:159], a[60:63], v[52:55]
    v_exp_f32 v48, v48

    s_add_u32 m0, s30, 12288
    v_mfma_f32_16x16x32_bf16 v[128:131], a[164:167], v[56:59], v[128:131]
    buffer_store_dwordx4 v[28:31], v15, s[16:19], s32 offen offset:1024 nt
    buffer_load_dwordx4 v15, s[4:7], s28 offen offset:1024 nt lds
    ds_read_b64_tr_b16 a[192:193], v8 offset:16384
    v_mul_f32 v49, s20, v49
    v_mul_f32 v50, s20, v50
    v_mfma_f32_16x16x32_bf16 v[132:135], a[172:175], v[56:59], v[132:135]
    ds_read_b64_tr_b16 a[194:195], v38 offset:16384
    v_mul_f32 v51, s20, v51
    v_mfma_f32_16x16x32_bf16 v[136:139], a[180:183], v[56:59], v[136:139]
    v_exp_f32 v49, v49
    v_mfma_f32_16x16x32_bf16 v[140:143], a[188:191], v[56:59], v[140:143]
    v_exp_f32 v50, v50
    v_mfma_f32_16x16x32_bf16 v[144:147], a[196:199], v[56:59], v[144:147]
    ds_read_b64_tr_b16 a[200:201], v8 offset:16392
    v_mul_f32 v52, s20, v52
    v_mfma_f32_16x16x32_bf16 v[148:151], a[204:207], v[56:59], v[148:151]
    v_exp_f32 v51, v51
    v_mfma_f32_16x16x32_bf16 v[152:155], a[212:215], v[56:59], v[152:155]
    v_exp_f32 v52, v52
    v_mfma_f32_16x16x32_bf16 v[156:159], a[220:223], v[56:59], v[156:159]
    ds_read_b64_tr_b16 a[202:203], v38 offset:16392
    v_mul_f32 v53, s20, v53
    v_mfma_f32_16x16x32_bf16 v[40:43], a[128:131], a[64:67], 0
    v_mul_f32 v54, s20, v54
    v_mul_f32 v55, s20, v55
    v_mfma_f32_16x16x32_bf16 v[40:43], a[132:135], a[68:71], v[40:43]
    v_exp_f32 v53, v53
    v_mfma_f32_16x16x32_bf16 v[40:43], a[136:139], a[72:75], v[40:43]
    buffer_store_dwordx4 v[32:35], v16, s[16:19], s32 offen offset:2048 nt
    buffer_load_dwordx4 v16, s[4:7], s28 offen offset:2048 nt lds
    v_cvt_pk_bf16_f32 v60, v48, v49
    v_cvt_pk_bf16_f32 v61, v50, v51
    v_mfma_f32_16x16x32_bf16 v[40:43], a[140:143], a[76:79], v[40:43]
    v_exp_f32 v54, v54
    v_mfma_f32_16x16x32_bf16 v[44:47], a[144:147], a[64:67], 0
    v_exp_f32 v55, v55
    v_mfma_f32_16x16x32_bf16 v[44:47], a[148:151], a[68:71], v[44:47]
    s_add_u32 m0, s35, 40960
    v_cvt_pk_bf16_f32 v62, v52, v53
    v_cvt_pk_bf16_f32 v63, v54, v55
    v_mfma_f32_16x16x32_bf16 v[44:47], a[152:155], a[72:75], v[44:47]
    buffer_load_dwordx4 v19, s[12:15], s22 offen offset:1024 lds
    v_mfma_f32_16x16x32_bf16 v[44:47], a[156:159], a[76:79], v[44:47]
    s_xor_b32 s22, s22, 24576
    ds_read_b64_tr_b16 a[208:209], v9 offset:16384
    v_mul_f32 v40, s20, v40
    v_smfmac_f32_16x16x64_bf16 a[228:231], a[238:241], v[56:63], v26
    v_exp_f32 v40, v40
    v_mfma_f32_16x16x32_bf16 v[160:163], a[164:167], v[60:63], v[160:163]
    ds_read_b128 v[28:31], v24 offset:15360
    v_mul_f32 v41, s20, v41
    v_mul_f32 v42, s20, v42
    v_mfma_f32_16x16x32_bf16 v[164:167], a[172:175], v[60:63], v[164:167]
    ds_read_b64_tr_b16 a[210:211], v39 offset:16384
    v_mul_f32 v43, s20, v43
    v_mfma_f32_16x16x32_bf16 v[168:171], a[180:183], v[60:63], v[168:171]
    v_exp_f32 v41, v41
    v_mfma_f32_16x16x32_bf16 v[172:175], a[188:191], v[60:63], v[172:175]
    v_exp_f32 v42, v42
    v_mfma_f32_16x16x32_bf16 v[176:179], a[196:199], v[60:63], v[176:179]
    ds_read_b64_tr_b16 a[216:217], v9 offset:16392
    v_mul_f32 v44, s20, v44
    v_mfma_f32_16x16x32_bf16 v[180:183], a[204:207], v[60:63], v[180:183]
    v_exp_f32 v43, v43
    v_mfma_f32_16x16x32_bf16 v[184:187], a[212:215], v[60:63], v[184:187]
    v_exp_f32 v44, v44
    v_mfma_f32_16x16x32_bf16 v[188:191], a[220:223], v[60:63], v[188:191]
    s_waitcnt lgkmcnt(15)
    ds_read_b64_tr_b16 a[218:219], v39 offset:16392
    v_mul_f32 v45, s20, v45
L_B10:
    v_mfma_f32_16x16x32_bf16 v[48:51], a[96:99], a[0:3], 0
    v_mul_f32 v46, s20, v46
    v_mul_f32 v47, s20, v47
    v_mfma_f32_16x16x32_bf16 v[48:51], a[100:103], a[4:7], v[48:51]
    v_exp_f32 v45, v45
    v_mfma_f32_16x16x32_bf16 v[48:51], a[104:107], a[8:11], v[48:51]
    v_cvt_pk_bf16_f32 v56, v40, v41
    v_cvt_pk_bf16_f32 v57, v42, v43
    v_mfma_f32_16x16x32_bf16 v[48:51], a[108:111], a[12:15], v[48:51]
    v_exp_f32 v46, v46
    v_mfma_f32_16x16x32_bf16 v[52:55], a[112:115], a[0:3], 0
    v_exp_f32 v47, v47
    v_mfma_f32_16x16x32_bf16 v[52:55], a[116:119], a[4:7], v[52:55]
    s_waitcnt vmcnt(14) lgkmcnt(0)
    v_cvt_pk_bf16_f32 v58, v44, v45
    v_cvt_pk_bf16_f32 v59, v46, v47
    v_mfma_f32_16x16x32_bf16 v[52:55], a[120:123], a[8:11], v[52:55]
    s_barrier
    v_mfma_f32_16x16x32_bf16 v[52:55], a[124:127], a[12:15], v[52:55]
    ds_read_b128 a[128:131], v2 offset:24576
    v_mul_f32 v48, s20, v48
    v_mfma_f32_16x16x32_bf16 a[232:235], a[248:251], v[56:59], a[232:235]
    v_exp_f32 v48, v48
    v_mul_f32 v49, s20, v49
    v_mul_f32 v50, s20, v50
    v_mfma_f32_16x16x32_bf16 v[192:195], a[164:167], v[56:59], v[192:195]
    ds_read_b128 a[132:135], v3 offset:24576
    v_mul_f32 v51, s20, v51
    v_mfma_f32_16x16x32_bf16 v[196:199], a[172:175], v[56:59], v[196:199]
    v_exp_f32 v49, v49
    v_mfma_f32_16x16x32_bf16 v[200:203], a[180:183], v[56:59], v[200:203]
    v_exp_f32 v50, v50
    v_mfma_f32_16x16x32_bf16 v[204:207], a[188:191], v[56:59], v[204:207]
    ds_read_b128 a[136:139], v4 offset:24576
    v_mul_f32 v52, s20, v52
    v_mfma_f32_16x16x32_bf16 v[208:211], a[196:199], v[56:59], v[208:211]
    v_exp_f32 v51, v51
    v_mfma_f32_16x16x32_bf16 v[212:215], a[204:207], v[56:59], v[212:215]
    v_exp_f32 v52, v52
    v_mfma_f32_16x16x32_bf16 v[216:219], a[212:215], v[56:59], v[216:219]
    ds_read_b128 a[140:143], v5 offset:24576
    v_mul_f32 v53, s20, v53
    v_mfma_f32_16x16x32_bf16 v[220:223], a[220:223], v[56:59], v[220:223]
    v_mul_f32 v54, s20, v54
    v_mul_f32 v55, s20, v55
    v_mfma_f32_16x16x32_bf16 v[40:43], a[96:99], a[16:19], 0
    v_exp_f32 v53, v53
    v_mfma_f32_16x16x32_bf16 v[40:43], a[100:103], a[20:23], v[40:43]
    v_cvt_pk_bf16_f32 v60, v48, v49
    v_cvt_pk_bf16_f32 v61, v50, v51
    v_mfma_f32_16x16x32_bf16 v[40:43], a[104:107], a[24:27], v[40:43]
    v_exp_f32 v54, v54
    v_mfma_f32_16x16x32_bf16 v[40:43], a[108:111], a[28:31], v[40:43]
    v_exp_f32 v55, v55
    v_mfma_f32_16x16x32_bf16 v[44:47], a[112:115], a[16:19], 0
    s_add_u32 m0, s35, 16384
    v_cvt_pk_bf16_f32 v62, v52, v53
    v_cvt_pk_bf16_f32 v63, v54, v55
    v_mfma_f32_16x16x32_bf16 v[44:47], a[116:119], a[20:23], v[44:47]
    buffer_load_dwordx4 v18, s[8:11], s22 offen lds
    v_mfma_f32_16x16x32_bf16 v[44:47], a[120:123], a[24:27], v[44:47]
    ds_read_b128 a[144:147], v0 offset:24576
    v_mul_f32 v40, s20, v40
    v_mfma_f32_16x16x32_bf16 v[44:47], a[124:127], a[28:31], v[44:47]
    v_exp_f32 v40, v40

    v_mfma_f32_16x16x32_bf16 v[64:67], a[160:163], v[60:63], v[64:67]
    v_mul_f32 v41, s20, v41
    v_mul_f32 v42, s20, v42
    v_mfma_f32_16x16x32_bf16 v[68:71], a[168:171], v[60:63], v[68:71]
    ds_read_b128 a[148:151], v1 offset:24576
    v_mul_f32 v43, s20, v43
    v_mfma_f32_16x16x32_bf16 v[72:75], a[176:179], v[60:63], v[72:75]
    v_exp_f32 v41, v41
    v_mfma_f32_16x16x32_bf16 v[76:79], a[184:187], v[60:63], v[76:79]
    v_exp_f32 v42, v42
    v_mfma_f32_16x16x32_bf16 v[80:83], a[192:195], v[60:63], v[80:83]
    ds_read_b128 a[152:155], v25 offset:24576
    v_mul_f32 v44, s20, v44
    v_mfma_f32_16x16x32_bf16 v[84:87], a[200:203], v[60:63], v[84:87]
    v_exp_f32 v43, v43
    v_mfma_f32_16x16x32_bf16 v[88:91], a[208:211], v[60:63], v[88:91]
    v_exp_f32 v44, v44
    v_mfma_f32_16x16x32_bf16 v[92:95], a[216:219], v[60:63], v[92:95]
    ds_read_b128 a[156:159], v27 offset:24576
    v_mul_f32 v45, s20, v45
    v_mfma_f32_16x16x32_bf16 v[48:51], a[96:99], a[32:35], 0
    v_mul_f32 v46, s20, v46
    v_mul_f32 v47, s20, v47
    v_mfma_f32_16x16x32_bf16 v[48:51], a[100:103], a[36:39], v[48:51]
    v_exp_f32 v45, v45
    v_mfma_f32_16x16x32_bf16 v[48:51], a[104:107], a[40:43], v[48:51]
    v_cvt_pk_bf16_f32 v56, v40, v41
    v_cvt_pk_bf16_f32 v57, v42, v43
    v_mfma_f32_16x16x32_bf16 v[48:51], a[108:111], a[44:47], v[48:51]
    v_exp_f32 v46, v46
    v_mfma_f32_16x16x32_bf16 v[52:55], a[112:115], a[32:35], 0
    v_exp_f32 v47, v47
    v_mfma_f32_16x16x32_bf16 v[52:55], a[116:119], a[36:39], v[52:55]
    v_cvt_pk_bf16_f32 v58, v44, v45
    v_cvt_pk_bf16_f32 v59, v46, v47
    v_mfma_f32_16x16x32_bf16 v[52:55], a[120:123], a[40:43], v[52:55]
    buffer_load_dwordx4 v18, s[8:11], s22 offen offset:1024 lds
    v_mfma_f32_16x16x32_bf16 v[52:55], a[124:127], a[44:47], v[52:55]
    ds_read_b64_tr_b16 a[164:165], v6 offset:24576
    v_mul_f32 v48, s20, v48
    v_smfmac_f32_16x16x64_bf16 a[224:227], a[242:245], v[56:63], v26
    v_exp_f32 v48, v48
    v_mul_f32 v49, s20, v49
    v_mul_f32 v50, s20, v50
    v_mfma_f32_16x16x32_bf16 v[96:99], a[160:163], v[56:59], v[96:99]
    ds_read_b64_tr_b16 a[166:167], v36 offset:24576
    v_mul_f32 v51, s20, v51
    v_mfma_f32_16x16x32_bf16 v[100:103], a[168:171], v[56:59], v[100:103]
    v_exp_f32 v49, v49
    v_mfma_f32_16x16x32_bf16 v[104:107], a[176:179], v[56:59], v[104:107]
    v_exp_f32 v50, v50
    v_mfma_f32_16x16x32_bf16 v[108:111], a[184:187], v[56:59], v[108:111]
    ds_read_b64_tr_b16 a[172:173], v6 offset:24584
    v_mul_f32 v52, s20, v52
    v_mfma_f32_16x16x32_bf16 v[112:115], a[192:195], v[56:59], v[112:115]
    v_exp_f32 v51, v51
    v_mfma_f32_16x16x32_bf16 v[116:119], a[200:203], v[56:59], v[116:119]
    v_exp_f32 v52, v52
    v_mfma_f32_16x16x32_bf16 v[120:123], a[208:211], v[56:59], v[120:123]
    ds_read_b64_tr_b16 a[174:175], v36 offset:24584
    v_mul_f32 v53, s20, v53
    v_mfma_f32_16x16x32_bf16 v[124:127], a[216:219], v[56:59], v[124:127]
    v_mul_f32 v54, s20, v54
    v_mul_f32 v55, s20, v55
    v_mfma_f32_16x16x32_bf16 v[40:43], a[96:99], a[48:51], 0
    v_exp_f32 v53, v53
    v_mfma_f32_16x16x32_bf16 v[40:43], a[100:103], a[52:55], v[40:43]
    v_cvt_pk_bf16_f32 v60, v48, v49
    v_cvt_pk_bf16_f32 v61, v50, v51
    v_mfma_f32_16x16x32_bf16 v[40:43], a[104:107], a[56:59], v[40:43]
    v_exp_f32 v54, v54
    v_mfma_f32_16x16x32_bf16 v[40:43], a[108:111], a[60:63], v[40:43]
    v_exp_f32 v55, v55
    v_mfma_f32_16x16x32_bf16 v[44:47], a[112:115], a[48:51], 0
    s_add_u32 m0, s35, 49152
    v_cvt_pk_bf16_f32 v62, v52, v53
    v_cvt_pk_bf16_f32 v63, v54, v55
    v_mfma_f32_16x16x32_bf16 v[44:47], a[116:119], a[52:55], v[44:47]
    buffer_load_dwordx4 v19, s[12:15], s22 offen lds
    v_mfma_f32_16x16x32_bf16 v[44:47], a[120:123], a[56:59], v[44:47]
    ds_read_b64_tr_b16 a[180:181], v7 offset:24576
    v_mul_f32 v40, s20, v40
    v_mfma_f32_16x16x32_bf16 v[44:47], a[124:127], a[60:63], v[44:47]
    v_exp_f32 v40, v40

    v_mfma_f32_16x16x32_bf16 v[128:131], a[160:163], v[60:63], v[128:131]
    v_mul_f32 v41, s20, v41
    v_mul_f32 v42, s20, v42
    v_mfma_f32_16x16x32_bf16 v[132:135], a[168:171], v[60:63], v[132:135]
    ds_read_b64_tr_b16 a[182:183], v37 offset:24576
    v_mul_f32 v43, s20, v43
    v_mfma_f32_16x16x32_bf16 v[136:139], a[176:179], v[60:63], v[136:139]
    v_exp_f32 v41, v41
    v_mfma_f32_16x16x32_bf16 v[140:143], a[184:187], v[60:63], v[140:143]
    v_exp_f32 v42, v42
    v_mfma_f32_16x16x32_bf16 v[144:147], a[192:195], v[60:63], v[144:147]
    ds_read_b64_tr_b16 a[188:189], v7 offset:24584
    v_mul_f32 v44, s20, v44
    v_mfma_f32_16x16x32_bf16 v[148:151], a[200:203], v[60:63], v[148:151]
    v_exp_f32 v43, v43
    v_mfma_f32_16x16x32_bf16 v[152:155], a[208:211], v[60:63], v[152:155]
    v_exp_f32 v44, v44
    v_mfma_f32_16x16x32_bf16 v[156:159], a[216:219], v[60:63], v[156:159]
    ds_read_b64_tr_b16 a[190:191], v37 offset:24584
    v_mul_f32 v45, s20, v45
    v_mfma_f32_16x16x32_bf16 v[48:51], a[96:99], a[64:67], 0
    v_mul_f32 v46, s20, v46
    v_mul_f32 v47, s20, v47
    v_mfma_f32_16x16x32_bf16 v[48:51], a[100:103], a[68:71], v[48:51]
    v_exp_f32 v45, v45
    v_mfma_f32_16x16x32_bf16 v[48:51], a[104:107], a[72:75], v[48:51]
    v_cvt_pk_bf16_f32 v56, v40, v41
    v_cvt_pk_bf16_f32 v57, v42, v43
    v_mfma_f32_16x16x32_bf16 v[48:51], a[108:111], a[76:79], v[48:51]
    v_exp_f32 v46, v46
    v_mfma_f32_16x16x32_bf16 v[52:55], a[112:115], a[64:67], 0
    v_exp_f32 v47, v47
    v_mfma_f32_16x16x32_bf16 v[52:55], a[116:119], a[68:71], v[52:55]
    v_cvt_pk_bf16_f32 v58, v44, v45
    v_cvt_pk_bf16_f32 v59, v46, v47
    v_mfma_f32_16x16x32_bf16 v[52:55], a[120:123], a[72:75], v[52:55]
    buffer_load_dwordx4 v19, s[12:15], s22 offen offset:1024 lds
    v_mfma_f32_16x16x32_bf16 v[52:55], a[124:127], a[76:79], v[52:55]
    s_add_u32 m0, s30, 12288
    ds_read_b64_tr_b16 a[196:197], v8 offset:24576
    v_mul_f32 v48, s20, v48
    v_smfmac_f32_16x16x64_bf16 a[228:231], a[242:245], v[56:63], v26
    buffer_store_dwordx4 v[28:31], v17, s[16:19], s32 offen offset:3072 nt
    buffer_load_dwordx4 v17, s[4:7], s28 offen offset:3072 nt lds
    v_exp_f32 v48, v48
    v_mul_f32 v49, s20, v49
    v_mul_f32 v50, s20, v50
    v_mfma_f32_16x16x32_bf16 v[160:163], a[160:163], v[56:59], v[160:163]
    s_xor_b32 s22, s22, 8192
    ds_read_b64_tr_b16 a[198:199], v38 offset:24576
    v_mul_f32 v51, s20, v51
    v_mfma_f32_16x16x32_bf16 v[164:167], a[168:171], v[56:59], v[164:167]
    v_exp_f32 v49, v49
    v_mfma_f32_16x16x32_bf16 v[168:171], a[176:179], v[56:59], v[168:171]
    v_exp_f32 v50, v50
    v_mfma_f32_16x16x32_bf16 v[172:175], a[184:187], v[56:59], v[172:175]
    ds_read_b64_tr_b16 a[204:205], v8 offset:24584
    v_mul_f32 v52, s20, v52
    v_mfma_f32_16x16x32_bf16 v[176:179], a[192:195], v[56:59], v[176:179]
    v_exp_f32 v51, v51
    v_mfma_f32_16x16x32_bf16 v[180:183], a[200:203], v[56:59], v[180:183]
    v_exp_f32 v52, v52
    v_mfma_f32_16x16x32_bf16 v[184:187], a[208:211], v[56:59], v[184:187]
    ds_read_b64_tr_b16 a[206:207], v38 offset:24584
    v_mul_f32 v53, s20, v53
    v_mfma_f32_16x16x32_bf16 v[188:191], a[216:219], v[56:59], v[188:191]
    s_waitcnt lgkmcnt(12)
    v_mul_f32 v54, s20, v54
    v_mul_f32 v55, s20, v55
    v_mfma_f32_16x16x32_bf16 v[40:43], a[112:115], a[80:83], 0
    v_exp_f32 v53, v53
    v_mfma_f32_16x16x32_bf16 v[40:43], a[116:119], a[84:87], v[40:43]
    v_cvt_pk_bf16_f32 v60, v48, v49
    v_cvt_pk_bf16_f32 v61, v50, v51
    v_mfma_f32_16x16x32_bf16 v[40:43], a[120:123], a[88:91], v[40:43]
    v_exp_f32 v54, v54
    v_mfma_f32_16x16x32_bf16 v[40:43], a[124:127], a[92:95], v[40:43]
    v_exp_f32 v55, v55
    v_mfma_f32_16x16x32_bf16 v[44:47], a[128:131], a[80:83], 0
    v_cvt_pk_bf16_f32 v62, v52, v53
    v_cvt_pk_bf16_f32 v63, v54, v55
    v_mfma_f32_16x16x32_bf16 v[44:47], a[132:135], a[84:87], v[44:47]
    ds_read_b128 v[28:31], v24 offset:16384
    ds_read_b128 v[32:35], v24 offset:17408
    v_mfma_f32_16x16x32_bf16 v[44:47], a[136:139], a[88:91], v[44:47]
    ds_read_b64_tr_b16 a[212:213], v9 offset:24576
    v_mul_f32 v40, s20, v40
    v_mfma_f32_16x16x32_bf16 v[44:47], a[140:143], a[92:95], v[44:47]
    v_exp_f32 v40, v40

    v_mfma_f32_16x16x32_bf16 v[192:195], a[160:163], v[60:63], v[192:195]
    v_mul_f32 v41, s20, v41
    v_mul_f32 v42, s20, v42
    v_mfma_f32_16x16x32_bf16 v[196:199], a[168:171], v[60:63], v[196:199]
    ds_read_b64_tr_b16 a[214:215], v39 offset:24576
    v_mul_f32 v43, s20, v43
    v_mfma_f32_16x16x32_bf16 v[200:203], a[176:179], v[60:63], v[200:203]
    v_exp_f32 v41, v41
    v_mfma_f32_16x16x32_bf16 v[204:207], a[184:187], v[60:63], v[204:207]
    v_exp_f32 v42, v42
    v_mfma_f32_16x16x32_bf16 v[208:211], a[192:195], v[60:63], v[208:211]
    ds_read_b64_tr_b16 a[220:221], v9 offset:24584
    v_mul_f32 v44, s20, v44
    v_mfma_f32_16x16x32_bf16 v[212:215], a[200:203], v[60:63], v[212:215]
    v_exp_f32 v43, v43
    v_mfma_f32_16x16x32_bf16 v[216:219], a[208:211], v[60:63], v[216:219]
    v_exp_f32 v44, v44
    v_mfma_f32_16x16x32_bf16 v[220:223], a[216:219], v[60:63], v[220:223]
    ds_read_b64_tr_b16 a[222:223], v39 offset:24584
    v_mul_f32 v45, s20, v45
L_B11:
    v_mfma_f32_16x16x32_bf16 v[48:51], a[128:131], a[0:3], 0
    v_mul_f32 v46, s20, v46
    v_mul_f32 v47, s20, v47
    v_mfma_f32_16x16x32_bf16 v[48:51], a[132:135], a[4:7], v[48:51]
    v_exp_f32 v45, v45
    v_mfma_f32_16x16x32_bf16 v[48:51], a[136:139], a[8:11], v[48:51]
    v_cvt_pk_bf16_f32 v56, v40, v41
    v_cvt_pk_bf16_f32 v57, v42, v43
    v_mfma_f32_16x16x32_bf16 v[48:51], a[140:143], a[12:15], v[48:51]
    v_exp_f32 v46, v46
    v_mfma_f32_16x16x32_bf16 v[52:55], a[144:147], a[0:3], 0
    v_exp_f32 v47, v47
    v_mfma_f32_16x16x32_bf16 v[52:55], a[148:151], a[4:7], v[52:55]
    s_waitcnt vmcnt(16) lgkmcnt(0)
    v_cvt_pk_bf16_f32 v58, v44, v45
    v_cvt_pk_bf16_f32 v59, v46, v47
    v_mfma_f32_16x16x32_bf16 v[52:55], a[152:155], a[8:11], v[52:55]
    s_barrier
    v_mfma_f32_16x16x32_bf16 v[52:55], a[156:159], a[12:15], v[52:55]
    ds_read_b128 a[96:99], v2 offset:0
    v_mul_f32 v48, s20, v48
    v_smfmac_f32_16x16x64_bf16 a[232:235], a[242:245], v[56:63], v26
    ds_read_b128 a[100:103], v3 offset:0
    v_exp_f32 v48, v48
    v_mul_f32 v49, s20, v49
    v_mul_f32 v50, s20, v50
    v_mfma_f32_16x16x32_bf16 v[224:227], a[162:165], v[56:59], v[224:227]
    ds_read_b128 a[104:107], v4 offset:0
    v_mul_f32 v51, s20, v51
    v_mfma_f32_16x16x32_bf16 v[228:231], a[170:173], v[56:59], v[228:231]
    v_exp_f32 v49, v49
    v_mfma_f32_16x16x32_bf16 v[232:235], a[178:181], v[56:59], v[232:235]
    v_exp_f32 v50, v50
    v_mfma_f32_16x16x32_bf16 v[236:239], a[186:189], v[56:59], v[236:239]
    ds_read_b128 a[108:111], v5 offset:0
    v_mul_f32 v52, s20, v52
    v_mfma_f32_16x16x32_bf16 v[240:243], a[194:197], v[56:59], v[240:243]
    v_exp_f32 v51, v51
    v_mfma_f32_16x16x32_bf16 v[244:247], a[202:205], v[56:59], v[244:247]
    v_exp_f32 v52, v52
    v_mfma_f32_16x16x32_bf16 v[248:251], a[210:213], v[56:59], v[248:251]
    ds_read_b128 a[112:115], v0 offset:0
    v_mul_f32 v53, s20, v53
    v_mfma_f32_16x16x32_bf16 v[252:255], a[218:221], v[56:59], v[252:255]
    v_mul_f32 v54, s20, v54
    v_mul_f32 v55, s20, v55
    v_mfma_f32_16x16x32_bf16 v[40:43], a[128:131], a[16:19], 0
    v_exp_f32 v53, v53
    v_mfma_f32_16x16x32_bf16 v[40:43], a[132:135], a[20:23], v[40:43]
    v_cvt_pk_bf16_f32 v60, v48, v49
    v_cvt_pk_bf16_f32 v61, v50, v51
    v_mfma_f32_16x16x32_bf16 v[40:43], a[136:139], a[24:27], v[40:43]
    v_exp_f32 v54, v54
    v_mfma_f32_16x16x32_bf16 v[40:43], a[140:143], a[28:31], v[40:43]
    v_exp_f32 v55, v55
    v_mfma_f32_16x16x32_bf16 v[44:47], a[144:147], a[16:19], 0
    s_add_u32 m0, s35, 24576
    v_cvt_pk_bf16_f32 v62, v52, v53
    v_cvt_pk_bf16_f32 v63, v54, v55
    v_mfma_f32_16x16x32_bf16 v[44:47], a[148:151], a[20:23], v[44:47]
    buffer_load_dwordx4 v18, s[8:11], s22 offen lds
    v_mfma_f32_16x16x32_bf16 v[44:47], a[152:155], a[24:27], v[44:47]
    ds_read_b128 a[116:119], v1 offset:0
    v_mul_f32 v40, s20, v40
    v_mfma_f32_16x16x32_bf16 v[44:47], a[156:159], a[28:31], v[44:47]
    v_exp_f32 v40, v40

    v_mfma_f32_16x16x32_bf16 v[64:67], a[164:167], v[60:63], v[64:67]
    ds_read_b128 a[120:123], v25 offset:0
    v_mul_f32 v41, s20, v41
    v_mul_f32 v42, s20, v42
    v_mfma_f32_16x16x32_bf16 v[68:71], a[172:175], v[60:63], v[68:71]
    ds_read_b128 a[124:127], v27 offset:0
    v_mul_f32 v43, s20, v43
    v_mfma_f32_16x16x32_bf16 v[72:75], a[180:183], v[60:63], v[72:75]
    v_exp_f32 v41, v41
    v_mfma_f32_16x16x32_bf16 v[76:79], a[188:191], v[60:63], v[76:79]
    v_exp_f32 v42, v42
    v_mfma_f32_16x16x32_bf16 v[80:83], a[196:199], v[60:63], v[80:83]
    ds_read_b64_tr_b16 a[160:161], v6 offset:0
    v_mul_f32 v44, s20, v44
    v_mfma_f32_16x16x32_bf16 v[84:87], a[204:207], v[60:63], v[84:87]
    v_exp_f32 v43, v43
    v_mfma_f32_16x16x32_bf16 v[88:91], a[212:215], v[60:63], v[88:91]
    v_exp_f32 v44, v44
    v_mfma_f32_16x16x32_bf16 v[92:95], a[220:223], v[60:63], v[92:95]
    ds_read_b64_tr_b16 a[162:163], v36 offset:0
    v_mul_f32 v45, s20, v45
    v_mfma_f32_16x16x32_bf16 v[48:51], a[128:131], a[32:35], 0
    v_mul_f32 v46, s20, v46
    v_mul_f32 v47, s20, v47
    v_mfma_f32_16x16x32_bf16 v[48:51], a[132:135], a[36:39], v[48:51]
    v_exp_f32 v45, v45
    v_mfma_f32_16x16x32_bf16 v[48:51], a[136:139], a[40:43], v[48:51]
    v_cvt_pk_bf16_f32 v56, v40, v41
    v_cvt_pk_bf16_f32 v57, v42, v43
    v_mfma_f32_16x16x32_bf16 v[48:51], a[140:143], a[44:47], v[48:51]
    v_exp_f32 v46, v46
    v_mfma_f32_16x16x32_bf16 v[52:55], a[144:147], a[32:35], 0
    v_exp_f32 v47, v47
    v_mfma_f32_16x16x32_bf16 v[52:55], a[148:151], a[36:39], v[52:55]
    v_cvt_pk_bf16_f32 v58, v44, v45
    v_cvt_pk_bf16_f32 v59, v46, v47
    v_mfma_f32_16x16x32_bf16 v[52:55], a[152:155], a[40:43], v[52:55]
    buffer_load_dwordx4 v18, s[8:11], s22 offen offset:1024 lds
    v_mfma_f32_16x16x32_bf16 v[52:55], a[156:159], a[44:47], v[52:55]
    ds_read_b64_tr_b16 a[168:169], v6 offset:8
    v_mul_f32 v48, s20, v48
    v_smfmac_f32_16x16x64_bf16 a[224:227], a[242:245], v[56:63], v26
    ds_read_b64_tr_b16 a[170:171], v36 offset:8
    v_exp_f32 v48, v48
    v_mul_f32 v49, s20, v49
    v_mul_f32 v50, s20, v50
    v_mfma_f32_16x16x32_bf16 v[96:99], a[164:167], v[56:59], v[96:99]
    ds_read_b64_tr_b16 a[176:177], v7 offset:0
    v_mul_f32 v51, s20, v51
    v_mfma_f32_16x16x32_bf16 v[100:103], a[172:175], v[56:59], v[100:103]
    v_exp_f32 v49, v49
    v_mfma_f32_16x16x32_bf16 v[104:107], a[180:183], v[56:59], v[104:107]
    v_exp_f32 v50, v50
    v_mfma_f32_16x16x32_bf16 v[108:111], a[188:191], v[56:59], v[108:111]
    ds_read_b64_tr_b16 a[178:179], v37 offset:0
    v_mul_f32 v52, s20, v52
    v_mfma_f32_16x16x32_bf16 v[112:115], a[196:199], v[56:59], v[112:115]
    v_exp_f32 v51, v51
    v_mfma_f32_16x16x32_bf16 v[116:119], a[204:207], v[56:59], v[116:119]
    v_exp_f32 v52, v52
    v_mfma_f32_16x16x32_bf16 v[120:123], a[212:215], v[56:59], v[120:123]
    ds_read_b64_tr_b16 a[184:185], v7 offset:8
    v_mul_f32 v53, s20, v53
    v_mfma_f32_16x16x32_bf16 v[124:127], a[220:223], v[56:59], v[124:127]
    v_mul_f32 v54, s20, v54
    v_mul_f32 v55, s20, v55
    v_mfma_f32_16x16x32_bf16 v[40:43], a[128:131], a[48:51], 0
    v_exp_f32 v53, v53
    v_mfma_f32_16x16x32_bf16 v[40:43], a[132:135], a[52:55], v[40:43]
    v_cvt_pk_bf16_f32 v60, v48, v49
    v_cvt_pk_bf16_f32 v61, v50, v51
    v_mfma_f32_16x16x32_bf16 v[40:43], a[136:139], a[56:59], v[40:43]
    v_exp_f32 v54, v54
    v_mfma_f32_16x16x32_bf16 v[40:43], a[140:143], a[60:63], v[40:43]
    v_exp_f32 v55, v55
    v_mfma_f32_16x16x32_bf16 v[44:47], a[144:147], a[48:51], 0
    s_add_u32 m0, s35, 57344
    v_cvt_pk_bf16_f32 v62, v52, v53
    v_cvt_pk_bf16_f32 v63, v54, v55
    v_mfma_f32_16x16x32_bf16 v[44:47], a[148:151], a[52:55], v[44:47]
    buffer_load_dwordx4 v19, s[12:15], s22 offen lds
    v_mfma_f32_16x16x32_bf16 v[44:47], a[152:155], a[56:59], v[44:47]
    s_add_u32 s28, s24, 16384
    ds_read_b64_tr_b16 a[186:187], v37 offset:8
    v_mul_f32 v40, s20, v40
    v_mfma_f32_16x16x32_bf16 v[44:47], a[156:159], a[60:63], v[44:47]
    s_add_u32 s32, s31, 16384
    v_exp_f32 v40, v40

    s_add_u32 m0, s30, 16384
    v_mfma_f32_16x16x32_bf16 v[128:131], a[164:167], v[60:63], v[128:131]
    buffer_store_dwordx4 v[28:31], v14, s[16:19], s32 offen nt
    buffer_load_dwordx4 v14, s[4:7], s28 offen nt lds
    ds_read_b64_tr_b16 a[192:193], v8 offset:0
    v_mul_f32 v41, s20, v41
    v_mul_f32 v42, s20, v42
    v_mfma_f32_16x16x32_bf16 v[132:135], a[172:175], v[60:63], v[132:135]
    ds_read_b64_tr_b16 a[194:195], v38 offset:0
    v_mul_f32 v43, s20, v43
    v_mfma_f32_16x16x32_bf16 v[136:139], a[180:183], v[60:63], v[136:139]
    v_exp_f32 v41, v41
    v_mfma_f32_16x16x32_bf16 v[140:143], a[188:191], v[60:63], v[140:143]
    v_exp_f32 v42, v42
    v_mfma_f32_16x16x32_bf16 v[144:147], a[196:199], v[60:63], v[144:147]
    ds_read_b64_tr_b16 a[200:201], v8 offset:8
    v_mul_f32 v44, s20, v44
    v_mfma_f32_16x16x32_bf16 v[148:151], a[204:207], v[60:63], v[148:151]
    v_exp_f32 v43, v43
    v_mfma_f32_16x16x32_bf16 v[152:155], a[212:215], v[60:63], v[152:155]
    v_exp_f32 v44, v44
    v_mfma_f32_16x16x32_bf16 v[156:159], a[220:223], v[60:63], v[156:159]
    ds_read_b64_tr_b16 a[202:203], v38 offset:8
    v_mul_f32 v45, s20, v45
    v_mfma_f32_16x16x32_bf16 v[48:51], a[128:131], a[64:67], 0
    v_mul_f32 v46, s20, v46
    v_mul_f32 v47, s20, v47
    v_mfma_f32_16x16x32_bf16 v[48:51], a[132:135], a[68:71], v[48:51]
    v_exp_f32 v45, v45
    v_mfma_f32_16x16x32_bf16 v[48:51], a[136:139], a[72:75], v[48:51]
    buffer_store_dwordx4 v[32:35], v15, s[16:19], s32 offen offset:1024 nt
    buffer_load_dwordx4 v15, s[4:7], s28 offen offset:1024 nt lds
    v_cvt_pk_bf16_f32 v56, v40, v41
    v_cvt_pk_bf16_f32 v57, v42, v43
    v_mfma_f32_16x16x32_bf16 v[48:51], a[140:143], a[76:79], v[48:51]
    v_exp_f32 v46, v46
    v_mfma_f32_16x16x32_bf16 v[52:55], a[144:147], a[64:67], 0
    v_exp_f32 v47, v47
    v_mfma_f32_16x16x32_bf16 v[52:55], a[148:151], a[68:71], v[52:55]
    s_add_u32 m0, s35, 57344
    v_cvt_pk_bf16_f32 v58, v44, v45
    v_cvt_pk_bf16_f32 v59, v46, v47
    v_mfma_f32_16x16x32_bf16 v[52:55], a[152:155], a[72:75], v[52:55]
    buffer_load_dwordx4 v19, s[12:15], s22 offen offset:1024 lds
    v_mfma_f32_16x16x32_bf16 v[52:55], a[156:159], a[76:79], v[52:55]
    s_xor_b32 s22, s22, 122880
    ds_read_b64_tr_b16 a[208:209], v9 offset:0
    v_mul_f32 v48, s20, v48
    v_smfmac_f32_16x16x64_bf16 a[228:231], a[242:245], v[56:63], v26
    v_exp_f32 v48, v48
    v_mfma_f32_16x16x32_bf16 v[160:163], a[164:167], v[56:59], v[160:163]
    ds_read_b128 v[28:31], v24 offset:18432
    ds_read_b128 v[32:35], v24 offset:19456
    v_mul_f32 v49, s20, v49
    v_mul_f32 v50, s20, v50
    v_mfma_f32_16x16x32_bf16 v[164:167], a[172:175], v[56:59], v[164:167]
    ds_read_b64_tr_b16 a[210:211], v39 offset:0
    v_mul_f32 v51, s20, v51
    v_mfma_f32_16x16x32_bf16 v[168:171], a[180:183], v[56:59], v[168:171]
    v_exp_f32 v49, v49
    v_mfma_f32_16x16x32_bf16 v[172:175], a[188:191], v[56:59], v[172:175]
    v_exp_f32 v50, v50
    v_mfma_f32_16x16x32_bf16 v[176:179], a[196:199], v[56:59], v[176:179]
    ds_read_b64_tr_b16 a[216:217], v9 offset:8
    v_mul_f32 v52, s20, v52
    v_mfma_f32_16x16x32_bf16 v[180:183], a[204:207], v[56:59], v[180:183]
    v_exp_f32 v51, v51
    v_mfma_f32_16x16x32_bf16 v[184:187], a[212:215], v[56:59], v[184:187]
    v_exp_f32 v52, v52
    v_mfma_f32_16x16x32_bf16 v[188:191], a[220:223], v[56:59], v[188:191]
    s_waitcnt lgkmcnt(15)
    ds_read_b64_tr_b16 a[218:219], v39 offset:8
    v_mul_f32 v53, s20, v53
L_B12:
    v_mfma_f32_16x16x32_bf16 v[40:43], a[96:99], a[0:3], 0
    s_mov_b32 s22, s23
    v_mul_f32 v54, s20, v54
    v_mul_f32 v55, s20, v55
    v_mfma_f32_16x16x32_bf16 v[40:43], a[100:103], a[4:7], v[40:43]
    v_exp_f32 v53, v53
    v_mfma_f32_16x16x32_bf16 v[40:43], a[104:107], a[8:11], v[40:43]
    v_cvt_pk_bf16_f32 v60, v48, v49
    v_cvt_pk_bf16_f32 v61, v50, v51
    v_mfma_f32_16x16x32_bf16 v[40:43], a[108:111], a[12:15], v[40:43]
    v_exp_f32 v54, v54
    v_mfma_f32_16x16x32_bf16 v[44:47], a[112:115], a[0:3], 0
    v_exp_f32 v55, v55
    v_mfma_f32_16x16x32_bf16 v[44:47], a[116:119], a[4:7], v[44:47]
    s_waitcnt vmcnt(14) lgkmcnt(0)
    v_cvt_pk_bf16_f32 v62, v52, v53
    v_cvt_pk_bf16_f32 v63, v54, v55
    v_mfma_f32_16x16x32_bf16 v[44:47], a[120:123], a[8:11], v[44:47]
    s_barrier
    v_mfma_f32_16x16x32_bf16 v[44:47], a[124:127], a[12:15], v[44:47]
    ds_read_b128 a[128:131], v2 offset:8192
    v_mul_f32 v40, s20, v40
    v_mfma_f32_16x16x32_bf16 a[232:235], a[248:251], v[60:63], a[232:235]
    v_exp_f32 v40, v40
    v_mul_f32 v41, s20, v41
    v_mul_f32 v42, s20, v42
    v_mfma_f32_16x16x32_bf16 v[192:195], a[164:167], v[60:63], v[192:195]
    ds_read_b128 a[132:135], v3 offset:8192
    v_mul_f32 v43, s20, v43
    v_mfma_f32_16x16x32_bf16 v[196:199], a[172:175], v[60:63], v[196:199]
    v_exp_f32 v41, v41
    v_mfma_f32_16x16x32_bf16 v[200:203], a[180:183], v[60:63], v[200:203]
    v_exp_f32 v42, v42
    v_mfma_f32_16x16x32_bf16 v[204:207], a[188:191], v[60:63], v[204:207]
    ds_read_b128 a[136:139], v4 offset:8192
    v_mul_f32 v44, s20, v44
    v_mfma_f32_16x16x32_bf16 v[208:211], a[196:199], v[60:63], v[208:211]
    v_exp_f32 v43, v43
    v_mfma_f32_16x16x32_bf16 v[212:215], a[204:207], v[60:63], v[212:215]
    v_exp_f32 v44, v44
    v_mfma_f32_16x16x32_bf16 v[216:219], a[212:215], v[60:63], v[216:219]
    ds_read_b128 a[140:143], v5 offset:8192
    v_mul_f32 v45, s20, v45
    v_mfma_f32_16x16x32_bf16 v[220:223], a[220:223], v[60:63], v[220:223]
    v_mul_f32 v46, s20, v46
    v_mul_f32 v47, s20, v47
    v_mfma_f32_16x16x32_bf16 v[48:51], a[96:99], a[16:19], 0
    v_exp_f32 v45, v45
    v_mfma_f32_16x16x32_bf16 v[48:51], a[100:103], a[20:23], v[48:51]
    v_cvt_pk_bf16_f32 v56, v40, v41
    v_cvt_pk_bf16_f32 v57, v42, v43
    v_mfma_f32_16x16x32_bf16 v[48:51], a[104:107], a[24:27], v[48:51]
    v_exp_f32 v46, v46
    v_mfma_f32_16x16x32_bf16 v[48:51], a[108:111], a[28:31], v[48:51]
    v_exp_f32 v47, v47
    v_mfma_f32_16x16x32_bf16 v[52:55], a[112:115], a[16:19], 0
    s_add_u32 m0, s35, 0
    v_cvt_pk_bf16_f32 v58, v44, v45
    v_cvt_pk_bf16_f32 v59, v46, v47
    v_mfma_f32_16x16x32_bf16 v[52:55], a[116:119], a[20:23], v[52:55]
    buffer_load_dwordx4 v18, s[8:11], s22 offen lds
    v_mfma_f32_16x16x32_bf16 v[52:55], a[120:123], a[24:27], v[52:55]
    ds_read_b128 a[144:147], v0 offset:8192
    v_mul_f32 v48, s20, v48
    v_mfma_f32_16x16x32_bf16 v[52:55], a[124:127], a[28:31], v[52:55]
    v_exp_f32 v48, v48

    v_mfma_f32_16x16x32_bf16 v[64:67], a[160:163], v[56:59], v[64:67]
    v_mul_f32 v49, s20, v49
    v_mul_f32 v50, s20, v50
    v_mfma_f32_16x16x32_bf16 v[68:71], a[168:171], v[56:59], v[68:71]
    ds_read_b128 a[148:151], v1 offset:8192
    v_mul_f32 v51, s20, v51
    v_mfma_f32_16x16x32_bf16 v[72:75], a[176:179], v[56:59], v[72:75]
    v_exp_f32 v49, v49
    v_mfma_f32_16x16x32_bf16 v[76:79], a[184:187], v[56:59], v[76:79]
    v_exp_f32 v50, v50
    v_mfma_f32_16x16x32_bf16 v[80:83], a[192:195], v[56:59], v[80:83]
    ds_read_b128 a[152:155], v25 offset:8192
    v_mul_f32 v52, s20, v52
    v_mfma_f32_16x16x32_bf16 v[84:87], a[200:203], v[56:59], v[84:87]
    v_exp_f32 v51, v51
    v_mfma_f32_16x16x32_bf16 v[88:91], a[208:211], v[56:59], v[88:91]
    v_exp_f32 v52, v52
    v_mfma_f32_16x16x32_bf16 v[92:95], a[216:219], v[56:59], v[92:95]
    ds_read_b128 a[156:159], v27 offset:8192
    v_mul_f32 v53, s20, v53
    v_mfma_f32_16x16x32_bf16 v[40:43], a[96:99], a[32:35], 0
    v_mul_f32 v54, s20, v54
    v_mul_f32 v55, s20, v55
    v_mfma_f32_16x16x32_bf16 v[40:43], a[100:103], a[36:39], v[40:43]
    v_exp_f32 v53, v53
    v_mfma_f32_16x16x32_bf16 v[40:43], a[104:107], a[40:43], v[40:43]
    v_cvt_pk_bf16_f32 v60, v48, v49
    v_cvt_pk_bf16_f32 v61, v50, v51
    v_mfma_f32_16x16x32_bf16 v[40:43], a[108:111], a[44:47], v[40:43]
    v_exp_f32 v54, v54
    v_mfma_f32_16x16x32_bf16 v[44:47], a[112:115], a[32:35], 0
    v_exp_f32 v55, v55
    v_mfma_f32_16x16x32_bf16 v[44:47], a[116:119], a[36:39], v[44:47]
    v_cvt_pk_bf16_f32 v62, v52, v53
    v_cvt_pk_bf16_f32 v63, v54, v55
    v_mfma_f32_16x16x32_bf16 v[44:47], a[120:123], a[40:43], v[44:47]
    buffer_load_dwordx4 v18, s[8:11], s22 offen offset:1024 lds
    v_mfma_f32_16x16x32_bf16 v[44:47], a[124:127], a[44:47], v[44:47]
    ds_read_b64_tr_b16 a[164:165], v6 offset:8192
    v_mul_f32 v40, s20, v40
    v_smfmac_f32_16x16x64_bf16 a[224:227], a[238:241], v[56:63], v26
    v_exp_f32 v40, v40
    v_mul_f32 v41, s20, v41
    v_mul_f32 v42, s20, v42
    v_mfma_f32_16x16x32_bf16 v[96:99], a[160:163], v[60:63], v[96:99]
    ds_read_b64_tr_b16 a[166:167], v36 offset:8192
    v_mul_f32 v43, s20, v43
    v_mfma_f32_16x16x32_bf16 v[100:103], a[168:171], v[60:63], v[100:103]
    v_exp_f32 v41, v41
    v_mfma_f32_16x16x32_bf16 v[104:107], a[176:179], v[60:63], v[104:107]
    v_exp_f32 v42, v42
    v_mfma_f32_16x16x32_bf16 v[108:111], a[184:187], v[60:63], v[108:111]
    ds_read_b64_tr_b16 a[172:173], v6 offset:8200
    v_mul_f32 v44, s20, v44
    v_mfma_f32_16x16x32_bf16 v[112:115], a[192:195], v[60:63], v[112:115]
    v_exp_f32 v43, v43
    v_mfma_f32_16x16x32_bf16 v[116:119], a[200:203], v[60:63], v[116:119]
    v_exp_f32 v44, v44
    v_mfma_f32_16x16x32_bf16 v[120:123], a[208:211], v[60:63], v[120:123]
    ds_read_b64_tr_b16 a[174:175], v36 offset:8200
    v_mul_f32 v45, s20, v45
    v_mfma_f32_16x16x32_bf16 v[124:127], a[216:219], v[60:63], v[124:127]
    v_mul_f32 v46, s20, v46
    v_mul_f32 v47, s20, v47
    v_mfma_f32_16x16x32_bf16 v[48:51], a[96:99], a[48:51], 0
    v_exp_f32 v45, v45
    v_mfma_f32_16x16x32_bf16 v[48:51], a[100:103], a[52:55], v[48:51]
    v_cvt_pk_bf16_f32 v56, v40, v41
    v_cvt_pk_bf16_f32 v57, v42, v43
    v_mfma_f32_16x16x32_bf16 v[48:51], a[104:107], a[56:59], v[48:51]
    v_exp_f32 v46, v46
    v_mfma_f32_16x16x32_bf16 v[48:51], a[108:111], a[60:63], v[48:51]
    v_exp_f32 v47, v47
    v_mfma_f32_16x16x32_bf16 v[52:55], a[112:115], a[48:51], 0
    s_add_u32 m0, s35, 32768
    v_cvt_pk_bf16_f32 v58, v44, v45
    v_cvt_pk_bf16_f32 v59, v46, v47
    v_mfma_f32_16x16x32_bf16 v[52:55], a[116:119], a[52:55], v[52:55]
    buffer_load_dwordx4 v19, s[12:15], s22 offen lds
    v_mfma_f32_16x16x32_bf16 v[52:55], a[120:123], a[56:59], v[52:55]
    ds_read_b64_tr_b16 a[180:181], v7 offset:8192
    v_mul_f32 v48, s20, v48
    v_mfma_f32_16x16x32_bf16 v[52:55], a[124:127], a[60:63], v[52:55]
    v_exp_f32 v48, v48

    v_mfma_f32_16x16x32_bf16 v[128:131], a[160:163], v[56:59], v[128:131]
    v_mul_f32 v49, s20, v49
    v_mul_f32 v50, s20, v50
    v_mfma_f32_16x16x32_bf16 v[132:135], a[168:171], v[56:59], v[132:135]
    ds_read_b64_tr_b16 a[182:183], v37 offset:8192
    v_mul_f32 v51, s20, v51
    v_mfma_f32_16x16x32_bf16 v[136:139], a[176:179], v[56:59], v[136:139]
    v_exp_f32 v49, v49
    v_mfma_f32_16x16x32_bf16 v[140:143], a[184:187], v[56:59], v[140:143]
    v_exp_f32 v50, v50
    v_mfma_f32_16x16x32_bf16 v[144:147], a[192:195], v[56:59], v[144:147]
    ds_read_b64_tr_b16 a[188:189], v7 offset:8200
    v_mul_f32 v52, s20, v52
    v_mfma_f32_16x16x32_bf16 v[148:151], a[200:203], v[56:59], v[148:151]
    v_exp_f32 v51, v51
    v_mfma_f32_16x16x32_bf16 v[152:155], a[208:211], v[56:59], v[152:155]
    v_exp_f32 v52, v52
    v_mfma_f32_16x16x32_bf16 v[156:159], a[216:219], v[56:59], v[156:159]
    ds_read_b64_tr_b16 a[190:191], v37 offset:8200
    v_mul_f32 v53, s20, v53
    v_mfma_f32_16x16x32_bf16 v[40:43], a[96:99], a[64:67], 0
    v_mul_f32 v54, s20, v54
    v_mul_f32 v55, s20, v55
    v_mfma_f32_16x16x32_bf16 v[40:43], a[100:103], a[68:71], v[40:43]
    v_exp_f32 v53, v53
    v_mfma_f32_16x16x32_bf16 v[40:43], a[104:107], a[72:75], v[40:43]
    v_cvt_pk_bf16_f32 v60, v48, v49
    v_cvt_pk_bf16_f32 v61, v50, v51
    v_mfma_f32_16x16x32_bf16 v[40:43], a[108:111], a[76:79], v[40:43]
    v_exp_f32 v54, v54
    v_mfma_f32_16x16x32_bf16 v[44:47], a[112:115], a[64:67], 0
    v_exp_f32 v55, v55
    v_mfma_f32_16x16x32_bf16 v[44:47], a[116:119], a[68:71], v[44:47]
    v_cvt_pk_bf16_f32 v62, v52, v53
    v_cvt_pk_bf16_f32 v63, v54, v55
    v_mfma_f32_16x16x32_bf16 v[44:47], a[120:123], a[72:75], v[44:47]
    buffer_load_dwordx4 v19, s[12:15], s22 offen offset:1024 lds
    v_mfma_f32_16x16x32_bf16 v[44:47], a[124:127], a[76:79], v[44:47]
    s_add_u32 m0, s30, 16384
    ds_read_b64_tr_b16 a[196:197], v8 offset:8192
    v_mul_f32 v40, s20, v40
    v_smfmac_f32_16x16x64_bf16 a[228:231], a[238:241], v[56:63], v26
    buffer_store_dwordx4 v[28:31], v16, s[16:19], s32 offen offset:2048 nt
    buffer_load_dwordx4 v16, s[4:7], s28 offen offset:2048 nt lds
    v_exp_f32 v40, v40
    v_mul_f32 v41, s20, v41
    v_mul_f32 v42, s20, v42
    v_mfma_f32_16x16x32_bf16 v[160:163], a[160:163], v[60:63], v[160:163]
    s_xor_b32 s22, s22, 8192
    ds_read_b64_tr_b16 a[198:199], v38 offset:8192
    v_mul_f32 v43, s20, v43
    v_mfma_f32_16x16x32_bf16 v[164:167], a[168:171], v[60:63], v[164:167]
    v_exp_f32 v41, v41
    v_mfma_f32_16x16x32_bf16 v[168:171], a[176:179], v[60:63], v[168:171]
    v_exp_f32 v42, v42
    v_mfma_f32_16x16x32_bf16 v[172:175], a[184:187], v[60:63], v[172:175]
    ds_read_b64_tr_b16 a[204:205], v8 offset:8200
    v_mul_f32 v44, s20, v44
    v_mfma_f32_16x16x32_bf16 v[176:179], a[192:195], v[60:63], v[176:179]
    v_exp_f32 v43, v43
    v_mfma_f32_16x16x32_bf16 v[180:183], a[200:203], v[60:63], v[180:183]
    v_exp_f32 v44, v44
    v_mfma_f32_16x16x32_bf16 v[184:187], a[208:211], v[60:63], v[184:187]
    ds_read_b64_tr_b16 a[206:207], v38 offset:8200
    v_mul_f32 v45, s20, v45
    v_mfma_f32_16x16x32_bf16 v[188:191], a[216:219], v[60:63], v[188:191]
    s_waitcnt lgkmcnt(12)
    v_mul_f32 v46, s20, v46
    v_mul_f32 v47, s20, v47
    v_mfma_f32_16x16x32_bf16 v[48:51], a[112:115], a[80:83], 0
    v_exp_f32 v45, v45
    v_mfma_f32_16x16x32_bf16 v[48:51], a[116:119], a[84:87], v[48:51]
    buffer_store_dwordx4 v[32:35], v17, s[16:19], s32 offen offset:3072 nt
    buffer_load_dwordx4 v17, s[4:7], s28 offen offset:3072 nt lds
    v_cvt_pk_bf16_f32 v56, v40, v41
    v_cvt_pk_bf16_f32 v57, v42, v43
    v_mfma_f32_16x16x32_bf16 v[48:51], a[120:123], a[88:91], v[48:51]
    v_exp_f32 v46, v46
    v_mfma_f32_16x16x32_bf16 v[48:51], a[124:127], a[92:95], v[48:51]
    v_exp_f32 v47, v47
    v_mfma_f32_16x16x32_bf16 v[52:55], a[128:131], a[80:83], 0
    v_cvt_pk_bf16_f32 v58, v44, v45
    v_cvt_pk_bf16_f32 v59, v46, v47
    v_mfma_f32_16x16x32_bf16 v[52:55], a[132:135], a[84:87], v[52:55]
    ds_read_b128 v[28:31], v24 offset:20480
    ds_read_b128 v[32:35], v24 offset:21504
    v_mfma_f32_16x16x32_bf16 v[52:55], a[136:139], a[88:91], v[52:55]
    ds_read_b64_tr_b16 a[212:213], v9 offset:8192
    v_mul_f32 v48, s20, v48
    v_mfma_f32_16x16x32_bf16 v[52:55], a[140:143], a[92:95], v[52:55]
    v_exp_f32 v48, v48

    v_mfma_f32_16x16x32_bf16 v[192:195], a[160:163], v[56:59], v[192:195]
    v_mul_f32 v49, s20, v49
    v_mul_f32 v50, s20, v50
    v_mfma_f32_16x16x32_bf16 v[196:199], a[168:171], v[56:59], v[196:199]
    ds_read_b64_tr_b16 a[214:215], v39 offset:8192
    v_mul_f32 v51, s20, v51
    v_mfma_f32_16x16x32_bf16 v[200:203], a[176:179], v[56:59], v[200:203]
    v_exp_f32 v49, v49
    v_mfma_f32_16x16x32_bf16 v[204:207], a[184:187], v[56:59], v[204:207]
    v_exp_f32 v50, v50
    v_mfma_f32_16x16x32_bf16 v[208:211], a[192:195], v[56:59], v[208:211]
    ds_read_b64_tr_b16 a[220:221], v9 offset:8200
    v_mul_f32 v52, s20, v52
    v_mfma_f32_16x16x32_bf16 v[212:215], a[200:203], v[56:59], v[212:215]
    v_exp_f32 v51, v51
    v_mfma_f32_16x16x32_bf16 v[216:219], a[208:211], v[56:59], v[216:219]
    v_exp_f32 v52, v52
    v_mfma_f32_16x16x32_bf16 v[220:223], a[216:219], v[56:59], v[220:223]
    ds_read_b64_tr_b16 a[222:223], v39 offset:8200
    v_mul_f32 v53, s20, v53
L_B13:
    v_mfma_f32_16x16x32_bf16 v[40:43], a[128:131], a[0:3], 0
    v_mul_f32 v54, s20, v54
    v_mul_f32 v55, s20, v55
    v_mfma_f32_16x16x32_bf16 v[40:43], a[132:135], a[4:7], v[40:43]
    v_exp_f32 v53, v53
    v_mfma_f32_16x16x32_bf16 v[40:43], a[136:139], a[8:11], v[40:43]
    v_cvt_pk_bf16_f32 v60, v48, v49
    v_cvt_pk_bf16_f32 v61, v50, v51
    v_mfma_f32_16x16x32_bf16 v[40:43], a[140:143], a[12:15], v[40:43]
    v_exp_f32 v54, v54
    v_mfma_f32_16x16x32_bf16 v[44:47], a[144:147], a[0:3], 0
    v_exp_f32 v55, v55
    v_mfma_f32_16x16x32_bf16 v[44:47], a[148:151], a[4:7], v[44:47]
    s_waitcnt vmcnt(18) lgkmcnt(0)
    v_cvt_pk_bf16_f32 v62, v52, v53
    v_cvt_pk_bf16_f32 v63, v54, v55
    v_mfma_f32_16x16x32_bf16 v[44:47], a[152:155], a[8:11], v[44:47]
    s_barrier
    v_mfma_f32_16x16x32_bf16 v[44:47], a[156:159], a[12:15], v[44:47]
    ds_read_b128 a[96:99], v2 offset:16384
    v_mul_f32 v40, s20, v40
    v_smfmac_f32_16x16x64_bf16 a[232:235], a[238:241], v[56:63], v26
    ds_read_b128 a[100:103], v3 offset:16384
    v_exp_f32 v40, v40
    v_mul_f32 v41, s20, v41
    v_mul_f32 v42, s20, v42
    v_mfma_f32_16x16x32_bf16 v[224:227], a[162:165], v[60:63], v[224:227]
    ds_read_b128 a[104:107], v4 offset:16384
    v_mul_f32 v43, s20, v43
    v_mfma_f32_16x16x32_bf16 v[228:231], a[170:173], v[60:63], v[228:231]
    v_exp_f32 v41, v41
    v_mfma_f32_16x16x32_bf16 v[232:235], a[178:181], v[60:63], v[232:235]
    v_exp_f32 v42, v42
    v_mfma_f32_16x16x32_bf16 v[236:239], a[186:189], v[60:63], v[236:239]
    ds_read_b128 a[108:111], v5 offset:16384
    v_mul_f32 v44, s20, v44
    v_mfma_f32_16x16x32_bf16 v[240:243], a[194:197], v[60:63], v[240:243]
    v_exp_f32 v43, v43
    v_mfma_f32_16x16x32_bf16 v[244:247], a[202:205], v[60:63], v[244:247]
    v_exp_f32 v44, v44
    v_mfma_f32_16x16x32_bf16 v[248:251], a[210:213], v[60:63], v[248:251]
    ds_read_b128 a[112:115], v0 offset:16384
    v_mul_f32 v45, s20, v45
    v_mfma_f32_16x16x32_bf16 v[252:255], a[218:221], v[60:63], v[252:255]
    v_mul_f32 v46, s20, v46
    v_mul_f32 v47, s20, v47
    v_mfma_f32_16x16x32_bf16 v[48:51], a[128:131], a[16:19], 0
    v_exp_f32 v45, v45
    v_mfma_f32_16x16x32_bf16 v[48:51], a[132:135], a[20:23], v[48:51]
    v_cvt_pk_bf16_f32 v56, v40, v41
    v_cvt_pk_bf16_f32 v57, v42, v43
    v_mfma_f32_16x16x32_bf16 v[48:51], a[136:139], a[24:27], v[48:51]
    v_exp_f32 v46, v46
    v_mfma_f32_16x16x32_bf16 v[48:51], a[140:143], a[28:31], v[48:51]
    v_exp_f32 v47, v47
    v_mfma_f32_16x16x32_bf16 v[52:55], a[144:147], a[16:19], 0
    s_add_u32 m0, s35, 8192
    v_cvt_pk_bf16_f32 v58, v44, v45
    v_cvt_pk_bf16_f32 v59, v46, v47
    v_mfma_f32_16x16x32_bf16 v[52:55], a[148:151], a[20:23], v[52:55]
    buffer_load_dwordx4 v18, s[8:11], s22 offen lds
    v_mfma_f32_16x16x32_bf16 v[52:55], a[152:155], a[24:27], v[52:55]
    ds_read_b128 a[116:119], v1 offset:16384
    v_mul_f32 v48, s20, v48
    v_mfma_f32_16x16x32_bf16 v[52:55], a[156:159], a[28:31], v[52:55]
    v_exp_f32 v48, v48

    v_mfma_f32_16x16x32_bf16 v[64:67], a[164:167], v[56:59], v[64:67]
    ds_read_b128 a[120:123], v25 offset:16384
    v_mul_f32 v49, s20, v49
    v_mul_f32 v50, s20, v50
    v_mfma_f32_16x16x32_bf16 v[68:71], a[172:175], v[56:59], v[68:71]
    ds_read_b128 a[124:127], v27 offset:16384
    v_mul_f32 v51, s20, v51
    v_mfma_f32_16x16x32_bf16 v[72:75], a[180:183], v[56:59], v[72:75]
    v_exp_f32 v49, v49
    v_mfma_f32_16x16x32_bf16 v[76:79], a[188:191], v[56:59], v[76:79]
    v_exp_f32 v50, v50
    v_mfma_f32_16x16x32_bf16 v[80:83], a[196:199], v[56:59], v[80:83]
    ds_read_b64_tr_b16 a[160:161], v6 offset:16384
    v_mul_f32 v52, s20, v52
    v_mfma_f32_16x16x32_bf16 v[84:87], a[204:207], v[56:59], v[84:87]
    v_exp_f32 v51, v51
    v_mfma_f32_16x16x32_bf16 v[88:91], a[212:215], v[56:59], v[88:91]
    v_exp_f32 v52, v52
    v_mfma_f32_16x16x32_bf16 v[92:95], a[220:223], v[56:59], v[92:95]
    ds_read_b64_tr_b16 a[162:163], v36 offset:16384
    v_mul_f32 v53, s20, v53
    v_mfma_f32_16x16x32_bf16 v[40:43], a[128:131], a[32:35], 0
    v_mul_f32 v54, s20, v54
    v_mul_f32 v55, s20, v55
    v_mfma_f32_16x16x32_bf16 v[40:43], a[132:135], a[36:39], v[40:43]
    v_exp_f32 v53, v53
    v_mfma_f32_16x16x32_bf16 v[40:43], a[136:139], a[40:43], v[40:43]
    v_cvt_pk_bf16_f32 v60, v48, v49
    v_cvt_pk_bf16_f32 v61, v50, v51
    v_mfma_f32_16x16x32_bf16 v[40:43], a[140:143], a[44:47], v[40:43]
    v_exp_f32 v54, v54
    v_mfma_f32_16x16x32_bf16 v[44:47], a[144:147], a[32:35], 0
    v_exp_f32 v55, v55
    v_mfma_f32_16x16x32_bf16 v[44:47], a[148:151], a[36:39], v[44:47]
    v_cvt_pk_bf16_f32 v62, v52, v53
    v_cvt_pk_bf16_f32 v63, v54, v55
    v_mfma_f32_16x16x32_bf16 v[44:47], a[152:155], a[40:43], v[44:47]
    buffer_load_dwordx4 v18, s[8:11], s22 offen offset:1024 lds
    v_mfma_f32_16x16x32_bf16 v[44:47], a[156:159], a[44:47], v[44:47]
    ds_read_b64_tr_b16 a[168:169], v6 offset:16392
    v_mul_f32 v40, s20, v40
    v_smfmac_f32_16x16x64_bf16 a[224:227], a[238:241], v[56:63], v26
    ds_read_b64_tr_b16 a[170:171], v36 offset:16392
    v_exp_f32 v40, v40
    v_mul_f32 v41, s20, v41
    v_mul_f32 v42, s20, v42
    v_mfma_f32_16x16x32_bf16 v[96:99], a[164:167], v[60:63], v[96:99]
    ds_read_b64_tr_b16 a[176:177], v7 offset:16384
    v_mul_f32 v43, s20, v43
    v_mfma_f32_16x16x32_bf16 v[100:103], a[172:175], v[60:63], v[100:103]
    v_exp_f32 v41, v41
    v_mfma_f32_16x16x32_bf16 v[104:107], a[180:183], v[60:63], v[104:107]
    v_exp_f32 v42, v42
    v_mfma_f32_16x16x32_bf16 v[108:111], a[188:191], v[60:63], v[108:111]
    ds_read_b64_tr_b16 a[178:179], v37 offset:16384
    v_mul_f32 v44, s20, v44
    v_mfma_f32_16x16x32_bf16 v[112:115], a[196:199], v[60:63], v[112:115]
    v_exp_f32 v43, v43
    v_mfma_f32_16x16x32_bf16 v[116:119], a[204:207], v[60:63], v[116:119]
    v_exp_f32 v44, v44
    v_mfma_f32_16x16x32_bf16 v[120:123], a[212:215], v[60:63], v[120:123]
    ds_read_b64_tr_b16 a[184:185], v7 offset:16392
    v_mul_f32 v45, s20, v45
    v_mfma_f32_16x16x32_bf16 v[124:127], a[220:223], v[60:63], v[124:127]
    v_mul_f32 v46, s20, v46
    v_mul_f32 v47, s20, v47
    v_mfma_f32_16x16x32_bf16 v[48:51], a[128:131], a[48:51], 0
    v_exp_f32 v45, v45
    v_mfma_f32_16x16x32_bf16 v[48:51], a[132:135], a[52:55], v[48:51]
    v_cvt_pk_bf16_f32 v56, v40, v41
    v_cvt_pk_bf16_f32 v57, v42, v43
    v_mfma_f32_16x16x32_bf16 v[48:51], a[136:139], a[56:59], v[48:51]
    v_exp_f32 v46, v46
    v_mfma_f32_16x16x32_bf16 v[48:51], a[140:143], a[60:63], v[48:51]
    v_exp_f32 v47, v47
    v_mfma_f32_16x16x32_bf16 v[52:55], a[144:147], a[48:51], 0
    s_add_u32 m0, s35, 40960
    v_cvt_pk_bf16_f32 v58, v44, v45
    v_cvt_pk_bf16_f32 v59, v46, v47
    v_mfma_f32_16x16x32_bf16 v[52:55], a[148:151], a[52:55], v[52:55]
    buffer_load_dwordx4 v19, s[12:15], s22 offen lds
    v_mfma_f32_16x16x32_bf16 v[52:55], a[152:155], a[56:59], v[52:55]
    s_add_u32 s28, s24, 20480
    ds_read_b64_tr_b16 a[186:187], v37 offset:16392
    v_mul_f32 v48, s20, v48
    v_mfma_f32_16x16x32_bf16 v[52:55], a[156:159], a[60:63], v[52:55]
    s_add_u32 s32, s31, 20480
    v_exp_f32 v48, v48

    s_add_u32 m0, s30, 20480
    v_mfma_f32_16x16x32_bf16 v[128:131], a[164:167], v[56:59], v[128:131]
    buffer_store_dwordx4 v[28:31], v14, s[16:19], s32 offen nt
    buffer_load_dwordx4 v14, s[4:7], s28 offen nt lds
    ds_read_b64_tr_b16 a[192:193], v8 offset:16384
    v_mul_f32 v49, s20, v49
    v_mul_f32 v50, s20, v50
    v_mfma_f32_16x16x32_bf16 v[132:135], a[172:175], v[56:59], v[132:135]
    ds_read_b64_tr_b16 a[194:195], v38 offset:16384
    v_mul_f32 v51, s20, v51
    v_mfma_f32_16x16x32_bf16 v[136:139], a[180:183], v[56:59], v[136:139]
    v_exp_f32 v49, v49
    v_mfma_f32_16x16x32_bf16 v[140:143], a[188:191], v[56:59], v[140:143]
    v_exp_f32 v50, v50
    v_mfma_f32_16x16x32_bf16 v[144:147], a[196:199], v[56:59], v[144:147]
    ds_read_b64_tr_b16 a[200:201], v8 offset:16392
    v_mul_f32 v52, s20, v52
    v_mfma_f32_16x16x32_bf16 v[148:151], a[204:207], v[56:59], v[148:151]
    v_exp_f32 v51, v51
    v_mfma_f32_16x16x32_bf16 v[152:155], a[212:215], v[56:59], v[152:155]
    v_exp_f32 v52, v52
    v_mfma_f32_16x16x32_bf16 v[156:159], a[220:223], v[56:59], v[156:159]
    ds_read_b64_tr_b16 a[202:203], v38 offset:16392
    v_mul_f32 v53, s20, v53
    v_mfma_f32_16x16x32_bf16 v[40:43], a[128:131], a[64:67], 0
    v_mul_f32 v54, s20, v54
    v_mul_f32 v55, s20, v55
    v_mfma_f32_16x16x32_bf16 v[40:43], a[132:135], a[68:71], v[40:43]
    v_exp_f32 v53, v53
    v_mfma_f32_16x16x32_bf16 v[40:43], a[136:139], a[72:75], v[40:43]
    buffer_store_dwordx4 v[32:35], v15, s[16:19], s32 offen offset:1024 nt
    buffer_load_dwordx4 v15, s[4:7], s28 offen offset:1024 nt lds
    v_cvt_pk_bf16_f32 v60, v48, v49
    v_cvt_pk_bf16_f32 v61, v50, v51
    v_mfma_f32_16x16x32_bf16 v[40:43], a[140:143], a[76:79], v[40:43]
    v_exp_f32 v54, v54
    v_mfma_f32_16x16x32_bf16 v[44:47], a[144:147], a[64:67], 0
    v_exp_f32 v55, v55
    v_mfma_f32_16x16x32_bf16 v[44:47], a[148:151], a[68:71], v[44:47]
    s_add_u32 m0, s35, 40960
    v_cvt_pk_bf16_f32 v62, v52, v53
    v_cvt_pk_bf16_f32 v63, v54, v55
    v_mfma_f32_16x16x32_bf16 v[44:47], a[152:155], a[72:75], v[44:47]
    buffer_load_dwordx4 v19, s[12:15], s22 offen offset:1024 lds
    v_mfma_f32_16x16x32_bf16 v[44:47], a[156:159], a[76:79], v[44:47]
    s_xor_b32 s22, s22, 24576
    ds_read_b64_tr_b16 a[208:209], v9 offset:16384
    v_mul_f32 v40, s20, v40
    v_smfmac_f32_16x16x64_bf16 a[228:231], a[238:241], v[56:63], v26
    v_exp_f32 v40, v40
    v_mfma_f32_16x16x32_bf16 v[160:163], a[164:167], v[60:63], v[160:163]
    ds_read_b128 v[28:31], v24 offset:22528
    ds_read_b128 v[32:35], v24 offset:23552
    v_mul_f32 v41, s20, v41
    v_mul_f32 v42, s20, v42
    v_mfma_f32_16x16x32_bf16 v[164:167], a[172:175], v[60:63], v[164:167]
    ds_read_b64_tr_b16 a[210:211], v39 offset:16384
    v_mul_f32 v43, s20, v43
    v_mfma_f32_16x16x32_bf16 v[168:171], a[180:183], v[60:63], v[168:171]
    v_exp_f32 v41, v41
    v_mfma_f32_16x16x32_bf16 v[172:175], a[188:191], v[60:63], v[172:175]
    v_exp_f32 v42, v42
    v_mfma_f32_16x16x32_bf16 v[176:179], a[196:199], v[60:63], v[176:179]
    ds_read_b64_tr_b16 a[216:217], v9 offset:16392
    v_mul_f32 v44, s20, v44
    v_mfma_f32_16x16x32_bf16 v[180:183], a[204:207], v[60:63], v[180:183]
    v_exp_f32 v43, v43
    v_mfma_f32_16x16x32_bf16 v[184:187], a[212:215], v[60:63], v[184:187]
    v_exp_f32 v44, v44
    v_mfma_f32_16x16x32_bf16 v[188:191], a[220:223], v[60:63], v[188:191]
    s_waitcnt lgkmcnt(15)
    ds_read_b64_tr_b16 a[218:219], v39 offset:16392
    v_mul_f32 v45, s20, v45
L_B14:
    v_mfma_f32_16x16x32_bf16 v[48:51], a[96:99], a[0:3], 0
    s_mov_b32 s31, s26
    v_mul_f32 v46, s20, v46
    v_mul_f32 v47, s20, v47
    v_mfma_f32_16x16x32_bf16 v[48:51], a[100:103], a[4:7], v[48:51]
    s_mov_b32 s45, s27
    v_exp_f32 v45, v45
    v_mfma_f32_16x16x32_bf16 v[48:51], a[104:107], a[8:11], v[48:51]
    s_mov_b32 s26, s24
    v_cvt_pk_bf16_f32 v56, v40, v41
    v_cvt_pk_bf16_f32 v57, v42, v43
    v_mfma_f32_16x16x32_bf16 v[48:51], a[108:111], a[12:15], v[48:51]
    s_mov_b32 s27, s25
    v_exp_f32 v46, v46
    v_mfma_f32_16x16x32_bf16 v[52:55], a[112:115], a[0:3], 0
    s_add_u32 s33, s33, 1
    v_exp_f32 v47, v47
    v_mfma_f32_16x16x32_bf16 v[52:55], a[116:119], a[4:7], v[52:55]
    s_waitcnt vmcnt(16) lgkmcnt(0)
    v_cvt_pk_bf16_f32 v58, v44, v45
    v_cvt_pk_bf16_f32 v59, v46, v47
    v_mfma_f32_16x16x32_bf16 v[52:55], a[120:123], a[8:11], v[52:55]
    s_barrier
    v_mfma_f32_16x16x32_bf16 v[52:55], a[124:127], a[12:15], v[52:55]
    s_lshl_b32 s41, s33, 5
    ds_read_b128 a[128:131], v2 offset:24576
    v_mul_f32 v48, s20, v48
    v_mfma_f32_16x16x32_bf16 a[232:235], a[248:251], v[56:59], a[232:235]
    s_add_u32 s41, s41, s37
    v_exp_f32 v48, v48
    v_mul_f32 v49, s20, v49
    v_mul_f32 v50, s20, v50
    v_mfma_f32_16x16x32_bf16 v[192:195], a[164:167], v[56:59], v[192:195]
    s_lshr_b32 s42, s41, 1
    ds_read_b128 a[132:135], v3 offset:24576
    v_mul_f32 v51, s20, v51
    v_mfma_f32_16x16x32_bf16 v[196:199], a[172:175], v[56:59], v[196:199]
    s_xor_b32 s43, s33, s37
    v_exp_f32 v49, v49
    v_mfma_f32_16x16x32_bf16 v[200:203], a[180:183], v[56:59], v[200:203]
    s_and_b32 s43, s43, 1
    v_exp_f32 v50, v50
    v_mfma_f32_16x16x32_bf16 v[204:207], a[188:191], v[56:59], v[204:207]
    s_mul_i32 s44, s43, s58
    ds_read_b128 a[136:139], v4 offset:24576
    v_mul_f32 v52, s20, v52
    v_mfma_f32_16x16x32_bf16 v[208:211], a[196:199], v[56:59], v[208:211]
    s_mul_i32 s43, s43, 22
    v_exp_f32 v51, v51
    v_mfma_f32_16x16x32_bf16 v[212:215], a[204:207], v[56:59], v[212:215]
    s_add_u32 s43, s43, 24
    v_exp_f32 v52, v52
    v_mfma_f32_16x16x32_bf16 v[216:219], a[212:215], v[56:59], v[216:219]
    s_lshl_b32 s42, s42, 3
    ds_read_b128 a[140:143], v5 offset:24576
    v_mul_f32 v53, s20, v53
    v_mfma_f32_16x16x32_bf16 v[220:223], a[220:223], v[56:59], v[220:223]
    s_add_u32 s42, s42, s38
    v_mul_f32 v54, s20, v54
    v_mul_f32 v55, s20, v55
    v_mfma_f32_16x16x32_bf16 v[40:43], a[96:99], a[16:19], 0
    s_lshl_b32 s23, s42, 17
    v_exp_f32 v53, v53
    v_mfma_f32_16x16x32_bf16 v[40:43], a[100:103], a[20:23], v[40:43]
    s_mul_i32 s42, s42, 46
    v_cvt_pk_bf16_f32 v60, v48, v49
    v_cvt_pk_bf16_f32 v61, v50, v51
    v_mfma_f32_16x16x32_bf16 v[40:43], a[104:107], a[24:27], v[40:43]
    s_add_u32 s44, s44, s36
    v_exp_f32 v54, v54
    v_mfma_f32_16x16x32_bf16 v[40:43], a[108:111], a[28:31], v[40:43]
    s_add_u32 s44, s44, s42
    v_exp_f32 v55, v55
    v_mfma_f32_16x16x32_bf16 v[44:47], a[112:115], a[16:19], 0
    s_add_u32 m0, s35, 16384
    v_cvt_pk_bf16_f32 v62, v52, v53
    v_cvt_pk_bf16_f32 v63, v54, v55
    v_mfma_f32_16x16x32_bf16 v[44:47], a[116:119], a[20:23], v[44:47]
    buffer_load_dwordx4 v18, s[8:11], s22 offen lds
    v_mfma_f32_16x16x32_bf16 v[44:47], a[120:123], a[24:27], v[44:47]
    s_lshl_b32 s24, s44, 12
    ds_read_b128 a[144:147], v0 offset:24576
    v_mul_f32 v40, s20, v40
    v_mfma_f32_16x16x32_bf16 v[44:47], a[124:127], a[28:31], v[44:47]
    s_add_u32 s43, s43, s42
    v_exp_f32 v40, v40

    s_lshl_b32 s43, s43, 12
    v_mfma_f32_16x16x32_bf16 v[64:67], a[160:163], v[60:63], v[64:67]
    s_min_u32 s25, s43, 96468992
    v_mul_f32 v41, s20, v41
    v_mul_f32 v42, s20, v42
    v_mfma_f32_16x16x32_bf16 v[68:71], a[168:171], v[60:63], v[68:71]
    ds_read_b128 a[148:151], v1 offset:24576
    v_mul_f32 v43, s20, v43
    v_mfma_f32_16x16x32_bf16 v[72:75], a[176:179], v[60:63], v[72:75]
    v_exp_f32 v41, v41
    v_mfma_f32_16x16x32_bf16 v[76:79], a[184:187], v[60:63], v[76:79]
    v_exp_f32 v42, v42
    v_mfma_f32_16x16x32_bf16 v[80:83], a[192:195], v[60:63], v[80:83]
    ds_read_b128 a[152:155], v25 offset:24576
    v_mul_f32 v44, s20, v44
    v_mfma_f32_16x16x32_bf16 v[84:87], a[200:203], v[60:63], v[84:87]
    v_exp_f32 v43, v43
    v_mfma_f32_16x16x32_bf16 v[88:91], a[208:211], v[60:63], v[88:91]
    v_exp_f32 v44, v44
    v_mfma_f32_16x16x32_bf16 v[92:95], a[216:219], v[60:63], v[92:95]
    ds_read_b128 a[156:159], v27 offset:24576
    v_mul_f32 v45, s20, v45
    v_mfma_f32_16x16x32_bf16 v[48:51], a[96:99], a[32:35], 0
    v_mul_f32 v46, s20, v46
    v_mul_f32 v47, s20, v47
    v_mfma_f32_16x16x32_bf16 v[48:51], a[100:103], a[36:39], v[48:51]
    v_exp_f32 v45, v45
    v_mfma_f32_16x16x32_bf16 v[48:51], a[104:107], a[40:43], v[48:51]
    v_cvt_pk_bf16_f32 v56, v40, v41
    v_cvt_pk_bf16_f32 v57, v42, v43
    v_mfma_f32_16x16x32_bf16 v[48:51], a[108:111], a[44:47], v[48:51]
    v_exp_f32 v46, v46
    v_mfma_f32_16x16x32_bf16 v[52:55], a[112:115], a[32:35], 0
    v_exp_f32 v47, v47
    v_mfma_f32_16x16x32_bf16 v[52:55], a[116:119], a[36:39], v[52:55]
    v_cvt_pk_bf16_f32 v58, v44, v45
    v_cvt_pk_bf16_f32 v59, v46, v47
    v_mfma_f32_16x16x32_bf16 v[52:55], a[120:123], a[40:43], v[52:55]
    buffer_load_dwordx4 v18, s[8:11], s22 offen offset:1024 lds
    v_mfma_f32_16x16x32_bf16 v[52:55], a[124:127], a[44:47], v[52:55]
    ds_read_b64_tr_b16 a[164:165], v6 offset:24576
    v_mul_f32 v48, s20, v48
    v_smfmac_f32_16x16x64_bf16 a[224:227], a[242:245], v[56:63], v26
    v_exp_f32 v48, v48
    v_mul_f32 v49, s20, v49
    v_mul_f32 v50, s20, v50
    v_mfma_f32_16x16x32_bf16 v[96:99], a[160:163], v[56:59], v[96:99]
    ds_read_b64_tr_b16 a[166:167], v36 offset:24576
    v_mul_f32 v51, s20, v51
    v_mfma_f32_16x16x32_bf16 v[100:103], a[168:171], v[56:59], v[100:103]
    v_exp_f32 v49, v49
    v_mfma_f32_16x16x32_bf16 v[104:107], a[176:179], v[56:59], v[104:107]
    v_exp_f32 v50, v50
    v_mfma_f32_16x16x32_bf16 v[108:111], a[184:187], v[56:59], v[108:111]
    ds_read_b64_tr_b16 a[172:173], v6 offset:24584
    v_mul_f32 v52, s20, v52
    v_mfma_f32_16x16x32_bf16 v[112:115], a[192:195], v[56:59], v[112:115]
    v_exp_f32 v51, v51
    v_mfma_f32_16x16x32_bf16 v[116:119], a[200:203], v[56:59], v[116:119]
    v_exp_f32 v52, v52
    v_mfma_f32_16x16x32_bf16 v[120:123], a[208:211], v[56:59], v[120:123]
    ds_read_b64_tr_b16 a[174:175], v36 offset:24584
    v_mul_f32 v53, s20, v53
    v_mfma_f32_16x16x32_bf16 v[124:127], a[216:219], v[56:59], v[124:127]
    v_mul_f32 v54, s20, v54
    v_mul_f32 v55, s20, v55
    v_mfma_f32_16x16x32_bf16 v[40:43], a[96:99], a[48:51], 0
    v_exp_f32 v53, v53
    v_mfma_f32_16x16x32_bf16 v[40:43], a[100:103], a[52:55], v[40:43]
    v_cvt_pk_bf16_f32 v60, v48, v49
    v_cvt_pk_bf16_f32 v61, v50, v51
    v_mfma_f32_16x16x32_bf16 v[40:43], a[104:107], a[56:59], v[40:43]
    v_exp_f32 v54, v54
    v_mfma_f32_16x16x32_bf16 v[40:43], a[108:111], a[60:63], v[40:43]
    v_exp_f32 v55, v55
    v_mfma_f32_16x16x32_bf16 v[44:47], a[112:115], a[48:51], 0
    s_add_u32 m0, s35, 49152
    v_cvt_pk_bf16_f32 v62, v52, v53
    v_cvt_pk_bf16_f32 v63, v54, v55
    v_mfma_f32_16x16x32_bf16 v[44:47], a[116:119], a[52:55], v[44:47]
    buffer_load_dwordx4 v19, s[12:15], s22 offen lds
    v_mfma_f32_16x16x32_bf16 v[44:47], a[120:123], a[56:59], v[44:47]
    ds_read_b64_tr_b16 a[180:181], v7 offset:24576
    v_mul_f32 v40, s20, v40
    v_mfma_f32_16x16x32_bf16 v[44:47], a[124:127], a[60:63], v[44:47]
    v_exp_f32 v40, v40

    v_mfma_f32_16x16x32_bf16 v[128:131], a[160:163], v[60:63], v[128:131]
    v_mul_f32 v41, s20, v41
    v_mul_f32 v42, s20, v42
    v_mfma_f32_16x16x32_bf16 v[132:135], a[168:171], v[60:63], v[132:135]
    ds_read_b64_tr_b16 a[182:183], v37 offset:24576
    v_mul_f32 v43, s20, v43
    v_mfma_f32_16x16x32_bf16 v[136:139], a[176:179], v[60:63], v[136:139]
    v_exp_f32 v41, v41
    v_mfma_f32_16x16x32_bf16 v[140:143], a[184:187], v[60:63], v[140:143]
    v_exp_f32 v42, v42
    v_mfma_f32_16x16x32_bf16 v[144:147], a[192:195], v[60:63], v[144:147]
    ds_read_b64_tr_b16 a[188:189], v7 offset:24584
    v_mul_f32 v44, s20, v44
    v_mfma_f32_16x16x32_bf16 v[148:151], a[200:203], v[60:63], v[148:151]
    v_exp_f32 v43, v43
    v_mfma_f32_16x16x32_bf16 v[152:155], a[208:211], v[60:63], v[152:155]
    v_exp_f32 v44, v44
    v_mfma_f32_16x16x32_bf16 v[156:159], a[216:219], v[60:63], v[156:159]
    ds_read_b64_tr_b16 a[190:191], v37 offset:24584
    v_mul_f32 v45, s20, v45
    v_mfma_f32_16x16x32_bf16 v[48:51], a[96:99], a[64:67], 0
    v_mul_f32 v46, s20, v46
    v_mul_f32 v47, s20, v47
    v_mfma_f32_16x16x32_bf16 v[48:51], a[100:103], a[68:71], v[48:51]
    v_exp_f32 v45, v45
    v_mfma_f32_16x16x32_bf16 v[48:51], a[104:107], a[72:75], v[48:51]
    v_cvt_pk_bf16_f32 v56, v40, v41
    v_cvt_pk_bf16_f32 v57, v42, v43
    v_mfma_f32_16x16x32_bf16 v[48:51], a[108:111], a[76:79], v[48:51]
    v_exp_f32 v46, v46
    v_mfma_f32_16x16x32_bf16 v[52:55], a[112:115], a[64:67], 0
    v_exp_f32 v47, v47
    v_mfma_f32_16x16x32_bf16 v[52:55], a[116:119], a[68:71], v[52:55]
    v_cvt_pk_bf16_f32 v58, v44, v45
    v_cvt_pk_bf16_f32 v59, v46, v47
    v_mfma_f32_16x16x32_bf16 v[52:55], a[120:123], a[72:75], v[52:55]
    buffer_load_dwordx4 v19, s[12:15], s22 offen offset:1024 lds
    v_mfma_f32_16x16x32_bf16 v[52:55], a[124:127], a[76:79], v[52:55]
    s_add_u32 m0, s30, 20480
    ds_read_b64_tr_b16 a[196:197], v8 offset:24576
    v_mul_f32 v48, s20, v48
    v_smfmac_f32_16x16x64_bf16 a[228:231], a[242:245], v[56:63], v26
    buffer_store_dwordx4 v[28:31], v16, s[16:19], s32 offen offset:2048 nt
    buffer_load_dwordx4 v16, s[4:7], s28 offen offset:2048 nt lds
    v_exp_f32 v48, v48
    v_mul_f32 v49, s20, v49
    v_mul_f32 v50, s20, v50
    v_mfma_f32_16x16x32_bf16 v[160:163], a[160:163], v[56:59], v[160:163]
    s_xor_b32 s22, s22, 8192
    ds_read_b64_tr_b16 a[198:199], v38 offset:24576
    v_mul_f32 v51, s20, v51
    v_mfma_f32_16x16x32_bf16 v[164:167], a[168:171], v[56:59], v[164:167]
    v_exp_f32 v49, v49
    v_mfma_f32_16x16x32_bf16 v[168:171], a[176:179], v[56:59], v[168:171]
    v_exp_f32 v50, v50
    v_mfma_f32_16x16x32_bf16 v[172:175], a[184:187], v[56:59], v[172:175]
    ds_read_b64_tr_b16 a[204:205], v8 offset:24584
    v_mul_f32 v52, s20, v52
    v_mfma_f32_16x16x32_bf16 v[176:179], a[192:195], v[56:59], v[176:179]
    v_exp_f32 v51, v51
    v_mfma_f32_16x16x32_bf16 v[180:183], a[200:203], v[56:59], v[180:183]
    v_exp_f32 v52, v52
    v_mfma_f32_16x16x32_bf16 v[184:187], a[208:211], v[56:59], v[184:187]
    ds_read_b64_tr_b16 a[206:207], v38 offset:24584
    v_mul_f32 v53, s20, v53
    v_mfma_f32_16x16x32_bf16 v[188:191], a[216:219], v[56:59], v[188:191]
    s_waitcnt lgkmcnt(12)
    v_mul_f32 v54, s20, v54
    v_mul_f32 v55, s20, v55
    v_mfma_f32_16x16x32_bf16 v[40:43], a[112:115], a[80:83], 0
    v_exp_f32 v53, v53
    v_mfma_f32_16x16x32_bf16 v[40:43], a[116:119], a[84:87], v[40:43]
    buffer_store_dwordx4 v[32:35], v17, s[16:19], s32 offen offset:3072 nt
    buffer_load_dwordx4 v17, s[4:7], s28 offen offset:3072 nt lds
    v_cvt_pk_bf16_f32 v60, v48, v49
    v_cvt_pk_bf16_f32 v61, v50, v51
    v_mfma_f32_16x16x32_bf16 v[40:43], a[120:123], a[88:91], v[40:43]
    v_exp_f32 v54, v54
    v_mfma_f32_16x16x32_bf16 v[40:43], a[124:127], a[92:95], v[40:43]
    s_mov_b32 s18, s45
    v_exp_f32 v55, v55
    v_mfma_f32_16x16x32_bf16 v[44:47], a[128:131], a[80:83], 0
    v_cvt_pk_bf16_f32 v62, v52, v53
    v_cvt_pk_bf16_f32 v63, v54, v55
    v_mfma_f32_16x16x32_bf16 v[44:47], a[132:135], a[84:87], v[44:47]
    s_mov_b32 s6, s25
    v_mfma_f32_16x16x32_bf16 v[44:47], a[136:139], a[88:91], v[44:47]
    ds_read_b64_tr_b16 a[212:213], v9 offset:24576
    v_mul_f32 v40, s20, v40
    v_mfma_f32_16x16x32_bf16 v[44:47], a[140:143], a[92:95], v[44:47]
    v_exp_f32 v40, v40

    v_mfma_f32_16x16x32_bf16 v[192:195], a[160:163], v[60:63], v[192:195]
    v_mul_f32 v41, s20, v41
    v_mul_f32 v42, s20, v42
    v_mfma_f32_16x16x32_bf16 v[196:199], a[168:171], v[60:63], v[196:199]
    ds_read_b64_tr_b16 a[214:215], v39 offset:24576
    v_mul_f32 v43, s20, v43
    v_mfma_f32_16x16x32_bf16 v[200:203], a[176:179], v[60:63], v[200:203]
    v_exp_f32 v41, v41
    v_mfma_f32_16x16x32_bf16 v[204:207], a[184:187], v[60:63], v[204:207]
    v_exp_f32 v42, v42
    v_mfma_f32_16x16x32_bf16 v[208:211], a[192:195], v[60:63], v[208:211]
    ds_read_b64_tr_b16 a[220:221], v9 offset:24584
    v_mul_f32 v44, s20, v44
    v_mfma_f32_16x16x32_bf16 v[212:215], a[200:203], v[60:63], v[212:215]
    v_exp_f32 v43, v43
    v_mfma_f32_16x16x32_bf16 v[216:219], a[208:211], v[60:63], v[216:219]
    v_exp_f32 v44, v44
    v_mfma_f32_16x16x32_bf16 v[220:223], a[216:219], v[60:63], v[220:223]
    ds_read_b64_tr_b16 a[222:223], v39 offset:24584
    v_mul_f32 v45, s20, v45
    s_cmp_gt_u32 s33, 4
    s_cbranch_scc1 L_finB
L_B15:
    v_mfma_f32_16x16x32_bf16 v[48:51], a[128:131], a[0:3], 0
    v_mul_f32 v46, s20, v46
    v_mul_f32 v47, s20, v47
    v_mfma_f32_16x16x32_bf16 v[48:51], a[132:135], a[4:7], v[48:51]
    v_exp_f32 v45, v45
    v_mfma_f32_16x16x32_bf16 v[48:51], a[136:139], a[8:11], v[48:51]
    v_cvt_pk_bf16_f32 v56, v40, v41
    v_cvt_pk_bf16_f32 v57, v42, v43
    v_mfma_f32_16x16x32_bf16 v[48:51], a[140:143], a[12:15], v[48:51]
    v_exp_f32 v46, v46
    v_mfma_f32_16x16x32_bf16 v[52:55], a[144:147], a[0:3], 0
    v_exp_f32 v47, v47
    v_mfma_f32_16x16x32_bf16 v[52:55], a[148:151], a[4:7], v[52:55]
    s_waitcnt vmcnt(20) lgkmcnt(0)
    v_cvt_pk_bf16_f32 v58, v44, v45
    v_cvt_pk_bf16_f32 v59, v46, v47
    v_mfma_f32_16x16x32_bf16 v[52:55], a[152:155], a[8:11], v[52:55]
    s_barrier
    v_mfma_f32_16x16x32_bf16 v[52:55], a[156:159], a[12:15], v[52:55]
    ds_read_b128 a[96:99], v2 offset:0
    v_mul_f32 v48, s20, v48
    v_smfmac_f32_16x16x64_bf16 a[232:235], a[242:245], v[56:63], v26
    v_exp_f32 v48, v48
    v_mfma_f32_16x16x32_bf16 v[224:227], a[162:165], v[56:59], v[224:227]
    ds_read_b128 a[100:103], v3 offset:0
    v_mul_f32 v49, s20, v49
    v_mul_f32 v50, s20, v50
    v_mfma_f32_16x16x32_bf16 v[228:231], a[170:173], v[56:59], v[228:231]
    ds_read_b128 a[104:107], v4 offset:0
    ds_read_b128 a[0:3], v10 offset:0
    v_mul_f32 v51, s20, v51
    v_mfma_f32_16x16x32_bf16 v[232:235], a[178:181], v[56:59], v[232:235]
    ds_read_b128 a[4:7], v11 offset:0
    v_exp_f32 v49, v49
    v_mfma_f32_16x16x32_bf16 v[236:239], a[186:189], v[56:59], v[236:239]
    ds_read_b128 a[8:11], v12 offset:0
    v_exp_f32 v50, v50
    v_mfma_f32_16x16x32_bf16 v[240:243], a[194:197], v[56:59], v[240:243]
    ds_read_b128 a[108:111], v5 offset:0
    ds_read_b128 a[12:15], v13 offset:0
    v_mul_f32 v52, s20, v52
    v_mfma_f32_16x16x32_bf16 v[244:247], a[202:205], v[56:59], v[244:247]
    v_exp_f32 v51, v51
    v_mfma_f32_16x16x32_bf16 v[248:251], a[210:213], v[56:59], v[248:251]
    v_exp_f32 v52, v52
    v_mfma_f32_16x16x32_bf16 v[252:255], a[218:221], v[56:59], v[252:255]
    ds_read_b128 a[112:115], v0 offset:0
    v_mul_f32 v53, s20, v53
    v_mfma_f32_16x16x32_bf16 v[40:43], a[128:131], a[16:19], 0
    v_mul_f32 v54, s20, v54
    v_mul_f32 v55, s20, v55
    v_mfma_f32_16x16x32_bf16 v[40:43], a[132:135], a[20:23], v[40:43]
    v_exp_f32 v53, v53
    v_accvgpr_read_b32 v23, a234
    v_accvgpr_read_b32 v22, a235
    v_add_f32 v23, v23, v22
    v_mfma_f32_16x16x32_bf16 v[40:43], a[136:139], a[24:27], v[40:43]
    v_cvt_pk_bf16_f32 v60, v48, v49
    v_cvt_pk_bf16_f32 v61, v50, v51
    v_mfma_f32_16x16x32_bf16 v[40:43], a[140:143], a[28:31], v[40:43]
    v_exp_f32 v54, v54
    v_mov_b32_sdwa v240, v23 dst_sel:BYTE_0 dst_unused:UNUSED_PRESERVE src0_sel:BYTE_1
    v_mfma_f32_16x16x32_bf16 v[44:47], a[144:147], a[16:19], 0
    v_exp_f32 v55, v55
    v_mov_b32_sdwa v241, v23 dst_sel:BYTE_0 dst_unused:UNUSED_PRESERVE src0_sel:BYTE_2
    v_mfma_f32_16x16x32_bf16 v[44:47], a[148:151], a[20:23], v[44:47]
    s_add_u32 m0, s35, 24576
    v_cvt_pk_bf16_f32 v62, v52, v53
    v_cvt_pk_bf16_f32 v63, v54, v55
    v_mov_b32_sdwa v242, v23 dst_sel:BYTE_0 dst_unused:UNUSED_PRESERVE src0_sel:BYTE_3
    v_mfma_f32_16x16x32_bf16 v[44:47], a[152:155], a[24:27], v[44:47]
    buffer_load_dwordx4 v18, s[8:11], s22 offen lds
    v_mfma_f32_16x16x32_bf16 v[44:47], a[156:159], a[28:31], v[44:47]
    ds_read_b128 a[116:119], v1 offset:0
    v_mul_f32 v40, s20, v40
    v_mfma_f32_16x16x32_bf16 a[224:227], a[248:251], v[60:63], a[224:227]
    v_exp_f32 v40, v40
    v_mfma_f32_16x16x32_bf16 v[64:67], a[164:167], v[60:63], v[64:67]
    ds_read_b128 a[120:123], v25 offset:0
    v_mul_f32 v41, s20, v41
    v_mul_f32 v42, s20, v42
    v_mfma_f32_16x16x32_bf16 v[68:71], a[172:175], v[60:63], v[68:71]
    ds_read_b128 a[124:127], v27 offset:0
    ds_read_b128 a[16:19], v10 offset:4096
    v_mul_f32 v43, s20, v43
    v_mfma_f32_16x16x32_bf16 v[72:75], a[180:183], v[60:63], v[72:75]
    ds_read_b128 a[20:23], v11 offset:4096
    v_exp_f32 v41, v41
    v_accvgpr_read_b32 v23, a224
    v_accvgpr_read_b32 v22, a225
    v_add_f32 v23, v23, v22
    v_mfma_f32_16x16x32_bf16 v[76:79], a[188:191], v[60:63], v[76:79]
    ds_read_b128 a[24:27], v12 offset:4096
    v_exp_f32 v42, v42
    v_mfma_f32_16x16x32_bf16 v[80:83], a[196:199], v[60:63], v[80:83]
    ds_read_b64_tr_b16 a[160:161], v6 offset:0
    ds_read_b128 a[28:31], v13 offset:4096
    v_mul_f32 v44, s20, v44
    v_rcp_f32 v22, v23
    v_mfma_f32_16x16x32_bf16 v[84:87], a[204:207], v[60:63], v[84:87]
    v_exp_f32 v43, v43
    v_mfma_f32_16x16x32_bf16 v[88:91], a[212:215], v[60:63], v[88:91]
    v_exp_f32 v44, v44
    v_pk_mul_f32 v[64:65], v[64:65], v[22:23] op_sel_hi:[1,0]
    v_pk_mul_f32 v[66:67], v[66:67], v[22:23] op_sel_hi:[1,0]
    v_pk_mul_f32 v[68:69], v[68:69], v[22:23] op_sel_hi:[1,0]
    v_pk_mul_f32 v[70:71], v[70:71], v[22:23] op_sel_hi:[1,0]
    v_max3_u32 v21, v21, v22, v23
    v_cvt_pk_bf16_f32 v64, v64, v65
    v_cvt_pk_bf16_f32 v65, v66, v67
    v_cvt_pk_bf16_f32 v66, v68, v69
    v_cvt_pk_bf16_f32 v67, v70, v71
    v_mfma_f32_16x16x32_bf16 v[92:95], a[220:223], v[60:63], v[92:95]
    ds_read_b64_tr_b16 a[162:163], v36 offset:0
    v_mul_f32 v45, s20, v45
    v_mfma_f32_16x16x32_bf16 v[48:51], a[128:131], a[32:35], 0
    v_mul_f32 v46, s20, v46
    v_mul_f32 v47, s20, v47
    v_mfma_f32_16x16x32_bf16 v[48:51], a[132:135], a[36:39], v[48:51]
    ds_write_b128 v10, v[64:67] offset:0
    v_exp_f32 v45, v45
    v_pk_mul_f32 v[72:73], v[72:73], v[22:23] op_sel_hi:[1,0]
    v_pk_mul_f32 v[74:75], v[74:75], v[22:23] op_sel_hi:[1,0]
    v_pk_mul_f32 v[76:77], v[76:77], v[22:23] op_sel_hi:[1,0]
    v_pk_mul_f32 v[78:79], v[78:79], v[22:23] op_sel_hi:[1,0]
    v_cvt_pk_bf16_f32 v72, v72, v73
    v_cvt_pk_bf16_f32 v73, v74, v75
    v_cvt_pk_bf16_f32 v74, v76, v77
    v_cvt_pk_bf16_f32 v75, v78, v79
    v_mfma_f32_16x16x32_bf16 v[48:51], a[136:139], a[40:43], v[48:51]
    v_cvt_pk_bf16_f32 v56, v40, v41
    v_cvt_pk_bf16_f32 v57, v42, v43
    v_mfma_f32_16x16x32_bf16 v[48:51], a[140:143], a[44:47], v[48:51]
    v_exp_f32 v46, v46
    v_mfma_f32_16x16x32_bf16 v[52:55], a[144:147], a[32:35], 0
    ds_write_b128 v11, v[72:75] offset:0
    v_exp_f32 v47, v47
    v_pk_mul_f32 v[80:81], v[80:81], v[22:23] op_sel_hi:[1,0]
    v_pk_mul_f32 v[82:83], v[82:83], v[22:23] op_sel_hi:[1,0]
    v_pk_mul_f32 v[84:85], v[84:85], v[22:23] op_sel_hi:[1,0]
    v_pk_mul_f32 v[86:87], v[86:87], v[22:23] op_sel_hi:[1,0]
    v_cvt_pk_bf16_f32 v80, v80, v81
    v_cvt_pk_bf16_f32 v81, v82, v83
    v_cvt_pk_bf16_f32 v82, v84, v85
    v_cvt_pk_bf16_f32 v83, v86, v87
    v_mfma_f32_16x16x32_bf16 v[52:55], a[148:151], a[36:39], v[52:55]
    v_cvt_pk_bf16_f32 v58, v44, v45
    v_cvt_pk_bf16_f32 v59, v46, v47
    v_mfma_f32_16x16x32_bf16 v[52:55], a[152:155], a[40:43], v[52:55]
    buffer_load_dwordx4 v18, s[8:11], s22 offen offset:1024 lds
    v_mfma_f32_16x16x32_bf16 v[52:55], a[156:159], a[44:47], v[52:55]
    ds_read_b64_tr_b16 a[168:169], v6 offset:8
    v_mul_f32 v48, s20, v48
    v_mfma_f32_16x16x32_bf16 a[226:229], a[248:251], v[56:59], a[226:229]
    v_exp_f32 v48, v48
    v_mfma_f32_16x16x32_bf16 v[96:99], a[164:167], v[56:59], v[96:99]
    ds_write_b128 v12, v[80:83] offset:0
    ds_read_b64_tr_b16 a[170:171], v36 offset:8
    v_mul_f32 v49, s20, v49
    v_mul_f32 v50, s20, v50
    v_pk_mul_f32 v[88:89], v[88:89], v[22:23] op_sel_hi:[1,0]
    v_pk_mul_f32 v[90:91], v[90:91], v[22:23] op_sel_hi:[1,0]
    v_pk_mul_f32 v[92:93], v[92:93], v[22:23] op_sel_hi:[1,0]
    v_pk_mul_f32 v[94:95], v[94:95], v[22:23] op_sel_hi:[1,0]
    v_cvt_pk_bf16_f32 v88, v88, v89
    v_cvt_pk_bf16_f32 v89, v90, v91
    v_cvt_pk_bf16_f32 v90, v92, v93
    v_cvt_pk_bf16_f32 v91, v94, v95
    v_mfma_f32_16x16x32_bf16 v[100:103], a[172:175], v[56:59], v[100:103]
    ds_read_b64_tr_b16 a[176:177], v7 offset:0
    ds_read_b128 a[32:35], v10 offset:8192
    v_mul_f32 v51, s20, v51
    v_mfma_f32_16x16x32_bf16 v[104:107], a[180:183], v[56:59], v[104:107]
    ds_read_b128 a[36:39], v11 offset:8192
    v_exp_f32 v49, v49
    v_accvgpr_read_b32 v23, a226
    v_accvgpr_read_b32 v22, a227
    v_add_f32 v23, v23, v22
    v_mfma_f32_16x16x32_bf16 v[108:111], a[188:191], v[56:59], v[108:111]
    ds_read_b128 a[40:43], v12 offset:8192
    v_exp_f32 v50, v50
    v_mfma_f32_16x16x32_bf16 v[112:115], a[196:199], v[56:59], v[112:115]
    ds_read_b64_tr_b16 a[178:179], v37 offset:0
    ds_read_b128 a[44:47], v13 offset:8192
    v_mul_f32 v52, s20, v52
    v_rcp_f32 v22, v23
    v_mfma_f32_16x16x32_bf16 v[116:119], a[204:207], v[56:59], v[116:119]
    v_exp_f32 v51, v51
    v_mfma_f32_16x16x32_bf16 v[120:123], a[212:215], v[56:59], v[120:123]
    ds_write_b128 v13, v[88:91] offset:0
    v_exp_f32 v52, v52
    v_pk_mul_f32 v[96:97], v[96:97], v[22:23] op_sel_hi:[1,0]
    v_pk_mul_f32 v[98:99], v[98:99], v[22:23] op_sel_hi:[1,0]
    v_pk_mul_f32 v[100:101], v[100:101], v[22:23] op_sel_hi:[1,0]
    v_pk_mul_f32 v[102:103], v[102:103], v[22:23] op_sel_hi:[1,0]
    v_max3_u32 v21, v21, v22, v23
    v_cvt_pk_bf16_f32 v96, v96, v97
    v_cvt_pk_bf16_f32 v97, v98, v99
    v_cvt_pk_bf16_f32 v98, v100, v101
    v_cvt_pk_bf16_f32 v99, v102, v103
    v_mfma_f32_16x16x32_bf16 v[124:127], a[220:223], v[56:59], v[124:127]
    ds_read_b64_tr_b16 a[184:185], v7 offset:8
    v_mul_f32 v53, s20, v53
    v_mfma_f32_16x16x32_bf16 v[40:43], a[128:131], a[48:51], 0
    v_mul_f32 v54, s20, v54
    v_mul_f32 v55, s20, v55
    v_mfma_f32_16x16x32_bf16 v[40:43], a[132:135], a[52:55], v[40:43]
    ds_write_b128 v10, v[96:99] offset:4096
    ds_read_b128 v[28:31], v24 offset:0
    ds_read_b128 v[32:35], v24 offset:1024
    v_exp_f32 v53, v53
    v_pk_mul_f32 v[104:105], v[104:105], v[22:23] op_sel_hi:[1,0]
    v_pk_mul_f32 v[106:107], v[106:107], v[22:23] op_sel_hi:[1,0]
    v_pk_mul_f32 v[108:109], v[108:109], v[22:23] op_sel_hi:[1,0]
    v_pk_mul_f32 v[110:111], v[110:111], v[22:23] op_sel_hi:[1,0]
    v_cvt_pk_bf16_f32 v104, v104, v105
    v_cvt_pk_bf16_f32 v105, v106, v107
    v_cvt_pk_bf16_f32 v106, v108, v109
    v_cvt_pk_bf16_f32 v107, v110, v111
    v_mfma_f32_16x16x32_bf16 v[40:43], a[136:139], a[56:59], v[40:43]
    s_add_u32 s28, s24, 0
    v_cvt_pk_bf16_f32 v60, v48, v49
    v_cvt_pk_bf16_f32 v61, v50, v51
    v_mfma_f32_16x16x32_bf16 v[40:43], a[140:143], a[60:63], v[40:43]
    s_add_u32 s32, s31, 0
    v_exp_f32 v54, v54
    v_mfma_f32_16x16x32_bf16 v[44:47], a[144:147], a[48:51], 0
    ds_write_b128 v11, v[104:107] offset:4096
    v_exp_f32 v55, v55
    v_pk_mul_f32 v[112:113], v[112:113], v[22:23] op_sel_hi:[1,0]
    v_pk_mul_f32 v[114:115], v[114:115], v[22:23] op_sel_hi:[1,0]
    v_pk_mul_f32 v[116:117], v[116:117], v[22:23] op_sel_hi:[1,0]
    v_pk_mul_f32 v[118:119], v[118:119], v[22:23] op_sel_hi:[1,0]
    v_cvt_pk_bf16_f32 v112, v112, v113
    v_cvt_pk_bf16_f32 v113, v114, v115
    v_cvt_pk_bf16_f32 v114, v116, v117
    v_cvt_pk_bf16_f32 v115, v118, v119
    v_mfma_f32_16x16x32_bf16 v[44:47], a[148:151], a[52:55], v[44:47]
    s_add_u32 m0, s35, 57344
    v_cvt_pk_bf16_f32 v62, v52, v53
    v_cvt_pk_bf16_f32 v63, v54, v55
    v_mfma_f32_16x16x32_bf16 v[44:47], a[152:155], a[56:59], v[44:47]
    buffer_load_dwordx4 v19, s[12:15], s22 offen lds
    v_mfma_f32_16x16x32_bf16 v[44:47], a[156:159], a[60:63], v[44:47]
    s_add_u32 m0, s30, 0
    ds_read_b64_tr_b16 a[186:187], v37 offset:8
    v_mul_f32 v40, s20, v40
    v_mfma_f32_16x16x32_bf16 a[228:231], a[248:251], v[60:63], a[228:231]
    s_waitcnt vmcnt(63)
    v_exp_f32 v40, v40
    v_mfma_f32_16x16x32_bf16 v[128:131], a[164:167], v[60:63], v[128:131]
    ds_write_b128 v12, v[112:115] offset:4096
    ds_read_b64_tr_b16 a[192:193], v8 offset:0
    v_mul_f32 v41, s20, v41
    v_mul_f32 v42, s20, v42
    v_pk_mul_f32 v[120:121], v[120:121], v[22:23] op_sel_hi:[1,0]
    v_pk_mul_f32 v[122:123], v[122:123], v[22:23] op_sel_hi:[1,0]
    v_pk_mul_f32 v[124:125], v[124:125], v[22:23] op_sel_hi:[1,0]
    v_pk_mul_f32 v[126:127], v[126:127], v[22:23] op_sel_hi:[1,0]
    v_cvt_pk_bf16_f32 v120, v120, v121
    v_cvt_pk_bf16_f32 v121, v122, v123
    v_cvt_pk_bf16_f32 v122, v124, v125
    v_cvt_pk_bf16_f32 v123, v126, v127
    v_mfma_f32_16x16x32_bf16 v[132:135], a[172:175], v[60:63], v[132:135]
    ds_read_b64_tr_b16 a[194:195], v38 offset:0
    ds_read_b128 a[48:51], v10 offset:12288
    v_mul_f32 v43, s20, v43
    v_mfma_f32_16x16x32_bf16 v[136:139], a[180:183], v[60:63], v[136:139]
    s_waitcnt lgkmcnt(6)
    ds_read_b128 a[52:55], v11 offset:12288
    v_exp_f32 v41, v41
    v_accvgpr_read_b32 v23, a228
    v_accvgpr_read_b32 v22, a229
    v_add_f32 v23, v23, v22
    v_mfma_f32_16x16x32_bf16 v[140:143], a[188:191], v[60:63], v[140:143]
    buffer_store_dwordx4 v[28:31], v14, s[16:19], s32 offen nt
    buffer_load_dwordx4 v14, s[4:7], s28 offen nt lds
    ds_read_b128 a[56:59], v12 offset:12288
    v_exp_f32 v42, v42
    v_mfma_f32_16x16x32_bf16 v[144:147], a[196:199], v[60:63], v[144:147]
    ds_read_b64_tr_b16 a[200:201], v8 offset:8
    ds_read_b128 a[60:63], v13 offset:12288
    v_mul_f32 v44, s20, v44
    v_rcp_f32 v22, v23
    v_mfma_f32_16x16x32_bf16 v[148:151], a[204:207], v[60:63], v[148:151]
    v_exp_f32 v43, v43
    v_mfma_f32_16x16x32_bf16 v[152:155], a[212:215], v[60:63], v[152:155]
    ds_write_b128 v13, v[120:123] offset:4096
    v_exp_f32 v44, v44
    v_pk_mul_f32 v[128:129], v[128:129], v[22:23] op_sel_hi:[1,0]
    v_pk_mul_f32 v[130:131], v[130:131], v[22:23] op_sel_hi:[1,0]
    v_pk_mul_f32 v[132:133], v[132:133], v[22:23] op_sel_hi:[1,0]
    v_pk_mul_f32 v[134:135], v[134:135], v[22:23] op_sel_hi:[1,0]
    v_max3_u32 v21, v21, v22, v23
    v_cvt_pk_bf16_f32 v128, v128, v129
    v_cvt_pk_bf16_f32 v129, v130, v131
    v_cvt_pk_bf16_f32 v130, v132, v133
    v_cvt_pk_bf16_f32 v131, v134, v135
    v_mfma_f32_16x16x32_bf16 v[156:159], a[220:223], v[60:63], v[156:159]
    ds_read_b64_tr_b16 a[202:203], v38 offset:8
    v_mul_f32 v45, s20, v45
    v_mfma_f32_16x16x32_bf16 v[48:51], a[128:131], a[64:67], 0
    v_mul_f32 v46, s20, v46
    v_mul_f32 v47, s20, v47
    v_mfma_f32_16x16x32_bf16 v[48:51], a[132:135], a[68:71], v[48:51]
    ds_write_b128 v10, v[128:131] offset:8192
    v_exp_f32 v45, v45
    v_pk_mul_f32 v[136:137], v[136:137], v[22:23] op_sel_hi:[1,0]
    v_pk_mul_f32 v[138:139], v[138:139], v[22:23] op_sel_hi:[1,0]
    v_pk_mul_f32 v[140:141], v[140:141], v[22:23] op_sel_hi:[1,0]
    v_pk_mul_f32 v[142:143], v[142:143], v[22:23] op_sel_hi:[1,0]
    v_cvt_pk_bf16_f32 v136, v136, v137
    v_cvt_pk_bf16_f32 v137, v138, v139
    v_cvt_pk_bf16_f32 v138, v140, v141
    v_cvt_pk_bf16_f32 v139, v142, v143
    v_mfma_f32_16x16x32_bf16 v[48:51], a[136:139], a[72:75], v[48:51]
    buffer_store_dwordx4 v[32:35], v15, s[16:19], s32 offen offset:1024 nt
    buffer_load_dwordx4 v15, s[4:7], s28 offen offset:1024 nt lds
    v_cvt_pk_bf16_f32 v56, v40, v41
    v_cvt_pk_bf16_f32 v57, v42, v43
    v_mfma_f32_16x16x32_bf16 v[48:51], a[140:143], a[76:79], v[48:51]
    v_exp_f32 v46, v46
    v_mfma_f32_16x16x32_bf16 v[52:55], a[144:147], a[64:67], 0
    ds_write_b128 v11, v[136:139] offset:8192
    v_exp_f32 v47, v47
    v_pk_mul_f32 v[144:145], v[144:145], v[22:23] op_sel_hi:[1,0]
    v_pk_mul_f32 v[146:147], v[146:147], v[22:23] op_sel_hi:[1,0]
    v_pk_mul_f32 v[148:149], v[148:149], v[22:23] op_sel_hi:[1,0]
    v_pk_mul_f32 v[150:151], v[150:151], v[22:23] op_sel_hi:[1,0]
    v_cvt_pk_bf16_f32 v144, v144, v145
    v_cvt_pk_bf16_f32 v145, v146, v147
    v_cvt_pk_bf16_f32 v146, v148, v149
    v_cvt_pk_bf16_f32 v147, v150, v151
    v_mfma_f32_16x16x32_bf16 v[52:55], a[148:151], a[68:71], v[52:55]
    s_add_u32 m0, s35, 57344
    v_cvt_pk_bf16_f32 v58, v44, v45
    v_cvt_pk_bf16_f32 v59, v46, v47
    v_mfma_f32_16x16x32_bf16 v[52:55], a[152:155], a[72:75], v[52:55]
    buffer_load_dwordx4 v19, s[12:15], s22 offen offset:1024 lds
    v_mfma_f32_16x16x32_bf16 v[52:55], a[156:159], a[76:79], v[52:55]
    s_xor_b32 s22, s22, 57344
    ds_read_b64_tr_b16 a[208:209], v9 offset:0
    v_mul_f32 v48, s20, v48
    v_mfma_f32_16x16x32_bf16 a[230:233], a[248:251], v[56:59], a[230:233]
    s_waitcnt vmcnt(24)
    v_exp_f32 v48, v48
    v_mfma_f32_16x16x32_bf16 v[160:163], a[164:167], v[56:59], v[160:163]
    ds_write_b128 v12, v[144:147] offset:8192
    ds_read_b128 v[28:31], v24 offset:2048
    v_mul_f32 v49, s20, v49
    v_mul_f32 v50, s20, v50
    v_pk_mul_f32 v[152:153], v[152:153], v[22:23] op_sel_hi:[1,0]
    v_pk_mul_f32 v[154:155], v[154:155], v[22:23] op_sel_hi:[1,0]
    v_pk_mul_f32 v[156:157], v[156:157], v[22:23] op_sel_hi:[1,0]
    v_pk_mul_f32 v[158:159], v[158:159], v[22:23] op_sel_hi:[1,0]
    v_cvt_pk_bf16_f32 v152, v152, v153
    v_cvt_pk_bf16_f32 v153, v154, v155
    v_cvt_pk_bf16_f32 v154, v156, v157
    v_cvt_pk_bf16_f32 v155, v158, v159
    v_mfma_f32_16x16x32_bf16 v[164:167], a[172:175], v[56:59], v[164:167]
    ds_read_b64_tr_b16 a[210:211], v39 offset:0
    ds_read_b128 a[64:67], v10 offset:16384
    v_mul_f32 v51, s20, v51
    v_mfma_f32_16x16x32_bf16 v[168:171], a[180:183], v[56:59], v[168:171]
    ds_read_b128 a[68:71], v11 offset:16384
    v_exp_f32 v49, v49
    v_accvgpr_read_b32 v23, a230
    v_accvgpr_read_b32 v22, a231
    v_add_f32 v23, v23, v22
    v_mfma_f32_16x16x32_bf16 v[172:175], a[188:191], v[56:59], v[172:175]
    ds_read_b128 a[72:75], v12 offset:16384
    v_exp_f32 v50, v50
    v_mfma_f32_16x16x32_bf16 v[176:179], a[196:199], v[56:59], v[176:179]
    ds_read_b64_tr_b16 a[216:217], v9 offset:8
    ds_read_b128 a[76:79], v13 offset:16384
    v_mul_f32 v52, s20, v52
    v_rcp_f32 v22, v23
    v_mfma_f32_16x16x32_bf16 v[180:183], a[204:207], v[56:59], v[180:183]
    v_exp_f32 v51, v51
    v_mfma_f32_16x16x32_bf16 v[184:187], a[212:215], v[56:59], v[184:187]
    ds_write_b128 v13, v[152:155] offset:8192
    v_exp_f32 v52, v52
    v_pk_mul_f32 v[160:161], v[160:161], v[22:23] op_sel_hi:[1,0]
    v_pk_mul_f32 v[162:163], v[162:163], v[22:23] op_sel_hi:[1,0]
    v_pk_mul_f32 v[164:165], v[164:165], v[22:23] op_sel_hi:[1,0]
    v_pk_mul_f32 v[166:167], v[166:167], v[22:23] op_sel_hi:[1,0]
    v_max3_u32 v21, v21, v22, v23
    v_cvt_pk_bf16_f32 v160, v160, v161
    v_cvt_pk_bf16_f32 v161, v162, v163
    v_cvt_pk_bf16_f32 v162, v164, v165
    v_cvt_pk_bf16_f32 v163, v166, v167
    v_mfma_f32_16x16x32_bf16 v[188:191], a[220:223], v[56:59], v[188:191]
    s_waitcnt lgkmcnt(15)
    ds_read_b64_tr_b16 a[218:219], v39 offset:8
    v_mul_f32 v53, s20, v53
L_A0:
    v_mfma_f32_16x16x32_bf16 v[40:43], a[96:99], a[0:3], 0
    v_mul_f32 v54, s20, v54
    v_mul_f32 v55, s20, v55
    v_mfma_f32_16x16x32_bf16 v[40:43], a[100:103], a[4:7], v[40:43]
    ds_write_b128 v10, v[160:163] offset:12288
    v_exp_f32 v53, v53
    v_pk_mul_f32 v[168:169], v[168:169], v[22:23] op_sel_hi:[1,0]
    v_pk_mul_f32 v[170:171], v[170:171], v[22:23] op_sel_hi:[1,0]
    v_pk_mul_f32 v[172:173], v[172:173], v[22:23] op_sel_hi:[1,0]
    v_pk_mul_f32 v[174:175], v[174:175], v[22:23] op_sel_hi:[1,0]
    v_cvt_pk_bf16_f32 v168, v168, v169
    v_cvt_pk_bf16_f32 v169, v170, v171
    v_cvt_pk_bf16_f32 v170, v172, v173
    v_cvt_pk_bf16_f32 v171, v174, v175
    v_mfma_f32_16x16x32_bf16 v[40:43], a[104:107], a[8:11], v[40:43]
    v_cvt_pk_bf16_f32 v60, v48, v49
    v_cvt_pk_bf16_f32 v61, v50, v51
    v_mfma_f32_16x16x32_bf16 v[40:43], a[108:111], a[12:15], v[40:43]
    v_exp_f32 v54, v54
    v_mfma_f32_16x16x32_bf16 v[44:47], a[112:115], a[0:3], 0
    ds_write_b128 v11, v[168:171] offset:12288
    v_exp_f32 v55, v55
    v_pk_mul_f32 v[176:177], v[176:177], v[22:23] op_sel_hi:[1,0]
    v_pk_mul_f32 v[178:179], v[178:179], v[22:23] op_sel_hi:[1,0]
    v_pk_mul_f32 v[180:181], v[180:181], v[22:23] op_sel_hi:[1,0]
    v_pk_mul_f32 v[182:183], v[182:183], v[22:23] op_sel_hi:[1,0]
    v_cvt_pk_bf16_f32 v176, v176, v177
    v_cvt_pk_bf16_f32 v177, v178, v179
    v_cvt_pk_bf16_f32 v178, v180, v181
    v_cvt_pk_bf16_f32 v179, v182, v183
    v_mfma_f32_16x16x32_bf16 v[44:47], a[116:119], a[4:7], v[44:47]
    s_waitcnt vmcnt(16) lgkmcnt(2)
    v_cvt_pk_bf16_f32 v62, v52, v53
    v_cvt_pk_bf16_f32 v63, v54, v55
    v_mfma_f32_16x16x32_bf16 v[44:47], a[120:123], a[8:11], v[44:47]
    s_barrier
    v_mfma_f32_16x16x32_bf16 v[44:47], a[124:127], a[12:15], v[44:47]
    ds_read_b128 a[128:131], v2 offset:8192
    v_mul_f32 v40, s20, v40
    v_mfma_f32_16x16x32_bf16 a[232:235], a[248:251], v[60:63], a[232:235]
    v_exp_f32 v40, v40
    v_mfma_f32_16x16x32_bf16 v[192:195], a[164:167], v[60:63], v[192:195]
    ds_write_b128 v12, v[176:179] offset:12288
    v_mul_f32 v41, s20, v41
    v_mul_f32 v42, s20, v42
    v_pk_mul_f32 v[184:185], v[184:185], v[22:23] op_sel_hi:[1,0]
    v_pk_mul_f32 v[186:187], v[186:187], v[22:23] op_sel_hi:[1,0]
    v_pk_mul_f32 v[188:189], v[188:189], v[22:23] op_sel_hi:[1,0]
    v_pk_mul_f32 v[190:191], v[190:191], v[22:23] op_sel_hi:[1,0]
    v_cvt_pk_bf16_f32 v184, v184, v185
    v_cvt_pk_bf16_f32 v185, v186, v187
    v_cvt_pk_bf16_f32 v186, v188, v189
    v_cvt_pk_bf16_f32 v187, v190, v191
    v_mfma_f32_16x16x32_bf16 v[196:199], a[172:175], v[60:63], v[196:199]
    ds_read_b128 a[132:135], v3 offset:8192
    v_mul_f32 v43, s20, v43
    v_mfma_f32_16x16x32_bf16 v[200:203], a[180:183], v[60:63], v[200:203]
    v_exp_f32 v41, v41
    v_accvgpr_read_b32 v23, a232
    v_accvgpr_read_b32 v22, a233
    v_add_f32 v23, v23, v22
    v_mfma_f32_16x16x32_bf16 v[204:207], a[188:191], v[60:63], v[204:207]
    v_exp_f32 v42, v42
    v_mfma_f32_16x16x32_bf16 v[208:211], a[196:199], v[60:63], v[208:211]
    ds_read_b128 a[136:139], v4 offset:8192
    v_mul_f32 v44, s20, v44
    v_rcp_f32 v22, v23
    v_mfma_f32_16x16x32_bf16 v[212:215], a[204:207], v[60:63], v[212:215]
    v_exp_f32 v43, v43
    v_mfma_f32_16x16x32_bf16 v[216:219], a[212:215], v[60:63], v[216:219]
    ds_write_b128 v13, v[184:187] offset:12288
    v_exp_f32 v44, v44
    v_pk_mul_f32 v[192:193], v[192:193], v[22:23] op_sel_hi:[1,0]
    v_pk_mul_f32 v[194:195], v[194:195], v[22:23] op_sel_hi:[1,0]
    v_pk_mul_f32 v[196:197], v[196:197], v[22:23] op_sel_hi:[1,0]
    v_pk_mul_f32 v[198:199], v[198:199], v[22:23] op_sel_hi:[1,0]
    v_max3_u32 v21, v21, v22, v23
    v_cvt_pk_bf16_f32 v192, v192, v193
    v_cvt_pk_bf16_f32 v193, v194, v195
    v_cvt_pk_bf16_f32 v194, v196, v197
    v_cvt_pk_bf16_f32 v195, v198, v199
    v_mfma_f32_16x16x32_bf16 v[220:223], a[220:223], v[60:63], v[220:223]
    ds_read_b128 a[140:143], v5 offset:8192
    v_mul_f32 v45, s20, v45
    v_mfma_f32_16x16x32_bf16 v[48:51], a[96:99], a[16:19], 0
    v_mul_f32 v46, s20, v46
    v_mul_f32 v47, s20, v47
    v_mfma_f32_16x16x32_bf16 v[48:51], a[100:103], a[20:23], v[48:51]
    ds_write_b128 v10, v[192:195] offset:16384
    v_exp_f32 v45, v45
    v_pk_mul_f32 v[200:201], v[200:201], v[22:23] op_sel_hi:[1,0]
    v_pk_mul_f32 v[202:203], v[202:203], v[22:23] op_sel_hi:[1,0]
    v_pk_mul_f32 v[204:205], v[204:205], v[22:23] op_sel_hi:[1,0]
    v_pk_mul_f32 v[206:207], v[206:207], v[22:23] op_sel_hi:[1,0]
    v_cvt_pk_bf16_f32 v200, v200, v201
    v_cvt_pk_bf16_f32 v201, v202, v203
    v_cvt_pk_bf16_f32 v202, v204, v205
    v_cvt_pk_bf16_f32 v203, v206, v207
    v_mfma_f32_16x16x32_bf16 v[48:51], a[104:107], a[24:27], v[48:51]
    v_cvt_pk_bf16_f32 v56, v40, v41
    v_cvt_pk_bf16_f32 v57, v42, v43
    v_mfma_f32_16x16x32_bf16 v[48:51], a[108:111], a[28:31], v[48:51]
    v_exp_f32 v46, v46
    v_mfma_f32_16x16x32_bf16 v[52:55], a[112:115], a[16:19], 0
    ds_write_b128 v11, v[200:203] offset:16384
    v_exp_f32 v47, v47
    v_pk_mul_f32 v[208:209], v[208:209], v[22:23] op_sel_hi:[1,0]
    v_pk_mul_f32 v[210:211], v[210:211], v[22:23] op_sel_hi:[1,0]
    v_pk_mul_f32 v[212:213], v[212:213], v[22:23] op_sel_hi:[1,0]
    v_pk_mul_f32 v[214:215], v[214:215], v[22:23] op_sel_hi:[1,0]
    v_cvt_pk_bf16_f32 v208, v208, v209
    v_cvt_pk_bf16_f32 v209, v210, v211
    v_cvt_pk_bf16_f32 v210, v212, v213
    v_cvt_pk_bf16_f32 v211, v214, v215
    v_mfma_f32_16x16x32_bf16 v[52:55], a[116:119], a[20:23], v[52:55]
    s_add_u32 m0, s35, 0
    v_cvt_pk_bf16_f32 v58, v44, v45
    v_cvt_pk_bf16_f32 v59, v46, v47
    v_mfma_f32_16x16x32_bf16 v[52:55], a[120:123], a[24:27], v[52:55]
    buffer_load_dwordx4 v18, s[8:11], s22 offen lds
    v_mfma_f32_16x16x32_bf16 v[52:55], a[124:127], a[28:31], v[52:55]
    ds_read_b128 a[144:147], v0 offset:8192
    v_mul_f32 v48, s20, v48

    v_exp_f32 v48, v48
    v_accvgpr_write_b32 a224, 0
    v_accvgpr_write_b32 a225, 0
    v_accvgpr_write_b32 a226, 0
    v_accvgpr_write_b32 a227, 0
    v_mfma_f32_16x16x32_bf16 v[64:67], a[160:163], v[56:59], 0
    ds_write_b128 v12, v[208:211] offset:16384
    v_mul_f32 v49, s20, v49
    v_mul_f32 v50, s20, v50
    v_pk_mul_f32 v[216:217], v[216:217], v[22:23] op_sel_hi:[1,0]
    v_pk_mul_f32 v[218:219], v[218:219], v[22:23] op_sel_hi:[1,0]
    v_pk_mul_f32 v[220:221], v[220:221], v[22:23] op_sel_hi:[1,0]
    v_pk_mul_f32 v[222:223], v[222:223], v[22:23] op_sel_hi:[1,0]
    v_cvt_pk_bf16_f32 v216, v216, v217
    v_cvt_pk_bf16_f32 v217, v218, v219
    v_cvt_pk_bf16_f32 v218, v220, v221
    v_cvt_pk_bf16_f32 v219, v222, v223
    v_mfma_f32_16x16x32_bf16 v[68:71], a[168:171], v[56:59], 0
    ds_read_b128 a[148:151], v1 offset:8192
    v_mul_f32 v51, s20, v51
    v_mfma_f32_16x16x32_bf16 v[72:75], a[176:179], v[56:59], 0
    v_exp_f32 v49, v49
    v_mfma_f32_16x16x32_bf16 v[76:79], a[184:187], v[56:59], 0
    v_exp_f32 v50, v50
    v_mfma_f32_16x16x32_bf16 v[80:83], a[192:195], v[56:59], 0
    ds_read_b128 a[152:155], v25 offset:8192
    v_mul_f32 v52, s20, v52
    v_mfma_f32_16x16x32_bf16 v[84:87], a[200:203], v[56:59], 0
    v_exp_f32 v51, v51
    v_mfma_f32_16x16x32_bf16 v[88:91], a[208:211], v[56:59], 0
    ds_write_b128 v13, v[216:219] offset:16384
    v_exp_f32 v52, v52
    v_mfma_f32_16x16x32_bf16 v[92:95], a[216:219], v[56:59], 0
    ds_read_b128 a[156:159], v27 offset:8192
    v_mul_f32 v53, s20, v53
    v_mfma_f32_16x16x32_bf16 v[40:43], a[96:99], a[32:35], 0
    v_mul_f32 v54, s20, v54
    v_mul_f32 v55, s20, v55
    v_mfma_f32_16x16x32_bf16 v[40:43], a[100:103], a[36:39], v[40:43]
    v_exp_f32 v53, v53
    v_mfma_f32_16x16x32_bf16 v[40:43], a[104:107], a[40:43], v[40:43]
    v_cvt_pk_bf16_f32 v60, v48, v49
    v_cvt_pk_bf16_f32 v61, v50, v51
    v_mfma_f32_16x16x32_bf16 v[40:43], a[108:111], a[44:47], v[40:43]
    v_exp_f32 v54, v54
    v_mfma_f32_16x16x32_bf16 v[44:47], a[112:115], a[32:35], 0
    v_exp_f32 v55, v55
    v_mfma_f32_16x16x32_bf16 v[44:47], a[116:119], a[36:39], v[44:47]
    v_cvt_pk_bf16_f32 v62, v52, v53
    v_cvt_pk_bf16_f32 v63, v54, v55
    v_mfma_f32_16x16x32_bf16 v[44:47], a[120:123], a[40:43], v[44:47]
    buffer_load_dwordx4 v18, s[8:11], s22 offen offset:1024 lds
    v_mfma_f32_16x16x32_bf16 v[44:47], a[124:127], a[44:47], v[44:47]
    ds_read_b64_tr_b16 a[164:165], v6 offset:8192
    v_mul_f32 v40, s20, v40
    v_smfmac_f32_16x16x64_bf16 a[224:227], a[238:241], v[56:63], v26
    s_waitcnt vmcnt(10)
    v_exp_f32 v40, v40
    v_mfma_f32_16x16x32_bf16 v[96:99], a[160:163], v[60:63], 0
    v_mul_f32 v41, s20, v41
    v_mul_f32 v42, s20, v42
    v_mfma_f32_16x16x32_bf16 v[100:103], a[168:171], v[60:63], 0
    ds_read_b128 a[80:83], v10 offset:20480
    ds_read_b64_tr_b16 a[166:167], v36 offset:8192
    v_mul_f32 v43, s20, v43
    v_mfma_f32_16x16x32_bf16 v[104:107], a[176:179], v[60:63], 0
    ds_read_b128 a[84:87], v11 offset:20480
    v_exp_f32 v41, v41
    v_mfma_f32_16x16x32_bf16 v[108:111], a[184:187], v[60:63], 0
    ds_read_b128 a[88:91], v12 offset:20480
    v_exp_f32 v42, v42
    v_mfma_f32_16x16x32_bf16 v[112:115], a[192:195], v[60:63], 0
    ds_read_b128 a[92:95], v13 offset:20480
    ds_read_b64_tr_b16 a[172:173], v6 offset:8200
    v_mul_f32 v44, s20, v44
    v_mfma_f32_16x16x32_bf16 v[116:119], a[200:203], v[60:63], 0
    v_exp_f32 v43, v43
    v_mfma_f32_16x16x32_bf16 v[120:123], a[208:211], v[60:63], 0
    v_exp_f32 v44, v44
    v_mfma_f32_16x16x32_bf16 v[124:127], a[216:219], v[60:63], 0
    ds_read_b64_tr_b16 a[174:175], v36 offset:8200
    v_mul_f32 v45, s20, v45
    v_mfma_f32_16x16x32_bf16 v[48:51], a[96:99], a[48:51], 0
    ds_write_b128 v24, v[240:243] offset:20480
    v_mul_f32 v46, s20, v46
    v_mul_f32 v47, s20, v47
    v_mfma_f32_16x16x32_bf16 v[48:51], a[100:103], a[52:55], v[48:51]
    ds_write_b128 v24, v[244:247] offset:21504
    v_exp_f32 v45, v45
    v_mfma_f32_16x16x32_bf16 v[48:51], a[104:107], a[56:59], v[48:51]
    v_cvt_pk_bf16_f32 v56, v40, v41
    v_cvt_pk_bf16_f32 v57, v42, v43
    v_mfma_f32_16x16x32_bf16 v[48:51], a[108:111], a[60:63], v[48:51]
    ds_write_b128 v24, v[248:251] offset:22528
    v_exp_f32 v46, v46
    v_mfma_f32_16x16x32_bf16 v[52:55], a[112:115], a[48:51], 0
    ds_write_b128 v24, v[252:255] offset:23552
    v_exp_f32 v47, v47
    v_mfma_f32_16x16x32_bf16 v[52:55], a[116:119], a[52:55], v[52:55]
    s_add_u32 m0, s35, 32768
    v_cvt_pk_bf16_f32 v58, v44, v45
    v_cvt_pk_bf16_f32 v59, v46, v47
    v_mfma_f32_16x16x32_bf16 v[52:55], a[120:123], a[56:59], v[52:55]
    buffer_load_dwordx4 v19, s[12:15], s22 offen lds
    v_mfma_f32_16x16x32_bf16 v[52:55], a[124:127], a[60:63], v[52:55]
    ds_read_b64_tr_b16 a[180:181], v7 offset:8192
    v_mul_f32 v48, s20, v48

    v_exp_f32 v48, v48
    v_accvgpr_write_b32 a228, 0
    v_accvgpr_write_b32 a229, 0
    v_accvgpr_write_b32 a230, 0
    v_accvgpr_write_b32 a231, 0
    v_mfma_f32_16x16x32_bf16 v[128:131], a[160:163], v[56:59], 0
    v_mul_f32 v49, s20, v49
    v_mul_f32 v50, s20, v50
    v_mfma_f32_16x16x32_bf16 v[132:135], a[168:171], v[56:59], 0
    ds_read_b64_tr_b16 a[182:183], v37 offset:8192
    v_mul_f32 v51, s20, v51
    v_mfma_f32_16x16x32_bf16 v[136:139], a[176:179], v[56:59], 0
    s_waitcnt lgkmcnt(2)
    v_exp_f32 v49, v49
    v_mfma_f32_16x16x32_bf16 v[140:143], a[184:187], v[56:59], 0
    s_barrier
    v_exp_f32 v50, v50
    v_add_u32 v255, s50, v24
    v_mfma_f32_16x16x32_bf16 v[144:147], a[192:195], v[56:59], 0
    ds_read_b64_tr_b16 a[188:189], v7 offset:8200
    v_mul_f32 v52, s20, v52
    v_mfma_f32_16x16x32_bf16 v[148:151], a[200:203], v[56:59], 0
    ds_read_b128 v[240:243], v255 offset:20480
    v_exp_f32 v51, v51
    v_mfma_f32_16x16x32_bf16 v[152:155], a[208:211], v[56:59], 0
    ds_read_b128 v[244:247], v255 offset:21504
    v_exp_f32 v52, v52
    v_mfma_f32_16x16x32_bf16 v[156:159], a[216:219], v[56:59], 0
    ds_read_b64_tr_b16 a[190:191], v37 offset:8200
    v_mul_f32 v53, s20, v53
    v_mfma_f32_16x16x32_bf16 v[40:43], a[96:99], a[64:67], 0
    ds_read_b128 v[248:251], v255 offset:22528
    v_mul_f32 v54, s20, v54
    v_mul_f32 v55, s20, v55
    v_mfma_f32_16x16x32_bf16 v[40:43], a[100:103], a[68:71], v[40:43]
    ds_read_b128 v[252:255], v255 offset:23552
    v_exp_f32 v53, v53
    v_mfma_f32_16x16x32_bf16 v[40:43], a[104:107], a[72:75], v[40:43]
    v_cvt_pk_bf16_f32 v60, v48, v49
    v_cvt_pk_bf16_f32 v61, v50, v51
    v_mfma_f32_16x16x32_bf16 v[40:43], a[108:111], a[76:79], v[40:43]
    v_exp_f32 v54, v54
    v_mfma_f32_16x16x32_bf16 v[44:47], a[112:115], a[64:67], 0
    s_add_u32 s28, s24, 0
    v_exp_f32 v55, v55
    v_mfma_f32_16x16x32_bf16 v[44:47], a[116:119], a[68:71], v[44:47]
    s_add_u32 s32, s31, 0
    v_cvt_pk_bf16_f32 v62, v52, v53
    v_cvt_pk_bf16_f32 v63, v54, v55
    v_mfma_f32_16x16x32_bf16 v[44:47], a[120:123], a[72:75], v[44:47]
    buffer_load_dwordx4 v19, s[12:15], s22 offen offset:1024 lds
    v_mfma_f32_16x16x32_bf16 v[44:47], a[124:127], a[76:79], v[44:47]
    s_add_u32 m0, s30, 0
    ds_read_b64_tr_b16 a[196:197], v8 offset:8192
    v_mul_f32 v40, s20, v40
    v_smfmac_f32_16x16x64_bf16 a[228:231], a[238:241], v[56:63], v26
    s_waitcnt lgkmcnt(1)
    v_exp_f32 v40, v40
    v_pk_add_f32 v[228:229], v[228:229], v[244:245]
    v_pk_add_f32 v[230:231], v[230:231], v[246:247]
    v_mfma_f32_16x16x32_bf16 v[160:163], a[160:163], v[60:63], 0
    buffer_store_dwordx4 v[28:31], v16, s[16:19], s32 offen offset:2048 nt
    buffer_load_dwordx4 v16, s[4:7], s28 offen offset:2048 nt lds
    v_mul_f32 v41, s20, v41
    v_mul_f32 v42, s20, v42
    v_mov_b32_sdwa v245, v240 dst_sel:BYTE_1 dst_unused:UNUSED_PAD src0_sel:BYTE_0
    v_pk_add_f32 v[224:225], v[224:225], v[240:241]
    v_mfma_f32_16x16x32_bf16 v[164:167], a[168:171], v[60:63], 0
    s_xor_b32 s22, s22, 8192
    ds_read_b64_tr_b16 a[198:199], v38 offset:8192
    v_mul_f32 v43, s20, v43
    v_mov_b32_sdwa v245, v241 dst_sel:BYTE_2 dst_unused:UNUSED_PRESERVE src0_sel:BYTE_0
    v_pk_add_f32 v[226:227], v[226:227], v[242:243]
    v_mfma_f32_16x16x32_bf16 v[168:171], a[176:179], v[60:63], 0
    v_exp_f32 v41, v41
    v_mov_b32_sdwa v245, v242 dst_sel:BYTE_3 dst_unused:UNUSED_PRESERVE src0_sel:BYTE_0
    v_accvgpr_read_b32 v244, a234
    v_accvgpr_read_b32 v246, a235
    v_add_f32 v244, v244, v246
    v_mfma_f32_16x16x32_bf16 v[172:175], a[184:187], v[60:63], 0
    v_exp_f32 v42, v42
    v_pk_add_f32 v[232:233], v[232:233], v[248:249]
    v_add_f32 v245, v244, v245
    v_mfma_f32_16x16x32_bf16 v[176:179], a[192:195], v[60:63], 0
    ds_read_b64_tr_b16 a[204:205], v8 offset:8200
    v_mul_f32 v44, s20, v44
    v_pk_add_f32 v[234:235], v[234:235], v[250:251]
    v_rcp_f32 v244, v245
    v_mfma_f32_16x16x32_bf16 v[180:183], a[200:203], v[60:63], 0
    v_exp_f32 v43, v43
    v_pk_add_f32 v[236:237], v[236:237], v[252:253]
    v_pk_add_f32 v[238:239], v[238:239], v[254:255]
    v_mfma_f32_16x16x32_bf16 v[184:187], a[208:211], v[60:63], 0
    v_exp_f32 v44, v44
    v_max3_u32 v21, v21, v244, v245
    v_pk_mul_f32 v[224:225], v[224:225], v[244:245] op_sel_hi:[1,0]
    v_mfma_f32_16x16x32_bf16 v[188:191], a[216:219], v[60:63], 0
    ds_read_b64_tr_b16 a[206:207], v38 offset:8200
    v_mul_f32 v45, s20, v45
    v_pk_mul_f32 v[226:227], v[226:227], v[244:245] op_sel_hi:[1,0]
    v_pk_mul_f32 v[228:229], v[228:229], v[244:245] op_sel_hi:[1,0]
    v_mfma_f32_16x16x32_bf16 v[48:51], a[96:99], a[80:83], 0
    v_mul_f32 v46, s20, v46
    v_mul_f32 v47, s20, v47
    v_pk_mul_f32 v[230:231], v[230:231], v[244:245] op_sel_hi:[1,0]
    v_cvt_pk_bf16_f32 v224, v224, v225
    v_mfma_f32_16x16x32_bf16 v[48:51], a[100:103], a[84:87], v[48:51]
    v_exp_f32 v45, v45
    v_cvt_pk_bf16_f32 v225, v226, v227
    v_cvt_pk_bf16_f32 v226, v228, v229
    v_mfma_f32_16x16x32_bf16 v[48:51], a[104:107], a[88:91], v[48:51]
    v_cvt_pk_bf16_f32 v56, v40, v41
    v_cvt_pk_bf16_f32 v57, v42, v43
    v_cvt_pk_bf16_f32 v227, v230, v231
    v_pk_mul_f32 v[232:233], v[232:233], v[244:245] op_sel_hi:[1,0]
    v_mfma_f32_16x16x32_bf16 v[48:51], a[108:111], a[92:95], v[48:51]
    s_add_u32 s44, s31, s49
    v_exp_f32 v46, v46
    v_pk_mul_f32 v[234:235], v[234:235], v[244:245] op_sel_hi:[1,0]
    v_pk_mul_f32 v[236:237], v[236:237], v[244:245] op_sel_hi:[1,0]
    v_mfma_f32_16x16x32_bf16 v[52:55], a[112:115], a[80:83], 0
    buffer_store_dwordx4 v[224:227], v20, s[16:19], s44 offen nt
    v_exp_f32 v47, v47
    v_pk_mul_f32 v[238:239], v[238:239], v[244:245] op_sel_hi:[1,0]
    v_cvt_pk_bf16_f32 v232, v232, v233
    v_mfma_f32_16x16x32_bf16 v[52:55], a[116:119], a[84:87], v[52:55]
    v_cvt_pk_bf16_f32 v58, v44, v45
    v_cvt_pk_bf16_f32 v59, v46, v47
    v_cvt_pk_bf16_f32 v233, v234, v235
    v_cvt_pk_bf16_f32 v234, v236, v237
    v_mfma_f32_16x16x32_bf16 v[52:55], a[120:123], a[88:91], v[52:55]
    ds_read_b128 v[28:31], v24 offset:3072
    v_cvt_pk_bf16_f32 v235, v238, v239
    v_mfma_f32_16x16x32_bf16 v[52:55], a[124:127], a[92:95], v[52:55]
    ds_read_b64_tr_b16 a[212:213], v9 offset:8192
    v_mul_f32 v48, s20, v48
    v_cmp_lt_u32 vcc, s21, v21
    v_mov_b32 v21, 0

    buffer_store_dwordx4 v[232:235], v20, s[16:19], s44 offen offset:64 nt
    v_exp_f32 v48, v48
    v_accvgpr_write_b32 a232, 0
    v_accvgpr_write_b32 a233, 0
    v_accvgpr_write_b32 a234, 0
    v_accvgpr_write_b32 a235, 0
    v_mfma_f32_16x16x32_bf16 v[192:195], a[160:163], v[56:59], 0
    s_or_b32 s41, vcc_lo, vcc_hi
    v_mul_f32 v49, s20, v49
    v_mul_f32 v50, s20, v50
    v_mfma_f32_16x16x32_bf16 v[196:199], a[168:171], v[56:59], 0
    s_min_u32 s41, s41, 1
    ds_read_b64_tr_b16 a[214:215], v39 offset:8192
    v_mul_f32 v51, s20, v51
    v_mfma_f32_16x16x32_bf16 v[200:203], a[176:179], v[56:59], 0
    s_lshl_b32 s41, s41, s33
    v_exp_f32 v49, v49
    v_mfma_f32_16x16x32_bf16 v[204:207], a[184:187], v[56:59], 0
    s_or_b32 s34, s34, s41
    v_exp_f32 v50, v50
    v_mfma_f32_16x16x32_bf16 v[208:211], a[192:195], v[56:59], 0
    ds_read_b64_tr_b16 a[220:221], v9 offset:8200
    v_mul_f32 v52, s20, v52
    v_mfma_f32_16x16x32_bf16 v[212:215], a[200:203], v[56:59], 0
    v_exp_f32 v51, v51
    v_mfma_f32_16x16x32_bf16 v[216:219], a[208:211], v[56:59], 0
    v_exp_f32 v52, v52
    v_mfma_f32_16x16x32_bf16 v[220:223], a[216:219], v[56:59], 0
    s_waitcnt lgkmcnt(15)
    ds_read_b64_tr_b16 a[222:223], v39 offset:8200
    v_mul_f32 v53, s20, v53
    s_branch L_A1
L_proB:
    v_mfma_f32_16x16x32_bf16 v[40:43], a[96:99], a[0:3], 0
    s_nop 0
    v_mfma_f32_16x16x32_bf16 v[40:43], a[100:103], a[4:7], v[40:43]
    s_nop 0
    v_mfma_f32_16x16x32_bf16 v[40:43], a[104:107], a[8:11], v[40:43]
    s_nop 0
    v_mfma_f32_16x16x32_bf16 v[40:43], a[108:111], a[12:15], v[40:43]
    s_nop 0
    v_mfma_f32_16x16x32_bf16 v[44:47], a[112:115], a[0:3], 0
    s_nop 0
    v_mfma_f32_16x16x32_bf16 v[44:47], a[116:119], a[4:7], v[44:47]
    s_nop 0
    v_mfma_f32_16x16x32_bf16 v[44:47], a[120:123], a[8:11], v[44:47]
    s_nop 0
    v_mfma_f32_16x16x32_bf16 v[44:47], a[124:127], a[12:15], v[44:47]
    s_add_u32 m0, s35, 8192
    s_nop 0
    buffer_load_dwordx4 v18, s[8:11], s22 offen lds
    buffer_load_dwordx4 v18, s[8:11], s22 offen offset:1024 lds
    s_add_u32 m0, s35, 40960
    s_nop 0
    buffer_load_dwordx4 v19, s[12:15], s22 offen lds
    buffer_load_dwordx4 v19, s[12:15], s22 offen offset:1024 lds
    s_xor_b32 s22, s22, 24576
    s_waitcnt vmcnt(17)
    v_mul_f32 v40, s20, v40
    s_nop 1
    ds_read_b128 a[16:19], v10 offset:4096
    v_exp_f32 v40, v40
    s_nop 1
    ds_read_b128 a[20:23], v11 offset:4096
    v_mul_f32 v41, s20, v41
    v_mul_f32 v42, s20, v42
    s_nop 1
    ds_read_b128 a[24:27], v12 offset:4096
    v_mul_f32 v43, s20, v43
    s_nop 1
    ds_read_b128 a[28:31], v13 offset:4096
    v_exp_f32 v41, v41
    s_nop 1
    v_exp_f32 v42, v42
    s_nop 1
    v_mul_f32 v44, s20, v44
    s_nop 1
    v_exp_f32 v43, v43
    s_nop 1
    v_exp_f32 v44, v44
    s_nop 1
    s_waitcnt lgkmcnt(0)
    v_mul_f32 v45, s20, v45
    v_mfma_f32_16x16x32_bf16 v[48:51], a[96:99], a[16:19], 0
    v_mul_f32 v46, s20, v46
    v_mul_f32 v47, s20, v47
    v_mfma_f32_16x16x32_bf16 v[48:51], a[100:103], a[20:23], v[48:51]
    v_exp_f32 v45, v45
    v_mfma_f32_16x16x32_bf16 v[48:51], a[104:107], a[24:27], v[48:51]
    v_cvt_pk_bf16_f32 v56, v40, v41
    v_cvt_pk_bf16_f32 v57, v42, v43
    v_mfma_f32_16x16x32_bf16 v[48:51], a[108:111], a[28:31], v[48:51]
    v_exp_f32 v46, v46
    v_mfma_f32_16x16x32_bf16 v[52:55], a[112:115], a[16:19], 0
    v_exp_f32 v47, v47
    v_mfma_f32_16x16x32_bf16 v[52:55], a[116:119], a[20:23], v[52:55]
    v_cvt_pk_bf16_f32 v58, v44, v45
    v_cvt_pk_bf16_f32 v59, v46, v47
    v_mfma_f32_16x16x32_bf16 v[52:55], a[120:123], a[24:27], v[52:55]
    s_nop 0
    v_mfma_f32_16x16x32_bf16 v[52:55], a[124:127], a[28:31], v[52:55]
    s_add_u32 m0, s30, 20480
    s_add_u32 s28, s24, s48
    buffer_load_dwordx4 v14, s[4:7], s28 offen nt lds
    buffer_load_dwordx4 v15, s[4:7], s28 offen offset:1024 nt lds
    buffer_load_dwordx4 v16, s[4:7], s28 offen offset:2048 nt lds
    buffer_load_dwordx4 v17, s[4:7], s28 offen offset:3072 nt lds
    s_mov_b32 s26, s24
    s_mov_b32 s27, s25
    s_add_u32 s33, s33, 1
    s_lshl_b32 s41, s33, 5
    s_add_u32 s41, s41, s37
    s_lshr_b32 s42, s41, 1
    s_xor_b32 s43, s33, s37
    s_and_b32 s43, s43, 1
    s_mul_i32 s44, s43, s58
    s_mul_i32 s43, s43, 22
    s_add_u32 s43, s43, 24
    s_lshl_b32 s42, s42, 3
    s_add_u32 s42, s42, s38
    s_lshl_b32 s23, s42, 17
    s_mul_i32 s42, s42, 46
    s_add_u32 s44, s44, s36
    s_add_u32 s44, s44, s42
    s_lshl_b32 s24, s44, 12
    s_add_u32 s43, s43, s42
    s_lshl_b32 s43, s43, 12
    s_min_u32 s25, s43, 96468992
    s_mov_b32 s6, s25
    s_waitcnt vmcnt(17)
    v_mul_f32 v48, s20, v48

    ds_read_b128 a[32:35], v10 offset:8192
    v_exp_f32 v48, v48
    v_accvgpr_write_b32 a224, 0
    v_accvgpr_write_b32 a225, 0
    v_accvgpr_write_b32 a226, 0
    v_accvgpr_write_b32 a227, 0
    v_mfma_f32_16x16x32_bf16 v[64:67], a[160:163], v[56:59], 0
    ds_read_b128 a[36:39], v11 offset:8192
    v_mul_f32 v49, s20, v49
    v_mul_f32 v50, s20, v50
    v_mfma_f32_16x16x32_bf16 v[68:71], a[168:171], v[56:59], 0
    ds_read_b128 a[40:43], v12 offset:8192
    v_mul_f32 v51, s20, v51
    v_mfma_f32_16x16x32_bf16 v[72:75], a[176:179], v[56:59], 0
    ds_read_b128 a[44:47], v13 offset:8192
    v_exp_f32 v49, v49
    v_mfma_f32_16x16x32_bf16 v[76:79], a[184:187], v[56:59], 0
    v_exp_f32 v50, v50
    v_mfma_f32_16x16x32_bf16 v[80:83], a[192:195], v[56:59], 0
    v_mul_f32 v52, s20, v52
    v_mfma_f32_16x16x32_bf16 v[84:87], a[200:203], v[56:59], 0
    v_exp_f32 v51, v51
    v_mfma_f32_16x16x32_bf16 v[88:91], a[208:211], v[56:59], 0
    v_exp_f32 v52, v52
    v_mfma_f32_16x16x32_bf16 v[92:95], a[216:219], v[56:59], 0
    s_waitcnt lgkmcnt(0)
    v_mul_f32 v53, s20, v53
    v_mfma_f32_16x16x32_bf16 v[40:43], a[96:99], a[32:35], 0
    v_mul_f32 v54, s20, v54
    v_mul_f32 v55, s20, v55
    v_mfma_f32_16x16x32_bf16 v[40:43], a[100:103], a[36:39], v[40:43]
    v_exp_f32 v53, v53
    v_mfma_f32_16x16x32_bf16 v[40:43], a[104:107], a[40:43], v[40:43]
    v_cvt_pk_bf16_f32 v60, v48, v49
    v_cvt_pk_bf16_f32 v61, v50, v51
    v_mfma_f32_16x16x32_bf16 v[40:43], a[108:111], a[44:47], v[40:43]
    v_exp_f32 v54, v54
    v_mfma_f32_16x16x32_bf16 v[44:47], a[112:115], a[32:35], 0
    v_exp_f32 v55, v55
    v_mfma_f32_16x16x32_bf16 v[44:47], a[116:119], a[36:39], v[44:47]
    v_cvt_pk_bf16_f32 v62, v52, v53
    v_cvt_pk_bf16_f32 v63, v54, v55
    v_mfma_f32_16x16x32_bf16 v[44:47], a[120:123], a[40:43], v[44:47]
    s_nop 0
    v_mfma_f32_16x16x32_bf16 v[44:47], a[124:127], a[44:47], v[44:47]
    s_add_u32 m0, s35, 16384
    s_nop 0
    buffer_load_dwordx4 v18, s[8:11], s22 offen lds
    buffer_load_dwordx4 v18, s[8:11], s22 offen offset:1024 lds
    s_add_u32 m0, s35, 49152
    s_nop 0
    buffer_load_dwordx4 v19, s[12:15], s22 offen lds
    buffer_load_dwordx4 v19, s[12:15], s22 offen offset:1024 lds
    s_xor_b32 s22, s22, 8192
    s_waitcnt vmcnt(16)
    v_mul_f32 v40, s20, v40
    v_smfmac_f32_16x16x64_bf16 a[224:227], a[238:241], v[56:63], v26
    ds_read_b128 a[48:51], v10 offset:12288
    v_exp_f32 v40, v40
    v_mfma_f32_16x16x32_bf16 v[96:99], a[160:163], v[60:63], 0
    ds_read_b128 a[52:55], v11 offset:12288
    v_mul_f32 v41, s20, v41
    v_mul_f32 v42, s20, v42
    v_mfma_f32_16x16x32_bf16 v[100:103], a[168:171], v[60:63], 0
    ds_read_b128 a[56:59], v12 offset:12288
    v_mul_f32 v43, s20, v43
    v_mfma_f32_16x16x32_bf16 v[104:107], a[176:179], v[60:63], 0
    ds_read_b128 a[60:63], v13 offset:12288
    v_exp_f32 v41, v41
    v_mfma_f32_16x16x32_bf16 v[108:111], a[184:187], v[60:63], 0
    v_exp_f32 v42, v42
    v_mfma_f32_16x16x32_bf16 v[112:115], a[192:195], v[60:63], 0
    v_mul_f32 v44, s20, v44
    v_mfma_f32_16x16x32_bf16 v[116:119], a[200:203], v[60:63], 0
    v_exp_f32 v43, v43
    v_mfma_f32_16x16x32_bf16 v[120:123], a[208:211], v[60:63], 0
    v_exp_f32 v44, v44
    v_mfma_f32_16x16x32_bf16 v[124:127], a[216:219], v[60:63], 0
    s_waitcnt lgkmcnt(0)
    v_mul_f32 v45, s20, v45
    v_mfma_f32_16x16x32_bf16 v[48:51], a[96:99], a[48:51], 0
    v_mul_f32 v46, s20, v46
    v_mul_f32 v47, s20, v47
    v_mfma_f32_16x16x32_bf16 v[48:51], a[100:103], a[52:55], v[48:51]
    v_exp_f32 v45, v45
    v_mfma_f32_16x16x32_bf16 v[48:51], a[104:107], a[56:59], v[48:51]
    v_cvt_pk_bf16_f32 v56, v40, v41
    v_cvt_pk_bf16_f32 v57, v42, v43
    v_mfma_f32_16x16x32_bf16 v[48:51], a[108:111], a[60:63], v[48:51]
    v_exp_f32 v46, v46
    v_mfma_f32_16x16x32_bf16 v[52:55], a[112:115], a[48:51], 0
    v_exp_f32 v47, v47
    v_mfma_f32_16x16x32_bf16 v[52:55], a[116:119], a[52:55], v[52:55]
    v_cvt_pk_bf16_f32 v58, v44, v45
    v_cvt_pk_bf16_f32 v59, v46, v47
    v_mfma_f32_16x16x32_bf16 v[52:55], a[120:123], a[56:59], v[52:55]
    s_nop 0
    v_mfma_f32_16x16x32_bf16 v[52:55], a[124:127], a[60:63], v[52:55]
    s_add_u32 m0, s35, 24576
    s_nop 0
    buffer_load_dwordx4 v18, s[8:11], s22 offen lds
    buffer_load_dwordx4 v18, s[8:11], s22 offen offset:1024 lds
    s_add_u32 m0, s35, 57344
    s_nop 0
    buffer_load_dwordx4 v19, s[12:15], s22 offen lds
    buffer_load_dwordx4 v19, s[12:15], s22 offen offset:1024 lds
    s_xor_b32 s22, s22, 57344
    s_waitcnt vmcnt(16)
    v_mul_f32 v48, s20, v48

    ds_read_b128 a[64:67], v10 offset:16384
    v_exp_f32 v48, v48
    v_accvgpr_write_b32 a228, 0
    v_accvgpr_write_b32 a229, 0
    v_accvgpr_write_b32 a230, 0
    v_accvgpr_write_b32 a231, 0
    v_mfma_f32_16x16x32_bf16 v[128:131], a[160:163], v[56:59], 0
    ds_read_b128 a[68:71], v11 offset:16384
    v_mul_f32 v49, s20, v49
    v_mul_f32 v50, s20, v50
    v_mfma_f32_16x16x32_bf16 v[132:135], a[168:171], v[56:59], 0
    ds_read_b128 a[72:75], v12 offset:16384
    v_mul_f32 v51, s20, v51
    v_mfma_f32_16x16x32_bf16 v[136:139], a[176:179], v[56:59], 0
    ds_read_b128 a[76:79], v13 offset:16384
    v_exp_f32 v49, v49
    v_mfma_f32_16x16x32_bf16 v[140:143], a[184:187], v[56:59], 0
    v_exp_f32 v50, v50
    v_mfma_f32_16x16x32_bf16 v[144:147], a[192:195], v[56:59], 0
    v_mul_f32 v52, s20, v52
    v_mfma_f32_16x16x32_bf16 v[148:151], a[200:203], v[56:59], 0
    v_exp_f32 v51, v51
    v_mfma_f32_16x16x32_bf16 v[152:155], a[208:211], v[56:59], 0
    v_exp_f32 v52, v52
    v_mfma_f32_16x16x32_bf16 v[156:159], a[216:219], v[56:59], 0
    s_waitcnt lgkmcnt(0)
    v_mul_f32 v53, s20, v53
    v_mfma_f32_16x16x32_bf16 v[40:43], a[96:99], a[64:67], 0
    v_mul_f32 v54, s20, v54
    v_mul_f32 v55, s20, v55
    v_mfma_f32_16x16x32_bf16 v[40:43], a[100:103], a[68:71], v[40:43]
    v_exp_f32 v53, v53
    v_mfma_f32_16x16x32_bf16 v[40:43], a[104:107], a[72:75], v[40:43]
    v_cvt_pk_bf16_f32 v60, v48, v49
    v_cvt_pk_bf16_f32 v61, v50, v51
    v_mfma_f32_16x16x32_bf16 v[40:43], a[108:111], a[76:79], v[40:43]
    v_exp_f32 v54, v54
    v_mfma_f32_16x16x32_bf16 v[44:47], a[112:115], a[64:67], 0
    v_exp_f32 v55, v55
    v_mfma_f32_16x16x32_bf16 v[44:47], a[116:119], a[68:71], v[44:47]
    s_waitcnt vmcnt(12) lgkmcnt(0)
    v_cvt_pk_bf16_f32 v62, v52, v53
    v_cvt_pk_bf16_f32 v63, v54, v55
    v_mfma_f32_16x16x32_bf16 v[44:47], a[120:123], a[72:75], v[44:47]
    s_barrier
    v_mfma_f32_16x16x32_bf16 v[44:47], a[124:127], a[76:79], v[44:47]
    s_waitcnt vmcnt(8)
    v_mul_f32 v40, s20, v40
    v_smfmac_f32_16x16x64_bf16 a[228:231], a[238:241], v[56:63], v26
    ds_read_b128 a[80:83], v10 offset:20480
    v_exp_f32 v40, v40
    v_mfma_f32_16x16x32_bf16 v[160:163], a[160:163], v[60:63], 0
    ds_read_b128 a[84:87], v11 offset:20480
    v_mul_f32 v41, s20, v41
    v_mul_f32 v42, s20, v42
    v_mfma_f32_16x16x32_bf16 v[164:167], a[168:171], v[60:63], 0
    ds_read_b128 a[88:91], v12 offset:20480
    v_mul_f32 v43, s20, v43
    v_mfma_f32_16x16x32_bf16 v[168:171], a[176:179], v[60:63], 0
    ds_read_b128 a[92:95], v13 offset:20480
    v_exp_f32 v41, v41
    v_mfma_f32_16x16x32_bf16 v[172:175], a[184:187], v[60:63], 0
    ds_read_b128 a[128:131], v2 offset:8192
    v_exp_f32 v42, v42
    v_mfma_f32_16x16x32_bf16 v[176:179], a[192:195], v[60:63], 0
    ds_read_b128 a[132:135], v3 offset:8192
    v_mul_f32 v44, s20, v44
    v_mfma_f32_16x16x32_bf16 v[180:183], a[200:203], v[60:63], 0
    ds_read_b128 a[136:139], v4 offset:8192
    v_exp_f32 v43, v43
    v_mfma_f32_16x16x32_bf16 v[184:187], a[208:211], v[60:63], 0
    ds_read_b128 a[140:143], v5 offset:8192
    v_exp_f32 v44, v44
    v_mfma_f32_16x16x32_bf16 v[188:191], a[216:219], v[60:63], 0
    s_waitcnt lgkmcnt(4)
    ds_read_b128 a[144:147], v0 offset:8192
    v_mul_f32 v45, s20, v45
    v_mfma_f32_16x16x32_bf16 v[48:51], a[112:115], a[80:83], 0
    ds_read_b128 a[148:151], v1 offset:8192
    v_mul_f32 v46, s20, v46
    v_mul_f32 v47, s20, v47
    s_add_u32 m0, s35, 0
    s_nop 0
    buffer_load_dwordx4 v18, s[8:11], s22 offen lds
    v_mfma_f32_16x16x32_bf16 v[48:51], a[116:119], a[84:87], v[48:51]
    ds_read_b128 a[152:155], v25 offset:8192
    v_exp_f32 v45, v45
    v_mfma_f32_16x16x32_bf16 v[48:51], a[120:123], a[88:91], v[48:51]
    ds_read_b128 a[156:159], v27 offset:8192
    v_cvt_pk_bf16_f32 v56, v40, v41
    v_cvt_pk_bf16_f32 v57, v42, v43
    s_nop 0
    buffer_load_dwordx4 v18, s[8:11], s22 offen offset:1024 lds
    v_mfma_f32_16x16x32_bf16 v[48:51], a[124:127], a[92:95], v[48:51]
    s_waitcnt lgkmcnt(4)
    ds_read_b64_tr_b16 a[164:165], v6 offset:8192
    v_exp_f32 v46, v46
    v_mfma_f32_16x16x32_bf16 v[52:55], a[128:131], a[80:83], 0
    ds_read_b64_tr_b16 a[166:167], v36 offset:8192
    v_exp_f32 v47, v47
    s_add_u32 m0, s35, 32768
    s_nop 0
    buffer_load_dwordx4 v19, s[12:15], s22 offen lds
    v_mfma_f32_16x16x32_bf16 v[52:55], a[132:135], a[84:87], v[52:55]
    ds_read_b64_tr_b16 a[172:173], v6 offset:8200
    v_cvt_pk_bf16_f32 v58, v44, v45
    v_cvt_pk_bf16_f32 v59, v46, v47
    v_mfma_f32_16x16x32_bf16 v[52:55], a[136:139], a[88:91], v[52:55]
    ds_read_b64_tr_b16 a[174:175], v36 offset:8200
    s_nop 0
    buffer_load_dwordx4 v19, s[12:15], s22 offen offset:1024 lds
    v_mfma_f32_16x16x32_bf16 v[52:55], a[140:143], a[92:95], v[52:55]
    ds_read_b64_tr_b16 a[180:181], v7 offset:8192
    v_mul_f32 v48, s20, v48

    ds_read_b64_tr_b16 a[182:183], v37 offset:8192
    v_exp_f32 v48, v48
    v_accvgpr_write_b32 a232, 0
    v_accvgpr_write_b32 a233, 0
    v_accvgpr_write_b32 a234, 0
    v_accvgpr_write_b32 a235, 0
    s_add_u32 s32, s31, 0
    s_nop 0
    buffer_store_dwordx4 v[28:31], v14, s[16:19], s32 offen nt
    v_mfma_f32_16x16x32_bf16 v[192:195], a[160:163], v[56:59], 0
    ds_read_b64_tr_b16 a[188:189], v7 offset:8200
    v_mul_f32 v49, s20, v49
    v_mul_f32 v50, s20, v50
    v_mfma_f32_16x16x32_bf16 v[196:199], a[168:171], v[56:59], 0
    ds_read_b64_tr_b16 a[190:191], v37 offset:8200
    v_mul_f32 v51, s20, v51
    s_nop 0
    buffer_store_dwordx4 v[32:35], v14, s[16:19], s32 offen nt
    v_mfma_f32_16x16x32_bf16 v[200:203], a[176:179], v[56:59], 0
    ds_read_b64_tr_b16 a[196:197], v8 offset:8192
    v_exp_f32 v49, v49
    v_mfma_f32_16x16x32_bf16 v[204:207], a[184:187], v[56:59], 0
    ds_read_b64_tr_b16 a[198:199], v38 offset:8192
    v_exp_f32 v50, v50
    s_nop 0
    buffer_store_dwordx4 v[28:31], v14, s[16:19], s32 offen nt
    v_mfma_f32_16x16x32_bf16 v[208:211], a[192:195], v[56:59], 0
    ds_read_b64_tr_b16 a[204:205], v8 offset:8200
    v_mul_f32 v52, s20, v52
    v_mfma_f32_16x16x32_bf16 v[212:215], a[200:203], v[56:59], 0
    ds_read_b64_tr_b16 a[206:207], v38 offset:8200
    v_exp_f32 v51, v51
    s_nop 0
    buffer_store_dwordx4 v[32:35], v14, s[16:19], s32 offen nt
    v_mfma_f32_16x16x32_bf16 v[216:219], a[208:211], v[56:59], 0
    ds_read_b64_tr_b16 a[212:213], v9 offset:8192
    v_exp_f32 v52, v52
    v_mfma_f32_16x16x32_bf16 v[220:223], a[216:219], v[56:59], 0
    s_waitcnt lgkmcnt(13)
    ds_read_b64_tr_b16 a[214:215], v39 offset:8192
    ds_read_b64_tr_b16 a[220:221], v9 offset:8200
    ds_read_b64_tr_b16 a[222:223], v39 offset:8200
    v_mul_f32 v53, s20, v53
    s_xor_b32 s22, s22, 8192
    s_branch L_B1
L_finA:
    v_mfma_f32_16x16x32_bf16 v[40:43], a[128:131], a[0:3], 0
    v_mul_f32 v54, s20, v54
    v_mul_f32 v55, s20, v55
    v_mfma_f32_16x16x32_bf16 v[40:43], a[132:135], a[4:7], v[40:43]
    v_exp_f32 v53, v53
    v_mfma_f32_16x16x32_bf16 v[40:43], a[136:139], a[8:11], v[40:43]
    v_cvt_pk_bf16_f32 v60, v48, v49
    v_cvt_pk_bf16_f32 v61, v50, v51
    v_mfma_f32_16x16x32_bf16 v[40:43], a[140:143], a[12:15], v[40:43]
    v_exp_f32 v54, v54
    v_mfma_f32_16x16x32_bf16 v[44:47], a[144:147], a[0:3], 0
    v_exp_f32 v55, v55
    v_mfma_f32_16x16x32_bf16 v[44:47], a[148:151], a[4:7], v[44:47]
    s_waitcnt vmcnt(63) lgkmcnt(0)
    v_cvt_pk_bf16_f32 v62, v52, v53
    v_cvt_pk_bf16_f32 v63, v54, v55
    v_mfma_f32_16x16x32_bf16 v[44:47], a[152:155], a[8:11], v[44:47]
    s_nop 0
    v_mfma_f32_16x16x32_bf16 v[44:47], a[156:159], a[12:15], v[44:47]
    v_mul_f32 v40, s20, v40
    v_smfmac_f32_16x16x64_bf16 a[232:235], a[238:241], v[56:63], v26
    v_exp_f32 v40, v40
    v_mfma_f32_16x16x32_bf16 v[224:227], a[160:163], v[60:63], v[224:227]
    v_mul_f32 v41, s20, v41
    v_mul_f32 v42, s20, v42
    v_mfma_f32_16x16x32_bf16 v[228:231], a[168:171], v[60:63], v[228:231]
    v_mul_f32 v43, s20, v43
    v_mfma_f32_16x16x32_bf16 v[232:235], a[176:179], v[60:63], v[232:235]
    v_exp_f32 v41, v41
    v_mfma_f32_16x16x32_bf16 v[236:239], a[184:187], v[60:63], v[236:239]
    v_exp_f32 v42, v42
    v_mfma_f32_16x16x32_bf16 v[240:243], a[192:195], v[60:63], v[240:243]
    v_mul_f32 v44, s20, v44
    v_mfma_f32_16x16x32_bf16 v[244:247], a[200:203], v[60:63], v[244:247]
    v_exp_f32 v43, v43
    v_mfma_f32_16x16x32_bf16 v[248:251], a[208:211], v[60:63], v[248:251]
    v_exp_f32 v44, v44
    v_mfma_f32_16x16x32_bf16 v[252:255], a[216:219], v[60:63], v[252:255]
    v_mul_f32 v45, s20, v45
    v_mfma_f32_16x16x32_bf16 v[48:51], a[128:131], a[16:19], 0
    v_mul_f32 v46, s20, v46
    v_mul_f32 v47, s20, v47
    v_mfma_f32_16x16x32_bf16 v[48:51], a[132:135], a[20:23], v[48:51]
    v_exp_f32 v45, v45
    v_mfma_f32_16x16x32_bf16 v[48:51], a[136:139], a[24:27], v[48:51]
    v_cvt_pk_bf16_f32 v56, v40, v41
    v_cvt_pk_bf16_f32 v57, v42, v43
    v_mfma_f32_16x16x32_bf16 v[48:51], a[140:143], a[28:31], v[48:51]
    v_exp_f32 v46, v46
    v_mfma_f32_16x16x32_bf16 v[52:55], a[144:147], a[16:19], 0
    v_exp_f32 v47, v47
    v_mfma_f32_16x16x32_bf16 v[52:55], a[148:151], a[20:23], v[52:55]
    v_cvt_pk_bf16_f32 v58, v44, v45
    v_cvt_pk_bf16_f32 v59, v46, v47
    v_mfma_f32_16x16x32_bf16 v[52:55], a[152:155], a[24:27], v[52:55]
    s_nop 0
    v_mfma_f32_16x16x32_bf16 v[52:55], a[156:159], a[28:31], v[52:55]
    v_mul_f32 v48, s20, v48
    v_mfma_f32_16x16x32_bf16 a[224:227], a[248:251], v[56:59], a[224:227]
    s_waitcnt vmcnt(63)
    v_exp_f32 v48, v48
    v_mfma_f32_16x16x32_bf16 v[64:67], a[164:167], v[56:59], v[64:67]
    v_mul_f32 v49, s20, v49
    v_mul_f32 v50, s20, v50
    v_mfma_f32_16x16x32_bf16 v[68:71], a[172:175], v[56:59], v[68:71]
    v_mul_f32 v51, s20, v51
    v_mfma_f32_16x16x32_bf16 v[72:75], a[180:183], v[56:59], v[72:75]
    v_exp_f32 v49, v49
    v_accvgpr_read_b32 v23, a224
    v_accvgpr_read_b32 v22, a225
    v_add_f32 v23, v23, v22
    v_mfma_f32_16x16x32_bf16 v[76:79], a[188:191], v[56:59], v[76:79]
    v_exp_f32 v50, v50
    v_mfma_f32_16x16x32_bf16 v[80:83], a[196:199], v[56:59], v[80:83]
    v_mul_f32 v52, s20, v52
    v_rcp_f32 v22, v23
    v_mfma_f32_16x16x32_bf16 v[84:87], a[204:207], v[56:59], v[84:87]
    v_exp_f32 v51, v51
    v_mfma_f32_16x16x32_bf16 v[88:91], a[212:215], v[56:59], v[88:91]
    v_exp_f32 v52, v52
    v_pk_mul_f32 v[64:65], v[64:65], v[22:23] op_sel_hi:[1,0]
    v_pk_mul_f32 v[66:67], v[66:67], v[22:23] op_sel_hi:[1,0]
    v_pk_mul_f32 v[68:69], v[68:69], v[22:23] op_sel_hi:[1,0]
    v_pk_mul_f32 v[70:71], v[70:71], v[22:23] op_sel_hi:[1,0]
    v_max3_u32 v21, v21, v22, v23
    v_cvt_pk_bf16_f32 v64, v64, v65
    v_cvt_pk_bf16_f32 v65, v66, v67
    v_cvt_pk_bf16_f32 v66, v68, v69
    v_cvt_pk_bf16_f32 v67, v70, v71
    v_mfma_f32_16x16x32_bf16 v[92:95], a[220:223], v[56:59], v[92:95]
    v_mul_f32 v53, s20, v53
    v_mfma_f32_16x16x32_bf16 v[40:43], a[128:131], a[32:35], 0
    v_mul_f32 v54, s20, v54
    v_mul_f32 v55, s20, v55
    v_mfma_f32_16x16x32_bf16 v[40:43], a[132:135], a[36:39], v[40:43]
    ds_write_b128 v10, v[64:67] offset:0
    v_exp_f32 v53, v53
    v_pk_mul_f32 v[72:73], v[72:73], v[22:23] op_sel_hi:[1,0]
    v_pk_mul_f32 v[74:75], v[74:75], v[22:23] op_sel_hi:[1,0]
    v_pk_mul_f32 v[76:77], v[76:77], v[22:23] op_sel_hi:[1,0]
    v_pk_mul_f32 v[78:79], v[78:79], v[22:23] op_sel_hi:[1,0]
    v_cvt_pk_bf16_f32 v72, v72, v73
    v_cvt_pk_bf16_f32 v73, v74, v75
    v_cvt_pk_bf16_f32 v74, v76, v77
    v_cvt_pk_bf16_f32 v75, v78, v79
    v_mfma_f32_16x16x32_bf16 v[40:43], a[136:139], a[40:43], v[40:43]
    v_cvt_pk_bf16_f32 v60, v48, v49
    v_cvt_pk_bf16_f32 v61, v50, v51
    v_mfma_f32_16x16x32_bf16 v[40:43], a[140:143], a[44:47], v[40:43]
    v_exp_f32 v54, v54
    v_mfma_f32_16x16x32_bf16 v[44:47], a[144:147], a[32:35], 0
    ds_write_b128 v11, v[72:75] offset:0
    v_exp_f32 v55, v55
    v_pk_mul_f32 v[80:81], v[80:81], v[22:23] op_sel_hi:[1,0]
    v_pk_mul_f32 v[82:83], v[82:83], v[22:23] op_sel_hi:[1,0]
    v_pk_mul_f32 v[84:85], v[84:85], v[22:23] op_sel_hi:[1,0]
    v_pk_mul_f32 v[86:87], v[86:87], v[22:23] op_sel_hi:[1,0]
    v_cvt_pk_bf16_f32 v80, v80, v81
    v_cvt_pk_bf16_f32 v81, v82, v83
    v_cvt_pk_bf16_f32 v82, v84, v85
    v_cvt_pk_bf16_f32 v83, v86, v87
    v_mfma_f32_16x16x32_bf16 v[44:47], a[148:151], a[36:39], v[44:47]
    v_cvt_pk_bf16_f32 v62, v52, v53
    v_cvt_pk_bf16_f32 v63, v54, v55
    v_mfma_f32_16x16x32_bf16 v[44:47], a[152:155], a[40:43], v[44:47]
    s_nop 0
    v_mfma_f32_16x16x32_bf16 v[44:47], a[156:159], a[44:47], v[44:47]
    v_mul_f32 v40, s20, v40
    v_mfma_f32_16x16x32_bf16 a[226:229], a[248:251], v[60:63], a[226:229]
    s_waitcnt vmcnt(63)
    v_exp_f32 v40, v40
    v_mfma_f32_16x16x32_bf16 v[96:99], a[164:167], v[60:63], v[96:99]
    ds_write_b128 v12, v[80:83] offset:0
    v_mul_f32 v41, s20, v41
    v_mul_f32 v42, s20, v42
    v_pk_mul_f32 v[88:89], v[88:89], v[22:23] op_sel_hi:[1,0]
    v_pk_mul_f32 v[90:91], v[90:91], v[22:23] op_sel_hi:[1,0]
    v_pk_mul_f32 v[92:93], v[92:93], v[22:23] op_sel_hi:[1,0]
    v_pk_mul_f32 v[94:95], v[94:95], v[22:23] op_sel_hi:[1,0]
    v_cvt_pk_bf16_f32 v88, v88, v89
    v_cvt_pk_bf16_f32 v89, v90, v91
    v_cvt_pk_bf16_f32 v90, v92, v93
    v_cvt_pk_bf16_f32 v91, v94, v95
    v_mfma_f32_16x16x32_bf16 v[100:103], a[172:175], v[60:63], v[100:103]
    v_mul_f32 v43, s20, v43
    v_mfma_f32_16x16x32_bf16 v[104:107], a[180:183], v[60:63], v[104:107]
    v_exp_f32 v41, v41
    v_accvgpr_read_b32 v23, a226
    v_accvgpr_read_b32 v22, a227
    v_add_f32 v23, v23, v22
    v_mfma_f32_16x16x32_bf16 v[108:111], a[188:191], v[60:63], v[108:111]
    v_exp_f32 v42, v42
    v_mfma_f32_16x16x32_bf16 v[112:115], a[196:199], v[60:63], v[112:115]
    v_mul_f32 v44, s20, v44
    v_rcp_f32 v22, v23
    v_mfma_f32_16x16x32_bf16 v[116:119], a[204:207], v[60:63], v[116:119]
    v_exp_f32 v43, v43
    v_mfma_f32_16x16x32_bf16 v[120:123], a[212:215], v[60:63], v[120:123]
    ds_write_b128 v13, v[88:91] offset:0
    v_exp_f32 v44, v44
    v_pk_mul_f32 v[96:97], v[96:97], v[22:23] op_sel_hi:[1,0]
    v_pk_mul_f32 v[98:99], v[98:99], v[22:23] op_sel_hi:[1,0]
    v_pk_mul_f32 v[100:101], v[100:101], v[22:23] op_sel_hi:[1,0]
    v_pk_mul_f32 v[102:103], v[102:103], v[22:23] op_sel_hi:[1,0]
    v_max3_u32 v21, v21, v22, v23
    v_cvt_pk_bf16_f32 v96, v96, v97
    v_cvt_pk_bf16_f32 v97, v98, v99
    v_cvt_pk_bf16_f32 v98, v100, v101
    v_cvt_pk_bf16_f32 v99, v102, v103
    v_mfma_f32_16x16x32_bf16 v[124:127], a[220:223], v[60:63], v[124:127]
    ds_read_b128 v[64:67], v24 offset:0
    ds_read_b128 v[68:71], v24 offset:1024
    v_mul_f32 v45, s20, v45
    v_mfma_f32_16x16x32_bf16 v[48:51], a[128:131], a[48:51], 0
    v_mul_f32 v46, s20, v46
    v_mul_f32 v47, s20, v47
    v_mfma_f32_16x16x32_bf16 v[48:51], a[132:135], a[52:55], v[48:51]
    ds_write_b128 v10, v[96:99] offset:4096
    v_exp_f32 v45, v45
    v_pk_mul_f32 v[104:105], v[104:105], v[22:23] op_sel_hi:[1,0]
    v_pk_mul_f32 v[106:107], v[106:107], v[22:23] op_sel_hi:[1,0]
    v_pk_mul_f32 v[108:109], v[108:109], v[22:23] op_sel_hi:[1,0]
    v_pk_mul_f32 v[110:111], v[110:111], v[22:23] op_sel_hi:[1,0]
    v_cvt_pk_bf16_f32 v104, v104, v105
    v_cvt_pk_bf16_f32 v105, v106, v107
    v_cvt_pk_bf16_f32 v106, v108, v109
    v_cvt_pk_bf16_f32 v107, v110, v111
    v_mfma_f32_16x16x32_bf16 v[48:51], a[136:139], a[56:59], v[48:51]
    ds_read_b128 v[72:75], v24 offset:2048
    v_cvt_pk_bf16_f32 v56, v40, v41
    v_cvt_pk_bf16_f32 v57, v42, v43
    v_mfma_f32_16x16x32_bf16 v[48:51], a[140:143], a[60:63], v[48:51]
    v_exp_f32 v46, v46
    v_mfma_f32_16x16x32_bf16 v[52:55], a[144:147], a[48:51], 0
    ds_write_b128 v11, v[104:107] offset:4096
    v_exp_f32 v47, v47
    v_pk_mul_f32 v[112:113], v[112:113], v[22:23] op_sel_hi:[1,0]
    v_pk_mul_f32 v[114:115], v[114:115], v[22:23] op_sel_hi:[1,0]
    v_pk_mul_f32 v[116:117], v[116:117], v[22:23] op_sel_hi:[1,0]
    v_pk_mul_f32 v[118:119], v[118:119], v[22:23] op_sel_hi:[1,0]
    v_cvt_pk_bf16_f32 v112, v112, v113
    v_cvt_pk_bf16_f32 v113, v114, v115
    v_cvt_pk_bf16_f32 v114, v116, v117
    v_cvt_pk_bf16_f32 v115, v118, v119
    v_mfma_f32_16x16x32_bf16 v[52:55], a[148:151], a[52:55], v[52:55]
    ds_read_b128 v[76:79], v24 offset:3072
    v_cvt_pk_bf16_f32 v58, v44, v45
    v_cvt_pk_bf16_f32 v59, v46, v47
    v_mfma_f32_16x16x32_bf16 v[52:55], a[152:155], a[56:59], v[52:55]
    s_add_u32 s32, s31, 0
    s_waitcnt lgkmcnt(2)
    v_mfma_f32_16x16x32_bf16 v[52:55], a[156:159], a[60:63], v[52:55]
    buffer_store_dwordx4 v[64:67], v14, s[16:19], s32 offen nt
    v_mul_f32 v48, s20, v48
    v_mfma_f32_16x16x32_bf16 a[228:231], a[248:251], v[56:59], a[228:231]
    s_waitcnt vmcnt(63)
    v_exp_f32 v48, v48
    v_mfma_f32_16x16x32_bf16 v[128:131], a[164:167], v[56:59], v[128:131]
    ds_write_b128 v12, v[112:115] offset:4096
    v_mul_f32 v49, s20, v49
    v_mul_f32 v50, s20, v50
    v_pk_mul_f32 v[120:121], v[120:121], v[22:23] op_sel_hi:[1,0]
    v_pk_mul_f32 v[122:123], v[122:123], v[22:23] op_sel_hi:[1,0]
    v_pk_mul_f32 v[124:125], v[124:125], v[22:23] op_sel_hi:[1,0]
    v_pk_mul_f32 v[126:127], v[126:127], v[22:23] op_sel_hi:[1,0]
    v_cvt_pk_bf16_f32 v120, v120, v121
    v_cvt_pk_bf16_f32 v121, v122, v123
    v_cvt_pk_bf16_f32 v122, v124, v125
    v_cvt_pk_bf16_f32 v123, v126, v127
    v_mfma_f32_16x16x32_bf16 v[132:135], a[172:175], v[56:59], v[132:135]
    v_mul_f32 v51, s20, v51
    v_mfma_f32_16x16x32_bf16 v[136:139], a[180:183], v[56:59], v[136:139]
    buffer_store_dwordx4 v[68:71], v15, s[16:19], s32 offen offset:1024 nt
    v_exp_f32 v49, v49
    v_accvgpr_read_b32 v23, a228
    v_accvgpr_read_b32 v22, a229
    v_add_f32 v23, v23, v22
    v_mfma_f32_16x16x32_bf16 v[140:143], a[188:191], v[56:59], v[140:143]
    v_exp_f32 v50, v50
    v_mfma_f32_16x16x32_bf16 v[144:147], a[196:199], v[56:59], v[144:147]
    buffer_store_dwordx4 v[72:75], v16, s[16:19], s32 offen offset:2048 nt
    v_mul_f32 v52, s20, v52
    v_rcp_f32 v22, v23
    v_mfma_f32_16x16x32_bf16 v[148:151], a[204:207], v[56:59], v[148:151]
    v_exp_f32 v51, v51
    v_mfma_f32_16x16x32_bf16 v[152:155], a[212:215], v[56:59], v[152:155]
    ds_write_b128 v13, v[120:123] offset:4096
    v_exp_f32 v52, v52
    v_pk_mul_f32 v[128:129], v[128:129], v[22:23] op_sel_hi:[1,0]
    v_pk_mul_f32 v[130:131], v[130:131], v[22:23] op_sel_hi:[1,0]
    v_pk_mul_f32 v[132:133], v[132:133], v[22:23] op_sel_hi:[1,0]
    v_pk_mul_f32 v[134:135], v[134:135], v[22:23] op_sel_hi:[1,0]
    v_max3_u32 v21, v21, v22, v23
    v_cvt_pk_bf16_f32 v128, v128, v129
    v_cvt_pk_bf16_f32 v129, v130, v131
    v_cvt_pk_bf16_f32 v130, v132, v133
    v_cvt_pk_bf16_f32 v131, v134, v135
    s_waitcnt lgkmcnt(2)
    v_mfma_f32_16x16x32_bf16 v[156:159], a[220:223], v[56:59], v[156:159]
    buffer_store_dwordx4 v[76:79], v17, s[16:19], s32 offen offset:3072 nt
    ds_read_b128 v[96:99], v24 offset:4096
    ds_read_b128 v[100:103], v24 offset:5120
    v_mul_f32 v53, s20, v53
    v_mfma_f32_16x16x32_bf16 v[40:43], a[128:131], a[64:67], 0
    v_mul_f32 v54, s20, v54
    v_mul_f32 v55, s20, v55
    v_mfma_f32_16x16x32_bf16 v[40:43], a[132:135], a[68:71], v[40:43]
    ds_write_b128 v10, v[128:131] offset:8192
    v_exp_f32 v53, v53
    v_pk_mul_f32 v[136:137], v[136:137], v[22:23] op_sel_hi:[1,0]
    v_pk_mul_f32 v[138:139], v[138:139], v[22:23] op_sel_hi:[1,0]
    v_pk_mul_f32 v[140:141], v[140:141], v[22:23] op_sel_hi:[1,0]
    v_pk_mul_f32 v[142:143], v[142:143], v[22:23] op_sel_hi:[1,0]
    v_cvt_pk_bf16_f32 v136, v136, v137
    v_cvt_pk_bf16_f32 v137, v138, v139
    v_cvt_pk_bf16_f32 v138, v140, v141
    v_cvt_pk_bf16_f32 v139, v142, v143
    v_mfma_f32_16x16x32_bf16 v[40:43], a[136:139], a[72:75], v[40:43]
    ds_read_b128 v[104:107], v24 offset:6144
    v_cvt_pk_bf16_f32 v60, v48, v49
    v_cvt_pk_bf16_f32 v61, v50, v51
    v_mfma_f32_16x16x32_bf16 v[40:43], a[140:143], a[76:79], v[40:43]
    v_exp_f32 v54, v54
    v_mfma_f32_16x16x32_bf16 v[44:47], a[144:147], a[64:67], 0
    ds_write_b128 v11, v[136:139] offset:8192
    v_exp_f32 v55, v55
    v_pk_mul_f32 v[144:145], v[144:145], v[22:23] op_sel_hi:[1,0]
    v_pk_mul_f32 v[146:147], v[146:147], v[22:23] op_sel_hi:[1,0]
    v_pk_mul_f32 v[148:149], v[148:149], v[22:23] op_sel_hi:[1,0]
    v_pk_mul_f32 v[150:151], v[150:151], v[22:23] op_sel_hi:[1,0]
    v_cvt_pk_bf16_f32 v144, v144, v145
    v_cvt_pk_bf16_f32 v145, v146, v147
    v_cvt_pk_bf16_f32 v146, v148, v149
    v_cvt_pk_bf16_f32 v147, v150, v151
    v_mfma_f32_16x16x32_bf16 v[44:47], a[148:151], a[68:71], v[44:47]
    ds_read_b128 v[108:111], v24 offset:7168
    v_cvt_pk_bf16_f32 v62, v52, v53
    v_cvt_pk_bf16_f32 v63, v54, v55
    v_mfma_f32_16x16x32_bf16 v[44:47], a[152:155], a[72:75], v[44:47]
    s_add_u32 s32, s31, 4096
    s_waitcnt lgkmcnt(2)
    v_mfma_f32_16x16x32_bf16 v[44:47], a[156:159], a[76:79], v[44:47]
    buffer_store_dwordx4 v[96:99], v14, s[16:19], s32 offen nt
    v_mul_f32 v40, s20, v40
    v_mfma_f32_16x16x32_bf16 a[230:233], a[248:251], v[60:63], a[230:233]
    s_waitcnt vmcnt(17)
    v_exp_f32 v40, v40
    v_mfma_f32_16x16x32_bf16 v[160:163], a[164:167], v[60:63], v[160:163]
    ds_write_b128 v12, v[144:147] offset:8192
    v_mul_f32 v41, s20, v41
    v_mul_f32 v42, s20, v42
    v_pk_mul_f32 v[152:153], v[152:153], v[22:23] op_sel_hi:[1,0]
    v_pk_mul_f32 v[154:155], v[154:155], v[22:23] op_sel_hi:[1,0]
    v_pk_mul_f32 v[156:157], v[156:157], v[22:23] op_sel_hi:[1,0]
    v_pk_mul_f32 v[158:159], v[158:159], v[22:23] op_sel_hi:[1,0]
    v_cvt_pk_bf16_f32 v152, v152, v153
    v_cvt_pk_bf16_f32 v153, v154, v155
    v_cvt_pk_bf16_f32 v154, v156, v157
    v_cvt_pk_bf16_f32 v155, v158, v159
    v_mfma_f32_16x16x32_bf16 v[164:167], a[172:175], v[60:63], v[164:167]
    v_mul_f32 v43, s20, v43
    v_mfma_f32_16x16x32_bf16 v[168:171], a[180:183], v[60:63], v[168:171]
    buffer_store_dwordx4 v[100:103], v15, s[16:19], s32 offen offset:1024 nt
    v_exp_f32 v41, v41
    v_accvgpr_read_b32 v23, a230
    v_accvgpr_read_b32 v22, a231
    v_add_f32 v23, v23, v22
    v_mfma_f32_16x16x32_bf16 v[172:175], a[188:191], v[60:63], v[172:175]
    v_exp_f32 v42, v42
    v_mfma_f32_16x16x32_bf16 v[176:179], a[196:199], v[60:63], v[176:179]
    buffer_store_dwordx4 v[104:107], v16, s[16:19], s32 offen offset:2048 nt
    v_mul_f32 v44, s20, v44
    v_rcp_f32 v22, v23
    v_mfma_f32_16x16x32_bf16 v[180:183], a[204:207], v[60:63], v[180:183]
    v_exp_f32 v43, v43
    v_mfma_f32_16x16x32_bf16 v[184:187], a[212:215], v[60:63], v[184:187]
    ds_write_b128 v13, v[152:155] offset:8192
    v_exp_f32 v44, v44
    v_pk_mul_f32 v[160:161], v[160:161], v[22:23] op_sel_hi:[1,0]
    v_pk_mul_f32 v[162:163], v[162:163], v[22:23] op_sel_hi:[1,0]
    v_pk_mul_f32 v[164:165], v[164:165], v[22:23] op_sel_hi:[1,0]
    v_pk_mul_f32 v[166:167], v[166:167], v[22:23] op_sel_hi:[1,0]
    v_max3_u32 v21, v21, v22, v23
    v_cvt_pk_bf16_f32 v160, v160, v161
    v_cvt_pk_bf16_f32 v161, v162, v163
    v_cvt_pk_bf16_f32 v162, v164, v165
    v_cvt_pk_bf16_f32 v163, v166, v167
    s_waitcnt lgkmcnt(2)
    v_mfma_f32_16x16x32_bf16 v[188:191], a[220:223], v[60:63], v[188:191]
    buffer_store_dwordx4 v[108:111], v17, s[16:19], s32 offen offset:3072 nt
    ds_read_b128 v[128:131], v24 offset:8192
    ds_read_b128 v[132:135], v24 offset:9216
    v_mul_f32 v45, s20, v45
    v_mfma_f32_16x16x32_bf16 v[48:51], a[128:131], a[80:83], 0
    v_mul_f32 v46, s20, v46
    v_mul_f32 v47, s20, v47
    v_mfma_f32_16x16x32_bf16 v[48:51], a[132:135], a[84:87], v[48:51]
    ds_write_b128 v10, v[160:163] offset:12288
    v_exp_f32 v45, v45
    v_pk_mul_f32 v[168:169], v[168:169], v[22:23] op_sel_hi:[1,0]
    v_pk_mul_f32 v[170:171], v[170:171], v[22:23] op_sel_hi:[1,0]
    v_pk_mul_f32 v[172:173], v[172:173], v[22:23] op_sel_hi:[1,0]
    v_pk_mul_f32 v[174:175], v[174:175], v[22:23] op_sel_hi:[1,0]
    v_cvt_pk_bf16_f32 v168, v168, v169
    v_cvt_pk_bf16_f32 v169, v170, v171
    v_cvt_pk_bf16_f32 v170, v172, v173
    v_cvt_pk_bf16_f32 v171, v174, v175
    v_mfma_f32_16x16x32_bf16 v[48:51], a[136:139], a[88:91], v[48:51]
    ds_read_b128 v[136:139], v24 offset:10240
    v_cvt_pk_bf16_f32 v56, v40, v41
    v_cvt_pk_bf16_f32 v57, v42, v43
    v_mfma_f32_16x16x32_bf16 v[48:51], a[140:143], a[92:95], v[48:51]
    v_exp_f32 v46, v46
    v_mfma_f32_16x16x32_bf16 v[52:55], a[144:147], a[80:83], 0
    ds_write_b128 v11, v[168:171] offset:12288
    v_exp_f32 v47, v47
    v_pk_mul_f32 v[176:177], v[176:177], v[22:23] op_sel_hi:[1,0]
    v_pk_mul_f32 v[178:179], v[178:179], v[22:23] op_sel_hi:[1,0]
    v_pk_mul_f32 v[180:181], v[180:181], v[22:23] op_sel_hi:[1,0]
    v_pk_mul_f32 v[182:183], v[182:183], v[22:23] op_sel_hi:[1,0]
    v_cvt_pk_bf16_f32 v176, v176, v177
    v_cvt_pk_bf16_f32 v177, v178, v179
    v_cvt_pk_bf16_f32 v178, v180, v181
    v_cvt_pk_bf16_f32 v179, v182, v183
    v_mfma_f32_16x16x32_bf16 v[52:55], a[148:151], a[84:87], v[52:55]
    ds_read_b128 v[140:143], v24 offset:11264
    v_cvt_pk_bf16_f32 v58, v44, v45
    v_cvt_pk_bf16_f32 v59, v46, v47
    v_mfma_f32_16x16x32_bf16 v[52:55], a[152:155], a[88:91], v[52:55]
    s_add_u32 s32, s31, 8192
    s_waitcnt lgkmcnt(2)
    v_mfma_f32_16x16x32_bf16 v[52:55], a[156:159], a[92:95], v[52:55]
    buffer_store_dwordx4 v[128:131], v14, s[16:19], s32 offen nt
    v_mul_f32 v48, s20, v48
    v_mfma_f32_16x16x32_bf16 a[232:235], a[248:251], v[56:59], a[232:235]
    s_waitcnt vmcnt(9)
    v_exp_f32 v48, v48
    v_mfma_f32_16x16x32_bf16 v[192:195], a[164:167], v[56:59], v[192:195]
    ds_write_b128 v12, v[176:179] offset:12288
    v_mul_f32 v49, s20, v49
    v_mul_f32 v50, s20, v50
    v_pk_mul_f32 v[184:185], v[184:185], v[22:23] op_sel_hi:[1,0]
    v_pk_mul_f32 v[186:187], v[186:187], v[22:23] op_sel_hi:[1,0]
    v_pk_mul_f32 v[188:189], v[188:189], v[22:23] op_sel_hi:[1,0]
    v_pk_mul_f32 v[190:191], v[190:191], v[22:23] op_sel_hi:[1,0]
    v_cvt_pk_bf16_f32 v184, v184, v185
    v_cvt_pk_bf16_f32 v185, v186, v187
    v_cvt_pk_bf16_f32 v186, v188, v189
    v_cvt_pk_bf16_f32 v187, v190, v191
    v_mfma_f32_16x16x32_bf16 v[196:199], a[172:175], v[56:59], v[196:199]
    v_mul_f32 v51, s20, v51
    v_mfma_f32_16x16x32_bf16 v[200:203], a[180:183], v[56:59], v[200:203]
    buffer_store_dwordx4 v[132:135], v15, s[16:19], s32 offen offset:1024 nt
    v_exp_f32 v49, v49
    v_accvgpr_read_b32 v23, a232
    v_accvgpr_read_b32 v22, a233
    v_add_f32 v23, v23, v22
    v_mfma_f32_16x16x32_bf16 v[204:207], a[188:191], v[56:59], v[204:207]
    v_exp_f32 v50, v50
    v_mfma_f32_16x16x32_bf16 v[208:211], a[196:199], v[56:59], v[208:211]
    buffer_store_dwordx4 v[136:139], v16, s[16:19], s32 offen offset:2048 nt
    v_mul_f32 v52, s20, v52
    v_rcp_f32 v22, v23
    v_mfma_f32_16x16x32_bf16 v[212:215], a[204:207], v[56:59], v[212:215]
    v_exp_f32 v51, v51
    v_mfma_f32_16x16x32_bf16 v[216:219], a[212:215], v[56:59], v[216:219]
    ds_write_b128 v13, v[184:187] offset:12288
    v_exp_f32 v52, v52
    v_pk_mul_f32 v[192:193], v[192:193], v[22:23] op_sel_hi:[1,0]
    v_pk_mul_f32 v[194:195], v[194:195], v[22:23] op_sel_hi:[1,0]
    v_pk_mul_f32 v[196:197], v[196:197], v[22:23] op_sel_hi:[1,0]
    v_pk_mul_f32 v[198:199], v[198:199], v[22:23] op_sel_hi:[1,0]
    v_max3_u32 v21, v21, v22, v23
    v_cvt_pk_bf16_f32 v192, v192, v193
    v_cvt_pk_bf16_f32 v193, v194, v195
    v_cvt_pk_bf16_f32 v194, v196, v197
    v_cvt_pk_bf16_f32 v195, v198, v199
    s_waitcnt lgkmcnt(2)
    v_mfma_f32_16x16x32_bf16 v[220:223], a[220:223], v[56:59], v[220:223]
    buffer_store_dwordx4 v[140:143], v17, s[16:19], s32 offen offset:3072 nt
    ds_read_b128 v[160:163], v24 offset:12288
    ds_read_b128 v[164:167], v24 offset:13312
    v_mul_f32 v53, s20, v53
    ds_read_b128 v[168:171], v24 offset:14336
    ds_read_b128 v[172:175], v24 offset:15360
    v_mul_f32 v54, s20, v54
    v_mul_f32 v55, s20, v55
    v_exp_f32 v53, v53
    v_cvt_pk_bf16_f32 v60, v48, v49
    v_cvt_pk_bf16_f32 v61, v50, v51
    v_exp_f32 v54, v54
    v_exp_f32 v55, v55
    ds_write_b128 v10, v[192:195] offset:16384
    v_pk_mul_f32 v[200:201], v[200:201], v[22:23] op_sel_hi:[1,0]
    v_pk_mul_f32 v[202:203], v[202:203], v[22:23] op_sel_hi:[1,0]
    v_pk_mul_f32 v[204:205], v[204:205], v[22:23] op_sel_hi:[1,0]
    v_pk_mul_f32 v[206:207], v[206:207], v[22:23] op_sel_hi:[1,0]
    v_cvt_pk_bf16_f32 v62, v52, v53
    v_cvt_pk_bf16_f32 v63, v54, v55
    v_pk_mul_f32 v[208:209], v[208:209], v[22:23] op_sel_hi:[1,0]
    v_pk_mul_f32 v[210:211], v[210:211], v[22:23] op_sel_hi:[1,0]
    v_pk_mul_f32 v[212:213], v[212:213], v[22:23] op_sel_hi:[1,0]
    v_pk_mul_f32 v[214:215], v[214:215], v[22:23] op_sel_hi:[1,0]
    s_add_u32 s32, s31, 12288
    v_pk_mul_f32 v[216:217], v[216:217], v[22:23] op_sel_hi:[1,0]
    v_pk_mul_f32 v[218:219], v[218:219], v[22:23] op_sel_hi:[1,0]
    v_pk_mul_f32 v[220:221], v[220:221], v[22:23] op_sel_hi:[1,0]
    v_pk_mul_f32 v[222:223], v[222:223], v[22:23] op_sel_hi:[1,0]
    s_waitcnt lgkmcnt(1)
    v_mfma_f32_16x16x32_bf16 a[234:237], a[248:251], v[60:63], a[234:237]
    buffer_store_dwordx4 v[160:163], v14, s[16:19], s32 offen nt
    v_cvt_pk_bf16_f32 v200, v200, v201
    v_cvt_pk_bf16_f32 v201, v202, v203
    v_mfma_f32_16x16x32_bf16 v[224:227], a[164:167], v[60:63], v[224:227]
    v_cvt_pk_bf16_f32 v202, v204, v205
    v_cvt_pk_bf16_f32 v203, v206, v207
    v_mfma_f32_16x16x32_bf16 v[228:231], a[172:175], v[60:63], v[228:231]
    ds_write_b128 v11, v[200:203] offset:16384
    v_cvt_pk_bf16_f32 v208, v208, v209
    v_cvt_pk_bf16_f32 v209, v210, v211
    v_mfma_f32_16x16x32_bf16 v[232:235], a[180:183], v[60:63], v[232:235]
    buffer_store_dwordx4 v[164:167], v15, s[16:19], s32 offen offset:1024 nt
    v_cvt_pk_bf16_f32 v210, v212, v213
    v_cvt_pk_bf16_f32 v211, v214, v215
    v_mfma_f32_16x16x32_bf16 v[236:239], a[188:191], v[60:63], v[236:239]
    ds_write_b128 v12, v[208:211] offset:16384
    v_cvt_pk_bf16_f32 v216, v216, v217
    v_cvt_pk_bf16_f32 v217, v218, v219
    v_mfma_f32_16x16x32_bf16 v[240:243], a[196:199], v[60:63], v[240:243]
    buffer_store_dwordx4 v[168:171], v16, s[16:19], s32 offen offset:2048 nt
    v_cvt_pk_bf16_f32 v218, v220, v221
    v_cvt_pk_bf16_f32 v219, v222, v223
    v_mfma_f32_16x16x32_bf16 v[244:247], a[204:207], v[60:63], v[244:247]
    ds_write_b128 v13, v[216:219] offset:16384
    v_accvgpr_read_b32 v23, a234
    v_accvgpr_read_b32 v22, a235
    v_add_f32 v23, v23, v22
    v_mfma_f32_16x16x32_bf16 v[248:251], a[212:215], v[60:63], v[248:251]
    v_rcp_f32 v22, v23
    v_mfma_f32_16x16x32_bf16 v[252:255], a[220:223], v[60:63], v[252:255]
    buffer_store_dwordx4 v[172:175], v17, s[16:19], s32 offen offset:3072 nt
    v_pk_mul_f32 v[224:225], v[224:225], v[22:23] op_sel_hi:[1,0]
    v_pk_mul_f32 v[226:227], v[226:227], v[22:23] op_sel_hi:[1,0]
    v_pk_mul_f32 v[228:229], v[228:229], v[22:23] op_sel_hi:[1,0]
    v_pk_mul_f32 v[230:231], v[230:231], v[22:23] op_sel_hi:[1,0]
    v_max3_u32 v21, v21, v22, v23
    v_cvt_pk_bf16_f32 v224, v224, v225
    v_cvt_pk_bf16_f32 v225, v226, v227
    v_cvt_pk_bf16_f32 v226, v228, v229
    v_cvt_pk_bf16_f32 v227, v230, v231
    ds_read_b128 v[192:195], v24 offset:16384
    ds_read_b128 v[196:199], v24 offset:17408
    ds_read_b128 v[200:203], v24 offset:18432
    ds_read_b128 v[204:207], v24 offset:19456
    v_pk_mul_f32 v[232:233], v[232:233], v[22:23] op_sel_hi:[1,0]
    v_pk_mul_f32 v[234:235], v[234:235], v[22:23] op_sel_hi:[1,0]
    v_pk_mul_f32 v[236:237], v[236:237], v[22:23] op_sel_hi:[1,0]
    v_pk_mul_f32 v[238:239], v[238:239], v[22:23] op_sel_hi:[1,0]
    v_cvt_pk_bf16_f32 v232, v232, v233
    v_cvt_pk_bf16_f32 v233, v234, v235
    v_cvt_pk_bf16_f32 v234, v236, v237
    v_cvt_pk_bf16_f32 v235, v238, v239
    ds_write_b128 v10, v[224:227] offset:20480
    s_add_u32 s32, s31, 16384
    v_pk_mul_f32 v[240:241], v[240:241], v[22:23] op_sel_hi:[1,0]
    v_pk_mul_f32 v[242:243], v[242:243], v[22:23] op_sel_hi:[1,0]
    v_pk_mul_f32 v[244:245], v[244:245], v[22:23] op_sel_hi:[1,0]
    v_pk_mul_f32 v[246:247], v[246:247], v[22:23] op_sel_hi:[1,0]
    v_cvt_pk_bf16_f32 v240, v240, v241
    v_cvt_pk_bf16_f32 v241, v242, v243
    v_cvt_pk_bf16_f32 v242, v244, v245
    v_cvt_pk_bf16_f32 v243, v246, v247
    ds_write_b128 v11, v[232:235] offset:20480
    v_pk_mul_f32 v[248:249], v[248:249], v[22:23] op_sel_hi:[1,0]
    v_pk_mul_f32 v[250:251], v[250:251], v[22:23] op_sel_hi:[1,0]
    v_pk_mul_f32 v[252:253], v[252:253], v[22:23] op_sel_hi:[1,0]
    v_pk_mul_f32 v[254:255], v[254:255], v[22:23] op_sel_hi:[1,0]
    v_cvt_pk_bf16_f32 v248, v248, v249
    v_cvt_pk_bf16_f32 v249, v250, v251
    v_cvt_pk_bf16_f32 v250, v252, v253
    v_cvt_pk_bf16_f32 v251, v254, v255
    ds_write_b128 v12, v[240:243] offset:20480
    s_waitcnt lgkmcnt(3)
    buffer_store_dwordx4 v[192:195], v14, s[16:19], s32 offen nt
    ds_write_b128 v13, v[248:251] offset:20480
    buffer_store_dwordx4 v[196:199], v15, s[16:19], s32 offen offset:1024 nt
    buffer_store_dwordx4 v[200:203], v16, s[16:19], s32 offen offset:2048 nt
    ds_read_b128 v[224:227], v24 offset:20480
    ds_read_b128 v[228:231], v24 offset:21504
    ds_read_b128 v[232:235], v24 offset:22528
    ds_read_b128 v[236:239], v24 offset:23552
    buffer_store_dwordx4 v[204:207], v17, s[16:19], s32 offen offset:3072 nt
    s_add_u32 s32, s31, 20480
    v_cmp_lt_u32 vcc, s21, v21
    s_or_b32 s41, vcc_lo, vcc_hi
    s_min_u32 s41, s41, 1
    s_lshl_b32 s41, s41, s33
    s_or_b32 s34, s34, s41
    s_waitcnt lgkmcnt(3)
    buffer_store_dwordx4 v[224:227], v14, s[16:19], s32 offen nt
    s_waitcnt lgkmcnt(2)
    buffer_store_dwordx4 v[228:231], v15, s[16:19], s32 offen offset:1024 nt
    s_waitcnt lgkmcnt(1)
    buffer_store_dwordx4 v[232:235], v16, s[16:19], s32 offen offset:2048 nt
    s_waitcnt lgkmcnt(0)
    buffer_store_dwordx4 v[236:239], v17, s[16:19], s32 offen offset:3072 nt
    s_branch L_tail
L_finB:
    v_mfma_f32_16x16x32_bf16 v[48:51], a[128:131], a[0:3], 0
    v_mul_f32 v46, s20, v46
    v_mul_f32 v47, s20, v47
    v_mfma_f32_16x16x32_bf16 v[48:51], a[132:135], a[4:7], v[48:51]
    v_exp_f32 v45, v45
    v_mfma_f32_16x16x32_bf16 v[48:51], a[136:139], a[8:11], v[48:51]
    v_cvt_pk_bf16_f32 v56, v40, v41
    v_cvt_pk_bf16_f32 v57, v42, v43
    v_mfma_f32_16x16x32_bf16 v[48:51], a[140:143], a[12:15], v[48:51]
    v_exp_f32 v46, v46
    v_mfma_f32_16x16x32_bf16 v[52:55], a[144:147], a[0:3], 0
    v_exp_f32 v47, v47
    v_mfma_f32_16x16x32_bf16 v[52:55], a[148:151], a[4:7], v[52:55]
    s_waitcnt vmcnt(63) lgkmcnt(0)
    v_cvt_pk_bf16_f32 v58, v44, v45
    v_cvt_pk_bf16_f32 v59, v46, v47
    v_mfma_f32_16x16x32_bf16 v[52:55], a[152:155], a[8:11], v[52:55]
    s_nop 0
    v_mfma_f32_16x16x32_bf16 v[52:55], a[156:159], a[12:15], v[52:55]
    v_mul_f32 v48, s20, v48
    v_smfmac_f32_16x16x64_bf16 a[232:235], a[242:245], v[56:63], v26
    v_exp_f32 v48, v48
    v_mfma_f32_16x16x32_bf16 v[224:227], a[162:165], v[56:59], v[224:227]
    v_mul_f32 v49, s20, v49
    v_mul_f32 v50, s20, v50
    v_mfma_f32_16x16x32_bf16 v[228:231], a[170:173], v[56:59], v[228:231]
    v_mul_f32 v51, s20, v51
    v_mfma_f32_16x16x32_bf16 v[232:235], a[178:181], v[56:59], v[232:235]
    v_exp_f32 v49, v49
    v_mfma_f32_16x16x32_bf16 v[236:239], a[186:189], v[56:59], v[236:239]
    v_exp_f32 v50, v50
    v_mfma_f32_16x16x32_bf16 v[240:243], a[194:197], v[56:59], v[240:243]
    v_mul_f32 v52, s20, v52
    v_mfma_f32_16x16x32_bf16 v[244:247], a[202:205], v[56:59], v[244:247]
    v_exp_f32 v51, v51
    v_mfma_f32_16x16x32_bf16 v[248:251], a[210:213], v[56:59], v[248:251]
    v_exp_f32 v52, v52
    v_mfma_f32_16x16x32_bf16 v[252:255], a[218:221], v[56:59], v[252:255]
    v_mul_f32 v53, s20, v53
    v_mfma_f32_16x16x32_bf16 v[40:43], a[128:131], a[16:19], 0
    v_mul_f32 v54, s20, v54
    v_mul_f32 v55, s20, v55
    v_mfma_f32_16x16x32_bf16 v[40:43], a[132:135], a[20:23], v[40:43]
    v_exp_f32 v53, v53
    v_accvgpr_read_b32 v23, a234
    v_accvgpr_read_b32 v22, a235
    v_add_f32 v23, v23, v22
    v_mfma_f32_16x16x32_bf16 v[40:43], a[136:139], a[24:27], v[40:43]
    v_cvt_pk_bf16_f32 v60, v48, v49
    v_cvt_pk_bf16_f32 v61, v50, v51
    v_mfma_f32_16x16x32_bf16 v[40:43], a[140:143], a[28:31], v[40:43]
    v_exp_f32 v54, v54
    v_mov_b32_sdwa v240, v23 dst_sel:BYTE_0 dst_unused:UNUSED_PRESERVE src0_sel:BYTE_1
    v_mfma_f32_16x16x32_bf16 v[44:47], a[144:147], a[16:19], 0
    v_exp_f32 v55, v55
    v_mov_b32_sdwa v241, v23 dst_sel:BYTE_0 dst_unused:UNUSED_PRESERVE src0_sel:BYTE_2
    v_mfma_f32_16x16x32_bf16 v[44:47], a[148:151], a[20:23], v[44:47]
    v_cvt_pk_bf16_f32 v62, v52, v53
    v_cvt_pk_bf16_f32 v63, v54, v55
    v_mov_b32_sdwa v242, v23 dst_sel:BYTE_0 dst_unused:UNUSED_PRESERVE src0_sel:BYTE_3
    v_mfma_f32_16x16x32_bf16 v[44:47], a[152:155], a[24:27], v[44:47]
    s_nop 0
    v_mfma_f32_16x16x32_bf16 v[44:47], a[156:159], a[28:31], v[44:47]
    s_waitcnt vmcnt(0)
    v_mul_f32 v40, s20, v40
    v_mfma_f32_16x16x32_bf16 a[224:227], a[248:251], v[60:63], a[224:227]
    s_waitcnt vmcnt(63)
    ds_write_b128 v24, v[240:243] offset:20480
    v_exp_f32 v40, v40
    v_mfma_f32_16x16x32_bf16 v[64:67], a[164:167], v[60:63], v[64:67]
    ds_write_b128 v24, v[244:247] offset:21504
    v_mul_f32 v41, s20, v41
    v_mul_f32 v42, s20, v42
    v_mfma_f32_16x16x32_bf16 v[68:71], a[172:175], v[60:63], v[68:71]
    v_mul_f32 v43, s20, v43
    v_mfma_f32_16x16x32_bf16 v[72:75], a[180:183], v[60:63], v[72:75]
    ds_write_b128 v24, v[248:251] offset:22528
    v_exp_f32 v41, v41
    v_accvgpr_read_b32 v23, a224
    v_accvgpr_read_b32 v22, a225
    v_add_f32 v23, v23, v22
    v_mfma_f32_16x16x32_bf16 v[76:79], a[188:191], v[60:63], v[76:79]
    ds_write_b128 v24, v[252:255] offset:23552
    v_exp_f32 v42, v42
    v_mfma_f32_16x16x32_bf16 v[80:83], a[196:199], v[60:63], v[80:83]
    v_mul_f32 v44, s20, v44
    v_rcp_f32 v22, v23
    v_mfma_f32_16x16x32_bf16 v[84:87], a[204:207], v[60:63], v[84:87]
    v_exp_f32 v43, v43
    v_mfma_f32_16x16x32_bf16 v[88:91], a[212:215], v[60:63], v[88:91]
    v_exp_f32 v44, v44
    v_pk_mul_f32 v[64:65], v[64:65], v[22:23] op_sel_hi:[1,0]
    v_pk_mul_f32 v[66:67], v[66:67], v[22:23] op_sel_hi:[1,0]
    v_pk_mul_f32 v[68:69], v[68:69], v[22:23] op_sel_hi:[1,0]
    v_pk_mul_f32 v[70:71], v[70:71], v[22:23] op_sel_hi:[1,0]
    v_max3_u32 v21, v21, v22, v23
    v_cvt_pk_bf16_f32 v64, v64, v65
    v_cvt_pk_bf16_f32 v65, v66, v67
    v_cvt_pk_bf16_f32 v66, v68, v69
    v_cvt_pk_bf16_f32 v67, v70, v71
    v_mfma_f32_16x16x32_bf16 v[92:95], a[220:223], v[60:63], v[92:95]
    v_mul_f32 v45, s20, v45
    v_mfma_f32_16x16x32_bf16 v[48:51], a[128:131], a[32:35], 0
    v_mul_f32 v46, s20, v46
    v_mul_f32 v47, s20, v47
    v_mfma_f32_16x16x32_bf16 v[48:51], a[132:135], a[36:39], v[48:51]
    ds_write_b128 v10, v[64:67] offset:0
    v_exp_f32 v45, v45
    v_pk_mul_f32 v[72:73], v[72:73], v[22:23] op_sel_hi:[1,0]
    v_pk_mul_f32 v[74:75], v[74:75], v[22:23] op_sel_hi:[1,0]
    v_pk_mul_f32 v[76:77], v[76:77], v[22:23] op_sel_hi:[1,0]
    v_pk_mul_f32 v[78:79], v[78:79], v[22:23] op_sel_hi:[1,0]
    v_cvt_pk_bf16_f32 v72, v72, v73
    v_cvt_pk_bf16_f32 v73, v74, v75
    v_cvt_pk_bf16_f32 v74, v76, v77
    v_cvt_pk_bf16_f32 v75, v78, v79
    v_mfma_f32_16x16x32_bf16 v[48:51], a[136:139], a[40:43], v[48:51]
    s_waitcnt lgkmcnt(1)
    v_cvt_pk_bf16_f32 v56, v40, v41
    v_cvt_pk_bf16_f32 v57, v42, v43
    v_mfma_f32_16x16x32_bf16 v[48:51], a[140:143], a[44:47], v[48:51]
    s_barrier
    v_exp_f32 v46, v46
    v_add_u32 v255, s50, v24
    v_mfma_f32_16x16x32_bf16 v[52:55], a[144:147], a[32:35], 0
    ds_write_b128 v11, v[72:75] offset:0
    v_exp_f32 v47, v47
    v_pk_mul_f32 v[80:81], v[80:81], v[22:23] op_sel_hi:[1,0]
    v_pk_mul_f32 v[82:83], v[82:83], v[22:23] op_sel_hi:[1,0]
    v_pk_mul_f32 v[84:85], v[84:85], v[22:23] op_sel_hi:[1,0]
    v_pk_mul_f32 v[86:87], v[86:87], v[22:23] op_sel_hi:[1,0]
    v_cvt_pk_bf16_f32 v80, v80, v81
    v_cvt_pk_bf16_f32 v81, v82, v83
    v_cvt_pk_bf16_f32 v82, v84, v85
    v_cvt_pk_bf16_f32 v83, v86, v87
    v_mfma_f32_16x16x32_bf16 v[52:55], a[148:151], a[36:39], v[52:55]
    ds_read_b128 v[240:243], v255 offset:20480
    v_cvt_pk_bf16_f32 v58, v44, v45
    v_cvt_pk_bf16_f32 v59, v46, v47
    v_mfma_f32_16x16x32_bf16 v[52:55], a[152:155], a[40:43], v[52:55]
    ds_read_b128 v[244:247], v255 offset:21504
    v_mfma_f32_16x16x32_bf16 v[52:55], a[156:159], a[44:47], v[52:55]
    v_mul_f32 v48, s20, v48
    v_mfma_f32_16x16x32_bf16 a[226:229], a[248:251], v[56:59], a[226:229]
    s_waitcnt vmcnt(63)
    ds_read_b128 v[248:251], v255 offset:22528
    v_exp_f32 v48, v48
    v_mfma_f32_16x16x32_bf16 v[96:99], a[164:167], v[56:59], v[96:99]
    ds_write_b128 v12, v[80:83] offset:0
    ds_read_b128 v[252:255], v255 offset:23552
    v_mul_f32 v49, s20, v49
    v_mul_f32 v50, s20, v50
    v_pk_mul_f32 v[88:89], v[88:89], v[22:23] op_sel_hi:[1,0]
    v_pk_mul_f32 v[90:91], v[90:91], v[22:23] op_sel_hi:[1,0]
    v_pk_mul_f32 v[92:93], v[92:93], v[22:23] op_sel_hi:[1,0]
    v_pk_mul_f32 v[94:95], v[94:95], v[22:23] op_sel_hi:[1,0]
    v_cvt_pk_bf16_f32 v88, v88, v89
    v_cvt_pk_bf16_f32 v89, v90, v91
    v_cvt_pk_bf16_f32 v90, v92, v93
    v_cvt_pk_bf16_f32 v91, v94, v95
    v_mfma_f32_16x16x32_bf16 v[100:103], a[172:175], v[56:59], v[100:103]
    v_mul_f32 v51, s20, v51
    v_mfma_f32_16x16x32_bf16 v[104:107], a[180:183], v[56:59], v[104:107]
    v_exp_f32 v49, v49
    v_accvgpr_read_b32 v23, a226
    v_accvgpr_read_b32 v22, a227
    v_add_f32 v23, v23, v22
    v_mfma_f32_16x16x32_bf16 v[108:111], a[188:191], v[56:59], v[108:111]
    v_exp_f32 v50, v50
    v_mfma_f32_16x16x32_bf16 v[112:115], a[196:199], v[56:59], v[112:115]
    v_mul_f32 v52, s20, v52
    v_rcp_f32 v22, v23
    v_mfma_f32_16x16x32_bf16 v[116:119], a[204:207], v[56:59], v[116:119]
    v_exp_f32 v51, v51
    v_mfma_f32_16x16x32_bf16 v[120:123], a[212:215], v[56:59], v[120:123]
    ds_write_b128 v13, v[88:91] offset:0
    v_exp_f32 v52, v52
    v_pk_mul_f32 v[96:97], v[96:97], v[22:23] op_sel_hi:[1,0]
    v_pk_mul_f32 v[98:99], v[98:99], v[22:23] op_sel_hi:[1,0]
    v_pk_mul_f32 v[100:101], v[100:101], v[22:23] op_sel_hi:[1,0]
    v_pk_mul_f32 v[102:103], v[102:103], v[22:23] op_sel_hi:[1,0]
    v_max3_u32 v21, v21, v22, v23
    v_cvt_pk_bf16_f32 v96, v96, v97
    v_cvt_pk_bf16_f32 v97, v98, v99
    v_cvt_pk_bf16_f32 v98, v100, v101
    v_cvt_pk_bf16_f32 v99, v102, v103
    v_mfma_f32_16x16x32_bf16 v[124:127], a[220:223], v[56:59], v[124:127]
    s_waitcnt lgkmcnt(1)
    ds_read_b128 v[64:67], v24 offset:0
    ds_read_b128 v[68:71], v24 offset:1024
    v_mul_f32 v53, s20, v53
    v_pk_add_f32 v[228:229], v[228:229], v[244:245]
    v_pk_add_f32 v[230:231], v[230:231], v[246:247]
    v_mfma_f32_16x16x32_bf16 v[40:43], a[128:131], a[48:51], 0
    v_mul_f32 v54, s20, v54
    v_mul_f32 v55, s20, v55
    v_mov_b32_sdwa v245, v240 dst_sel:BYTE_1 dst_unused:UNUSED_PAD src0_sel:BYTE_0
    v_pk_add_f32 v[224:225], v[224:225], v[240:241]
    v_mfma_f32_16x16x32_bf16 v[40:43], a[132:135], a[52:55], v[40:43]
    ds_write_b128 v10, v[96:99] offset:4096
    v_exp_f32 v53, v53
    v_pk_mul_f32 v[104:105], v[104:105], v[22:23] op_sel_hi:[1,0]
    v_pk_mul_f32 v[106:107], v[106:107], v[22:23] op_sel_hi:[1,0]
    v_pk_mul_f32 v[108:109], v[108:109], v[22:23] op_sel_hi:[1,0]
    v_pk_mul_f32 v[110:111], v[110:111], v[22:23] op_sel_hi:[1,0]
    v_cvt_pk_bf16_f32 v104, v104, v105
    v_cvt_pk_bf16_f32 v105, v106, v107
    v_cvt_pk_bf16_f32 v106, v108, v109
    v_cvt_pk_bf16_f32 v107, v110, v111
    v_mov_b32_sdwa v245, v241 dst_sel:BYTE_2 dst_unused:UNUSED_PRESERVE src0_sel:BYTE_0
    v_pk_add_f32 v[226:227], v[226:227], v[242:243]
    v_mfma_f32_16x16x32_bf16 v[40:43], a[136:139], a[56:59], v[40:43]
    ds_read_b128 v[72:75], v24 offset:2048
    v_cvt_pk_bf16_f32 v60, v48, v49
    v_cvt_pk_bf16_f32 v61, v50, v51
    v_mov_b32_sdwa v245, v242 dst_sel:BYTE_3 dst_unused:UNUSED_PRESERVE src0_sel:BYTE_0
    v_accvgpr_read_b32 v244, a234
    v_accvgpr_read_b32 v246, a235
    v_add_f32 v244, v244, v246
    v_mfma_f32_16x16x32_bf16 v[40:43], a[140:143], a[60:63], v[40:43]
    v_exp_f32 v54, v54
    v_pk_add_f32 v[232:233], v[232:233], v[248:249]
    v_add_f32 v245, v244, v245
    v_mfma_f32_16x16x32_bf16 v[44:47], a[144:147], a[48:51], 0
    ds_write_b128 v11, v[104:107] offset:4096
    v_exp_f32 v55, v55
    v_pk_mul_f32 v[112:113], v[112:113], v[22:23] op_sel_hi:[1,0]
    v_pk_mul_f32 v[114:115], v[114:115], v[22:23] op_sel_hi:[1,0]
    v_pk_mul_f32 v[116:117], v[116:117], v[22:23] op_sel_hi:[1,0]
    v_pk_mul_f32 v[118:119], v[118:119], v[22:23] op_sel_hi:[1,0]
    v_cvt_pk_bf16_f32 v112, v112, v113
    v_cvt_pk_bf16_f32 v113, v114, v115
    v_cvt_pk_bf16_f32 v114, v116, v117
    v_cvt_pk_bf16_f32 v115, v118, v119
    v_pk_add_f32 v[234:235], v[234:235], v[250:251]
    v_rcp_f32 v244, v245
    v_mfma_f32_16x16x32_bf16 v[44:47], a[148:151], a[52:55], v[44:47]
    ds_read_b128 v[76:79], v24 offset:3072
    v_cvt_pk_bf16_f32 v62, v52, v53
    v_cvt_pk_bf16_f32 v63, v54, v55
    v_pk_add_f32 v[236:237], v[236:237], v[252:253]
    v_pk_add_f32 v[238:239], v[238:239], v[254:255]
    v_mfma_f32_16x16x32_bf16 v[44:47], a[152:155], a[56:59], v[44:47]
    s_add_u32 s32, s31, 0
    v_max3_u32 v21, v21, v244, v245
    v_pk_mul_f32 v[224:225], v[224:225], v[244:245] op_sel_hi:[1,0]
    s_waitcnt lgkmcnt(2)
    v_mfma_f32_16x16x32_bf16 v[44:47], a[156:159], a[60:63], v[44:47]
    buffer_store_dwordx4 v[64:67], v14, s[16:19], s32 offen nt
    v_mul_f32 v40, s20, v40
    v_pk_mul_f32 v[226:227], v[226:227], v[244:245] op_sel_hi:[1,0]
    v_pk_mul_f32 v[228:229], v[228:229], v[244:245] op_sel_hi:[1,0]
    v_mfma_f32_16x16x32_bf16 a[228:231], a[248:251], v[60:63], a[228:231]
    s_waitcnt vmcnt(63)
    v_exp_f32 v40, v40
    v_pk_mul_f32 v[230:231], v[230:231], v[244:245] op_sel_hi:[1,0]
    v_cvt_pk_bf16_f32 v224, v224, v225
    v_mfma_f32_16x16x32_bf16 v[128:131], a[164:167], v[60:63], v[128:131]
    ds_write_b128 v12, v[112:115] offset:4096
    v_mul_f32 v41, s20, v41
    v_mul_f32 v42, s20, v42
    v_pk_mul_f32 v[120:121], v[120:121], v[22:23] op_sel_hi:[1,0]
    v_pk_mul_f32 v[122:123], v[122:123], v[22:23] op_sel_hi:[1,0]
    v_pk_mul_f32 v[124:125], v[124:125], v[22:23] op_sel_hi:[1,0]
    v_pk_mul_f32 v[126:127], v[126:127], v[22:23] op_sel_hi:[1,0]
    v_cvt_pk_bf16_f32 v120, v120, v121
    v_cvt_pk_bf16_f32 v121, v122, v123
    v_cvt_pk_bf16_f32 v122, v124, v125
    v_cvt_pk_bf16_f32 v123, v126, v127
    v_cvt_pk_bf16_f32 v225, v226, v227
    v_cvt_pk_bf16_f32 v226, v228, v229
    v_mfma_f32_16x16x32_bf16 v[132:135], a[172:175], v[60:63], v[132:135]
    s_add_u32 s44, s31, s49
    v_mul_f32 v43, s20, v43
    v_cvt_pk_bf16_f32 v227, v230, v231
    v_pk_mul_f32 v[232:233], v[232:233], v[244:245] op_sel_hi:[1,0]
    v_mfma_f32_16x16x32_bf16 v[136:139], a[180:183], v[60:63], v[136:139]
    buffer_store_dwordx4 v[68:71], v15, s[16:19], s32 offen offset:1024 nt
    v_exp_f32 v41, v41
    v_accvgpr_read_b32 v23, a228
    v_accvgpr_read_b32 v22, a229
    v_add_f32 v23, v23, v22
    v_pk_mul_f32 v[234:235], v[234:235], v[244:245] op_sel_hi:[1,0]
    v_pk_mul_f32 v[236:237], v[236:237], v[244:245] op_sel_hi:[1,0]
    v_mfma_f32_16x16x32_bf16 v[140:143], a[188:191], v[60:63], v[140:143]
    buffer_store_dwordx4 v[224:227], v20, s[16:19], s44 offen nt
    v_exp_f32 v42, v42
    v_pk_mul_f32 v[238:239], v[238:239], v[244:245] op_sel_hi:[1,0]
    v_cvt_pk_bf16_f32 v232, v232, v233
    v_mfma_f32_16x16x32_bf16 v[144:147], a[196:199], v[60:63], v[144:147]
    buffer_store_dwordx4 v[72:75], v16, s[16:19], s32 offen offset:2048 nt
    v_mul_f32 v44, s20, v44
    v_rcp_f32 v22, v23
    v_cvt_pk_bf16_f32 v233, v234, v235
    v_cvt_pk_bf16_f32 v234, v236, v237
    v_mfma_f32_16x16x32_bf16 v[148:151], a[204:207], v[60:63], v[148:151]
    v_exp_f32 v43, v43
    v_cvt_pk_bf16_f32 v235, v238, v239
    v_mfma_f32_16x16x32_bf16 v[152:155], a[212:215], v[60:63], v[152:155]
    ds_write_b128 v13, v[120:123] offset:4096
    v_exp_f32 v44, v44
    v_pk_mul_f32 v[128:129], v[128:129], v[22:23] op_sel_hi:[1,0]
    v_pk_mul_f32 v[130:131], v[130:131], v[22:23] op_sel_hi:[1,0]
    v_pk_mul_f32 v[132:133], v[132:133], v[22:23] op_sel_hi:[1,0]
    v_pk_mul_f32 v[134:135], v[134:135], v[22:23] op_sel_hi:[1,0]
    v_max3_u32 v21, v21, v22, v23
    v_cvt_pk_bf16_f32 v128, v128, v129
    v_cvt_pk_bf16_f32 v129, v130, v131
    v_cvt_pk_bf16_f32 v130, v132, v133
    v_cvt_pk_bf16_f32 v131, v134, v135
    v_mfma_f32_16x16x32_bf16 v[156:159], a[220:223], v[60:63], v[156:159]
    buffer_store_dwordx4 v[232:235], v20, s[16:19], s44 offen offset:64 nt
    s_waitcnt lgkmcnt(2)
    buffer_store_dwordx4 v[76:79], v17, s[16:19], s32 offen offset:3072 nt
    ds_read_b128 v[96:99], v24 offset:4096
    ds_read_b128 v[100:103], v24 offset:5120
    v_mul_f32 v45, s20, v45
    v_mfma_f32_16x16x32_bf16 v[48:51], a[128:131], a[64:67], 0
    v_mul_f32 v46, s20, v46
    v_mul_f32 v47, s20, v47
    v_mfma_f32_16x16x32_bf16 v[48:51], a[132:135], a[68:71], v[48:51]
    ds_write_b128 v10, v[128:131] offset:8192
    v_exp_f32 v45, v45
    v_pk_mul_f32 v[136:137], v[136:137], v[22:23] op_sel_hi:[1,0]
    v_pk_mul_f32 v[138:139], v[138:139], v[22:23] op_sel_hi:[1,0]
    v_pk_mul_f32 v[140:141], v[140:141], v[22:23] op_sel_hi:[1,0]
    v_pk_mul_f32 v[142:143], v[142:143], v[22:23] op_sel_hi:[1,0]
    v_cvt_pk_bf16_f32 v136, v136, v137
    v_cvt_pk_bf16_f32 v137, v138, v139
    v_cvt_pk_bf16_f32 v138, v140, v141
    v_cvt_pk_bf16_f32 v139, v142, v143
    v_mfma_f32_16x16x32_bf16 v[48:51], a[136:139], a[72:75], v[48:51]
    ds_read_b128 v[104:107], v24 offset:6144
    v_cvt_pk_bf16_f32 v56, v40, v41
    v_cvt_pk_bf16_f32 v57, v42, v43
    v_mfma_f32_16x16x32_bf16 v[48:51], a[140:143], a[76:79], v[48:51]
    v_exp_f32 v46, v46
    v_mfma_f32_16x16x32_bf16 v[52:55], a[144:147], a[64:67], 0
    ds_write_b128 v11, v[136:139] offset:8192
    v_exp_f32 v47, v47
    v_pk_mul_f32 v[144:145], v[144:145], v[22:23] op_sel_hi:[1,0]
    v_pk_mul_f32 v[146:147], v[146:147], v[22:23] op_sel_hi:[1,0]
    v_pk_mul_f32 v[148:149], v[148:149], v[22:23] op_sel_hi:[1,0]
    v_pk_mul_f32 v[150:151], v[150:151], v[22:23] op_sel_hi:[1,0]
    v_cvt_pk_bf16_f32 v144, v144, v145
    v_cvt_pk_bf16_f32 v145, v146, v147
    v_cvt_pk_bf16_f32 v146, v148, v149
    v_cvt_pk_bf16_f32 v147, v150, v151
    v_mfma_f32_16x16x32_bf16 v[52:55], a[148:151], a[68:71], v[52:55]
    ds_read_b128 v[108:111], v24 offset:7168
    v_cvt_pk_bf16_f32 v58, v44, v45
    v_cvt_pk_bf16_f32 v59, v46, v47
    v_mfma_f32_16x16x32_bf16 v[52:55], a[152:155], a[72:75], v[52:55]
    s_add_u32 s32, s31, 4096
    s_waitcnt lgkmcnt(2)
    v_mfma_f32_16x16x32_bf16 v[52:55], a[156:159], a[76:79], v[52:55]
    buffer_store_dwordx4 v[96:99], v14, s[16:19], s32 offen nt
    v_mul_f32 v48, s20, v48
    v_mfma_f32_16x16x32_bf16 a[230:233], a[248:251], v[56:59], a[230:233]
    s_waitcnt vmcnt(63)
    v_exp_f32 v48, v48
    v_mfma_f32_16x16x32_bf16 v[160:163], a[164:167], v[56:59], v[160:163]
    ds_write_b128 v12, v[144:147] offset:8192
    v_mul_f32 v49, s20, v49
    v_mul_f32 v50, s20, v50
    v_pk_mul_f32 v[152:153], v[152:153], v[22:23] op_sel_hi:[1,0]
    v_pk_mul_f32 v[154:155], v[154:155], v[22:23] op_sel_hi:[1,0]
    v_pk_mul_f32 v[156:157], v[156:157], v[22:23] op_sel_hi:[1,0]
    v_pk_mul_f32 v[158:159], v[158:159], v[22:23] op_sel_hi:[1,0]
    v_cvt_pk_bf16_f32 v152, v152, v153
    v_cvt_pk_bf16_f32 v153, v154, v155
    v_cvt_pk_bf16_f32 v154, v156, v157
    v_cvt_pk_bf16_f32 v155, v158, v159
    v_mfma_f32_16x16x32_bf16 v[164:167], a[172:175], v[56:59], v[164:167]
    v_mul_f32 v51, s20, v51
    v_mfma_f32_16x16x32_bf16 v[168:171], a[180:183], v[56:59], v[168:171]
    buffer_store_dwordx4 v[100:103], v15, s[16:19], s32 offen offset:1024 nt
    v_exp_f32 v49, v49
    v_accvgpr_read_b32 v23, a230
    v_accvgpr_read_b32 v22, a231
    v_add_f32 v23, v23, v22
    v_mfma_f32_16x16x32_bf16 v[172:175], a[188:191], v[56:59], v[172:175]
    v_exp_f32 v50, v50
    v_mfma_f32_16x16x32_bf16 v[176:179], a[196:199], v[56:59], v[176:179]
    buffer_store_dwordx4 v[104:107], v16, s[16:19], s32 offen offset:2048 nt
    v_mul_f32 v52, s20, v52
    v_rcp_f32 v22, v23
    v_mfma_f32_16x16x32_bf16 v[180:183], a[204:207], v[56:59], v[180:183]
    v_exp_f32 v51, v51
    v_mfma_f32_16x16x32_bf16 v[184:187], a[212:215], v[56:59], v[184:187]
    ds_write_b128 v13, v[152:155] offset:8192
    v_exp_f32 v52, v52
    v_pk_mul_f32 v[160:161], v[160:161], v[22:23] op_sel_hi:[1,0]
    v_pk_mul_f32 v[162:163], v[162:163], v[22:23] op_sel_hi:[1,0]
    v_pk_mul_f32 v[164:165], v[164:165], v[22:23] op_sel_hi:[1,0]
    v_pk_mul_f32 v[166:167], v[166:167], v[22:23] op_sel_hi:[1,0]
    v_max3_u32 v21, v21, v22, v23
    v_cvt_pk_bf16_f32 v160, v160, v161
    v_cvt_pk_bf16_f32 v161, v162, v163
    v_cvt_pk_bf16_f32 v162, v164, v165
    v_cvt_pk_bf16_f32 v163, v166, v167
    s_waitcnt lgkmcnt(2)
    v_mfma_f32_16x16x32_bf16 v[188:191], a[220:223], v[56:59], v[188:191]
    buffer_store_dwordx4 v[108:111], v17, s[16:19], s32 offen offset:3072 nt
    ds_read_b128 v[128:131], v24 offset:8192
    ds_read_b128 v[132:135], v24 offset:9216
    v_mul_f32 v53, s20, v53
    ds_read_b128 v[136:139], v24 offset:10240
    ds_read_b128 v[140:143], v24 offset:11264
    v_mul_f32 v54, s20, v54
    v_mul_f32 v55, s20, v55
    v_exp_f32 v53, v53
    v_cvt_pk_bf16_f32 v60, v48, v49
    v_cvt_pk_bf16_f32 v61, v50, v51
    v_exp_f32 v54, v54
    v_exp_f32 v55, v55
    ds_write_b128 v10, v[160:163] offset:12288
    v_pk_mul_f32 v[168:169], v[168:169], v[22:23] op_sel_hi:[1,0]
    v_pk_mul_f32 v[170:171], v[170:171], v[22:23] op_sel_hi:[1,0]
    v_pk_mul_f32 v[172:173], v[172:173], v[22:23] op_sel_hi:[1,0]
    v_pk_mul_f32 v[174:175], v[174:175], v[22:23] op_sel_hi:[1,0]
    v_cvt_pk_bf16_f32 v62, v52, v53
    v_cvt_pk_bf16_f32 v63, v54, v55
    v_pk_mul_f32 v[176:177], v[176:177], v[22:23] op_sel_hi:[1,0]
    v_pk_mul_f32 v[178:179], v[178:179], v[22:23] op_sel_hi:[1,0]
    v_pk_mul_f32 v[180:181], v[180:181], v[22:23] op_sel_hi:[1,0]
    v_pk_mul_f32 v[182:183], v[182:183], v[22:23] op_sel_hi:[1,0]
    s_add_u32 s32, s31, 8192
    v_pk_mul_f32 v[184:185], v[184:185], v[22:23] op_sel_hi:[1,0]
    v_pk_mul_f32 v[186:187], v[186:187], v[22:23] op_sel_hi:[1,0]
    v_pk_mul_f32 v[188:189], v[188:189], v[22:23] op_sel_hi:[1,0]
    v_pk_mul_f32 v[190:191], v[190:191], v[22:23] op_sel_hi:[1,0]
    s_waitcnt lgkmcnt(1)
    v_mfma_f32_16x16x32_bf16 a[232:235], a[248:251], v[60:63], a[232:235]
    buffer_store_dwordx4 v[128:131], v14, s[16:19], s32 offen nt
    v_cvt_pk_bf16_f32 v168, v168, v169
    v_cvt_pk_bf16_f32 v169, v170, v171
    v_mfma_f32_16x16x32_bf16 v[192:195], a[164:167], v[60:63], v[192:195]
    v_cvt_pk_bf16_f32 v170, v172, v173
    v_cvt_pk_bf16_f32 v171, v174, v175
    v_mfma_f32_16x16x32_bf16 v[196:199], a[172:175], v[60:63], v[196:199]
    ds_write_b128 v11, v[168:171] offset:12288
    v_cvt_pk_bf16_f32 v176, v176, v177
    v_cvt_pk_bf16_f32 v177, v178, v179
    v_mfma_f32_16x16x32_bf16 v[200:203], a[180:183], v[60:63], v[200:203]
    buffer_store_dwordx4 v[132:135], v15, s[16:19], s32 offen offset:1024 nt
    v_cvt_pk_bf16_f32 v178, v180, v181
    v_cvt_pk_bf16_f32 v179, v182, v183
    v_mfma_f32_16x16x32_bf16 v[204:207], a[188:191], v[60:63], v[204:207]
    ds_write_b128 v12, v[176:179] offset:12288
    v_cvt_pk_bf16_f32 v184, v184, v185
    v_cvt_pk_bf16_f32 v185, v186, v187
    v_mfma_f32_16x16x32_bf16 v[208:211], a[196:199], v[60:63], v[208:211]
    buffer_store_dwordx4 v[136:139], v16, s[16:19], s32 offen offset:2048 nt
    v_cvt_pk_bf16_f32 v186, v188, v189
    v_cvt_pk_bf16_f32 v187, v190, v191
    v_mfma_f32_16x16x32_bf16 v[212:215], a[204:207], v[60:63], v[212:215]
    ds_write_b128 v13, v[184:187] offset:12288
    v_accvgpr_read_b32 v23, a232
    v_accvgpr_read_b32 v22, a233
    v_add_f32 v23, v23, v22
    v_mfma_f32_16x16x32_bf16 v[216:219], a[212:215], v[60:63], v[216:219]
    v_rcp_f32 v22, v23
    v_mfma_f32_16x16x32_bf16 v[220:223], a[220:223], v[60:63], v[220:223]
    buffer_store_dwordx4 v[140:143], v17, s[16:19], s32 offen offset:3072 nt
    v_pk_mul_f32 v[192:193], v[192:193], v[22:23] op_sel_hi:[1,0]
    v_pk_mul_f32 v[194:195], v[194:195], v[22:23] op_sel_hi:[1,0]
    v_pk_mul_f32 v[196:197], v[196:197], v[22:23] op_sel_hi:[1,0]
    v_pk_mul_f32 v[198:199], v[198:199], v[22:23] op_sel_hi:[1,0]
    v_max3_u32 v21, v21, v22, v23
    v_cvt_pk_bf16_f32 v192, v192, v193
    v_cvt_pk_bf16_f32 v193, v194, v195
    v_cvt_pk_bf16_f32 v194, v196, v197
    v_cvt_pk_bf16_f32 v195, v198, v199
    ds_read_b128 v[160:163], v24 offset:12288
    ds_read_b128 v[164:167], v24 offset:13312
    ds_read_b128 v[168:171], v24 offset:14336
    ds_read_b128 v[172:175], v24 offset:15360
    v_pk_mul_f32 v[200:201], v[200:201], v[22:23] op_sel_hi:[1,0]
    v_pk_mul_f32 v[202:203], v[202:203], v[22:23] op_sel_hi:[1,0]
    v_pk_mul_f32 v[204:205], v[204:205], v[22:23] op_sel_hi:[1,0]
    v_pk_mul_f32 v[206:207], v[206:207], v[22:23] op_sel_hi:[1,0]
    v_cvt_pk_bf16_f32 v200, v200, v201
    v_cvt_pk_bf16_f32 v201, v202, v203
    v_cvt_pk_bf16_f32 v202, v204, v205
    v_cvt_pk_bf16_f32 v203, v206, v207
    ds_write_b128 v10, v[192:195] offset:16384
    s_add_u32 s32, s31, 12288
    v_pk_mul_f32 v[208:209], v[208:209], v[22:23] op_sel_hi:[1,0]
    v_pk_mul_f32 v[210:211], v[210:211], v[22:23] op_sel_hi:[1,0]
    v_pk_mul_f32 v[212:213], v[212:213], v[22:23] op_sel_hi:[1,0]
    v_pk_mul_f32 v[214:215], v[214:215], v[22:23] op_sel_hi:[1,0]
    v_cvt_pk_bf16_f32 v208, v208, v209
    v_cvt_pk_bf16_f32 v209, v210, v211
    v_cvt_pk_bf16_f32 v210, v212, v213
    v_cvt_pk_bf16_f32 v211, v214, v215
    ds_write_b128 v11, v[200:203] offset:16384
    v_pk_mul_f32 v[216:217], v[216:217], v[22:23] op_sel_hi:[1,0]
    v_pk_mul_f32 v[218:219], v[218:219], v[22:23] op_sel_hi:[1,0]
    v_pk_mul_f32 v[220:221], v[220:221], v[22:23] op_sel_hi:[1,0]
    v_pk_mul_f32 v[222:223], v[222:223], v[22:23] op_sel_hi:[1,0]
    v_cvt_pk_bf16_f32 v216, v216, v217
    v_cvt_pk_bf16_f32 v217, v218, v219
    v_cvt_pk_bf16_f32 v218, v220, v221
    v_cvt_pk_bf16_f32 v219, v222, v223
    ds_write_b128 v12, v[208:211] offset:16384
    s_waitcnt lgkmcnt(3)
    buffer_store_dwordx4 v[160:163], v14, s[16:19], s32 offen nt
    ds_write_b128 v13, v[216:219] offset:16384
    buffer_store_dwordx4 v[164:167], v15, s[16:19], s32 offen offset:1024 nt
    buffer_store_dwordx4 v[168:171], v16, s[16:19], s32 offen offset:2048 nt
    ds_read_b128 v[192:195], v24 offset:16384
    ds_read_b128 v[196:199], v24 offset:17408
    ds_read_b128 v[200:203], v24 offset:18432
    ds_read_b128 v[204:207], v24 offset:19456
    buffer_store_dwordx4 v[172:175], v17, s[16:19], s32 offen offset:3072 nt
    s_add_u32 s32, s31, 16384
    v_cmp_lt_u32 vcc, s21, v21
    s_or_b32 s41, vcc_lo, vcc_hi
    s_min_u32 s41, s41, 1
    s_lshl_b32 s41, s41, s33
    s_or_b32 s34, s34, s41
    s_waitcnt lgkmcnt(3)
    buffer_store_dwordx4 v[192:195], v14, s[16:19], s32 offen nt
    s_waitcnt lgkmcnt(2)
    buffer_store_dwordx4 v[196:199], v15, s[16:19], s32 offen offset:1024 nt
    s_waitcnt lgkmcnt(1)
    buffer_store_dwordx4 v[200:203], v16, s[16:19], s32 offen offset:2048 nt
    s_waitcnt lgkmcnt(0)
    buffer_store_dwordx4 v[204:207], v17, s[16:19], s32 offen offset:3072 nt
L_tail:
    s_lshr_b32 s34, s34, 2
    s_cmp_eq_u32 s34, 0
    s_cbranch_scc1 L_end
    s_waitcnt vmcnt(0) lgkmcnt(0)
    s_mov_b32 s33, 0
    s_sub_u32 s41, s30, 32768
    v_xor_b32 v6, s51, v6
    v_xor_b32 v7, s51, v7
    v_xor_b32 v8, s51, v8
    v_xor_b32 v9, s51, v9
    v_add_u32 v6, s41, v6
    v_add_u32 v7, s41, v7
    v_add_u32 v8, s41, v8
    v_add_u32 v9, s41, v9
    v_subrev_u32 v29, s35, v19
    v_and_b32 v28, 0xc00, v20
    v_add_u32 v28, v28, v20
L_fb_blk:
    s_bitcmp1_b32 s34, s33
    s_cbranch_scc0 L_fb_next
    s_lshl_b32 s41, s33, 5
    s_add_u32 s41, s41, s37
    s_lshr_b32 s42, s41, 1
    s_xor_b32 s43, s33, s37
    s_and_b32 s43, s43, 1
    s_mul_i32 s44, s43, s58
    s_mul_i32 s43, s43, 22
    s_add_u32 s43, s43, 24
    s_lshl_b32 s42, s42, 3
    s_add_u32 s42, s42, s38
    s_lshl_b32 s23, s42, 17
    s_mul_i32 s42, s42, 46
    s_add_u32 s44, s44, s36
    s_add_u32 s44, s44, s42
    s_lshl_b32 s24, s44, 12
    s_add_u32 s43, s43, s42
    s_lshl_b32 s43, s43, 12
    s_min_u32 s25, s43, 96468992
    s_mov_b32 s6, s25
    s_mov_b32 s18, s25
    s_mov_b32 s39, 0
L_fb_tile:
    buffer_load_dwordx4 v[64:67], v20, s[4:7], s24 offen offset:0
    buffer_load_dwordx4 v[68:71], v20, s[4:7], s24 offen offset:64
    buffer_load_dwordx4 v[72:75], v20, s[4:7], s24 offen offset:128
    buffer_load_dwordx4 v[76:79], v20, s[4:7], s24 offen offset:192
    s_and_b32 s22, s23, 0xfffe0000
    s_mov_b32 s41, 0
    v_mov_b32 v196, 0xff800000
L_fb_p1:
    buffer_load_dwordx4 v[80:83], v28, s[8:11], s22 offen offset:0
    buffer_load_dwordx4 v[84:87], v28, s[8:11], s22 offen offset:64
    buffer_load_dwordx4 v[88:91], v28, s[8:11], s22 offen offset:128
    buffer_load_dwordx4 v[92:95], v28, s[8:11], s22 offen offset:192
    buffer_load_dwordx4 v[96:99], v28, s[8:11], s22 offen offset:1024
    buffer_load_dwordx4 v[100:103], v28, s[8:11], s22 offen offset:1088
    buffer_load_dwordx4 v[104:107], v28, s[8:11], s22 offen offset:1152
    buffer_load_dwordx4 v[108:111], v28, s[8:11], s22 offen offset:1216
    s_waitcnt vmcnt(0)
    v_mfma_f32_16x16x32_bf16 v[112:115], v[80:83], v[64:67], 0
    v_mfma_f32_16x16x32_bf16 v[112:115], v[84:87], v[68:71], v[112:115]
    v_mfma_f32_16x16x32_bf16 v[112:115], v[88:91], v[72:75], v[112:115]
    v_mfma_f32_16x16x32_bf16 v[112:115], v[92:95], v[76:79], v[112:115]
    v_mfma_f32_16x16x32_bf16 v[116:119], v[96:99], v[64:67], 0
    v_mfma_f32_16x16x32_bf16 v[116:119], v[100:103], v[68:71], v[116:119]
    v_mfma_f32_16x16x32_bf16 v[116:119], v[104:107], v[72:75], v[116:119]
    v_mfma_f32_16x16x32_bf16 v[116:119], v[108:111], v[76:79], v[116:119]
    s_nop 7
    v_max3_f32 v196, v196, v112, v113
    v_max3_f32 v196, v196, v114, v115
    v_max3_f32 v196, v196, v116, v117
    v_max3_f32 v196, v196, v118, v119
    s_add_u32 s22, s22, 8192
    s_add_u32 s41, s41, 1
    s_cmp_lt_u32 s41, 16
    s_cbranch_scc1 L_fb_p1
    v_mov_b32 v197, v196
    s_nop 1
    v_permlane32_swap_b32 v196, v197
    s_nop 1
    v_max_f32 v196, v196, v197
    v_mov_b32 v197, v196
    s_nop 1
    v_permlane16_swap_b32 v196, v197
    s_nop 1
    v_max_f32 v196, v196, v197
    s_and_b32 s22, s23, 0xfffe0000
    s_mov_b32 s41, 0
    v_mov_b32 v160, 0
    v_mov_b32 v161, 0
    v_mov_b32 v162, 0
    v_mov_b32 v163, 0
    v_mov_b32 v164, 0
    v_mov_b32 v165, 0
    v_mov_b32 v166, 0
    v_mov_b32 v167, 0
    v_mov_b32 v168, 0
    v_mov_b32 v169, 0
    v_mov_b32 v170, 0
    v_mov_b32 v171, 0
    v_mov_b32 v172, 0
    v_mov_b32 v173, 0
    v_mov_b32 v174, 0
    v_mov_b32 v175, 0
    v_mov_b32 v176, 0
    v_mov_b32 v177, 0
    v_mov_b32 v178, 0
    v_mov_b32 v179, 0
    v_mov_b32 v180, 0
    v_mov_b32 v181, 0
    v_mov_b32 v182, 0
    v_mov_b32 v183, 0
    v_mov_b32 v184, 0
    v_mov_b32 v185, 0
    v_mov_b32 v186, 0
    v_mov_b32 v187, 0
    v_mov_b32 v188, 0
    v_mov_b32 v189, 0
    v_mov_b32 v190, 0
    v_mov_b32 v191, 0
    v_mov_b32 v192, 0
    v_mov_b32 v193, 0
    v_mov_b32 v194, 0
    v_mov_b32 v195, 0
L_fb_p2:
    s_add_u32 m0, s30, 0
    s_add_u32 s42, s22, 0
    buffer_load_dwordx4 v29, s[12:15], s42 offen offset:0 lds
    buffer_load_dwordx4 v29, s[12:15], s42 offen offset:1024 lds
    buffer_load_dwordx4 v29, s[12:15], s42 offen offset:2048 lds
    buffer_load_dwordx4 v29, s[12:15], s42 offen offset:3072 lds
    s_add_u32 m0, s30, 4096
    s_add_u32 s42, s22, 4096
    buffer_load_dwordx4 v29, s[12:15], s42 offen offset:0 lds
    buffer_load_dwordx4 v29, s[12:15], s42 offen offset:1024 lds
    buffer_load_dwordx4 v29, s[12:15], s42 offen offset:2048 lds
    buffer_load_dwordx4 v29, s[12:15], s42 offen offset:3072 lds
    buffer_load_dwordx4 v[80:83], v28, s[8:11], s22 offen offset:0
    buffer_load_dwordx4 v[84:87], v28, s[8:11], s22 offen offset:64
    buffer_load_dwordx4 v[88:91], v28, s[8:11], s22 offen offset:128
    buffer_load_dwordx4 v[92:95], v28, s[8:11], s22 offen offset:192
    buffer_load_dwordx4 v[96:99], v28, s[8:11], s22 offen offset:1024
    buffer_load_dwordx4 v[100:103], v28, s[8:11], s22 offen offset:1088
    buffer_load_dwordx4 v[104:107], v28, s[8:11], s22 offen offset:1152
    buffer_load_dwordx4 v[108:111], v28, s[8:11], s22 offen offset:1216
    s_waitcnt vmcnt(0)
    v_mfma_f32_16x16x32_bf16 v[112:115], v[80:83], v[64:67], 0
    v_mfma_f32_16x16x32_bf16 v[112:115], v[84:87], v[68:71], v[112:115]
    v_mfma_f32_16x16x32_bf16 v[112:115], v[88:91], v[72:75], v[112:115]
    v_mfma_f32_16x16x32_bf16 v[112:115], v[92:95], v[76:79], v[112:115]
    v_mfma_f32_16x16x32_bf16 v[116:119], v[96:99], v[64:67], 0
    v_mfma_f32_16x16x32_bf16 v[116:119], v[100:103], v[68:71], v[116:119]
    v_mfma_f32_16x16x32_bf16 v[116:119], v[104:107], v[72:75], v[116:119]
    v_mfma_f32_16x16x32_bf16 v[116:119], v[108:111], v[76:79], v[116:119]
    s_nop 7
    ds_read_b64_tr_b16 v[124:125], v6 offset:0
    ds_read_b64_tr_b16 v[126:127], v6 offset:1024
    ds_read_b64_tr_b16 v[128:129], v6 offset:8
    ds_read_b64_tr_b16 v[130:131], v6 offset:1032
    ds_read_b64_tr_b16 v[132:133], v7 offset:0
    ds_read_b64_tr_b16 v[134:135], v7 offset:1024
    ds_read_b64_tr_b16 v[136:137], v7 offset:8
    ds_read_b64_tr_b16 v[138:139], v7 offset:1032
    ds_read_b64_tr_b16 v[140:141], v8 offset:0
    ds_read_b64_tr_b16 v[142:143], v8 offset:1024
    ds_read_b64_tr_b16 v[144:145], v8 offset:8
    ds_read_b64_tr_b16 v[146:147], v8 offset:1032
    ds_read_b64_tr_b16 v[148:149], v9 offset:0
    ds_read_b64_tr_b16 v[150:151], v9 offset:1024
    ds_read_b64_tr_b16 v[152:153], v9 offset:8
    ds_read_b64_tr_b16 v[154:155], v9 offset:1032
    v_sub_f32 v112, v112, v196
    v_sub_f32 v113, v113, v196
    v_sub_f32 v114, v114, v196
    v_sub_f32 v115, v115, v196
    v_sub_f32 v116, v116, v196
    v_sub_f32 v117, v117, v196
    v_sub_f32 v118, v118, v196
    v_sub_f32 v119, v119, v196
    v_mul_f32 v112, s20, v112
    v_mul_f32 v113, s20, v113
    v_mul_f32 v114, s20, v114
    v_mul_f32 v115, s20, v115
    v_mul_f32 v116, s20, v116
    v_mul_f32 v117, s20, v117
    v_mul_f32 v118, s20, v118
    v_mul_f32 v119, s20, v119
    v_exp_f32 v112, v112
    v_exp_f32 v113, v113
    v_exp_f32 v114, v114
    v_exp_f32 v115, v115
    v_exp_f32 v116, v116
    v_exp_f32 v117, v117
    v_exp_f32 v118, v118
    v_exp_f32 v119, v119
    s_nop 0
    v_cvt_pk_bf16_f32 v120, v112, v113
    v_cvt_pk_bf16_f32 v121, v114, v115
    v_cvt_pk_bf16_f32 v122, v116, v117
    v_cvt_pk_bf16_f32 v123, v118, v119
    s_waitcnt lgkmcnt(0)
    s_nop 1
    v_mfma_f32_16x16x32_bf16 v[192:195], a[248:251], v[120:123], v[192:195]
    v_mfma_f32_16x16x32_bf16 v[160:163], v[124:127], v[120:123], v[160:163]
    v_mfma_f32_16x16x32_bf16 v[164:167], v[128:131], v[120:123], v[164:167]
    v_mfma_f32_16x16x32_bf16 v[168:171], v[132:135], v[120:123], v[168:171]
    v_mfma_f32_16x16x32_bf16 v[172:175], v[136:139], v[120:123], v[172:175]
    v_mfma_f32_16x16x32_bf16 v[176:179], v[140:143], v[120:123], v[176:179]
    v_mfma_f32_16x16x32_bf16 v[180:183], v[144:147], v[120:123], v[180:183]
    v_mfma_f32_16x16x32_bf16 v[184:187], v[148:151], v[120:123], v[184:187]
    v_mfma_f32_16x16x32_bf16 v[188:191], v[152:155], v[120:123], v[188:191]
    s_add_u32 s22, s22, 8192
    s_add_u32 s41, s41, 1
    s_cmp_lt_u32 s41, 16
    s_cbranch_scc1 L_fb_p2
    s_nop 7
    v_rcp_f32 v196, v192
    s_nop 0
    v_mul_f32 v160, v196, v160
    v_mul_f32 v161, v196, v161
    v_mul_f32 v162, v196, v162
    v_mul_f32 v163, v196, v163
    v_mul_f32 v164, v196, v164
    v_mul_f32 v165, v196, v165
    v_mul_f32 v166, v196, v166
    v_mul_f32 v167, v196, v167
    v_cvt_pk_bf16_f32 v160, v160, v161
    v_cvt_pk_bf16_f32 v161, v162, v163
    v_cvt_pk_bf16_f32 v162, v164, v165
    v_cvt_pk_bf16_f32 v163, v166, v167
    buffer_store_dwordx4 v[160:163], v20, s[16:19], s24 offen offset:0
    v_mul_f32 v168, v196, v168
    v_mul_f32 v169, v196, v169
    v_mul_f32 v170, v196, v170
    v_mul_f32 v171, v196, v171
    v_mul_f32 v172, v196, v172
    v_mul_f32 v173, v196, v173
    v_mul_f32 v174, v196, v174
    v_mul_f32 v175, v196, v175
    v_cvt_pk_bf16_f32 v168, v168, v169
    v_cvt_pk_bf16_f32 v169, v170, v171
    v_cvt_pk_bf16_f32 v170, v172, v173
    v_cvt_pk_bf16_f32 v171, v174, v175
    buffer_store_dwordx4 v[168:171], v20, s[16:19], s24 offen offset:64
    v_mul_f32 v176, v196, v176
    v_mul_f32 v177, v196, v177
    v_mul_f32 v178, v196, v178
    v_mul_f32 v179, v196, v179
    v_mul_f32 v180, v196, v180
    v_mul_f32 v181, v196, v181
    v_mul_f32 v182, v196, v182
    v_mul_f32 v183, v196, v183
    v_cvt_pk_bf16_f32 v176, v176, v177
    v_cvt_pk_bf16_f32 v177, v178, v179
    v_cvt_pk_bf16_f32 v178, v180, v181
    v_cvt_pk_bf16_f32 v179, v182, v183
    buffer_store_dwordx4 v[176:179], v20, s[16:19], s24 offen offset:128
    v_mul_f32 v184, v196, v184
    v_mul_f32 v185, v196, v185
    v_mul_f32 v186, v196, v186
    v_mul_f32 v187, v196, v187
    v_mul_f32 v188, v196, v188
    v_mul_f32 v189, v196, v189
    v_mul_f32 v190, v196, v190
    v_mul_f32 v191, v196, v191
    v_cvt_pk_bf16_f32 v184, v184, v185
    v_cvt_pk_bf16_f32 v185, v186, v187
    v_cvt_pk_bf16_f32 v186, v188, v189
    v_cvt_pk_bf16_f32 v187, v190, v191
    buffer_store_dwordx4 v[184:187], v20, s[16:19], s24 offen offset:192
    s_waitcnt vmcnt(0)
    s_add_u32 s24, s24, 4096
    s_add_u32 s39, s39, 1
    s_xor_b32 s41, s33, s37
    s_and_b32 s41, s41, 1
    s_sub_u32 s42, s48, 20480
    s_mul_i32 s41, s41, s42
    s_cmp_eq_u32 s39, 5
    s_cselect_b32 s41, s41, 0
    s_add_u32 s24, s24, s41
    s_cmp_lt_u32 s39, 6
    s_cbranch_scc1 L_fb_tile
L_fb_next:
    s_add_u32 s33, s33, 1
    s_cmp_lt_u32 s33, 4
    s_cbranch_scc1 L_fb_blk
L_end:
    s_endpgm
.p2align 12
.section .rodata,"a"
.p2align 6
.amdhsa_kernel standalone__gqa_softmax__near_ridge_kernel
  .amdhsa_next_free_vgpr 512
  .amdhsa_next_free_sgpr 102
  .amdhsa_accum_offset 256
  .amdhsa_group_segment_fixed_size 0
  .amdhsa_kernarg_size 48
  .amdhsa_user_sgpr_count 2
  .amdhsa_user_sgpr_kernarg_segment_ptr 1
  .amdhsa_system_sgpr_workgroup_id_x 1
.end_amdhsa_kernel
```
